```python
import torch

def _softmax(x, axis=-1):
    return torch.softmax(x, dim=axis)
def _gelu(x):
    return torch.nn.functional.gelu(x, approximate="tanh")
def _silu(x):
    return torch.nn.functional.silu(x)
def _sigmoid(x):
    return torch.sigmoid(x)
def _layernorm(x, axis=-1, eps=1e-5):
    m = x.mean(dim=axis, keepdim=True)
    v = x.var(dim=axis, keepdim=True, unbiased=False)
    return (x - m) / torch.sqrt(v + eps)
def _scatter_add(tgt, idx, src, axis=0):
    return tgt.clone().index_add_(axis, idx, src)
def _segment_sum(src, seg, n):
    out = torch.zeros((n,) + src.shape[1:], dtype=src.dtype)
    return out.index_add_(0, seg, src)
def _pad(x, pw):
    flat = tuple(v for pair in reversed(pw) for v in pair)
    return torch.nn.functional.pad(x, flat)

kernel_name = 'interleave_layers__mha_block__glu_gated_swiglu__prompt'

def setup_inputs():

    _w = (lambda a: (lambda t: t.to(torch.bfloat16) if t.is_floating_point() else t)(torch.as_tensor(a)))
    def _A_setup():
        B, S, D, H = 1, 2048, 576, 32
        return {
            "x": _w((lambda *s: torch.randn(*s, dtype=torch.bfloat16) * 0.05)(B, S, D)),
            "wqkv": _w((lambda *s: torch.randn(*s, dtype=torch.bfloat16) * 0.05)(D, 3 * D)),
            "wo": _w((lambda *s: torch.randn(*s, dtype=torch.bfloat16) * 0.05)(D, D)),
        }
    _A_in = _A_setup()

    def _B_setup():
        B, S, D, F = 1, 2048, 576, 4608
        return {
            "x": _w((lambda *s: torch.randn(*s, dtype=torch.bfloat16) * 0.05)(B, S, D)),
            "w1": _w((lambda *s: torch.randn(*s, dtype=torch.bfloat16) * 0.4)(D, F) * (2.0 / D) ** 0.5),
            "w3": _w((lambda *s: torch.randn(*s, dtype=torch.bfloat16) * 0.4)(D, F) * (2.0 / D) ** 0.5),
            "w2": _w((lambda *s: torch.randn(*s, dtype=torch.bfloat16) * 0.4)(F, D) * (2.0 / F) ** 0.5),
        }
    _B_in = _B_setup()

    return {
        "A_x": _A_in["x"],
        "A_wqkv": _A_in["wqkv"],
        "A_wo": _A_in["wo"],
        "B_x": _B_in["x"],
        "B_w1": _B_in["w1"],
        "B_w3": _B_in["w3"],
        "B_w2": _B_in["w2"],
    }

def reference(A_x, A_wqkv, A_wo, B_x, B_w1, B_w3, B_w2):
    def _A_ref(x, wqkv, wo):
        B, S, D = x.shape
        H = 32
        Dh = D // H
        qkv = (lambda x, *d: x.permute(*d))((x @ wqkv).reshape(B, S, 3, H, Dh), 2, 0, 3, 1, 4)
        q, k, v = qkv[0], qkv[1], qkv[2]
        scores = torch.einsum("bhqd,bhkd->bhqk", q, k) * (Dh ** -0.5)
        p = _softmax(scores, axis=-1)
        o = torch.einsum("bhqk,bhkd->bhqd", p, v)
        return (lambda x, *d: x.permute(*d))(o, 0, 2, 1, 3).reshape(B, S, D) @ wo

    def _B_ref(x, w1, w3, w2):
        gate = torch.einsum("bsd,df->bsf", x, w1)
        up = torch.einsum("bsd,df->bsf", x, w3)
        h = _silu(gate) * up
        out = torch.einsum("bsf,fd->bsd", h, w2)
        return out

    x = A_x
    x = x + _A_ref(_layernorm(x, axis=-1), A_wqkv, A_wo)
    x = x + _B_ref(_layernorm(x, axis=-1), B_w1, B_w3, B_w2)
    x = x + _A_ref(_layernorm(x, axis=-1), A_wqkv, A_wo)
    x = x + _B_ref(_layernorm(x, axis=-1), B_w1, B_w3, B_w2)
    return x
```

```asm
; @launch grid=(256,1,1) block=(256,1,1) lds=163840
.amdgcn_target "amdgcn-amd-amdhsa--gfx950"
.text
.globl interleave_layers__mha_block__glu_gated_swiglu__prompt_kernel
.p2align 8
.type interleave_layers__mha_block__glu_gated_swiglu__prompt_kernel,@function
interleave_layers__mha_block__glu_gated_swiglu__prompt_kernel:
    s_cmp_ge_u32 s2, 256
    s_cbranch_scc1 interleave_layers__mha_block__glu_gated_swiglu__prompt_end
    s_load_dwordx16 s[64:79], s[0:1], 0
    s_load_dwordx4 s[80:83], s[0:1], 64
    v_lshrrev_b32 v1, 6, v0
    v_and_b32 v0, 63, v0
    v_readfirstlane_b32 s3, v1
    v_lshlrev_b32 v1, 4, v0
    v_lshlrev_b32 v2, 3, v0
    s_getpc_b64 s[20:21]
pc_here:
    s_sub_u32 s20, s20, pc_here-interleave_layers__mha_block__glu_gated_swiglu__prompt_kernel
    s_subb_u32 s21, s21, 0
    s_lshr_b32 s22, s2, 3
    s_lshl_b32 s22, s22, 2
    s_add_u32 s22, s22, s3
    s_mul_i32 s22, s22, 640
    s_min_u32 s22, s22, code_end-interleave_layers__mha_block__glu_gated_swiglu__prompt_kernel-1024
    v_add_u32 v3, s22, v1
    global_load_dwordx4 v[248:251], v3, s[20:21]
    v_and_b32 v4, 15, v0
    v_lshrrev_b32 v5, 4, v0
    v_and_b32 v6, 12, v4
    v_and_b32 v7, 3, v4
    v_lshl_add_u32 v6, v6, 1, v7
    v_lshlrev_b32 v3, 3, v5
    v_mov_b32 v11, 0x3f80
    s_mov_b32 s6, 0x4a80000
    s_mov_b32 s7, 0x00020000
    s_mov_b32 s55, 0x00020000
    s_mov_b32 s90, 0x168000
    s_mov_b32 s91, 0x00020000
    v_and_b32 v8, 7, v0
    v_lshrrev_b32 v9, 3, v0
    v_mul_u32_u24 v13, 1152, v8
    v_lshl_add_u32 v13, v9, 4, v13
    v_lshlrev_b32 v218, 8, v9
    v_lshl_add_u32 v218, v8, 4, v218
    v_mov_b32 v237, v1
    v_mov_b32 v238, v1
    v_mov_b32 v239, v1
    v_mov_b32 v240, v1
    s_mov_b32 s59, 0x00020000
    s_mov_b32 s58, 5308416
    s_mul_i32 s24, s2, 9216
    s_mov_b32 s54, 2359296
    s_waitcnt lgkmcnt(0)
    s_mov_b32 s56, s76
    s_mov_b32 s57, s77
    s_mov_b32 s52, s64
    s_mov_b32 s53, s65
    s_add_u32 s4, s82, 0x1fffff
    s_addc_u32 s5, s83, 0
    s_and_b32 s4, s4, 0xffe00000
    s_cmp_lg_u32 s3, 0
    s_cbranch_scc1 a_stage
    buffer_load_dwordx4 v[20:23], v13, s[52:55], s24 offen offset:0
    buffer_load_dwordx4 v[24:27], v13, s[52:55], s24 offen offset:128
    buffer_load_dwordx4 v[28:31], v13, s[52:55], s24 offen offset:256
    buffer_load_dwordx4 v[32:35], v13, s[52:55], s24 offen offset:384
    buffer_load_dwordx4 v[36:39], v13, s[52:55], s24 offen offset:512
    buffer_load_dwordx4 v[40:43], v13, s[52:55], s24 offen offset:640
    buffer_load_dwordx4 v[44:47], v13, s[52:55], s24 offen offset:768
    buffer_load_dwordx4 v[48:51], v13, s[52:55], s24 offen offset:896
    buffer_load_dwordx4 v[52:55], v13, s[52:55], s24 offen offset:1024
    s_lshr_b32 s19, s2, 3
    s_lshr_b32 s18, s19, 4
    s_xor_b32 s18, s18, s19
    s_and_b32 s18, s18, 1
    s_lshl_b32 s18, s18, 13
    s_and_b32 s15, s19, 15
    s_mul_i32 s15, s15, 147456
    s_add_u32 s18, s18, s15
    s_add_u32 s18, s18, 0x3600000
    s_bfe_u32 s19, s2, 0x20001
    s_mul_i32 s19, s19, 18432
    s_and_b32 s17, s2, 1
    s_lshl_b32 s17, s17, 7
    s_add_u32 s19, s19, s17
    s_add_u32 s20, s19, 0
    s_and_b32 s15, s20, 0xffffe000
    s_add_u32 s20, s20, s15
    s_add_u32 s20, s20, s18
    s_add_u32 s21, s19, 2048
    s_and_b32 s15, s21, 0xffffe000
    s_add_u32 s21, s21, s15
    s_add_u32 s21, s21, s18
    s_add_u32 s22, s19, 4096
    s_and_b32 s15, s22, 0xffffe000
    s_add_u32 s22, s22, s15
    s_add_u32 s22, s22, s18
    s_add_u32 s23, s19, 6144
    s_and_b32 s15, s23, 0xffffe000
    s_add_u32 s23, s23, s15
    s_add_u32 s23, s23, s18
    s_add_u32 s24, s19, 8192
    s_and_b32 s15, s24, 0xffffe000
    s_add_u32 s24, s24, s15
    s_add_u32 s24, s24, s18
    s_add_u32 s25, s19, 10240
    s_and_b32 s15, s25, 0xffffe000
    s_add_u32 s25, s25, s15
    s_add_u32 s25, s25, s18
    s_add_u32 s26, s19, 12288
    s_and_b32 s15, s26, 0xffffe000
    s_add_u32 s26, s26, s15
    s_add_u32 s26, s26, s18
    s_add_u32 s27, s19, 14336
    s_and_b32 s15, s27, 0xffffe000
    s_add_u32 s27, s27, s15
    s_add_u32 s27, s27, s18
    s_add_u32 s28, s19, 16384
    s_and_b32 s15, s28, 0xffffe000
    s_add_u32 s28, s28, s15
    s_add_u32 s28, s28, s18
    s_mul_i32 s33, s2, 32
    s_add_u32 s33, s33, 622592
    s_waitcnt vmcnt(8)
    v_lshlrev_b32 v56, 16, v20
    v_and_b32 v57, 0xffff0000, v20
    v_pk_mul_f32 v[10:11], v[56:57], v[56:57]
    v_lshlrev_b32 v58, 16, v21
    v_and_b32 v59, 0xffff0000, v21
    v_pk_add_f32 v[8:9], v[56:57], v[58:59]
    v_pk_fma_f32 v[10:11], v[58:59], v[58:59], v[10:11]
    v_lshlrev_b32 v60, 16, v22
    v_and_b32 v61, 0xffff0000, v22
    v_pk_add_f32 v[8:9], v[8:9], v[60:61]
    v_pk_fma_f32 v[10:11], v[60:61], v[60:61], v[10:11]
    v_lshlrev_b32 v62, 16, v23
    v_and_b32 v63, 0xffff0000, v23
    v_pk_add_f32 v[8:9], v[8:9], v[62:63]
    v_pk_fma_f32 v[10:11], v[62:63], v[62:63], v[10:11]
    s_waitcnt vmcnt(7)
    v_lshlrev_b32 v64, 16, v24
    v_and_b32 v65, 0xffff0000, v24
    v_pk_add_f32 v[8:9], v[8:9], v[64:65]
    v_pk_fma_f32 v[10:11], v[64:65], v[64:65], v[10:11]
    v_lshlrev_b32 v66, 16, v25
    v_and_b32 v67, 0xffff0000, v25
    v_pk_add_f32 v[8:9], v[8:9], v[66:67]
    v_pk_fma_f32 v[10:11], v[66:67], v[66:67], v[10:11]
    v_lshlrev_b32 v68, 16, v26
    v_and_b32 v69, 0xffff0000, v26
    v_pk_add_f32 v[8:9], v[8:9], v[68:69]
    v_pk_fma_f32 v[10:11], v[68:69], v[68:69], v[10:11]
    v_lshlrev_b32 v70, 16, v27
    v_and_b32 v71, 0xffff0000, v27
    v_pk_add_f32 v[8:9], v[8:9], v[70:71]
    v_pk_fma_f32 v[10:11], v[70:71], v[70:71], v[10:11]
    s_waitcnt vmcnt(6)
    v_lshlrev_b32 v72, 16, v28
    v_and_b32 v73, 0xffff0000, v28
    v_pk_add_f32 v[8:9], v[8:9], v[72:73]
    v_pk_fma_f32 v[10:11], v[72:73], v[72:73], v[10:11]
    v_lshlrev_b32 v74, 16, v29
    v_and_b32 v75, 0xffff0000, v29
    v_pk_add_f32 v[8:9], v[8:9], v[74:75]
    v_pk_fma_f32 v[10:11], v[74:75], v[74:75], v[10:11]
    v_lshlrev_b32 v76, 16, v30
    v_and_b32 v77, 0xffff0000, v30
    v_pk_add_f32 v[8:9], v[8:9], v[76:77]
    v_pk_fma_f32 v[10:11], v[76:77], v[76:77], v[10:11]
    v_lshlrev_b32 v78, 16, v31
    v_and_b32 v79, 0xffff0000, v31
    v_pk_add_f32 v[8:9], v[8:9], v[78:79]
    v_pk_fma_f32 v[10:11], v[78:79], v[78:79], v[10:11]
    s_waitcnt vmcnt(5)
    v_lshlrev_b32 v80, 16, v32
    v_and_b32 v81, 0xffff0000, v32
    v_pk_add_f32 v[8:9], v[8:9], v[80:81]
    v_pk_fma_f32 v[10:11], v[80:81], v[80:81], v[10:11]
    v_lshlrev_b32 v82, 16, v33
    v_and_b32 v83, 0xffff0000, v33
    v_pk_add_f32 v[8:9], v[8:9], v[82:83]
    v_pk_fma_f32 v[10:11], v[82:83], v[82:83], v[10:11]
    v_lshlrev_b32 v84, 16, v34
    v_and_b32 v85, 0xffff0000, v34
    v_pk_add_f32 v[8:9], v[8:9], v[84:85]
    v_pk_fma_f32 v[10:11], v[84:85], v[84:85], v[10:11]
    v_lshlrev_b32 v86, 16, v35
    v_and_b32 v87, 0xffff0000, v35
    v_pk_add_f32 v[8:9], v[8:9], v[86:87]
    v_pk_fma_f32 v[10:11], v[86:87], v[86:87], v[10:11]
    s_waitcnt vmcnt(4)
    v_lshlrev_b32 v88, 16, v36
    v_and_b32 v89, 0xffff0000, v36
    v_pk_add_f32 v[8:9], v[8:9], v[88:89]
    v_pk_fma_f32 v[10:11], v[88:89], v[88:89], v[10:11]
    v_lshlrev_b32 v90, 16, v37
    v_and_b32 v91, 0xffff0000, v37
    v_pk_add_f32 v[8:9], v[8:9], v[90:91]
    v_pk_fma_f32 v[10:11], v[90:91], v[90:91], v[10:11]
    v_lshlrev_b32 v92, 16, v38
    v_and_b32 v93, 0xffff0000, v38
    v_pk_add_f32 v[8:9], v[8:9], v[92:93]
    v_pk_fma_f32 v[10:11], v[92:93], v[92:93], v[10:11]
    v_lshlrev_b32 v94, 16, v39
    v_and_b32 v95, 0xffff0000, v39
    v_pk_add_f32 v[8:9], v[8:9], v[94:95]
    v_pk_fma_f32 v[10:11], v[94:95], v[94:95], v[10:11]
    s_waitcnt vmcnt(3)
    v_lshlrev_b32 v96, 16, v40
    v_and_b32 v97, 0xffff0000, v40
    v_pk_add_f32 v[8:9], v[8:9], v[96:97]
    v_pk_fma_f32 v[10:11], v[96:97], v[96:97], v[10:11]
    v_lshlrev_b32 v98, 16, v41
    v_and_b32 v99, 0xffff0000, v41
    v_pk_add_f32 v[8:9], v[8:9], v[98:99]
    v_pk_fma_f32 v[10:11], v[98:99], v[98:99], v[10:11]
    v_lshlrev_b32 v100, 16, v42
    v_and_b32 v101, 0xffff0000, v42
    v_pk_add_f32 v[8:9], v[8:9], v[100:101]
    v_pk_fma_f32 v[10:11], v[100:101], v[100:101], v[10:11]
    v_lshlrev_b32 v102, 16, v43
    v_and_b32 v103, 0xffff0000, v43
    v_pk_add_f32 v[8:9], v[8:9], v[102:103]
    v_pk_fma_f32 v[10:11], v[102:103], v[102:103], v[10:11]
    s_waitcnt vmcnt(2)
    v_lshlrev_b32 v104, 16, v44
    v_and_b32 v105, 0xffff0000, v44
    v_pk_add_f32 v[8:9], v[8:9], v[104:105]
    v_pk_fma_f32 v[10:11], v[104:105], v[104:105], v[10:11]
    v_lshlrev_b32 v106, 16, v45
    v_and_b32 v107, 0xffff0000, v45
    v_pk_add_f32 v[8:9], v[8:9], v[106:107]
    v_pk_fma_f32 v[10:11], v[106:107], v[106:107], v[10:11]
    v_lshlrev_b32 v108, 16, v46
    v_and_b32 v109, 0xffff0000, v46
    v_pk_add_f32 v[8:9], v[8:9], v[108:109]
    v_pk_fma_f32 v[10:11], v[108:109], v[108:109], v[10:11]
    v_lshlrev_b32 v110, 16, v47
    v_and_b32 v111, 0xffff0000, v47
    v_pk_add_f32 v[8:9], v[8:9], v[110:111]
    v_pk_fma_f32 v[10:11], v[110:111], v[110:111], v[10:11]
    s_waitcnt vmcnt(1)
    v_lshlrev_b32 v112, 16, v48
    v_and_b32 v113, 0xffff0000, v48
    v_pk_add_f32 v[8:9], v[8:9], v[112:113]
    v_pk_fma_f32 v[10:11], v[112:113], v[112:113], v[10:11]
    v_lshlrev_b32 v114, 16, v49
    v_and_b32 v115, 0xffff0000, v49
    v_pk_add_f32 v[8:9], v[8:9], v[114:115]
    v_pk_fma_f32 v[10:11], v[114:115], v[114:115], v[10:11]
    v_lshlrev_b32 v116, 16, v50
    v_and_b32 v117, 0xffff0000, v50
    v_pk_add_f32 v[8:9], v[8:9], v[116:117]
    v_pk_fma_f32 v[10:11], v[116:117], v[116:117], v[10:11]
    v_lshlrev_b32 v118, 16, v51
    v_and_b32 v119, 0xffff0000, v51
    v_pk_add_f32 v[8:9], v[8:9], v[118:119]
    v_pk_fma_f32 v[10:11], v[118:119], v[118:119], v[10:11]
    s_waitcnt vmcnt(0)
    v_lshlrev_b32 v120, 16, v52
    v_and_b32 v121, 0xffff0000, v52
    v_pk_add_f32 v[8:9], v[8:9], v[120:121]
    v_pk_fma_f32 v[10:11], v[120:121], v[120:121], v[10:11]
    v_lshlrev_b32 v122, 16, v53
    v_and_b32 v123, 0xffff0000, v53
    v_pk_add_f32 v[8:9], v[8:9], v[122:123]
    v_pk_fma_f32 v[10:11], v[122:123], v[122:123], v[10:11]
    v_lshlrev_b32 v124, 16, v54
    v_and_b32 v125, 0xffff0000, v54
    v_pk_add_f32 v[8:9], v[8:9], v[124:125]
    v_pk_fma_f32 v[10:11], v[124:125], v[124:125], v[10:11]
    v_lshlrev_b32 v126, 16, v55
    v_and_b32 v127, 0xffff0000, v55
    v_pk_add_f32 v[8:9], v[8:9], v[126:127]
    v_pk_fma_f32 v[10:11], v[126:127], v[126:127], v[10:11]
    v_add_f32 v8, v8, v9
    v_add_f32 v9, v10, v11
    s_nop 0
    v_add_f32_dpp v8, v8, v8 row_ror:8 row_mask:0xf bank_mask:0xf
    v_add_f32_dpp v9, v9, v9 row_ror:8 row_mask:0xf bank_mask:0xf
    v_mov_b32 v10, v8
    v_mov_b32 v11, v9
    s_nop 0
    v_permlane16_swap_b32 v8, v10
    v_permlane16_swap_b32 v9, v11
    v_add_f32 v8, v8, v10
    v_add_f32 v9, v9, v11
    v_mov_b32 v10, v8
    v_mov_b32 v11, v9
    s_nop 0
    v_permlane32_swap_b32 v8, v10
    v_permlane32_swap_b32 v9, v11
    v_add_f32 v8, v8, v10
    v_add_f32 v9, v9, v11
    v_mul_f32 v8, 0x3ae38e39, v8
    v_mul_f32 v9, 0x3ae38e39, v9
    v_fma_f32 v9, -v8, v8, v9
    v_max_f32 v9, 0, v9
    v_add_f32 v9, 0x3727c5ac, v9
    v_rsq_f32 v9, v9
    v_mov_b32 v11, 0x3f80
    v_mul_f32 v8, -v8, v9
    v_pk_fma_f32 v[56:57], v[56:57], v[8:9], v[8:9] op_sel:[0,1,0] op_sel_hi:[1,1,0]
    v_pk_fma_f32 v[58:59], v[58:59], v[8:9], v[8:9] op_sel:[0,1,0] op_sel_hi:[1,1,0]
    v_pk_fma_f32 v[60:61], v[60:61], v[8:9], v[8:9] op_sel:[0,1,0] op_sel_hi:[1,1,0]
    v_pk_fma_f32 v[62:63], v[62:63], v[8:9], v[8:9] op_sel:[0,1,0] op_sel_hi:[1,1,0]
    v_cvt_pk_bf16_f32 v56, v56, v57
    v_cvt_pk_bf16_f32 v57, v58, v59
    v_cvt_pk_bf16_f32 v58, v60, v61
    v_cvt_pk_bf16_f32 v59, v62, v63
    buffer_store_dwordx4 v[56:59], v218, s[4:7], s20 offen sc1
    v_pk_fma_f32 v[64:65], v[64:65], v[8:9], v[8:9] op_sel:[0,1,0] op_sel_hi:[1,1,0]
    v_pk_fma_f32 v[66:67], v[66:67], v[8:9], v[8:9] op_sel:[0,1,0] op_sel_hi:[1,1,0]
    v_pk_fma_f32 v[68:69], v[68:69], v[8:9], v[8:9] op_sel:[0,1,0] op_sel_hi:[1,1,0]
    v_pk_fma_f32 v[70:71], v[70:71], v[8:9], v[8:9] op_sel:[0,1,0] op_sel_hi:[1,1,0]
    v_cvt_pk_bf16_f32 v64, v64, v65
    v_cvt_pk_bf16_f32 v65, v66, v67
    v_cvt_pk_bf16_f32 v66, v68, v69
    v_cvt_pk_bf16_f32 v67, v70, v71
    buffer_store_dwordx4 v[64:67], v218, s[4:7], s21 offen sc1
    v_pk_fma_f32 v[72:73], v[72:73], v[8:9], v[8:9] op_sel:[0,1,0] op_sel_hi:[1,1,0]
    v_pk_fma_f32 v[74:75], v[74:75], v[8:9], v[8:9] op_sel:[0,1,0] op_sel_hi:[1,1,0]
    v_pk_fma_f32 v[76:77], v[76:77], v[8:9], v[8:9] op_sel:[0,1,0] op_sel_hi:[1,1,0]
    v_pk_fma_f32 v[78:79], v[78:79], v[8:9], v[8:9] op_sel:[0,1,0] op_sel_hi:[1,1,0]
    v_cvt_pk_bf16_f32 v72, v72, v73
    v_cvt_pk_bf16_f32 v73, v74, v75
    v_cvt_pk_bf16_f32 v74, v76, v77
    v_cvt_pk_bf16_f32 v75, v78, v79
    buffer_store_dwordx4 v[72:75], v218, s[4:7], s22 offen sc1
    v_pk_fma_f32 v[80:81], v[80:81], v[8:9], v[8:9] op_sel:[0,1,0] op_sel_hi:[1,1,0]
    v_pk_fma_f32 v[82:83], v[82:83], v[8:9], v[8:9] op_sel:[0,1,0] op_sel_hi:[1,1,0]
    v_pk_fma_f32 v[84:85], v[84:85], v[8:9], v[8:9] op_sel:[0,1,0] op_sel_hi:[1,1,0]
    v_pk_fma_f32 v[86:87], v[86:87], v[8:9], v[8:9] op_sel:[0,1,0] op_sel_hi:[1,1,0]
    v_cvt_pk_bf16_f32 v80, v80, v81
    v_cvt_pk_bf16_f32 v81, v82, v83
    v_cvt_pk_bf16_f32 v82, v84, v85
    v_cvt_pk_bf16_f32 v83, v86, v87
    buffer_store_dwordx4 v[80:83], v218, s[4:7], s23 offen sc1
    v_pk_fma_f32 v[88:89], v[88:89], v[8:9], v[8:9] op_sel:[0,1,0] op_sel_hi:[1,1,0]
    v_pk_fma_f32 v[90:91], v[90:91], v[8:9], v[8:9] op_sel:[0,1,0] op_sel_hi:[1,1,0]
    v_pk_fma_f32 v[92:93], v[92:93], v[8:9], v[8:9] op_sel:[0,1,0] op_sel_hi:[1,1,0]
    v_pk_fma_f32 v[94:95], v[94:95], v[8:9], v[8:9] op_sel:[0,1,0] op_sel_hi:[1,1,0]
    v_cvt_pk_bf16_f32 v88, v88, v89
    v_cvt_pk_bf16_f32 v89, v90, v91
    v_cvt_pk_bf16_f32 v90, v92, v93
    v_cvt_pk_bf16_f32 v91, v94, v95
    buffer_store_dwordx4 v[88:91], v218, s[4:7], s24 offen sc1
    v_pk_fma_f32 v[96:97], v[96:97], v[8:9], v[8:9] op_sel:[0,1,0] op_sel_hi:[1,1,0]
    v_pk_fma_f32 v[98:99], v[98:99], v[8:9], v[8:9] op_sel:[0,1,0] op_sel_hi:[1,1,0]
    v_pk_fma_f32 v[100:101], v[100:101], v[8:9], v[8:9] op_sel:[0,1,0] op_sel_hi:[1,1,0]
    v_pk_fma_f32 v[102:103], v[102:103], v[8:9], v[8:9] op_sel:[0,1,0] op_sel_hi:[1,1,0]
    v_cvt_pk_bf16_f32 v96, v96, v97
    v_cvt_pk_bf16_f32 v97, v98, v99
    v_cvt_pk_bf16_f32 v98, v100, v101
    v_cvt_pk_bf16_f32 v99, v102, v103
    buffer_store_dwordx4 v[96:99], v218, s[4:7], s25 offen sc1
    v_pk_fma_f32 v[104:105], v[104:105], v[8:9], v[8:9] op_sel:[0,1,0] op_sel_hi:[1,1,0]
    v_pk_fma_f32 v[106:107], v[106:107], v[8:9], v[8:9] op_sel:[0,1,0] op_sel_hi:[1,1,0]
    v_pk_fma_f32 v[108:109], v[108:109], v[8:9], v[8:9] op_sel:[0,1,0] op_sel_hi:[1,1,0]
    v_pk_fma_f32 v[110:111], v[110:111], v[8:9], v[8:9] op_sel:[0,1,0] op_sel_hi:[1,1,0]
    v_cvt_pk_bf16_f32 v104, v104, v105
    v_cvt_pk_bf16_f32 v105, v106, v107
    v_cvt_pk_bf16_f32 v106, v108, v109
    v_cvt_pk_bf16_f32 v107, v110, v111
    buffer_store_dwordx4 v[104:107], v218, s[4:7], s26 offen sc1
    v_pk_fma_f32 v[112:113], v[112:113], v[8:9], v[8:9] op_sel:[0,1,0] op_sel_hi:[1,1,0]
    v_pk_fma_f32 v[114:115], v[114:115], v[8:9], v[8:9] op_sel:[0,1,0] op_sel_hi:[1,1,0]
    v_pk_fma_f32 v[116:117], v[116:117], v[8:9], v[8:9] op_sel:[0,1,0] op_sel_hi:[1,1,0]
    v_pk_fma_f32 v[118:119], v[118:119], v[8:9], v[8:9] op_sel:[0,1,0] op_sel_hi:[1,1,0]
    v_cvt_pk_bf16_f32 v112, v112, v113
    v_cvt_pk_bf16_f32 v113, v114, v115
    v_cvt_pk_bf16_f32 v114, v116, v117
    v_cvt_pk_bf16_f32 v115, v118, v119
    buffer_store_dwordx4 v[112:115], v218, s[4:7], s27 offen sc1
    v_pk_fma_f32 v[120:121], v[120:121], v[8:9], v[8:9] op_sel:[0,1,0] op_sel_hi:[1,1,0]
    v_pk_fma_f32 v[122:123], v[122:123], v[8:9], v[8:9] op_sel:[0,1,0] op_sel_hi:[1,1,0]
    v_pk_fma_f32 v[124:125], v[124:125], v[8:9], v[8:9] op_sel:[0,1,0] op_sel_hi:[1,1,0]
    v_pk_fma_f32 v[126:127], v[126:127], v[8:9], v[8:9] op_sel:[0,1,0] op_sel_hi:[1,1,0]
    v_cvt_pk_bf16_f32 v120, v120, v121
    v_cvt_pk_bf16_f32 v121, v122, v123
    v_cvt_pk_bf16_f32 v122, v124, v125
    v_cvt_pk_bf16_f32 v123, v126, v127
    buffer_store_dwordx4 v[120:123], v218, s[4:7], s28 offen sc1
a_common:
    s_mov_b32 s52, s80
    s_mov_b32 s53, s81
    s_mov_b32 s54, 256
    v_min_u32 v219, 1, v0
    v_lshlrev_b32 v219, 30, v219
    s_and_b32 s16, s2, 7
    s_lshr_b32 s17, s2, 3
    s_and_b32 s8, s16, 4
    s_and_b32 s18, s17, 3
    s_add_u32 s8, s8, s18
    s_and_b32 s9, s16, 3
    s_lshl_b32 s9, s9, 3
    s_lshr_b32 s17, s17, 2
    s_add_u32 s9, s9, s17
    s_lshl_b32 s10, s8, 2
    s_add_u32 s10, s10, s3
    s_mov_b32 s13, 0
    s_mov_b32 s14, 200000
    s_mul_i32 s11, s9, 73728
    s_add_u32 s11, s11, 0x100000
    s_add_u32 s48, s4, 0x1400000
    s_addc_u32 s49, s5, 0
    s_mov_b32 s50, 0x3680000
    s_add_u32 s88, s48, 0x2000000
    s_addc_u32 s89, s49, 0
    s_mov_b32 s51, 0x00020000
    s_cmp_lt_u32 s3, 2
    s_cselect_b64 vcc, -1, 0
    s_cselect_b32 s16, 4, 16
    s_and_b32 s17, s3, 1
    s_mul_i32 s16, s16, s17
    v_cndmask_b32 v7, v4, v6, vcc
    v_add_u32 v7, s16, v7
    v_sub_u32 v12, v7, v3
    v_and_b32 v13, 1, v12
    v_lshlrev_b32 v13, 4, v13
    v_lshlrev_b32 v13, v13, v11
    v_lshrrev_b32 v12, 1, v12
    v_cmp_eq_u32 vcc, 0, v12
    s_nop 1
    v_cndmask_b32 v16, 0, v13, vcc
    v_cmp_eq_u32 vcc, 1, v12
    s_nop 1
    v_cndmask_b32 v17, 0, v13, vcc
    v_cmp_eq_u32 vcc, 2, v12
    s_nop 1
    v_cndmask_b32 v18, 0, v13, vcc
    v_cmp_eq_u32 vcc, 3, v12
    s_nop 1
    v_cndmask_b32 v19, 0, v13, vcc
    s_lshl_b32 s16, s3, 10
    s_add_u32 s16, s16, 151552
    v_add_u32 v8, s16, v1
    ds_write_b128 v8, v[16:19]
    s_lshr_b32 s18, s3, 1
    s_mov_b32 s84, 1
    s_mov_b32 s12, 262144
    s_mul_i32 s81, s2, 128
    s_add_u32 s81, s81, 262144
    s_cmp_lg_u32 s3, 0
    s_cmov_b32 s81, 1073741824
    s_lshr_b32 s85, s2, 3
    s_add_u32 s85, s85, s3
    s_and_b32 s85, s85, 3
    s_mov_b32 s46, 2
    s_cmp_ge_u32 s2, 216
    s_cmov_b32 s85, 99
    s_mov_b32 s86, 3
    s_cmp_eq_u32 s85, 0
    s_cselect_b32 s98, 3, 99
    s_cmp_eq_u32 s85, 1
    s_cselect_b32 s99, 3, 99
    s_cmp_eq_u32 s85, 2
    s_cselect_b32 s100, 3, 99
    s_cmp_eq_u32 s85, 3
    s_cselect_b32 s101, 2, 99
    s_sub_u32 s16, s2, 216
    s_mul_i32 s92, s16, 128
    s_add_u32 s92, s92, 294912
    s_lshl_b32 s15, s3, 8
    s_add_u32 s15, s15, s16
    s_cmp_ge_u32 s15, 36
    s_cmov_b32 s92, 1073741824
    s_mov_b32 s47, 294912
    s_cmp_ge_u32 s2, 144
    s_cbranch_scc1 task_w2
    v_lshrrev_b32 v9, 3, v0
    v_and_b32 v8, 7, v0
    v_bfe_u32 v10, v0, 4, 1
    v_xor_b32 v8, v8, v10
    v_mul_u32_u24 v9, 9216, v9
    v_xor_b32 v10, 0, v8
    v_lshl_add_u32 v237, v10, 4, v9
    v_xor_b32 v10, 2, v8
    v_lshl_add_u32 v238, v10, 4, v9
    v_add_u32 v238, 72704, v238
    v_xor_b32 v10, 4, v8
    v_lshl_add_u32 v239, v10, 4, v9
    v_add_u32 v239, 145408, v239
    v_xor_b32 v10, 6, v8
    v_lshl_add_u32 v240, v10, 4, v9
    v_add_u32 v240, 218112, v240
    s_and_b32 s19, s2, 1
    s_cselect_b32 s56, s74, s72
    s_cselect_b32 s57, s75, s73
    s_and_b32 s20, s2, 0xfe
    s_lshl_b32 s43, s20, 6
    s_mul_i32 s21, s3, 294912
    s_add_u32 s43, s43, s21
    s_mov_b32 s39, 1179648
    s_add_u32 s20, s20, s18
    s_mul_i32 s26, s20, 7282
    s_lshr_b32 s26, s26, 16
    s_mul_i32 s27, s26, 9
    s_sub_u32 s27, s20, s27
    s_lshl_b32 s26, s26, 1
    s_sub_u32 s29, s27, 5
    s_add_u32 s30, s26, 1
    s_cmp_gt_u32 s27, 4
    s_cselect_b32 s29, s29, s27
    s_cselect_b32 s28, s30, s26
    s_lshl_b32 s22, s29, 1
    s_add_u32 s22, s22, s17
    s_min_u32 s23, s29, 1
    s_add_u32 s22, s22, s23
    s_add_u32 s30, s26, s17
    s_add_u32 s23, s17, 2
    s_cmp_eq_u32 s27, 4
    s_cmov_b32 s22, 2
    s_cmov_b32 s28, s30
    s_cselect_b32 s87, s23, s17
    s_lshl_b32 s87, s87, 10
    s_add_u32 s87, s87, 151552
    s_mul_i32 s94, s22, 36864
    s_lshl_b32 s23, s22, 11
    s_mov_b32 s95, 2048
    s_cmp_lt_u32 s22, 3
    s_cmov_b32 s94, s23
    s_cmov_b32 s95, 6144
    s_lshl_b32 s23, s19, 10
    s_add_u32 s94, s94, s23
    s_mul_i32 s23, s28, 331776
    s_add_u32 s94, s94, s23
    s_add_u32 s94, s94, 0x400000
    s_lshl_b32 s23, s18, 2
    v_add_u32 v8, s23, v5
    v_lshrrev_b32 v9, 1, v4
    v_xor_b32 v8, v8, v9
    v_lshlrev_b32 v8, 4, v8
    v_lshl_add_u32 v244, v6, 7, v8
    s_branch task_set
task_w2:
    s_sub_u32 s20, s2, 144
    s_mul_i32 s43, s20, 73728
    s_lshl_b32 s21, s3, 12
    s_add_u32 s43, s43, s21
    s_mov_b32 s39, 16384
    s_lshl_b32 s20, s20, 1
    s_add_u32 s20, s20, s18
    s_mul_i32 s24, s20, 1821
    s_lshr_b32 s24, s24, 16
    s_mul_i32 s25, s24, 36
    s_sub_u32 s25, s20, s25
    s_mul_i32 s26, s25, 7282
    s_lshr_b32 s26, s26, 16
    s_mul_i32 s27, s26, 9
    s_sub_u32 s27, s25, s27
    s_lshl_b32 s28, s26, 1
    s_sub_u32 s29, s27, 5
    s_add_u32 s30, s28, 1
    s_cmp_gt_u32 s27, 4
    s_cselect_b32 s29, s29, s27
    s_cselect_b32 s28, s30, s28
    s_min_u32 s30, s29, 1
    s_lshl_b32 s30, s30, 2
    s_lshl_b32 s29, s29, 3
    s_add_u32 s28, s28, s29
    s_add_u32 s28, s28, s30
    s_add_u32 s26, s26, 8
    s_cmp_eq_u32 s27, 4
    s_cmov_b32 s28, s26
    s_mul_i32 s24, s24, 144
    s_add_u32 s28, s28, s24
    s_mul_i32 s24, s17, 72
    s_add_u32 s28, s28, s24
    s_mul_i32 s94, s28, 9216
    s_add_u32 s94, s94, 0xe20000
    s_mul_i32 s23, s18, 36864
    s_mul_i32 s24, s17, 576
    s_add_u32 s23, s23, s24
    v_mul_u32_u24 v244, 1152, v6
    v_lshl_add_u32 v244, v5, 4, v244
    v_add_u32 v244, s23, v244
task_set:
    v_min_u32 v14, 7, v0
    v_lshlrev_b32 v14, 5, v14
    s_lshl_b32 s17, s10, 3
    v_add_u32 v10, s17, v0
    s_mul_i32 s17, s9, 18
    s_add_u32 s17, s17, 248
    v_min_u32 v12, 25, v0
    v_add_u32 v12, s17, v12
    v_cmp_gt_u32 vcc, 8, v0
    s_mov_b32 s45, 622592
    s_mov_b32 s44, 649216
    v_cndmask_b32 v10, v12, v10, vcc
    v_mul_u32_u24 v245, 32, v10
    buffer_load_dword v9, v14, s[52:55], 0 offen sc1
    s_lshl_b32 m0, s3, 12
    s_lshl_b32 s16, s2, 2
    s_add_u32 s16, s16, s3
    s_lshl_b32 s17, s16, 10
    s_add_u32 s18, s17, 0x6c000
    s_add_u32 s17, s17, 327680
    s_cmp_ge_u32 s16, 288
    s_cmov_b32 s17, s18
    s_cmp_ge_u32 s16, 928
    s_cmov_b32 s17, 1073741824
    v_mov_b32 v132, 0
    v_mov_b32 v133, 0
    v_mov_b32 v134, 0
    v_mov_b32 v135, 0
    s_sub_u32 s18, s2, 216
    s_lshl_b32 s19, s18, 21
    s_lshl_b32 s16, s3, 11
    s_add_u32 s19, s19, s16
    s_add_u32 s19, s19, 0x1f0000
    s_cmp_lt_u32 s18, 17
    s_cmov_b32 s94, s19
    s_cmov_b32 s85, 4
    s_cselect_b32 s19, s19, 1073741824
    v_bfe_u32 v136, v0, 3, 1
    v_lshlrev_b32 v136, 13, v136
    v_lshl_add_u32 v136, v5, 9, v136
    v_and_b32 v137, 7, v0
    v_lshl_add_u32 v136, v137, 4, v136
    s_waitcnt vmcnt(0)
    v_cmp_gt_u32 vcc, 1, v9
    s_nop 0
    s_cbranch_vccnz spin0
back0:
    v_mov_b32 v8, 1
    buffer_store_dword v8, v219, s[88:91], s33 offen sc1
    s_barrier
    buffer_store_dwordx4 v[132:135], v1, s[88:91], s17 offen sc1
    buffer_store_dwordx4 v[132:135], v136, s[48:51], s19 offen sc1
    buffer_load_dwordx4 v237, s[56:59], s43 offen offset:0 nt lds
    buffer_load_dwordx4 v238, s[56:59], s43 offen offset:1024 nt lds
    buffer_load_dwordx4 v239, s[56:59], s43 offen offset:2048 nt lds
    buffer_load_dwordx4 v240, s[56:59], s43 offen offset:3072 nt lds
    s_add_u32 s43, s43, s39
    s_add_u32 m0, m0, 16384
    buffer_load_dword v246, v245, s[88:91], s45 offen sc1
    s_waitcnt vmcnt(0)
    v_cmp_gt_u32 vcc, 1, v246
    s_nop 0
    s_cbranch_vccnz spin1
back1:
    s_mul_i32 s93, s3, 6144
    s_add_u32 s20, s93, s11
    s_add_u32 s93, s93, 73728
    s_add_u32 m0, s93, 0
    s_nop 0
    buffer_load_dwordx4 v1, s[4:7], s20 offen offset:0 sc1 lds
    buffer_load_dwordx4 v1, s[4:7], s20 offen offset:1024 sc1 lds
    buffer_load_dwordx4 v1, s[4:7], s20 offen offset:2048 sc1 lds
    s_add_u32 s20, s20, 3072
    s_add_u32 m0, s93, 3072
    s_nop 0
    buffer_load_dwordx4 v1, s[4:7], s20 offen offset:0 sc1 lds
    buffer_load_dwordx4 v1, s[4:7], s20 offen offset:1024 sc1 lds
    buffer_load_dwordx4 v1, s[4:7], s20 offen offset:2048 sc1 lds
    s_add_u32 s20, s20, 21504
    s_add_u32 m0, s93, 24576
    s_nop 0
    buffer_load_dwordx4 v1, s[4:7], s20 offen offset:0 sc1 lds
    buffer_load_dwordx4 v1, s[4:7], s20 offen offset:1024 sc1 lds
    buffer_load_dwordx4 v1, s[4:7], s20 offen offset:2048 sc1 lds
    s_add_u32 s20, s20, 3072
    s_add_u32 m0, s93, 27648
    s_nop 0
    buffer_load_dwordx4 v1, s[4:7], s20 offen offset:0 sc1 lds
    buffer_load_dwordx4 v1, s[4:7], s20 offen offset:1024 sc1 lds
    buffer_load_dwordx4 v1, s[4:7], s20 offen offset:2048 sc1 lds
    s_add_u32 s20, s20, 21504
    s_add_u32 m0, s93, 49152
    s_nop 0
    buffer_load_dwordx4 v1, s[4:7], s20 offen offset:0 sc1 lds
    buffer_load_dwordx4 v1, s[4:7], s20 offen offset:1024 sc1 lds
    buffer_load_dwordx4 v1, s[4:7], s20 offen offset:2048 sc1 lds
    s_add_u32 s20, s20, 3072
    s_add_u32 m0, s93, 52224
    s_nop 0
    buffer_load_dwordx4 v1, s[4:7], s20 offen offset:0 sc1 lds
    buffer_load_dwordx4 v1, s[4:7], s20 offen offset:1024 sc1 lds
    buffer_load_dwordx4 v1, s[4:7], s20 offen offset:2048 sc1 lds
    s_add_u32 s20, s20, 21504
    s_lshr_b32 s24, s10, 4
    s_xor_b32 s24, s24, s10
    s_and_b32 s24, s24, 1
    s_lshl_b32 s24, s24, 13
    s_and_b32 s15, s10, 15
    s_mul_i32 s15, s15, 147456
    s_add_u32 s24, s24, s15
    s_add_u32 s24, s24, 0x2200000
    s_mov_b32 s45, 1073741824
    s_branch qkv_go
a_stage:
    s_sub_u32 s15, s3, 1
    s_sub_u32 s21, s2, 192
    s_lshl_b32 s22, s15, 8
    s_add_u32 s21, s21, s22
    s_cmp_ge_u32 s21, 8
    s_cbranch_scc1 a_q
    v_mov_b32 v20, 0
    v_mov_b32 v21, 0
    v_mov_b32 v22, 0
    v_mov_b32 v23, 0
    s_mul_i32 s22, s21, 4096
    s_add_u32 s22, s22, 0x3498000
    buffer_store_dwordx4 v[20:23], v1, s[4:7], s22 offen offset:0 sc1
    buffer_store_dwordx4 v[20:23], v1, s[4:7], s22 offen offset:1024 sc1
    buffer_store_dwordx4 v[20:23], v1, s[4:7], s22 offen offset:2048 sc1
    buffer_store_dwordx4 v[20:23], v1, s[4:7], s22 offen offset:3072 sc1
    s_add_u32 s22, s22, 4096
    s_lshl_b32 s21, s21, 5
    v_mov_b32 v24, 1
    s_mov_b32 s52, s80
    s_mov_b32 s53, s81
    s_mov_b32 s54, 256
    s_waitcnt vmcnt(0)
    s_mov_b64 exec, 1
    buffer_store_dword v24, off, s[52:55], s21 sc1
    s_mov_b64 exec, -1
a_q:
    s_mov_b32 s52, s66
    s_mov_b32 s53, s67
    s_mov_b32 s54, 1990656
    s_and_b32 s21, s2, 7
    s_mul_i32 s21, s21, 24
    s_lshr_b32 s20, s2, 3
    s_add_u32 s20, s20, s21
    s_mul_i32 s20, s20, 3
    s_add_u32 s20, s20, s15
    s_and_b32 s21, s20, 31
    s_lshr_b32 s22, s20, 5
    s_cmp_ge_u32 s2, 192
    s_cmov_b32 s22, 18
    v_min_u32 v7, 2, v5
    v_mul_u32_u24 v10, 3456, v6
    v_lshl_add_u32 v7, v7, 4, v10
    s_mul_i32 s23, s22, 110592
    s_mul_i32 s24, s21, 36
    s_add_u32 s23, s23, s24
    s_add_u32 s24, s23, 13824
    buffer_load_dwordx4 v[96:99], v7, s[52:55], s23 offen offset:0
    buffer_load_dwordx4 v[100:103], v7, s[52:55], s23 offen offset:1152
    buffer_load_dwordx4 v[104:107], v7, s[52:55], s23 offen offset:2304
    buffer_load_dwordx4 v[108:111], v7, s[52:55], s24 offen offset:0
    buffer_load_dwordx4 v[112:115], v7, s[52:55], s24 offen offset:1152
    buffer_load_dwordx4 v[116:119], v7, s[52:55], s24 offen offset:2304
    s_mul_i32 s31, s21, 18
    s_add_u32 s31, s31, s22
    s_mul_i32 s33, s31, 32
    s_add_u32 s33, s33, 630784
    s_lshl_b32 s31, s31, 12
    s_add_u32 s31, s31, 0x100000
    s_cmp_eq_u32 s22, 18
    s_cmov_b32 s31, 1073741824
    s_cmov_b32 s33, 1073741824
    s_cmp_lt_u32 s2, 192
    s_cbranch_scc1 b_wq0
    s_cmp_lt_u32 s2, 200
    s_cbranch_scc1 a_common
    s_cmp_ge_u32 s2, 216
    s_cbranch_scc1 a_wo
    s_cmp_eq_u32 s3, 3
    s_cbranch_scc1 a_common
    s_lshl_b32 s20, s15, 4
    s_add_u32 s20, s20, s2
    s_sub_u32 s20, s20, 200
    v_mov_b32 v128, 0
    v_mov_b32 v129, 0
    v_mov_b32 v130, 0
    v_mov_b32 v131, 0
    s_mul_i32 s22, s20, 10240
    s_add_u32 s22, s22, 0x3400000
    buffer_store_dwordx4 v[128:131], v1, s[4:7], s22 offen offset:0 sc1
    buffer_store_dwordx4 v[128:131], v1, s[4:7], s22 offen offset:1024 sc1
    buffer_store_dwordx4 v[128:131], v1, s[4:7], s22 offen offset:2048 sc1
    buffer_store_dwordx4 v[128:131], v1, s[4:7], s22 offen offset:3072 sc1
    s_add_u32 s22, s22, 4096
    buffer_store_dwordx4 v[128:131], v1, s[4:7], s22 offen offset:0 sc1
    buffer_store_dwordx4 v[128:131], v1, s[4:7], s22 offen offset:1024 sc1
    buffer_store_dwordx4 v[128:131], v1, s[4:7], s22 offen offset:2048 sc1
    buffer_store_dwordx4 v[128:131], v1, s[4:7], s22 offen offset:3072 sc1
    s_add_u32 s22, s22, 4096
    buffer_store_dwordx4 v[128:131], v1, s[4:7], s22 offen offset:0 sc1
    buffer_store_dwordx4 v[128:131], v1, s[4:7], s22 offen offset:1024 sc1
    s_mul_i32 s33, s20, 32
    s_add_u32 s33, s33, 649216
    s_branch a_common
a_wo:
    s_mov_b32 s52, s68
    s_mov_b32 s53, s69
    s_mov_b32 s54, 663552
    s_and_b32 s21, s2, 1
    s_sub_u32 s22, s2, 216
    s_lshr_b32 s22, s22, 1
    v_lshrrev_b32 v7, 3, v4
    v_mul_u32_u24 v7, 18, v7
    v_and_b32 v8, 7, v4
    v_add_u32 v7, v7, v8
    v_lshrrev_b32 v8, 1, v4
    v_and_b32 v9, 1, v8
    v_lshrrev_b32 v8, 1, v8
    v_lshl_add_u32 v8, v8, 2, v9
    v_mul_u32_u24 v8, 18, v8
    v_and_b32 v9, 1, v4
    v_add3_u32 v8, v8, v9, 16
    s_mul_i32 s23, s22, 41472
    s_sub_u32 s25, s22, 16
    s_mul_i32 s25, s25, 331776
    s_mov_b32 s24, 41472
    s_cmp_lt_u32 s22, 16
    s_cselect_b64 vcc, -1, 0
    s_cmov_b32 s24, 9216
    s_cselect_b32 s23, s23, s25
    v_cndmask_b32 v7, v8, v7, vcc
    v_mul_u32_u24 v7, 1152, v7
    v_lshl_add_u32 v7, v5, 4, v7
    v_add_u32 v8, s24, v7
    s_mul_i32 s24, s21, 576
    s_add_u32 s23, s23, s24
    s_mul_i32 s24, s15, 192
    s_add_u32 s23, s23, s24
    buffer_load_dwordx4 v[96:99], v7, s[52:55], s23 offen offset:0
    buffer_load_dwordx4 v[100:103], v8, s[52:55], s23 offen offset:0
    buffer_load_dwordx4 v[104:107], v7, s[52:55], s23 offen offset:64
    buffer_load_dwordx4 v[108:111], v8, s[52:55], s23 offen offset:64
    buffer_load_dwordx4 v[112:115], v7, s[52:55], s23 offen offset:128
    buffer_load_dwordx4 v[116:119], v8, s[52:55], s23 offen offset:128
    s_mul_i32 s31, s21, 368640
    s_mul_i32 s24, s22, 5120
    s_add_u32 s31, s31, s24
    s_add_u32 s31, s31, 0x340000
    s_cmp_ge_u32 s2, 252
    s_cmov_b32 s31, 1073741824
b_wq0:
    v_mov_b32 v10, 99
    v_add_u32 v7, v3, v0
    v_sub_u32 v12, v7, v3
    v_and_b32 v13, 1, v12
    v_lshlrev_b32 v13, 4, v13
    v_lshlrev_b32 v13, v13, v11
    v_lshrrev_b32 v12, 1, v12
    v_cmp_eq_u32 vcc, 0, v12
    s_nop 1
    v_cndmask_b32 v16, 0, v13, vcc
    v_cmp_eq_u32 vcc, 1, v12
    s_nop 1
    v_cndmask_b32 v17, 0, v13, vcc
    v_cmp_eq_u32 vcc, 2, v12
    s_nop 1
    v_cndmask_b32 v18, 0, v13, vcc
    v_cmp_eq_u32 vcc, 3, v12
    s_nop 1
    v_cndmask_b32 v19, 0, v13, vcc
    s_lshl_b32 s17, s3, 10
    s_add_u32 s17, s17, 155648
    v_add_u32 v7, s17, v1
    ds_write_b128 v7, v[16:19]
    s_cmp_ge_u32 s2, 216
    s_cbranch_scc1 b_wo
    v_cmp_gt_u32 vcc, 8, v4
    v_subrev_u32 v7, 16, v6
    v_sub_u32 v12, v4, v3
    v_min_u32 v12, 8, v12
    v_lshl_add_u32 v12, v12, 4, s17
    ds_read_b128 v[32:35], v12
    v_cndmask_b32 v8, v10, v6, vcc
    v_cndmask_b32 v9, v7, v10, vcc
    v_sub_u32 v12, v8, v3
    v_min_u32 v12, 8, v12
    v_lshl_add_u32 v12, v12, 4, s17
    ds_read_b128 v[16:19], v12
    v_sub_u32 v12, v9, v3
    v_min_u32 v12, 8, v12
    v_lshl_add_u32 v12, v12, 4, s17
    ds_read_b128 v[24:27], v12
    v_add_u32 v8, 4, v8
    v_add_u32 v9, 4, v9
    v_sub_u32 v12, v8, v3
    v_min_u32 v12, 8, v12
    v_lshl_add_u32 v12, v12, 4, s17
    ds_read_b128 v[20:23], v12
    v_sub_u32 v12, v9, v3
    v_min_u32 v12, 8, v12
    v_lshl_add_u32 v12, v12, 4, s17
    ds_read_b128 v[28:31], v12
    v_bfe_u32 v7, v4, 2, 1
    v_add_u32 v7, 16, v7
    v_and_b32 v8, 11, v4
    v_cmp_eq_u32 s[22:23], 0, v8
    v_cmp_eq_u32 s[24:25], 8, v8
    v_cmp_eq_u32 s[26:27], 1, v8
    v_cndmask_b32 v9, v10, v7, s[22:23]
    v_sub_u32 v12, v9, v3
    v_min_u32 v12, 8, v12
    v_lshl_add_u32 v12, v12, 4, s17
    ds_read_b128 v[40:43], v12
    v_cndmask_b32 v9, v10, v7, s[24:25]
    v_sub_u32 v12, v9, v3
    v_min_u32 v12, 8, v12
    v_lshl_add_u32 v12, v12, 4, s17
    ds_read_b128 v[36:39], v12
    v_cndmask_b32 v9, v10, v7, s[26:27]
    v_sub_u32 v12, v9, v3
    v_min_u32 v12, 8, v12
    v_lshl_add_u32 v12, v12, 4, s17
    ds_read_b128 v[44:47], v12
    s_waitcnt vmcnt(0)
    s_waitcnt lgkmcnt(6)
    v_mfma_f32_16x16x32_bf16 v[48:51], v[96:99], v[16:19], 0
    s_waitcnt lgkmcnt(5)
    v_mfma_f32_16x16x32_bf16 v[48:51], v[100:103], v[24:27], v[48:51]
    v_mfma_f32_16x16x32_bf16 v[52:55], v[108:111], v[16:19], 0
    v_mfma_f32_16x16x32_bf16 v[52:55], v[112:115], v[24:27], v[52:55]
    s_waitcnt lgkmcnt(4)
    v_mfma_f32_16x16x32_bf16 v[56:59], v[96:99], v[20:23], 0
    s_waitcnt lgkmcnt(3)
    v_mfma_f32_16x16x32_bf16 v[56:59], v[100:103], v[28:31], v[56:59]
    v_mfma_f32_16x16x32_bf16 v[60:63], v[108:111], v[20:23], 0
    s_nop 0
    v_cvt_pk_bf16_f32 v48, v48, v49
    v_cvt_pk_bf16_f32 v49, v50, v51
    v_mfma_f32_16x16x32_bf16 v[60:63], v[112:115], v[28:31], v[60:63]
    v_cvt_pk_bf16_f32 v50, v52, v53
    v_cvt_pk_bf16_f32 v51, v54, v55
    v_mfma_f32_16x16x32_bf16 v[64:67], v[104:107], v[32:35], 0
    buffer_store_dwordx4 v[48:51], v1, s[4:7], s31 offen offset:0 sc1
    v_mfma_f32_16x16x32_bf16 v[68:71], v[116:119], v[32:35], 0
    s_waitcnt lgkmcnt(1)
    v_mfma_f32_16x16x32_bf16 v[72:75], v[96:99], v[36:39], 0
    v_cvt_pk_bf16_f32 v56, v56, v57
    v_cvt_pk_bf16_f32 v57, v58, v59
    v_mfma_f32_16x16x32_bf16 v[72:75], v[100:103], v[40:43], v[72:75]
    v_cvt_pk_bf16_f32 v58, v60, v61
    v_cvt_pk_bf16_f32 v59, v62, v63
    s_waitcnt lgkmcnt(0)
    v_mfma_f32_16x16x32_bf16 v[72:75], v[104:107], v[44:47], v[72:75]
    buffer_store_dwordx4 v[56:59], v1, s[4:7], s31 offen offset:1024 sc1
    v_mfma_f32_16x16x32_bf16 v[76:79], v[108:111], v[36:39], 0
    v_cvt_pk_bf16_f32 v64, v64, v65
    v_cvt_pk_bf16_f32 v65, v66, v67
    v_mfma_f32_16x16x32_bf16 v[76:79], v[112:115], v[40:43], v[76:79]
    v_cvt_pk_bf16_f32 v66, v68, v69
    v_cvt_pk_bf16_f32 v67, v70, v71
    v_mfma_f32_16x16x32_bf16 v[76:79], v[116:119], v[44:47], v[76:79]
    buffer_store_dwordx4 v[64:67], v1, s[4:7], s31 offen offset:2048 sc1
    v_cvt_pk_bf16_f32 v72, v72, v73
    v_cvt_pk_bf16_f32 v73, v74, v75
    s_nop 4
    v_cvt_pk_bf16_f32 v74, v76, v77
    v_cvt_pk_bf16_f32 v75, v78, v79
    buffer_store_dwordx4 v[72:75], v1, s[4:7], s31 offen offset:3072 sc1
    s_branch a_common
b_wo:
    v_add_u32 v7, 4, v6
    v_sub_u32 v12, v6, v3
    v_min_u32 v12, 8, v12
    v_lshl_add_u32 v12, v12, 4, s17
    ds_read_b128 v[20:23], v12
    v_sub_u32 v12, v7, v3
    v_min_u32 v12, 8, v12
    v_lshl_add_u32 v12, v12, 4, s17
    ds_read_b128 v[24:27], v12
    s_mov_b32 s22, 0
    s_mov_b32 s23, 1024
    s_mov_b32 s24, 2048
    s_mov_b32 s25, 3072
    s_mov_b32 s26, 92160
    s_mov_b32 s27, 93184
    s_cmp_eq_u32 s3, 3
    s_cmov_b32 s22, 186368
    s_cmov_b32 s23, 187392
    s_cmov_b32 s24, 276480
    s_cmov_b32 s25, 277504
    s_cmov_b32 s26, 278528
    s_cmov_b32 s27, 279552
    s_cmp_eq_u32 s3, 2
    s_cmov_b32 s22, 94208
    s_cmov_b32 s23, 95232
    s_cmov_b32 s24, 96256
    s_cmov_b32 s25, 188416
    s_cmov_b32 s26, 184320
    s_cmov_b32 s27, 185344
    s_cselect_b64 vcc, -1, 0
    s_cselect_b32 s28, s31, 1073741824
    v_add_u32 v9, 16, v4
    v_cndmask_b32 v8, v6, v4, vcc
    v_cndmask_b32 v9, v7, v9, vcc
    v_sub_u32 v12, v8, v3
    v_min_u32 v12, 8, v12
    v_lshl_add_u32 v12, v12, 4, s17
    ds_read_b128 v[28:31], v12
    v_sub_u32 v12, v9, v3
    v_min_u32 v12, 8, v12
    v_lshl_add_u32 v12, v12, 4, s17
    ds_read_b128 v[32:35], v12
    s_add_u32 s22, s22, s31
    s_add_u32 s23, s23, s31
    s_add_u32 s24, s24, s31
    s_add_u32 s25, s25, s31
    s_add_u32 s26, s26, s31
    s_add_u32 s27, s27, s31
    s_add_u32 s29, s28, 280576
    s_add_u32 s28, s28, 4096
    s_waitcnt vmcnt(0)
    s_waitcnt lgkmcnt(3)
    v_mfma_f32_16x16x32_bf16 v[176:179], v[96:99], v[20:23], 0
    v_mfma_f32_16x16x32_bf16 v[180:183], v[100:103], v[20:23], 0
    s_waitcnt lgkmcnt(2)
    v_mfma_f32_16x16x32_bf16 v[184:187], v[96:99], v[24:27], 0
    v_mfma_f32_16x16x32_bf16 v[188:191], v[100:103], v[24:27], 0
    s_waitcnt lgkmcnt(1)
    v_mfma_f32_16x16x32_bf16 v[192:195], v[104:107], v[28:31], 0
    s_nop 1
    v_cvt_pk_bf16_f32 v160, v176, v177
    v_mfma_f32_16x16x32_bf16 v[196:199], v[108:111], v[28:31], 0
    v_cvt_pk_bf16_f32 v161, v178, v179
    v_cvt_pk_bf16_f32 v162, v180, v181
    v_cvt_pk_bf16_f32 v163, v182, v183
    s_waitcnt lgkmcnt(0)
    v_mfma_f32_16x16x32_bf16 v[200:203], v[104:107], v[32:35], 0
    buffer_store_dwordx4 v[160:163], v1, s[4:7], s22 offen sc1
    v_cvt_pk_bf16_f32 v164, v184, v185
    v_mfma_f32_16x16x32_bf16 v[204:207], v[108:111], v[32:35], 0
    v_cvt_pk_bf16_f32 v165, v186, v187
    v_cvt_pk_bf16_f32 v166, v188, v189
    v_cvt_pk_bf16_f32 v167, v190, v191
    v_mfma_f32_16x16x32_bf16 v[176:179], v[112:115], v[20:23], 0
    buffer_store_dwordx4 v[164:167], v1, s[4:7], s23 offen sc1
    v_cvt_pk_bf16_f32 v168, v192, v193
    v_mfma_f32_16x16x32_bf16 v[180:183], v[116:119], v[20:23], 0
    v_cvt_pk_bf16_f32 v169, v194, v195
    v_cvt_pk_bf16_f32 v170, v196, v197
    v_cvt_pk_bf16_f32 v171, v198, v199
    v_mfma_f32_16x16x32_bf16 v[184:187], v[112:115], v[24:27], 0
    buffer_store_dwordx4 v[168:171], v1, s[4:7], s24 offen sc1
    buffer_store_dwordx4 v[168:171], v1, s[4:7], s28 offen sc1
    v_cvt_pk_bf16_f32 v160, v200, v201
    v_mfma_f32_16x16x32_bf16 v[188:191], v[116:119], v[24:27], 0
    v_cvt_pk_bf16_f32 v161, v202, v203
    v_cvt_pk_bf16_f32 v162, v204, v205
    v_cvt_pk_bf16_f32 v163, v206, v207
    buffer_store_dwordx4 v[160:163], v1, s[4:7], s25 offen sc1
    buffer_store_dwordx4 v[160:163], v1, s[4:7], s29 offen sc1
    v_cvt_pk_bf16_f32 v164, v176, v177
    v_cvt_pk_bf16_f32 v165, v178, v179
    v_cvt_pk_bf16_f32 v166, v180, v181
    v_cvt_pk_bf16_f32 v167, v182, v183
    buffer_store_dwordx4 v[164:167], v1, s[4:7], s26 offen sc1
    v_cvt_pk_bf16_f32 v168, v184, v185
    v_cvt_pk_bf16_f32 v169, v186, v187
    v_cvt_pk_bf16_f32 v170, v188, v189
    v_cvt_pk_bf16_f32 v171, v190, v191
    buffer_store_dwordx4 v[168:171], v1, s[4:7], s27 offen sc1
    s_branch a_common
layer:
    s_waitcnt vmcnt(1)
    v_cmp_gt_u32 vcc, 1, v4
    s_nop 0
    s_cbranch_vccz qkv_go
spin2:
    buffer_load_dword v4, v3, s[88:91], s16 offen sc1
    s_sub_u32 s14, s14, 1
    s_cbranch_scc1 spin2_out
    s_waitcnt vmcnt(0)
    v_cmp_gt_u32 vcc, 1, v4
    s_nop 0
    s_cbranch_vccnz spin2
back2:
qkv_go:
    buffer_load_dwordx4 v[48:51], v1, s[48:51], s24 offen offset:0 sc1
    buffer_load_dwordx4 v[52:55], v1, s[48:51], s24 offen offset:1024 sc1
    buffer_load_dwordx4 v[56:59], v1, s[48:51], s24 offen offset:2048 sc1
    buffer_load_dwordx4 v[60:63], v1, s[48:51], s24 offen offset:3072 sc1
    s_add_u32 s24, s24, 4096
    buffer_load_dwordx4 v[64:67], v1, s[48:51], s24 offen offset:0 sc1
    buffer_load_dwordx4 v[68:71], v1, s[48:51], s24 offen offset:1024 sc1
    buffer_load_dwordx4 v[72:75], v1, s[48:51], s24 offen offset:2048 sc1
    buffer_load_dwordx4 v[76:79], v1, s[48:51], s24 offen offset:3072 sc1
    s_add_u32 s24, s24, 12288
    buffer_load_dwordx4 v[80:83], v1, s[48:51], s24 offen offset:0 sc1
    buffer_load_dwordx4 v[84:87], v1, s[48:51], s24 offen offset:1024 sc1
    v_and_b32 v166, 3, v0
    v_mul_u32_u24 v166, 32, v166
    v_and_b32 v247, 31, v0
    v_mul_u32_u24 v247, 32, v247
    v_add_u32 v14, 73728, v1
    v_add_u32 v15, 106496, v1
    v_and_b32 v4, 15, v0
    v_lshrrev_b32 v3, 4, v0
    s_mul_i32 s22, s3, 7552
    s_add_u32 s22, s22, 73728
    v_lshrrev_b32 v6, 3, v4
    v_and_b32 v5, 7, v4
    v_lshl_add_u32 v11, v6, 4, v5
    v_and_b32 v5, 1, v3
    v_lshl_add_u32 v11, v5, 5, v11
    v_cmp_gt_u32 vcc, 2, v3
    v_mov_b32 v5, 4992
    s_add_u32 s23, s22, 512
    v_cndmask_b32 v6, 0, v5, vcc
    v_cndmask_b32 v7, v5, 0, vcc
    v_lshl_add_u32 v6, v11, 4, v6
    v_lshl_add_u32 v7, v11, 3, v7
    v_add_u32 v6, s23, v6
    v_add_u32 v7, s22, v7
    s_add_u32 s23, s22, 2560
    v_mul_u32_u24 v8, 288, v3
    v_lshrrev_b32 v9, 1, v3
    v_add_u32 v9, v9, v4
    v_lshl_add_u32 v8, v9, 4, v8
    v_add_u32 v8, s23, v8
    v_and_b32 v9, 3, v0
    v_mul_u32_u24 v9, 592, v9
    v_add_u32 v218, s23, v9
    v_lshrrev_b32 v9, 2, v4
    v_mul_u32_u24 v9, 288, v9
    v_lshrrev_b32 v10, 3, v4
    v_add_u32 v10, v10, v3
    v_lshl_add_u32 v9, v10, 4, v9
    v_and_b32 v10, 3, v4
    v_lshl_add_u32 v9, v10, 1, v9
    s_add_u32 s23, s23, 256
    v_add_u32 v9, s23, v9
    v_mov_b32 v5, 0x3eae1a93
    v_cndmask_b32 v10, 1.0, v5, vcc
    v_cndmask_b32 v11, v5, 1.0, vcc
    v_cndmask_b32 v12, 0, -0.5, vcc
    v_add_u32 v13, s22, v1
    v_mov_b32 v5, 147712
    v_cndmask_b32 v9, v5, v9, vcc
    s_waitcnt vmcnt(10)
    s_barrier
    ds_read_b128 a[0:3], v14 offset:0
    ds_read_b128 a[4:7], v14 offset:4096
    ds_read_b128 a[8:11], v14 offset:8192
    ds_read_b128 a[12:15], v14 offset:1024
    ds_read_b128 a[16:19], v14 offset:5120
    ds_read_b128 a[20:23], v14 offset:9216
    ds_read_b128 a[24:27], v14 offset:2048
    ds_read_b128 a[28:31], v14 offset:6144
    ds_read_b128 a[32:35], v14 offset:10240
    ds_read_b128 a[36:39], v14 offset:3072
    ds_read_b128 a[40:43], v14 offset:7168
    ds_read_b128 a[44:47], v14 offset:11264
    ds_read_b128 a[48:51], v14 offset:12288
qkv_pre:
    s_waitcnt vmcnt(9) lgkmcnt(12)
    v_mfma_f32_16x16x32_bf16 v[176:179], a[0:3], v[48:51], 0
    buffer_load_dwordx4 v[88:91], v1, s[48:51], s24 offen offset:2048 sc1
    ds_read_b128 a[52:55], v14 offset:16384
    s_waitcnt vmcnt(9) lgkmcnt(12)
    v_mfma_f32_16x16x32_bf16 v[176:179], a[4:7], v[52:55], v[176:179]
    s_waitcnt lgkmcnt(8)
    ds_read_b128 a[56:59], v14 offset:20480
    s_waitcnt vmcnt(8)
    v_mfma_f32_16x16x32_bf16 v[176:179], a[8:11], v[56:59], v[176:179]
    ds_read_b128 a[60:63], v14 offset:13312
    v_mfma_f32_16x16x32_bf16 v[180:183], a[12:15], v[48:51], 0
    buffer_load_dwordx4 v[92:95], v1, s[48:51], s24 offen offset:3072 sc1
    ds_read_b128 a[64:67], v14 offset:17408
    v_mfma_f32_16x16x32_bf16 v[180:183], a[16:19], v[52:55], v[180:183]
    s_waitcnt lgkmcnt(8)
    ds_read_b128 a[68:71], v14 offset:21504
    v_mfma_f32_16x16x32_bf16 v[180:183], a[20:23], v[56:59], v[180:183]
    ds_read_b128 a[72:75], v14 offset:14336
    v_mfma_f32_16x16x32_bf16 v[184:187], v[48:51], a[24:27], 0
    s_add_u32 s24, s24, 4096
    ds_read_b128 a[76:79], v14 offset:18432
    v_mfma_f32_16x16x32_bf16 v[184:187], v[52:55], a[28:31], v[184:187]
    s_waitcnt lgkmcnt(8)
    ds_read_b128 a[80:83], v14 offset:22528
    v_mfma_f32_16x16x32_bf16 v[184:187], v[56:59], a[32:35], v[184:187]
    ds_read_b128 a[84:87], v14 offset:15360
    v_mfma_f32_16x16x32_bf16 v[188:191], a[36:39], v[48:51], 0
    buffer_load_dwordx4 v[96:99], v1, s[48:51], s24 offen offset:0 sc1
    ds_read_b128 a[88:91], v14 offset:19456
    v_mfma_f32_16x16x32_bf16 v[188:191], a[40:43], v[52:55], v[188:191]
    s_waitcnt lgkmcnt(8)
    ds_read_b128 a[92:95], v14 offset:23552
    v_mfma_f32_16x16x32_bf16 v[188:191], a[44:47], v[56:59], v[188:191]
    s_waitcnt vmcnt(7)
    ds_read_b128 a[96:99], v14 offset:24576
    v_mfma_f32_16x16x32_bf16 v[176:179], a[48:51], v[60:63], v[176:179]
    buffer_load_dwordx4 v[100:103], v1, s[48:51], s24 offen offset:1024 sc1
    ds_read_b128 a[100:103], v14 offset:28672
    v_mfma_f32_16x16x32_bf16 v[176:179], a[52:55], v[64:67], v[176:179]
    s_waitcnt lgkmcnt(8)
    ds_read_b128 a[104:107], v14 offset:32768
    v_mfma_f32_16x16x32_bf16 v[176:179], a[56:59], v[68:71], v[176:179]
    ds_read_b128 a[108:111], v14 offset:25600
    v_mfma_f32_16x16x32_bf16 v[180:183], a[60:63], v[60:63], v[180:183]
    buffer_load_dwordx4 v[104:107], v1, s[48:51], s24 offen offset:2048 sc1
    ds_read_b128 a[112:115], v14 offset:29696
    v_mfma_f32_16x16x32_bf16 v[180:183], a[64:67], v[64:67], v[180:183]
    s_waitcnt lgkmcnt(8)
    ds_read_b128 a[116:119], v14 offset:33792
    v_mfma_f32_16x16x32_bf16 v[180:183], a[68:71], v[68:71], v[180:183]
    ds_read_b128 a[120:123], v14 offset:26624
    v_mfma_f32_16x16x32_bf16 v[184:187], v[60:63], a[72:75], v[184:187]
    buffer_load_dwordx4 v[108:111], v1, s[48:51], s24 offen offset:3072 sc1
    ds_read_b128 a[124:127], v14 offset:30720
    v_mfma_f32_16x16x32_bf16 v[184:187], v[64:67], a[76:79], v[184:187]
    s_waitcnt lgkmcnt(8)
    ds_read_b128 a[128:131], v14 offset:34816
    v_mfma_f32_16x16x32_bf16 v[184:187], v[68:71], a[80:83], v[184:187]
    ds_read_b128 a[132:135], v14 offset:27648
    v_mfma_f32_16x16x32_bf16 v[188:191], a[84:87], v[60:63], v[188:191]
    s_add_u32 s24, s24, 12288
    ds_read_b128 a[136:139], v14 offset:31744
    v_mfma_f32_16x16x32_bf16 v[188:191], a[88:91], v[64:67], v[188:191]
    s_waitcnt lgkmcnt(8)
    ds_read_b128 a[140:143], v14 offset:35840
    v_mfma_f32_16x16x32_bf16 v[188:191], a[92:95], v[68:71], v[188:191]
    s_waitcnt vmcnt(7)
    ds_read_b128 a[144:147], v14 offset:36864
    v_mfma_f32_16x16x32_bf16 v[176:179], a[96:99], v[72:75], v[176:179]
    buffer_load_dwordx4 v[112:115], v1, s[48:51], s24 offen offset:0 sc1
    ds_read_b128 a[148:151], v14 offset:40960
    v_mfma_f32_16x16x32_bf16 v[176:179], a[100:103], v[76:79], v[176:179]
    s_waitcnt lgkmcnt(8)
    ds_read_b128 a[152:155], v14 offset:45056
    v_mfma_f32_16x16x32_bf16 v[176:179], a[104:107], v[80:83], v[176:179]
    ds_read_b128 a[156:159], v14 offset:37888
    v_mfma_f32_16x16x32_bf16 v[180:183], a[108:111], v[72:75], v[180:183]
    buffer_load_dwordx4 v[116:119], v1, s[48:51], s24 offen offset:1024 sc1
    ds_read_b128 a[160:163], v14 offset:41984
    v_mfma_f32_16x16x32_bf16 v[180:183], a[112:115], v[76:79], v[180:183]
    s_waitcnt lgkmcnt(8)
    ds_read_b128 a[164:167], v14 offset:46080
    v_mfma_f32_16x16x32_bf16 v[180:183], a[116:119], v[80:83], v[180:183]
    ds_read_b128 a[168:171], v14 offset:38912
    v_mfma_f32_16x16x32_bf16 v[184:187], v[72:75], a[120:123], v[184:187]
    s_add_u32 s24, s24, 36864
    ds_read_b128 a[172:175], v14 offset:43008
    v_mfma_f32_16x16x32_bf16 v[184:187], v[76:79], a[124:127], v[184:187]
    s_waitcnt lgkmcnt(8)
    ds_read_b128 a[176:179], v14 offset:47104
    v_mfma_f32_16x16x32_bf16 v[184:187], v[80:83], a[128:131], v[184:187]
    ds_read_b128 a[180:183], v14 offset:39936
    v_mfma_f32_16x16x32_bf16 v[188:191], a[132:135], v[72:75], v[188:191]
    buffer_load_dwordx4 v[120:123], v1, s[48:51], s24 offen offset:0 sc1
    ds_read_b128 a[184:187], v14 offset:44032
    v_mfma_f32_16x16x32_bf16 v[188:191], a[136:139], v[76:79], v[188:191]
    s_waitcnt lgkmcnt(8)
    ds_read_b128 a[188:191], v14 offset:48128
    v_mfma_f32_16x16x32_bf16 v[188:191], a[140:143], v[80:83], v[188:191]
    s_waitcnt vmcnt(7)
    ds_read_b128 a[192:195], v15 offset:16384
    v_mfma_f32_16x16x32_bf16 v[176:179], a[144:147], v[84:87], v[176:179]
    ds_read_b128 a[196:199], v15 offset:20480
    v_mfma_f32_16x16x32_bf16 v[176:179], a[148:151], v[88:91], v[176:179]
    s_waitcnt lgkmcnt(8)
    buffer_load_dwordx4 v[124:127], v1, s[48:51], s24 offen offset:1024 sc1
    ds_read_b128 a[200:203], v15 offset:24576
    v_mfma_f32_16x16x32_bf16 v[176:179], a[152:155], v[92:95], v[176:179]
    ds_read_b128 a[204:207], v15 offset:17408
    v_mfma_f32_16x16x32_bf16 v[180:183], a[156:159], v[84:87], v[180:183]
    ds_read_b128 a[208:211], v15 offset:21504
    v_mfma_f32_16x16x32_bf16 v[180:183], a[160:163], v[88:91], v[180:183]
    s_waitcnt lgkmcnt(8)
    buffer_load_dwordx4 v[128:131], v1, s[48:51], s24 offen offset:2048 sc1
    ds_read_b128 a[212:215], v15 offset:25600
    v_mfma_f32_16x16x32_bf16 v[180:183], a[164:167], v[92:95], v[180:183]
    ds_read_b128 a[216:219], v15 offset:18432
    v_mfma_f32_16x16x32_bf16 v[184:187], v[84:87], a[168:171], v[184:187]
    ds_read_b128 a[220:223], v15 offset:22528
    v_mfma_f32_16x16x32_bf16 v[184:187], v[88:91], a[172:175], v[184:187]
    s_waitcnt lgkmcnt(8)
    buffer_load_dwordx4 v[132:135], v1, s[48:51], s24 offen offset:3072 sc1
    ds_read_b128 a[224:227], v15 offset:26624
    v_mfma_f32_16x16x32_bf16 v[184:187], v[92:95], a[176:179], v[184:187]
    ds_read_b128 a[228:231], v15 offset:19456
    v_mfma_f32_16x16x32_bf16 v[188:191], a[180:183], v[84:87], v[188:191]
    ds_read_b128 a[232:235], v15 offset:23552
    v_mfma_f32_16x16x32_bf16 v[188:191], a[184:187], v[88:91], v[188:191]
    s_waitcnt lgkmcnt(8)
    s_add_u32 s24, s24, 12288
    ds_read_b128 a[236:239], v15 offset:27648
    v_mfma_f32_16x16x32_bf16 v[188:191], a[188:191], v[92:95], v[188:191]
    s_waitcnt vmcnt(7)
    ds_read_b128 a[240:243], v15 offset:28672
    v_mfma_f32_16x16x32_bf16 v[176:179], a[192:195], v[96:99], v[176:179]
    ds_read_b128 a[244:247], v15 offset:32768
    v_mfma_f32_16x16x32_bf16 v[176:179], a[196:199], v[100:103], v[176:179]
    s_waitcnt lgkmcnt(8)
    buffer_load_dwordx4 v[136:139], v1, s[48:51], s24 offen offset:0 sc1
    ds_read_b128 a[248:251], v15 offset:36864
    v_mfma_f32_16x16x32_bf16 v[176:179], a[200:203], v[104:107], v[176:179]
    ds_read_b128 a[252:255], v15 offset:29696
    v_mfma_f32_16x16x32_bf16 v[180:183], a[204:207], v[96:99], v[180:183]
    ds_read_b128 v[16:19], v15 offset:33792
    v_mfma_f32_16x16x32_bf16 v[180:183], a[208:211], v[100:103], v[180:183]
    s_waitcnt lgkmcnt(8)
    buffer_load_dwordx4 v[140:143], v1, s[48:51], s24 offen offset:1024 sc1
    ds_read_b128 v[20:23], v15 offset:37888
    v_mfma_f32_16x16x32_bf16 v[180:183], a[212:215], v[104:107], v[180:183]
    ds_read_b128 v[24:27], v15 offset:30720
    v_mfma_f32_16x16x32_bf16 v[184:187], v[96:99], a[216:219], v[184:187]
    ds_read_b128 v[28:31], v15 offset:34816
    v_mfma_f32_16x16x32_bf16 v[184:187], v[100:103], a[220:223], v[184:187]
    s_waitcnt lgkmcnt(8)
    buffer_load_dwordx4 v[48:51], v1, s[48:51], s24 offen offset:2048 sc1
    ds_read_b128 v[32:35], v15 offset:38912
    v_mfma_f32_16x16x32_bf16 v[184:187], v[104:107], a[224:227], v[184:187]
    ds_read_b128 v[36:39], v15 offset:31744
    v_mfma_f32_16x16x32_bf16 v[188:191], a[228:231], v[96:99], v[188:191]
    ds_read_b128 v[40:43], v15 offset:35840
    v_mfma_f32_16x16x32_bf16 v[188:191], a[232:235], v[100:103], v[188:191]
    s_waitcnt lgkmcnt(8)
    buffer_load_dwordx4 v[52:55], v1, s[48:51], s24 offen offset:3072 sc1
    ds_read_b128 v[44:47], v15 offset:39936
    v_mfma_f32_16x16x32_bf16 v[188:191], a[236:239], v[104:107], v[188:191]
    s_waitcnt vmcnt(8)
    v_mfma_f32_16x16x32_bf16 v[176:179], a[240:243], v[108:111], v[176:179]
    v_mfma_f32_16x16x32_bf16 v[176:179], a[244:247], v[112:115], v[176:179]
    s_waitcnt lgkmcnt(6)
    s_add_u32 s24, s24, 4096
    v_mfma_f32_16x16x32_bf16 v[176:179], a[248:251], v[116:119], v[176:179]
    v_mfma_f32_16x16x32_bf16 v[180:183], a[252:255], v[108:111], v[180:183]
    v_mfma_f32_16x16x32_bf16 v[180:183], v[16:19], v[112:115], v[180:183]
    s_waitcnt lgkmcnt(3)
    buffer_load_dwordx4 v[56:59], v1, s[48:51], s24 offen offset:0 sc1
    v_mfma_f32_16x16x32_bf16 v[180:183], v[20:23], v[116:119], v[180:183]
    v_mfma_f32_16x16x32_bf16 v[184:187], v[108:111], v[24:27], v[184:187]
    v_mfma_f32_16x16x32_bf16 v[184:187], v[112:115], v[28:31], v[184:187]
    s_waitcnt lgkmcnt(0)
    buffer_load_dwordx4 v[60:63], v1, s[48:51], s24 offen offset:1024 sc1
    v_mfma_f32_16x16x32_bf16 v[184:187], v[116:119], v[32:35], v[184:187]
    v_mfma_f32_16x16x32_bf16 v[188:191], v[36:39], v[108:111], v[188:191]
    v_mfma_f32_16x16x32_bf16 v[188:191], v[40:43], v[112:115], v[188:191]
    v_mfma_f32_16x16x32_bf16 v[188:191], v[44:47], v[116:119], v[188:191]
    s_waitcnt vmcnt(7)
    buffer_load_dwordx4 v[64:67], v1, s[48:51], s24 offen offset:2048 sc1
    v_mfma_f32_16x16x32_bf16 v[192:195], a[0:3], v[120:123], 0
    v_mfma_f32_16x16x32_bf16 v[192:195], a[4:7], v[124:127], v[192:195]
    v_mfma_f32_16x16x32_bf16 v[192:195], a[8:11], v[128:131], v[192:195]
    s_barrier
    buffer_load_dword v246, v166, s[88:91], s45 offen sc1
    v_mfma_f32_16x16x32_bf16 v[196:199], a[12:15], v[120:123], 0
    buffer_load_dwordx4 v[68:71], v1, s[48:51], s24 offen offset:3072 sc1
    v_mfma_f32_16x16x32_bf16 v[196:199], a[16:19], v[124:127], v[196:199]
    v_mfma_f32_16x16x32_bf16 v[196:199], a[20:23], v[128:131], v[196:199]
    s_add_u32 s24, s24, 12288
    v_mfma_f32_16x16x32_bf16 v[200:203], v[120:123], a[24:27], 0
    v_mul_f32 v176, v176, v10
    v_mfma_f32_16x16x32_bf16 v[200:203], v[124:127], a[28:31], v[200:203]
    v_mfma_f32_16x16x32_bf16 v[200:203], v[128:131], a[32:35], v[200:203]
    buffer_load_dwordx4 v[72:75], v1, s[48:51], s24 offen offset:0 sc1
    v_mul_f32 v177, v177, v10
    v_mfma_f32_16x16x32_bf16 v[204:207], a[36:39], v[120:123], 0
    v_mfma_f32_16x16x32_bf16 v[204:207], a[40:43], v[124:127], v[204:207]
    v_mfma_f32_16x16x32_bf16 v[204:207], a[44:47], v[128:131], v[204:207]
    s_waitcnt vmcnt(8)
    buffer_load_dwordx4 v[76:79], v1, s[48:51], s24 offen offset:1024 sc1
    v_mul_f32 v178, v178, v10
    v_mfma_f32_16x16x32_bf16 v[192:195], a[48:51], v[132:135], v[192:195]
    v_mfma_f32_16x16x32_bf16 v[192:195], a[52:55], v[136:139], v[192:195]
    v_mfma_f32_16x16x32_bf16 v[192:195], a[56:59], v[140:143], v[192:195]
    buffer_load_dwordx4 v[80:83], v1, s[48:51], s24 offen offset:2048 sc1
    v_mul_f32 v179, v179, v10
    v_mfma_f32_16x16x32_bf16 v[196:199], a[60:63], v[132:135], v[196:199]
    v_mfma_f32_16x16x32_bf16 v[196:199], a[64:67], v[136:139], v[196:199]
    v_mfma_f32_16x16x32_bf16 v[196:199], a[68:71], v[140:143], v[196:199]
    buffer_load_dwordx4 v[84:87], v1, s[48:51], s24 offen offset:3072 sc1
    v_mul_f32 v180, v180, v10
    v_mfma_f32_16x16x32_bf16 v[200:203], v[132:135], a[72:75], v[200:203]
    v_mfma_f32_16x16x32_bf16 v[200:203], v[136:139], a[76:79], v[200:203]
    v_mfma_f32_16x16x32_bf16 v[200:203], v[140:143], a[80:83], v[200:203]
    s_add_u32 s24, s24, 4096
    v_mul_f32 v181, v181, v10
    v_mfma_f32_16x16x32_bf16 v[204:207], a[84:87], v[132:135], v[204:207]
    v_mfma_f32_16x16x32_bf16 v[204:207], a[88:91], v[136:139], v[204:207]
    v_mfma_f32_16x16x32_bf16 v[204:207], a[92:95], v[140:143], v[204:207]
    s_waitcnt vmcnt(8)
    buffer_load_dwordx4 v[88:91], v1, s[48:51], s24 offen offset:0 sc1
    v_mul_f32 v182, v182, v10
    v_mfma_f32_16x16x32_bf16 v[192:195], a[96:99], v[48:51], v[192:195]
    v_mfma_f32_16x16x32_bf16 v[192:195], a[100:103], v[52:55], v[192:195]
    v_mfma_f32_16x16x32_bf16 v[192:195], a[104:107], v[56:59], v[192:195]
    buffer_load_dwordx4 v[92:95], v1, s[48:51], s24 offen offset:1024 sc1
    v_mul_f32 v183, v183, v10
    v_mfma_f32_16x16x32_bf16 v[196:199], a[108:111], v[48:51], v[196:199]
    v_mfma_f32_16x16x32_bf16 v[196:199], a[112:115], v[52:55], v[196:199]
    v_mfma_f32_16x16x32_bf16 v[196:199], a[116:119], v[56:59], v[196:199]
    s_add_u32 s24, s24, 4294899712
    s_waitcnt vmcnt(7)
    v_cmp_gt_u32 vcc, s13, v246
    v_cvt_pk_bf16_f32 v176, v176, v177
    v_mfma_f32_16x16x32_bf16 v[200:203], v[48:51], a[120:123], v[200:203]
    v_mfma_f32_16x16x32_bf16 v[200:203], v[52:55], a[124:127], v[200:203]
    s_cbranch_vccnz spin3
back3:
    v_mfma_f32_16x16x32_bf16 v[200:203], v[56:59], a[128:131], v[200:203]
    v_cvt_pk_bf16_f32 v177, v178, v179
    v_mfma_f32_16x16x32_bf16 v[204:207], a[132:135], v[48:51], v[204:207]
    buffer_load_dwordx4 v[96:99], v1, s[48:51], s24 offen offset:0 sc1
    v_mfma_f32_16x16x32_bf16 v[204:207], a[136:139], v[52:55], v[204:207]
    v_and_b32 v4, 31, v0
    v_lshrrev_b32 v5, 5, v0
    v_mfma_f32_16x16x32_bf16 v[204:207], a[140:143], v[56:59], v[204:207]
    s_waitcnt vmcnt(7)
    buffer_load_dwordx4 v[100:103], v1, s[48:51], s24 offen offset:1024 sc1
    v_cvt_pk_bf16_f32 v178, v180, v181
    v_mfma_f32_16x16x32_bf16 v[192:195], a[144:147], v[60:63], v[192:195]
    v_cmp_eq_u32 vcc, 20, v4
    v_mfma_f32_16x16x32_bf16 v[192:195], a[148:151], v[64:67], v[192:195]
    s_lshr_b32 s16, s3, 1
    s_lshl_b32 s18, s9, 1
    v_cvt_pk_bf16_f32 v179, v182, v183
    v_mfma_f32_16x16x32_bf16 v[192:195], a[152:155], v[68:71], v[192:195]
    s_add_u32 s16, s16, s18
    buffer_load_dwordx4 v[104:107], v1, s[48:51], s24 offen offset:2048 sc1
    v_cndmask_b32 v3, v4, 17, vcc
    v_mfma_f32_16x16x32_bf16 v[196:199], a[156:159], v[60:63], v[196:199]
    v_lshlrev_b32 v3, 4, v3
    v_mul_u32_u24 v208, 288, v5
    v_mfma_f32_16x16x32_bf16 v[196:199], a[160:163], v[64:67], v[196:199]
    v_cvt_pk_bf16_f32 v160, v184, v185
    v_add_u32 v3, v3, v208
    v_mfma_f32_16x16x32_bf16 v[196:199], a[164:167], v[68:71], v[196:199]
    buffer_load_dwordx4 v[108:111], v1, s[48:51], s24 offen offset:3072 sc1
    v_and_b32 v208, 27, v4
    v_mfma_f32_16x16x32_bf16 v[200:203], v[60:63], a[168:171], v[200:203]
    v_cmp_eq_u32 vcc, 17, v208
    v_mov_b32 v209, 576
    v_mfma_f32_16x16x32_bf16 v[200:203], v[64:67], a[172:175], v[200:203]
    s_lshl_b32 s16, s16, 3
    s_add_u32 s16, s16, s8
    v_cvt_pk_bf16_f32 v161, v186, v187
    v_mfma_f32_16x16x32_bf16 v[200:203], v[68:71], a[176:179], v[200:203]
    s_add_u32 s24, s24, 4096
    v_cndmask_b32 v3, v3, v209, vcc
    v_add_u32 v3, 2560, v3
    v_mfma_f32_16x16x32_bf16 v[204:207], a[180:183], v[60:63], v[204:207]
    v_lshlrev_b32 v208, v4, 1
    v_mfma_f32_16x16x32_bf16 v[204:207], a[184:187], v[64:67], v[204:207]
    v_mul_f32 v188, v188, v11
    v_and_b32 v208, 0x0033ffff, v208
    v_mfma_f32_16x16x32_bf16 v[204:207], a[188:191], v[68:71], v[204:207]
    s_waitcnt vmcnt(7)
    buffer_load_dwordx4 v[112:115], v1, s[48:51], s24 offen offset:0 sc1
    v_cmp_eq_u32 vcc, 0, v208
    v_mfma_f32_16x16x32_bf16 v[192:195], a[192:195], v[72:75], v[192:195]
    s_mul_i32 s23, s16, 16384
    s_and_b32 s16, s3, 1
    v_mfma_f32_16x16x32_bf16 v[192:195], a[196:199], v[76:79], v[192:195]
    s_mul_i32 s19, s16, 4992
    s_add_u32 s23, s23, s19
    v_cvt_pk_bf16_f32 v189, v189, v189
    v_mfma_f32_16x16x32_bf16 v[192:195], a[200:203], v[80:83], v[192:195]
    s_mul_i32 s25, s13, 8388608
    buffer_load_dwordx4 v[116:119], v1, s[48:51], s24 offen offset:1024 sc1
    v_mfma_f32_16x16x32_bf16 v[196:199], a[204:207], v[72:75], v[196:199]
    s_add_u32 s25, s25, 0x2680000
    s_add_u32 s23, s23, s25
    v_mfma_f32_16x16x32_bf16 v[196:199], a[208:211], v[76:79], v[196:199]
    s_add_u32 s16, s16, s18
    v_cvt_pk_bf16_f32 v188, v188, v12
    v_mfma_f32_16x16x32_bf16 v[196:199], a[212:215], v[80:83], v[196:199]
    s_add_u32 s24, s24, 10240
    s_mul_i32 s16, s16, 131072
    s_add_u32 s16, s16, s25
    v_mfma_f32_16x16x32_bf16 v[200:203], v[72:75], a[216:219], v[200:203]
    s_add_u32 s52, s48, s16
    s_addc_u32 s53, s49, 0
    v_mfma_f32_16x16x32_bf16 v[200:203], v[76:79], a[220:223], v[200:203]
    s_mov_b32 s54, 131072
    ds_write_b128 v6, v[176:179] offset:0
    v_mfma_f32_16x16x32_bf16 v[200:203], v[80:83], a[224:227], v[200:203]
    s_mov_b32 s55, 0x00020000
    buffer_load_dwordx4 v[120:123], v1, s[48:51], s24 offen offset:0 sc1
    v_mfma_f32_16x16x32_bf16 v[204:207], a[228:231], v[72:75], v[204:207]
    s_add_u32 s21, s23, 4096
    v_mfma_f32_16x16x32_bf16 v[204:207], a[232:235], v[76:79], v[204:207]
    s_xor_b32 s16, s3, 1
    s_mul_i32 s16, s16, 7552
    ds_write_b32 v7, v188 offset:0
    v_mfma_f32_16x16x32_bf16 v[204:207], a[236:239], v[80:83], v[204:207]
    s_waitcnt vmcnt(7)
    s_add_u32 s16, s16, 73728
    buffer_load_dwordx4 v[124:127], v1, s[48:51], s24 offen offset:1024 sc1
    v_mfma_f32_16x16x32_bf16 v[192:195], a[240:243], v[84:87], v[192:195]
    s_and_b32 s17, s3, 1
    s_mul_i32 s19, s17, 15104
    v_mfma_f32_16x16x32_bf16 v[192:195], a[244:247], v[88:91], v[192:195]
    s_add_u32 s19, s19, 73728
    ds_write_b16 v9, v189 offset:0
    v_mfma_f32_16x16x32_bf16 v[192:195], a[248:251], v[92:95], v[192:195]
    buffer_load_dwordx4 v[128:131], v1, s[48:51], s24 offen offset:2048 sc1
    v_add_u32 v210, s22, v2
    v_mfma_f32_16x16x32_bf16 v[196:199], a[252:255], v[84:87], v[196:199]
    v_add_u32 v211, s16, v1
    v_add_u32 v212, s16, v2
    v_mfma_f32_16x16x32_bf16 v[196:199], v[16:19], v[88:91], v[196:199]
    v_add_u32 v213, s19, v1
    v_add_u32 v214, s19, v2
    v_mfma_f32_16x16x32_bf16 v[196:199], v[20:23], v[92:95], v[196:199]
    buffer_load_dwordx4 v[132:135], v1, s[48:51], s24 offen offset:3072 sc1
    v_mov_b32 v209, 3136
    v_mfma_f32_16x16x32_bf16 v[200:203], v[84:87], v[24:27], v[200:203]
    v_cndmask_b32 v215, v3, v209, vcc
    v_add_u32 v215, s19, v215
    v_mfma_f32_16x16x32_bf16 v[200:203], v[88:91], v[28:31], v[200:203]
    s_add_u32 s24, s24, 4096
    v_add_u32 v216, 73728, v1
    v_mfma_f32_16x16x32_bf16 v[200:203], v[92:95], v[32:35], v[200:203]
    v_mov_b32 v209, 0x100000
    v_cndmask_b32 v3, v3, v209, vcc
    v_mfma_f32_16x16x32_bf16 v[204:207], v[36:39], v[84:87], v[204:207]
    v_add_u32 v172, 4992, v1
    v_mfma_f32_16x16x32_bf16 v[204:207], v[40:43], v[88:91], v[204:207]
    buffer_load_dwordx4 v[136:139], v1, s[48:51], s24 offen offset:0 sc1
    v_add_u32 v173, 4992, v2
    v_mfma_f32_16x16x32_bf16 v[204:207], v[44:47], v[92:95], v[204:207]
    s_waitcnt vmcnt(8)
    v_add_u32 v174, 4992, v3
    v_mov_b32 v248, 0x3f803f80
    v_mfma_f32_16x16x32_bf16 v[176:179], a[0:3], v[96:99], 0
    v_mov_b32 v249, 0x3f803f80
    v_mfma_f32_16x16x32_bf16 v[176:179], a[4:7], v[100:103], v[176:179]
    buffer_load_dwordx4 v[140:143], v1, s[48:51], s24 offen offset:1024 sc1
    v_mov_b32 v250, 0x3f803f80
    v_mfma_f32_16x16x32_bf16 v[176:179], a[8:11], v[104:107], v[176:179]
    v_mov_b32 v251, 0x3f803f80
    v_mfma_f32_16x16x32_bf16 v[180:183], a[12:15], v[96:99], 0
    s_lshl_b32 s16, s9, 5
    s_add_u32 s40, s16, s10
    s_mul_i32 s40, s40, 128
    v_mfma_f32_16x16x32_bf16 v[180:183], a[16:19], v[100:103], v[180:183]
    s_add_u32 s40, s40, 0
    buffer_load_dwordx4 v[48:51], v1, s[48:51], s24 offen offset:2048 sc1
    v_mfma_f32_16x16x32_bf16 v[180:183], a[20:23], v[104:107], v[180:183]
    s_lshl_b32 s19, s17, 1
    s_add_u32 s41, s16, s19
    v_mfma_f32_16x16x32_bf16 v[184:187], v[96:99], a[24:27], 0
    s_mul_i32 s41, s41, 128
    v_mul_f32 v192, v192, v10
    v_mfma_f32_16x16x32_bf16 v[184:187], v[100:103], a[28:31], v[184:187]
    s_add_u32 s41, s41, 0
    buffer_load_dwordx4 v[52:55], v1, s[48:51], s24 offen offset:3072 sc1
    v_and_b32 v208, 1, v0
    v_mfma_f32_16x16x32_bf16 v[184:187], v[104:107], a[32:35], v[184:187]
    s_xor_b32 s16, s8, 1
    v_mul_f32 v193, v193, v10
    v_mfma_f32_16x16x32_bf16 v[188:191], a[36:39], v[96:99], 0
    s_lshl_b32 s16, s16, 2
    v_mfma_f32_16x16x32_bf16 v[188:191], a[40:43], v[100:103], v[188:191]
    s_add_u32 s24, s24, 12288
    v_add_u32 v175, s16, v208
    v_mul_u32_u24 v175, 128, v175
    v_mfma_f32_16x16x32_bf16 v[188:191], a[44:47], v[104:107], v[188:191]
    s_waitcnt vmcnt(8)
    v_mul_f32 v194, v194, v10
    v_bfe_u32 v167, v0, 1, 3
    v_mfma_f32_16x16x32_bf16 v[176:179], a[48:51], v[108:111], v[176:179]
    v_max_u32 v167, 2, v167
    v_xor_b32 v167, s8, v167
    v_mfma_f32_16x16x32_bf16 v[176:179], a[52:55], v[112:115], v[176:179]
    buffer_load_dwordx4 v[56:59], v1, s[48:51], s24 offen offset:0 sc1
    v_lshl_add_u32 v167, v167, 2, v208
    v_mfma_f32_16x16x32_bf16 v[176:179], a[56:59], v[116:119], v[176:179]
    v_mul_f32 v195, v195, v10
    v_mul_u32_u24 v167, 128, v167
    v_mfma_f32_16x16x32_bf16 v[180:183], a[60:63], v[108:111], v[180:183]
    s_lshl_b32 s34, s3, 12
    s_and_b32 s36, s9, 7
    v_mfma_f32_16x16x32_bf16 v[180:183], a[64:67], v[112:115], v[180:183]
    s_mul_i32 s37, s9, 331776
    s_add_u32 s37, s37, 0x400000
    buffer_load_dwordx4 v[60:63], v1, s[48:51], s24 offen offset:1024 sc1
    v_mfma_f32_16x16x32_bf16 v[180:183], a[68:71], v[116:119], v[180:183]
    s_add_u32 s38, s37, s34
    v_mul_f32 v196, v196, v10
    v_mfma_f32_16x16x32_bf16 v[184:187], v[108:111], a[72:75], v[184:187]
    s_mul_i32 s35, s36, 92160
    s_add_u32 s35, s35, s34
    v_mfma_f32_16x16x32_bf16 v[184:187], v[112:115], a[76:79], v[184:187]
    s_add_u32 s35, s35, 0x354000
    buffer_load_dwordx4 v[64:67], v1, s[48:51], s24 offen offset:2048 sc1
    v_mfma_f32_16x16x32_bf16 v[184:187], v[116:119], a[80:83], v[184:187]
    s_add_u32 s38, s38, 32768
    s_add_u32 s32, s34, 32768
    v_mul_f32 v197, v197, v10
    v_mfma_f32_16x16x32_bf16 v[188:191], a[84:87], v[108:111], v[188:191]
    s_mov_b32 s83, 0
    v_mfma_f32_16x16x32_bf16 v[188:191], a[88:91], v[112:115], v[188:191]
    s_mov_b32 s42, 1073741824
    buffer_load_dwordx4 v[68:71], v1, s[48:51], s24 offen offset:3072 sc1
    v_mfma_f32_16x16x32_bf16 v[188:191], a[92:95], v[116:119], v[188:191]
    s_waitcnt vmcnt(9)
    v_mul_f32 v198, v198, v10
    v_min_u32 v245, 17, v0
    v_mfma_f32_16x16x32_bf16 v[176:179], a[96:99], v[120:123], v[176:179]
    s_bfe_u32 s16, s9, 0x10002
    v_lshl_add_u32 v245, v245, 1, s16
    v_mfma_f32_16x16x32_bf16 v[176:179], a[100:103], v[124:127], v[176:179]
    s_add_u32 s24, s24, 38912
    v_mul_u32_u24 v245, 128, v245
    v_mfma_f32_16x16x32_bf16 v[176:179], a[104:107], v[128:131], v[176:179]
    s_lshr_b32 s16, s9, 1
    s_mul_i32 s16, s16, 9
    v_mul_f32 v199, v199, v10
    v_mfma_f32_16x16x32_bf16 v[180:183], a[108:111], v[120:123], v[180:183]
    s_and_b32 s19, s9, 1
    s_lshl_b32 s19, s19, 2
    buffer_load_dwordx4 v[72:75], v1, s[48:51], s24 offen offset:0 sc1
    v_mfma_f32_16x16x32_bf16 v[180:183], a[112:115], v[124:127], v[180:183]
    s_add_u32 s16, s16, s19
    v_mfma_f32_16x16x32_bf16 v[180:183], a[116:119], v[128:131], v[180:183]
    s_and_b32 s16, s16, 0xfe
    v_cvt_pk_bf16_f32 v192, v192, v193
    v_add_u32 v241, s16, v0
    v_mfma_f32_16x16x32_bf16 v[184:187], v[120:123], a[120:123], v[184:187]
    s_lshr_b32 s16, s9, 3
    buffer_load_dwordx4 v[76:79], v1, s[48:51], s24 offen offset:1024 sc1
    v_mfma_f32_16x16x32_bf16 v[184:187], v[124:127], a[124:127], v[184:187]
    s_mul_i32 s16, s16, 18
    s_add_u32 s16, s16, 138
    v_mfma_f32_16x16x32_bf16 v[184:187], v[128:131], a[128:131], v[184:187]
    v_cvt_pk_bf16_f32 v193, v194, v195
    v_min_u32 v208, 23, v0
    v_mfma_f32_16x16x32_bf16 v[188:191], a[132:135], v[120:123], v[188:191]
    s_add_u32 s24, s24, 10240
    v_add_u32 v208, s16, v208
    v_mfma_f32_16x16x32_bf16 v[188:191], a[136:139], v[124:127], v[188:191]
    v_cmp_gt_u32 vcc, 6, v0
    v_mov_b32 v242, 1
    v_mfma_f32_16x16x32_bf16 v[188:191], a[140:143], v[128:131], v[188:191]
    s_waitcnt vmcnt(8)
    v_cvt_pk_bf16_f32 v194, v196, v197
    v_cndmask_b32 v241, v208, v241, vcc
    v_mfma_f32_16x16x32_bf16 v[176:179], a[144:147], v[132:135], v[176:179]
    buffer_load_dwordx4 v[80:83], v1, s[48:51], s24 offen offset:0 sc1
    v_cmp_gt_u32 vcc, 32, v0
    v_mfma_f32_16x16x32_bf16 v[176:179], a[148:151], v[136:139], v[176:179]
    v_cvt_pk_bf16_f32 v195, v198, v199
    v_min_u32 v208, 48, v0
    v_mfma_f32_16x16x32_bf16 v[176:179], a[152:155], v[140:143], v[176:179]
    v_add_u32 v208, 184, v208
    v_cndmask_b32 v241, v208, v241, vcc
    v_mfma_f32_16x16x32_bf16 v[180:183], a[156:159], v[132:135], v[180:183]
    buffer_load_dwordx4 v[84:87], v1, s[48:51], s24 offen offset:1024 sc1
    v_mul_u32_u24 v241, 128, v241
    v_mfma_f32_16x16x32_bf16 v[180:183], a[160:163], v[136:139], v[180:183]
    s_mov_b32 s33, 3
    s_mov_b32 s29, 0x07060100
    v_cvt_pk_bf16_f32 v252, v200, v201
    v_mfma_f32_16x16x32_bf16 v[180:183], a[164:167], v[140:143], v[180:183]
    s_mul_i32 s31, s8, 16384
    s_mov_b32 s30, 0
    v_mfma_f32_16x16x32_bf16 v[184:187], v[132:135], a[168:171], v[184:187]
    s_add_u32 s16, s3, 1
    s_and_b32 s16, s16, 3
    buffer_load_dwordx4 v[88:91], v1, s[48:51], s24 offen offset:2048 sc1
    v_mfma_f32_16x16x32_bf16 v[184:187], v[136:139], a[172:175], v[184:187]
    s_mul_i32 s16, s16, 5120
    v_cvt_pk_bf16_f32 v253, v202, v203
    v_mfma_f32_16x16x32_bf16 v[184:187], v[140:143], a[176:179], v[184:187]
    s_xor_b32 s19, s3, 1
    v_mfma_f32_16x16x32_bf16 v[188:191], a[180:183], v[132:135], v[188:191]
    s_add_u32 s19, s19, 1
    s_and_b32 s19, s19, 3
    buffer_load_dwordx4 v[92:95], v1, s[48:51], s24 offen offset:3072 sc1
    v_mfma_f32_16x16x32_bf16 v[188:191], a[184:187], v[136:139], v[188:191]
    s_mul_i32 s19, s19, 5120
    v_mul_f32 v204, v204, v11
    v_mfma_f32_16x16x32_bf16 v[188:191], a[188:191], v[140:143], v[188:191]
    s_waitcnt vmcnt(9)
    s_add_u32 s16, s16, 143360
    s_add_u32 s19, s19, 143360
    v_mfma_f32_16x16x32_bf16 v[176:179], a[192:195], v[48:51], v[176:179]
    s_add_u32 s24, s24, 4096
    v_add_u32 v224, s16, v1
    v_mfma_f32_16x16x32_bf16 v[176:179], a[196:199], v[52:55], v[176:179]
    v_cvt_pk_bf16_f32 v205, v205, v205
    v_add_u32 v225, s16, v2
    v_mfma_f32_16x16x32_bf16 v[176:179], a[200:203], v[56:59], v[176:179]
    v_add_u32 v226, s19, v1
    v_add_u32 v227, s19, v2
    v_mfma_f32_16x16x32_bf16 v[180:183], a[204:207], v[48:51], v[180:183]
    buffer_load_dwordx4 v[96:99], v1, s[48:51], s24 offen offset:0 sc1
    v_and_b32 v208, 7, v4
    v_mfma_f32_16x16x32_bf16 v[180:183], a[208:211], v[52:55], v[180:183]
    v_cvt_pk_bf16_f32 v204, v204, v12
    v_lshrrev_b32 v209, 4, v4
    v_mfma_f32_16x16x32_bf16 v[180:183], a[212:215], v[56:59], v[180:183]
    v_lshl_add_u32 v208, v209, 3, v208
    v_bfe_u32 v209, v4, 3, 1
    v_mfma_f32_16x16x32_bf16 v[184:187], v[48:51], a[216:219], v[184:187]
    buffer_load_dwordx4 v[100:103], v1, s[48:51], s24 offen offset:1024 sc1
    v_lshlrev_b32 v228, 4, v208
    v_mfma_f32_16x16x32_bf16 v[184:187], v[52:55], a[220:223], v[184:187]
    ds_write_b128 v6, v[192:195] offset:1024
    v_lshl_add_u32 v228, v5, 8, v228
    v_mfma_f32_16x16x32_bf16 v[184:187], v[56:59], a[224:227], v[184:187]
    v_lshl_add_u32 v228, v209, 15, v228
    v_lshl_add_u32 v229, v209, 4, v208
    v_mfma_f32_16x16x32_bf16 v[188:191], a[228:231], v[48:51], v[188:191]
    buffer_load_dwordx4 v[104:107], v1, s[48:51], s24 offen offset:2048 sc1
    v_lshl_add_u32 v229, v5, 5, v229
    v_mfma_f32_16x16x32_bf16 v[188:191], a[232:235], v[52:55], v[188:191]
    ds_write_b32 v7, v204 offset:4
    v_lshlrev_b32 v229, 2, v229
    v_mfma_f32_16x16x32_bf16 v[188:191], a[236:239], v[56:59], v[188:191]
    s_waitcnt vmcnt(9)
    s_lshl_b32 s66, s9, 9
    buffer_load_dwordx4 v[108:111], v1, s[48:51], s24 offen offset:3072 sc1
    v_mfma_f32_16x16x32_bf16 v[176:179], a[240:243], v[60:63], v[176:179]
    s_and_b32 s15, s66, 0xffffe000
    s_add_u32 s66, s66, s15
    s_add_u32 s66, s66, 0x120000
    v_mfma_f32_16x16x32_bf16 v[176:179], a[244:247], v[64:67], v[176:179]
    s_lshl_b32 s68, s9, 8
    s_add_u32 s68, s68, 0x1f8000
    ds_write_b16 v9, v205 offset:1184
    v_mfma_f32_16x16x32_bf16 v[176:179], a[248:251], v[68:71], v[176:179]
    s_add_u32 s24, s24, 12288
    s_and_b32 s69, s10, 15
    s_lshl_b32 s69, s69, 5
    v_mfma_f32_16x16x32_bf16 v[180:183], a[252:255], v[60:63], v[180:183]
    s_add_u32 s69, s69, s9
    v_mfma_f32_16x16x32_bf16 v[180:183], v[16:19], v[64:67], v[180:183]
    s_mul_i32 s69, s69, 128
    s_and_b32 s15, s69, 0xffffe000
    v_mfma_f32_16x16x32_bf16 v[180:183], v[20:23], v[68:71], v[180:183]
    s_add_u32 s69, s69, s15
    buffer_load_dwordx4 v[112:115], v1, s[48:51], s24 offen offset:0 sc1
    v_mfma_f32_16x16x32_bf16 v[184:187], v[60:63], v[24:27], v[184:187]
    s_add_u32 s69, s69, 131072
    s_lshr_b32 s64, s9, 3
    v_mfma_f32_16x16x32_bf16 v[184:187], v[64:67], v[28:31], v[184:187]
    s_lshl_b32 s16, s8, 2
    v_mfma_f32_16x16x32_bf16 v[184:187], v[68:71], v[32:35], v[184:187]
    s_add_u32 s64, s64, s16
    buffer_load_dwordx4 v[116:119], v1, s[48:51], s24 offen offset:1024 sc1
    v_mfma_f32_16x16x32_bf16 v[188:191], v[36:39], v[60:63], v[188:191]
    s_lshr_b32 s16, s36, 2
    s_and_b32 s19, s36, 3
    v_mfma_f32_16x16x32_bf16 v[188:191], v[40:43], v[64:67], v[188:191]
    s_mul_i32 s16, s16, 9
    v_mfma_f32_16x16x32_bf16 v[188:191], v[44:47], v[68:71], v[188:191]
    s_waitcnt vmcnt(9)
    s_mul_i32 s72, s19, 5
    buffer_load_dwordx4 v[120:123], v1, s[48:51], s24 offen offset:2048 sc1
    v_mfma_f32_16x16x32_bf16 v[192:195], a[0:3], v[72:75], 0
    s_lshr_b32 s72, s72, 1
    s_add_u32 s72, s72, s16
    v_mfma_f32_16x16x32_bf16 v[192:195], a[4:7], v[76:79], v[192:195]
    s_lshl_b32 s72, s72, 10
    s_add_u32 s73, s16, 4
    v_mfma_f32_16x16x32_bf16 v[192:195], a[8:11], v[80:83], v[192:195]
    s_lshl_b32 s73, s73, 10
    buffer_load_dwordx4 v[124:127], v1, s[48:51], s24 offen offset:3072 sc1
    v_mfma_f32_16x16x32_bf16 v[196:199], a[12:15], v[72:75], 0
    s_and_b32 s16, s19, 2
    s_lshl_b32 s16, s16, 8
    v_mfma_f32_16x16x32_bf16 v[196:199], a[16:19], v[76:79], v[196:199]
    s_add_u32 s73, s73, s16
    v_mfma_f32_16x16x32_bf16 v[196:199], a[20:23], v[80:83], v[196:199]
    s_add_u32 s24, s24, 4096
    s_mul_i32 s16, s3, 18432
    s_mul_i32 s65, s64, 73728
    v_mfma_f32_16x16x32_bf16 v[200:203], v[72:75], a[24:27], 0
    s_add_u32 s65, s65, s16
    v_mul_f32 v176, v176, v10
    v_mfma_f32_16x16x32_bf16 v[200:203], v[76:79], a[28:31], v[200:203]
    s_lshr_b32 s70, s72, 4
    s_add_u32 s70, s70, s65
    v_mfma_f32_16x16x32_bf16 v[200:203], v[80:83], a[32:35], v[200:203]
    s_add_u32 s26, s70, 64
    buffer_load_dwordx4 v[128:131], v1, s[48:51], s24 offen offset:0 sc1
    v_mul_f32 v177, v177, v10
    v_mfma_f32_16x16x32_bf16 v[204:207], a[36:39], v[72:75], 0
    s_lshr_b32 s71, s73, 4
    v_mfma_f32_16x16x32_bf16 v[204:207], a[40:43], v[76:79], v[204:207]
    s_add_u32 s71, s71, s65
    s_add_u32 s72, s72, s16
    v_mfma_f32_16x16x32_bf16 v[204:207], a[44:47], v[80:83], v[204:207]
    s_waitcnt vmcnt(9)
    buffer_load_dwordx4 v[132:135], v1, s[48:51], s24 offen offset:1024 sc1
    v_mul_f32 v178, v178, v10
    v_mfma_f32_16x16x32_bf16 v[192:195], a[48:51], v[84:87], v[192:195]
    s_add_u32 s73, s73, s16
    s_add_u32 s27, s72, 1024
    s_and_b32 s15, s72, 0xffffe000
    v_mfma_f32_16x16x32_bf16 v[192:195], a[52:55], v[88:91], v[192:195]
    s_add_u32 s72, s72, s15
    v_mfma_f32_16x16x32_bf16 v[192:195], a[56:59], v[92:95], v[192:195]
    s_and_b32 s15, s27, 0xffffe000
    buffer_load_dwordx4 v[136:139], v1, s[48:51], s24 offen offset:2048 sc1
    v_mul_f32 v179, v179, v10
    v_mfma_f32_16x16x32_bf16 v[196:199], a[60:63], v[84:87], v[196:199]
    s_add_u32 s27, s27, s15
    s_and_b32 s15, s73, 0xffffe000
    v_mfma_f32_16x16x32_bf16 v[196:199], a[64:67], v[88:91], v[196:199]
    s_add_u32 s73, s73, s15
    s_add_u32 s77, s19, 1
    v_mfma_f32_16x16x32_bf16 v[196:199], a[68:71], v[92:95], v[196:199]
    s_and_b32 s77, s77, 2
    buffer_load_dwordx4 v[140:143], v1, s[48:51], s24 offen offset:3072 sc1
    v_mul_f32 v180, v180, v10
    v_mfma_f32_16x16x32_bf16 v[200:203], v[84:87], a[72:75], v[200:203]
    v_and_b32 v208, 15, v0
    v_lshlrev_b32 v236, 3, v208
    v_mfma_f32_16x16x32_bf16 v[200:203], v[88:91], a[76:79], v[200:203]
    v_mul_f32 v181, v181, v10
    v_lshlrev_b32 v230, 4, v208
    v_mfma_f32_16x16x32_bf16 v[200:203], v[92:95], a[80:83], v[200:203]
    v_lshl_add_u32 v230, v5, 8, v230
    v_mfma_f32_16x16x32_bf16 v[204:207], a[84:87], v[84:87], v[204:207]
    v_bfe_u32 v209, v0, 4, 1
    v_lshl_add_u32 v231, v209, 3, v230
    v_mfma_f32_16x16x32_bf16 v[204:207], a[88:91], v[88:91], v[204:207]
    v_mul_f32 v182, v182, v10
    v_lshl_add_u32 v230, v209, 30, v230
    v_mfma_f32_16x16x32_bf16 v[204:207], a[92:95], v[92:95], v[204:207]
    s_waitcnt vmcnt(9)
    v_mul_u32_u24 v232, 128, v4
    v_lshrrev_b32 v209, 4, v0
    v_mfma_f32_16x16x32_bf16 v[192:195], a[96:99], v[96:99], v[192:195]
    buffer_load_dword v246, v247, s[88:91], s44 offen sc1
    v_lshlrev_b32 v233, 10, v209
    v_mfma_f32_16x16x32_bf16 v[192:195], a[100:103], v[100:103], v[192:195]
    v_mul_f32 v183, v183, v10
    v_lshl_add_u32 v236, v209, 29, v236
    v_mfma_f32_16x16x32_bf16 v[192:195], a[104:107], v[104:107], v[192:195]
    v_mul_u32_u24 v165, 1152, v208
    v_lshl_add_u32 v164, v209, 4, v165
    v_mfma_f32_16x16x32_bf16 v[196:199], a[108:111], v[96:99], v[196:199]
    v_lshl_add_u32 v165, v209, 3, v165
    v_cmp_eq_u32 vcc, s13, 0
    v_mfma_f32_16x16x32_bf16 v[196:199], a[112:115], v[100:103], v[196:199]
    v_cvt_pk_bf16_f32 v176, v176, v177
    v_cndmask_b32 v164, v1, v164, vcc
    v_mfma_f32_16x16x32_bf16 v[196:199], a[116:119], v[104:107], v[196:199]
    v_cndmask_b32 v231, v231, v165, vcc
    v_lshl_add_u32 v233, v208, 2, v233
    v_mfma_f32_16x16x32_bf16 v[200:203], v[96:99], a[120:123], v[200:203]
    v_cvt_pk_bf16_f32 v177, v178, v179
    v_add_u32 v234, 49152, v1
    v_mfma_f32_16x16x32_bf16 v[200:203], v[100:103], a[124:127], v[200:203]
    v_add_u32 v235, 81920, v1
    v_mfma_f32_16x16x32_bf16 v[200:203], v[104:107], a[128:131], v[200:203]
    s_and_b32 s16, s64, 15
    s_mul_i32 s74, s16, 4096
    v_mfma_f32_16x16x32_bf16 v[204:207], a[132:135], v[96:99], v[204:207]
    s_and_b32 s15, s74, 0xffffe000
    v_cvt_pk_bf16_f32 v178, v180, v181
    v_mfma_f32_16x16x32_bf16 v[204:207], a[136:139], v[100:103], v[204:207]
    s_add_u32 s74, s74, s15
    s_add_u32 s74, s74, 131072
    v_mfma_f32_16x16x32_bf16 v[204:207], a[140:143], v[104:107], v[204:207]
    s_waitcnt vmcnt(7)
    s_lshl_b32 s79, s16, 3
    v_mfma_f32_16x16x32_bf16 v[192:195], a[144:147], v[108:111], v[192:195]
    s_add_u32 s79, s79, s36
    s_mul_i32 s79, s79, 128
    v_cvt_pk_bf16_f32 v179, v182, v183
    v_mfma_f32_16x16x32_bf16 v[192:195], a[148:151], v[112:115], v[192:195]
    s_and_b32 s15, s79, 0xffffe000
    v_mfma_f32_16x16x32_bf16 v[192:195], a[152:155], v[116:119], v[192:195]
    s_add_u32 s79, s79, s15
    s_add_u32 s79, s79, 589824
    v_mfma_f32_16x16x32_bf16 v[196:199], a[156:159], v[108:111], v[196:199]
    s_and_b32 s80, s10, 15
    v_cvt_pk_bf16_f32 v162, v184, v185
    v_mfma_f32_16x16x32_bf16 v[196:199], a[160:163], v[112:115], v[196:199]
    s_mul_i32 s80, s80, 1024
    s_and_b32 s15, s80, 0xffffe000
    v_mfma_f32_16x16x32_bf16 v[196:199], a[164:167], v[116:119], v[196:199]
    s_add_u32 s80, s80, s15
    v_cvt_pk_bf16_f32 v163, v186, v187
    v_mfma_f32_16x16x32_bf16 v[200:203], v[108:111], a[168:171], v[200:203]
    s_add_u32 s80, s80, 589824
    s_lshl_b32 s75, s3, 15
    v_mfma_f32_16x16x32_bf16 v[200:203], v[112:115], a[172:175], v[200:203]
    s_add_u32 s75, s75, 0x120000
    v_mfma_f32_16x16x32_bf16 v[200:203], v[116:119], a[176:179], v[200:203]
    s_lshl_b32 s76, s3, 6
    v_mul_f32 v188, v188, v11
    v_mfma_f32_16x16x32_bf16 v[204:207], a[180:183], v[108:111], v[204:207]
    s_add_u32 s76, s76, 0x1f8000
    s_lshl_b32 s78, s36, 9
    v_mfma_f32_16x16x32_bf16 v[204:207], a[184:187], v[112:115], v[204:207]
    s_lshl_b32 s16, s3, 7
    v_mfma_f32_16x16x32_bf16 v[204:207], a[188:191], v[116:119], v[204:207]
    s_waitcnt vmcnt(4)
    s_add_u32 s78, s78, s16
    v_cvt_pk_bf16_f32 v189, v189, v189
    v_mfma_f32_16x16x32_bf16 v[192:195], a[192:195], v[120:123], v[192:195]
    s_add_u32 s78, s78, 0x1fc000
    v_mov_b32 v145, 0
    v_mfma_f32_16x16x32_bf16 v[192:195], a[196:199], v[124:127], v[192:195]
    v_mov_b32 v146, 0
    v_mov_b32 v149, 0
    v_mfma_f32_16x16x32_bf16 v[192:195], a[200:203], v[128:131], v[192:195]
    v_cvt_pk_bf16_f32 v188, v188, v12
    v_mov_b32 v150, 0
    v_mfma_f32_16x16x32_bf16 v[196:199], a[204:207], v[120:123], v[196:199]
    v_mov_b32 v153, 0
    v_mov_b32 v154, 0
    v_mfma_f32_16x16x32_bf16 v[196:199], a[208:211], v[124:127], v[196:199]
    ds_write_b128 v6, v[176:179] offset:128
    v_mov_b32 v157, 0
    v_mfma_f32_16x16x32_bf16 v[196:199], a[212:215], v[128:131], v[196:199]
    v_mov_b32 v158, 0
    v_cmp_gt_u32 vcc, 56, v0
    v_mfma_f32_16x16x32_bf16 v[200:203], v[120:123], a[216:219], v[200:203]
    v_mov_b32 v209, 1073741824
    v_mfma_f32_16x16x32_bf16 v[200:203], v[124:127], a[220:223], v[200:203]
    ds_write_b128 v8, v[160:163] offset:0
    v_cndmask_b32 v217, v209, v1, vcc
    v_mfma_f32_16x16x32_bf16 v[200:203], v[128:131], a[224:227], v[200:203]
    ds_write_b128 v218, v[248:251] offset:576
    v_mfma_f32_16x16x32_bf16 v[204:207], a[228:231], v[120:123], v[204:207]
    v_mfma_f32_16x16x32_bf16 v[204:207], a[232:235], v[124:127], v[204:207]
    ds_write_b32 v7, v188 offset:64
    v_mfma_f32_16x16x32_bf16 v[204:207], a[236:239], v[128:131], v[204:207]
    s_waitcnt vmcnt(1)
    v_mfma_f32_16x16x32_bf16 v[192:195], a[240:243], v[132:135], v[192:195]
    v_mfma_f32_16x16x32_bf16 v[192:195], a[244:247], v[136:139], v[192:195]
    ds_write_b16 v9, v189 offset:8
    v_mfma_f32_16x16x32_bf16 v[192:195], a[248:251], v[140:143], v[192:195]
    s_waitcnt vmcnt(0)
    v_cmp_gt_u32 vcc, s84, v246
    v_mfma_f32_16x16x32_bf16 v[196:199], a[252:255], v[132:135], v[196:199]
    v_mfma_f32_16x16x32_bf16 v[196:199], v[16:19], v[136:139], v[196:199]
    s_cbranch_vccnz spin4
back4:
    v_mfma_f32_16x16x32_bf16 v[196:199], v[20:23], v[140:143], v[196:199]
    v_mfma_f32_16x16x32_bf16 v[200:203], v[132:135], v[24:27], v[200:203]
    v_mov_b32 v247, v164
    v_mfma_f32_16x16x32_bf16 v[200:203], v[136:139], v[28:31], v[200:203]
    v_mfma_f32_16x16x32_bf16 v[200:203], v[140:143], v[32:35], v[200:203]
    s_add_u32 m0, s34, 16384
    v_mfma_f32_16x16x32_bf16 v[204:207], v[36:39], v[132:135], v[204:207]
    v_mfma_f32_16x16x32_bf16 v[204:207], v[40:43], v[136:139], v[204:207]
    buffer_store_dword v242, v219, s[88:91], s92 offen sc1
    v_mfma_f32_16x16x32_bf16 v[204:207], v[44:47], v[140:143], v[204:207]
    v_pk_mul_f32 v[192:193], v[192:193], v[10:11] op_sel_hi:[1,0]
    v_pk_mul_f32 v[194:195], v[194:195], v[10:11] op_sel_hi:[1,0]
    v_pk_mul_f32 v[196:197], v[196:197], v[10:11] op_sel_hi:[1,0]
    v_pk_mul_f32 v[198:199], v[198:199], v[10:11] op_sel_hi:[1,0]
    v_cvt_pk_bf16_f32 v192, v192, v193
    v_cvt_pk_bf16_f32 v193, v194, v195
    v_cvt_pk_bf16_f32 v194, v196, v197
    v_cvt_pk_bf16_f32 v195, v198, v199
    v_cvt_pk_bf16_f32 v254, v200, v201
    v_cvt_pk_bf16_f32 v255, v202, v203
    v_mul_f32 v204, v204, v11
    v_cvt_pk_bf16_f32 v205, v205, v205
    v_cvt_pk_bf16_f32 v204, v204, v12
    ds_write_b128 v6, v[192:195] offset:1152
    ds_write_b128 v8, v[252:255] offset:1184
    ds_write_b32 v7, v204 offset:68
    ds_write_b16 v9, v205 offset:1192
    ds_read_b128 v[96:99], v13 offset:0
    ds_read_b128 v[100:103], v13 offset:1024
    ds_read_b128 v[104:107], v13 offset:2048
    ds_read_b128 v[108:111], v13 offset:3072
    ds_read_b128 v[112:115], v13 offset:4096
    s_waitcnt lgkmcnt(5)
    s_barrier
    ds_read_b128 v[168:171], v216 offset:512
    ds_read_b128 v[136:139], v211 offset:5504
    ds_read_b128 v[140:143], v211 offset:6528
    ds_read_b128 v[128:131], v13 offset:5504
    ds_read_b128 v[132:135], v13 offset:6528
    ds_read_b128 a[152:155], v213 offset:512
    ds_read_b64 v[160:161], v210 offset:4992
    ds_read_b64 v[162:163], v212 offset:4992
    ds_read_b64 a[160:161], v214
    s_waitcnt lgkmcnt(13)
    buffer_store_dwordx4 v[96:99], v1, s[48:51], s23 offen offset:0 sc1
    s_waitcnt lgkmcnt(12)
    buffer_store_dwordx4 v[100:103], v1, s[48:51], s23 offen offset:1024 sc1
    s_waitcnt lgkmcnt(11)
    buffer_store_dwordx4 v[104:107], v1, s[48:51], s23 offen offset:2048 sc1
    s_waitcnt lgkmcnt(10)
    buffer_store_dwordx4 v[108:111], v1, s[48:51], s23 offen offset:3072 sc1
    s_waitcnt lgkmcnt(9)
    buffer_store_dwordx4 v[112:115], v217, s[48:51], s21 offen offset:0 sc1
    s_waitcnt lgkmcnt(7)
    v_mfma_f32_32x32x16_bf16 v[48:63], v[168:171], v[136:139], 0
    ds_read_b128 a[192:195], v215 offset:0
    ds_read_b128 a[196:199], v215 offset:592
    s_waitcnt lgkmcnt(8)
    v_mfma_f32_32x32x16_bf16 v[64:79], v[168:171], v[140:143], 0
    ds_read_b128 a[156:159], v213 offset:1536
    ds_read_b128 a[200:203], v215 offset:1184
    s_waitcnt lgkmcnt(9)
    v_mfma_f32_32x32x16_bf16 v[16:31], v[168:171], v[128:131], 0
    ds_read_b128 a[204:207], v215 offset:1776
    ds_read_b64 a[170:171], v214 offset:7552
    s_waitcnt lgkmcnt(10)
    v_mfma_f32_32x32x16_bf16 v[32:47], v[168:171], v[132:135], 0
    ds_read_b128 a[162:165], v213 offset:8064
    ds_read_b128 a[166:169], v213 offset:9088
    s_waitcnt lgkmcnt(11)
    v_mfma_f32_32x32x16_bf16 v[80:95], a[152:155], v[136:139], 0
    ds_read_b128 a[208:211], v215 offset:7552
    ds_read_b128 a[212:215], v215 offset:8144
    ds_read_b128 a[216:219], v215 offset:8736
    ds_read_b128 a[220:223], v215 offset:9328
    v_max3_f32 v48, v48, v49, v50
    v_max3_f32 v48, v48, v51, v52
    s_waitcnt lgkmcnt(13)
    v_perm_b32 v152, v48, v162, s29
    v_perm_b32 v155, v48, v162, s29
    s_nop 0
    s_waitcnt lgkmcnt(12)
    v_mfma_f32_32x32x8_bf16 v[80:95], a[160:161], v[152:153], v[80:95]
    v_max3_f32 v64, v64, v65, v66
    v_max3_f32 v64, v64, v67, v68
    v_perm_b32 v156, v64, v163, s29
    v_perm_b32 v159, v64, v163, s29
    v_max3_f32 v16, v16, v17, v18
    v_max3_f32 v16, v16, v19, v20
    v_perm_b32 v144, v16, v160, s29
    v_perm_b32 v147, v16, v160, s29
    v_max3_f32 v32, v32, v33, v34
    v_max3_f32 v32, v32, v35, v36
    v_perm_b32 v148, v32, v161, s29
    v_perm_b32 v151, v32, v161, s29
    v_mfma_f32_32x32x16_bf16 v[96:111], a[152:155], v[140:143], 0
    s_and_b32 s21, s10, 15
    v_exp_f32 v80, v80
    v_exp_f32 v81, v81
    v_exp_f32 v82, v82
    v_exp_f32 v83, v83
    v_cvt_pk_bf16_f32 v112, v80, v81
    v_mfma_f32_32x32x8_bf16 v[96:111], a[160:161], v[156:157], v[96:111]
    v_exp_f32 v84, v84
    v_exp_f32 v85, v85
    v_exp_f32 v86, v86
    v_cvt_pk_bf16_f32 v113, v82, v83
    v_exp_f32 v87, v87
    v_cvt_pk_bf16_f32 v114, v84, v85
    s_lshl_b32 s16, s21, 21
    v_exp_f32 v88, v88
    v_exp_f32 v89, v89
    v_exp_f32 v90, v90
    v_cvt_pk_bf16_f32 v115, v86, v87
    v_exp_f32 v91, v91
    v_cvt_pk_bf16_f32 v116, v88, v89
    s_add_u32 s66, s66, s16
    v_exp_f32 v92, v92
    v_exp_f32 v93, v93
    v_exp_f32 v94, v94
    v_cvt_pk_bf16_f32 v117, v90, v91
    v_exp_f32 v95, v95
    v_cvt_pk_bf16_f32 v118, v92, v93
    v_cvt_pk_bf16_f32 v119, v94, v95
    v_mfma_f32_32x32x16_bf16 v[80:95], a[152:155], v[128:131], 0
    s_waitcnt lgkmcnt(0)
    v_exp_f32 v96, v96
    v_exp_f32 v97, v97
    v_exp_f32 v98, v98
    v_exp_f32 v99, v99
    v_cvt_pk_bf16_f32 v120, v96, v97
    v_mfma_f32_32x32x8_bf16 v[80:95], a[160:161], v[144:145], v[80:95]
    v_exp_f32 v100, v100
    v_exp_f32 v101, v101
    v_exp_f32 v102, v102
    v_cvt_pk_bf16_f32 v121, v98, v99
    v_exp_f32 v103, v103
    v_cvt_pk_bf16_f32 v122, v100, v101
    v_mfma_f32_32x32x16_bf16 v[48:63], a[192:195], v[112:115], 0
    s_barrier
    v_exp_f32 v104, v104
    v_exp_f32 v105, v105
    v_exp_f32 v106, v106
    v_cvt_pk_bf16_f32 v123, v102, v103
    v_exp_f32 v107, v107
    v_cvt_pk_bf16_f32 v124, v104, v105
    v_mfma_f32_32x32x16_bf16 v[48:63], a[196:199], v[116:119], v[48:63]
    v_exp_f32 v108, v108
    v_exp_f32 v109, v109
    v_exp_f32 v110, v110
    v_cvt_pk_bf16_f32 v125, v106, v107
    v_exp_f32 v111, v111
    v_cvt_pk_bf16_f32 v126, v108, v109
    v_cvt_pk_bf16_f32 v127, v110, v111
    v_mfma_f32_32x32x16_bf16 v[96:111], a[152:155], v[132:135], 0
    s_add_u32 s68, s68, s16
    v_exp_f32 v80, v80
    v_exp_f32 v81, v81
    v_exp_f32 v82, v82
    v_exp_f32 v83, v83
    v_cvt_pk_bf16_f32 v112, v80, v81
    v_mfma_f32_32x32x8_bf16 v[96:111], a[160:161], v[148:149], v[96:111]
    v_exp_f32 v84, v84
    v_exp_f32 v85, v85
    v_exp_f32 v86, v86
    v_cvt_pk_bf16_f32 v113, v82, v83
    v_exp_f32 v87, v87
    v_cvt_pk_bf16_f32 v114, v84, v85
    v_mfma_f32_32x32x16_bf16 v[64:79], a[192:195], v[120:123], 0
    s_and_b32 s22, s64, 15
    v_exp_f32 v88, v88
    v_exp_f32 v89, v89
    v_exp_f32 v90, v90
    v_cvt_pk_bf16_f32 v115, v86, v87
    v_exp_f32 v91, v91
    v_cvt_pk_bf16_f32 v116, v88, v89
    v_mfma_f32_32x32x16_bf16 v[64:79], a[196:199], v[124:127], v[64:79]
    s_lshl_b32 s16, s22, 21
    v_exp_f32 v92, v92
    v_exp_f32 v93, v93
    v_exp_f32 v94, v94
    v_cvt_pk_bf16_f32 v117, v90, v91
    v_exp_f32 v95, v95
    v_cvt_pk_bf16_f32 v118, v92, v93
    v_cvt_pk_bf16_f32 v119, v94, v95
    v_mfma_f32_32x32x16_bf16 v[80:95], a[156:159], v[136:139], 0
    s_add_u32 s75, s75, s16
    v_exp_f32 v96, v96
    v_exp_f32 v97, v97
    v_exp_f32 v98, v98
    v_exp_f32 v99, v99
    v_cvt_pk_bf16_f32 v120, v96, v97
    v_mfma_f32_32x32x8_bf16 v[80:95], a[160:161], v[154:155], v[80:95]
    v_exp_f32 v100, v100
    v_exp_f32 v101, v101
    v_exp_f32 v102, v102
    v_cvt_pk_bf16_f32 v121, v98, v99
    v_exp_f32 v103, v103
    v_cvt_pk_bf16_f32 v122, v100, v101
    v_mfma_f32_32x32x16_bf16 v[16:31], a[192:195], v[112:115], 0
    s_add_u32 s76, s76, s16
    v_exp_f32 v104, v104
    v_exp_f32 v105, v105
    v_exp_f32 v106, v106
    v_cvt_pk_bf16_f32 v123, v102, v103
    v_exp_f32 v107, v107
    v_cvt_pk_bf16_f32 v124, v104, v105
    v_mfma_f32_32x32x16_bf16 v[16:31], a[196:199], v[116:119], v[16:31]
    s_add_u32 s78, s78, s16
    v_exp_f32 v108, v108
    v_exp_f32 v109, v109
    v_exp_f32 v110, v110
    v_cvt_pk_bf16_f32 v125, v106, v107
    v_exp_f32 v111, v111
    v_cvt_pk_bf16_f32 v126, v108, v109
    v_cvt_pk_bf16_f32 v127, v110, v111
    v_mfma_f32_32x32x16_bf16 v[96:111], a[156:159], v[140:143], 0
    s_waitcnt vmcnt(0)
    v_exp_f32 v80, v80
    v_exp_f32 v81, v81
    v_exp_f32 v82, v82
    v_exp_f32 v83, v83
    v_cvt_pk_bf16_f32 v112, v80, v81
    v_mfma_f32_32x32x8_bf16 v[96:111], a[160:161], v[158:159], v[96:111]
    v_exp_f32 v84, v84
    v_exp_f32 v85, v85
    v_exp_f32 v86, v86
    v_cvt_pk_bf16_f32 v113, v82, v83
    v_exp_f32 v87, v87
    v_cvt_pk_bf16_f32 v114, v84, v85
    v_mfma_f32_32x32x16_bf16 v[32:47], a[192:195], v[120:123], 0
    buffer_store_dword v242, v219, s[88:91], s40 offen sc1
    v_exp_f32 v88, v88
    v_exp_f32 v89, v89
    v_exp_f32 v90, v90
    v_cvt_pk_bf16_f32 v115, v86, v87
    v_exp_f32 v91, v91
    v_cvt_pk_bf16_f32 v116, v88, v89
    v_mfma_f32_32x32x16_bf16 v[32:47], a[196:199], v[124:127], v[32:47]
    v_exp_f32 v92, v92
    v_exp_f32 v93, v93
    v_exp_f32 v94, v94
    v_cvt_pk_bf16_f32 v117, v90, v91
    v_exp_f32 v95, v95
    v_cvt_pk_bf16_f32 v118, v92, v93
    v_cvt_pk_bf16_f32 v119, v94, v95
    v_mfma_f32_32x32x16_bf16 v[80:95], a[156:159], v[128:131], 0
    s_add_u32 s17, s16, 0x1d4000
    v_exp_f32 v96, v96
    v_exp_f32 v97, v97
    v_exp_f32 v98, v98
    v_exp_f32 v99, v99
    v_cvt_pk_bf16_f32 v120, v96, v97
    v_mfma_f32_32x32x8_bf16 v[80:95], a[160:161], v[146:147], v[80:95]
    v_exp_f32 v100, v100
    v_exp_f32 v101, v101
    v_exp_f32 v102, v102
    v_cvt_pk_bf16_f32 v121, v98, v99
    v_exp_f32 v103, v103
    v_cvt_pk_bf16_f32 v122, v100, v101
    v_mfma_f32_32x32x16_bf16 v[48:63], a[200:203], v[112:115], v[48:63]
    s_add_u32 s18, s72, s17
    v_exp_f32 v104, v104
    v_exp_f32 v105, v105
    v_exp_f32 v106, v106
    v_cvt_pk_bf16_f32 v123, v102, v103
    v_exp_f32 v107, v107
    v_cvt_pk_bf16_f32 v124, v104, v105
    v_mfma_f32_32x32x16_bf16 v[48:63], a[204:207], v[116:119], v[48:63]
    s_add_u32 s19, s27, s17
    v_exp_f32 v108, v108
    v_exp_f32 v109, v109
    v_exp_f32 v110, v110
    v_cvt_pk_bf16_f32 v125, v106, v107
    v_exp_f32 v111, v111
    v_cvt_pk_bf16_f32 v126, v108, v109
    v_cvt_pk_bf16_f32 v127, v110, v111
    v_mfma_f32_32x32x16_bf16 v[96:111], a[156:159], v[132:135], 0
    v_exp_f32 v80, v80
    v_exp_f32 v81, v81
    v_exp_f32 v82, v82
    v_exp_f32 v83, v83
    v_cvt_pk_bf16_f32 v112, v80, v81
    v_mfma_f32_32x32x8_bf16 v[96:111], a[160:161], v[150:151], v[96:111]
    v_exp_f32 v84, v84
    v_exp_f32 v85, v85
    v_exp_f32 v86, v86
    v_cvt_pk_bf16_f32 v113, v82, v83
    v_exp_f32 v87, v87
    v_cvt_pk_bf16_f32 v114, v84, v85
    v_mfma_f32_32x32x16_bf16 v[64:79], a[200:203], v[120:123], v[64:79]
    s_cmp_eq_u32 s85, 4
    v_exp_f32 v88, v88
    v_exp_f32 v89, v89
    v_exp_f32 v90, v90
    v_cvt_pk_bf16_f32 v115, v86, v87
    v_exp_f32 v91, v91
    v_cvt_pk_bf16_f32 v116, v88, v89
    v_mfma_f32_32x32x16_bf16 v[64:79], a[204:207], v[124:127], v[64:79]
    s_cbranch_scc1 pack_probe
hook6:
    v_exp_f32 v92, v92
    v_exp_f32 v93, v93
    v_exp_f32 v94, v94
    v_cvt_pk_bf16_f32 v117, v90, v91
    v_exp_f32 v95, v95
    v_cvt_pk_bf16_f32 v118, v92, v93
    v_cvt_pk_bf16_f32 v119, v94, v95
    v_mfma_f32_32x32x16_bf16 v[80:95], a[162:165], v[136:139], 0
    s_add_u32 s17, s73, s17
    v_exp_f32 v96, v96
    v_exp_f32 v97, v97
    v_exp_f32 v98, v98
    v_exp_f32 v99, v99
    v_cvt_pk_bf16_f32 v120, v96, v97
    v_mfma_f32_32x32x8_bf16 v[80:95], a[170:171], v[152:153], v[80:95]
    v_exp_f32 v100, v100
    v_exp_f32 v101, v101
    v_exp_f32 v102, v102
    v_cvt_pk_bf16_f32 v121, v98, v99
    v_exp_f32 v103, v103
    v_cvt_pk_bf16_f32 v122, v100, v101
    v_mfma_f32_32x32x16_bf16 v[16:31], a[200:203], v[112:115], v[16:31]
    s_cmp_lg_u32 s13, 0
    s_cmov_b32 s70, s18
    s_cmov_b32 s26, s19
    s_cmov_b32 s71, s17
    v_exp_f32 v104, v104
    v_exp_f32 v105, v105
    v_exp_f32 v106, v106
    v_cvt_pk_bf16_f32 v123, v102, v103
    v_exp_f32 v107, v107
    v_cvt_pk_bf16_f32 v124, v104, v105
    v_mfma_f32_32x32x16_bf16 v[16:31], a[204:207], v[116:119], v[16:31]
    s_add_u32 s16, s16, 0x1b0000
    v_exp_f32 v108, v108
    v_exp_f32 v109, v109
    v_exp_f32 v110, v110
    v_cvt_pk_bf16_f32 v125, v106, v107
    v_exp_f32 v111, v111
    v_cvt_pk_bf16_f32 v126, v108, v109
    v_cvt_pk_bf16_f32 v127, v110, v111
    v_mfma_f32_32x32x16_bf16 v[96:111], a[162:165], v[140:143], 0
    buffer_load_dword v8, v175, s[88:91], s41 offen sc1
    v_exp_f32 v80, v80
    v_exp_f32 v81, v81
    v_exp_f32 v82, v82
    v_exp_f32 v83, v83
    v_cvt_pk_bf16_f32 v112, v80, v81
    v_mfma_f32_32x32x8_bf16 v[96:111], a[170:171], v[156:157], v[96:111]
    v_exp_f32 v84, v84
    v_exp_f32 v85, v85
    v_exp_f32 v86, v86
    v_cvt_pk_bf16_f32 v113, v82, v83
    v_exp_f32 v87, v87
    v_cvt_pk_bf16_f32 v114, v84, v85
    v_mfma_f32_32x32x16_bf16 v[32:47], a[200:203], v[120:123], v[32:47]
    v_exp_f32 v88, v88
    v_exp_f32 v89, v89
    v_exp_f32 v90, v90
    v_cvt_pk_bf16_f32 v115, v86, v87
    v_exp_f32 v91, v91
    v_cvt_pk_bf16_f32 v116, v88, v89
    v_mfma_f32_32x32x16_bf16 v[32:47], a[204:207], v[124:127], v[32:47]
    v_exp_f32 v92, v92
    v_exp_f32 v93, v93
    v_exp_f32 v94, v94
    v_cvt_pk_bf16_f32 v117, v90, v91
    v_exp_f32 v95, v95
    v_cvt_pk_bf16_f32 v118, v92, v93
    v_cvt_pk_bf16_f32 v119, v94, v95
    v_mfma_f32_32x32x16_bf16 v[80:95], a[162:165], v[128:131], 0
    s_add_u32 s72, s72, s16
    v_exp_f32 v96, v96
    v_exp_f32 v97, v97
    v_exp_f32 v98, v98
    v_exp_f32 v99, v99
    v_cvt_pk_bf16_f32 v120, v96, v97
    v_mfma_f32_32x32x8_bf16 v[80:95], a[170:171], v[144:145], v[80:95]
    v_exp_f32 v100, v100
    v_exp_f32 v101, v101
    v_exp_f32 v102, v102
    v_cvt_pk_bf16_f32 v121, v98, v99
    v_exp_f32 v103, v103
    v_cvt_pk_bf16_f32 v122, v100, v101
    v_mfma_f32_32x32x16_bf16 v[48:63], a[208:211], v[112:115], v[48:63]
    s_add_u32 s27, s27, s16
    v_exp_f32 v104, v104
    v_exp_f32 v105, v105
    v_exp_f32 v106, v106
    v_cvt_pk_bf16_f32 v123, v102, v103
    v_exp_f32 v107, v107
    v_cvt_pk_bf16_f32 v124, v104, v105
    v_mfma_f32_32x32x16_bf16 v[48:63], a[212:215], v[116:119], v[48:63]
    s_add_u32 s73, s73, s16
    v_exp_f32 v108, v108
    v_exp_f32 v109, v109
    v_exp_f32 v110, v110
    v_cvt_pk_bf16_f32 v125, v106, v107
    v_exp_f32 v111, v111
    v_cvt_pk_bf16_f32 v126, v108, v109
    v_cvt_pk_bf16_f32 v127, v110, v111
    v_mfma_f32_32x32x16_bf16 v[96:111], a[162:165], v[132:135], 0
    s_add_u32 s30, s30, 16384
    v_exp_f32 v80, v80
    v_exp_f32 v81, v81
    v_exp_f32 v82, v82
    v_exp_f32 v83, v83
    v_cvt_pk_bf16_f32 v112, v80, v81
    v_mfma_f32_32x32x8_bf16 v[96:111], a[170:171], v[148:149], v[96:111]
    v_exp_f32 v84, v84
    v_exp_f32 v85, v85
    v_exp_f32 v86, v86
    v_cvt_pk_bf16_f32 v113, v82, v83
    v_exp_f32 v87, v87
    v_cvt_pk_bf16_f32 v114, v84, v85
    v_mfma_f32_32x32x16_bf16 v[64:79], a[208:211], v[120:123], v[64:79]
    s_xor_b32 s28, s30, s31
    v_exp_f32 v88, v88
    v_exp_f32 v89, v89
    v_exp_f32 v90, v90
    v_cvt_pk_bf16_f32 v115, v86, v87
    v_exp_f32 v91, v91
    v_cvt_pk_bf16_f32 v116, v88, v89
    v_mfma_f32_32x32x16_bf16 v[64:79], a[212:215], v[124:127], v[64:79]
    s_waitcnt vmcnt(0)
    v_cmp_gt_u32 vcc, 1, v8
    v_exp_f32 v92, v92
    v_exp_f32 v93, v93
    v_exp_f32 v94, v94
    v_cvt_pk_bf16_f32 v117, v90, v91
    v_exp_f32 v95, v95
    v_cvt_pk_bf16_f32 v118, v92, v93
    v_cvt_pk_bf16_f32 v119, v94, v95
    v_mfma_f32_32x32x16_bf16 v[80:95], a[166:169], v[136:139], 0
    s_cbranch_vccnz spin5
back5:
    v_exp_f32 v96, v96
    v_exp_f32 v97, v97
    v_exp_f32 v98, v98
    v_exp_f32 v99, v99
    v_cvt_pk_bf16_f32 v120, v96, v97
    v_mfma_f32_32x32x8_bf16 v[80:95], a[170:171], v[154:155], v[80:95]
    v_exp_f32 v100, v100
    v_exp_f32 v101, v101
    v_exp_f32 v102, v102
    v_cvt_pk_bf16_f32 v121, v98, v99
    v_exp_f32 v103, v103
    v_cvt_pk_bf16_f32 v122, v100, v101
    v_mfma_f32_32x32x16_bf16 v[16:31], a[208:211], v[112:115], v[16:31]
    buffer_load_dwordx2 a[180:181], v2, s[52:55], s28 offen
    buffer_load_dwordx4 a[172:175], v1, s[52:55], s28 offen offset:512
    buffer_load_dwordx4 a[176:179], v1, s[52:55], s28 offen offset:1536
    buffer_load_dwordx4 a[224:227], v3, s[52:55], s28 offen offset:0
    buffer_load_dwordx4 a[228:231], v3, s[52:55], s28 offen offset:592
    buffer_load_dwordx4 a[232:235], v3, s[52:55], s28 offen offset:1184
    buffer_load_dwordx4 a[236:239], v3, s[52:55], s28 offen offset:1776
    buffer_load_dword v9, v167, s[88:91], s41 offen sc1
    v_exp_f32 v104, v104
    v_exp_f32 v105, v105
    v_exp_f32 v106, v106
    v_cvt_pk_bf16_f32 v123, v102, v103
    v_exp_f32 v107, v107
    v_cvt_pk_bf16_f32 v124, v104, v105
    v_mfma_f32_32x32x16_bf16 v[16:31], a[212:215], v[116:119], v[16:31]
    v_exp_f32 v108, v108
    v_exp_f32 v109, v109
    v_exp_f32 v110, v110
    v_cvt_pk_bf16_f32 v125, v106, v107
    v_exp_f32 v111, v111
    v_cvt_pk_bf16_f32 v126, v108, v109
    v_cvt_pk_bf16_f32 v127, v110, v111
    v_mfma_f32_32x32x16_bf16 v[96:111], a[166:169], v[140:143], 0
    s_bitcmp1_b32 s8, 2
    v_exp_f32 v80, v80
    v_exp_f32 v81, v81
    v_exp_f32 v82, v82
    v_exp_f32 v83, v83
    v_cvt_pk_bf16_f32 v112, v80, v81
    v_mfma_f32_32x32x8_bf16 v[96:111], a[170:171], v[158:159], v[96:111]
    v_exp_f32 v84, v84
    v_exp_f32 v85, v85
    v_exp_f32 v86, v86
    v_cvt_pk_bf16_f32 v113, v82, v83
    v_exp_f32 v87, v87
    v_cvt_pk_bf16_f32 v114, v84, v85
    v_mfma_f32_32x32x16_bf16 v[32:47], a[208:211], v[120:123], v[32:47]
    s_cselect_b32 s23, -1, 0
    v_exp_f32 v88, v88
    v_exp_f32 v89, v89
    v_exp_f32 v90, v90
    v_cvt_pk_bf16_f32 v115, v86, v87
    v_exp_f32 v91, v91
    v_cvt_pk_bf16_f32 v116, v88, v89
    v_mfma_f32_32x32x16_bf16 v[32:47], a[212:215], v[124:127], v[32:47]
    v_exp_f32 v92, v92
    v_exp_f32 v93, v93
    v_exp_f32 v94, v94
    v_cvt_pk_bf16_f32 v117, v90, v91
    v_exp_f32 v95, v95
    v_cvt_pk_bf16_f32 v118, v92, v93
    v_cvt_pk_bf16_f32 v119, v94, v95
    v_mfma_f32_32x32x16_bf16 v[80:95], a[166:169], v[128:131], 0
    v_exp_f32 v96, v96
    v_exp_f32 v97, v97
    v_exp_f32 v98, v98
    v_exp_f32 v99, v99
    v_cvt_pk_bf16_f32 v120, v96, v97
    v_mfma_f32_32x32x8_bf16 v[80:95], a[170:171], v[146:147], v[80:95]
    v_exp_f32 v100, v100
    v_exp_f32 v101, v101
    v_exp_f32 v102, v102
    v_cvt_pk_bf16_f32 v121, v98, v99
    v_exp_f32 v103, v103
    v_cvt_pk_bf16_f32 v122, v100, v101
    v_mfma_f32_32x32x16_bf16 v[48:63], a[216:219], v[112:115], v[48:63]
    v_exp_f32 v104, v104
    v_exp_f32 v105, v105
    v_exp_f32 v106, v106
    v_cvt_pk_bf16_f32 v123, v102, v103
    v_exp_f32 v107, v107
    v_cvt_pk_bf16_f32 v124, v104, v105
    v_mfma_f32_32x32x16_bf16 v[48:63], a[220:223], v[116:119], v[48:63]
    v_exp_f32 v108, v108
    v_exp_f32 v109, v109
    v_exp_f32 v110, v110
    v_cvt_pk_bf16_f32 v125, v106, v107
    v_exp_f32 v111, v111
    v_cvt_pk_bf16_f32 v126, v108, v109
    v_cvt_pk_bf16_f32 v127, v110, v111
    v_mfma_f32_32x32x16_bf16 v[96:111], a[166:169], v[132:135], 0
    v_exp_f32 v80, v80
    v_exp_f32 v81, v81
    v_exp_f32 v82, v82
    v_exp_f32 v83, v83
    v_cvt_pk_bf16_f32 v112, v80, v81
    v_mfma_f32_32x32x8_bf16 v[96:111], a[170:171], v[150:151], v[96:111]
    v_exp_f32 v84, v84
    v_exp_f32 v85, v85
    v_exp_f32 v86, v86
    v_cvt_pk_bf16_f32 v113, v82, v83
    v_exp_f32 v87, v87
    v_cvt_pk_bf16_f32 v114, v84, v85
    v_mfma_f32_32x32x16_bf16 v[64:79], a[216:219], v[120:123], v[64:79]
    v_exp_f32 v88, v88
    v_exp_f32 v89, v89
    v_exp_f32 v90, v90
    v_cvt_pk_bf16_f32 v115, v86, v87
    v_exp_f32 v91, v91
    v_cvt_pk_bf16_f32 v116, v88, v89
    v_mfma_f32_32x32x16_bf16 v[64:79], a[220:223], v[124:127], v[64:79]
    s_waitcnt vmcnt(1)
    v_exp_f32 v92, v92
    v_exp_f32 v93, v93
    v_exp_f32 v94, v94
    v_cvt_pk_bf16_f32 v117, v90, v91
    v_exp_f32 v95, v95
    v_cvt_pk_bf16_f32 v118, v92, v93
    v_cvt_pk_bf16_f32 v119, v94, v95
    v_mfma_f32_32x32x16_bf16 v[80:95], a[172:175], v[136:139], 0
    buffer_load_dwordx2 a[190:191], v173, s[52:55], s28 offen
    buffer_load_dwordx4 a[182:185], v172, s[52:55], s28 offen offset:512
    buffer_load_dwordx4 a[186:189], v172, s[52:55], s28 offen offset:1536
    buffer_load_dwordx4 a[240:243], v174, s[52:55], s28 offen offset:0
    buffer_load_dwordx4 a[244:247], v174, s[52:55], s28 offen offset:592
    buffer_load_dwordx4 a[248:251], v174, s[52:55], s28 offen offset:1184
    buffer_load_dwordx4 a[252:255], v174, s[52:55], s28 offen offset:1776
    v_exp_f32 v96, v96
    v_exp_f32 v97, v97
    v_exp_f32 v98, v98
    v_exp_f32 v99, v99
    v_cvt_pk_bf16_f32 v120, v96, v97
    v_mfma_f32_32x32x8_bf16 v[80:95], a[180:181], v[152:153], v[80:95]
    v_exp_f32 v100, v100
    v_exp_f32 v101, v101
    v_exp_f32 v102, v102
    v_cvt_pk_bf16_f32 v121, v98, v99
    v_exp_f32 v103, v103
    v_cvt_pk_bf16_f32 v122, v100, v101
    v_mfma_f32_32x32x16_bf16 v[16:31], a[216:219], v[112:115], v[16:31]
    v_exp_f32 v104, v104
    v_exp_f32 v105, v105
    v_exp_f32 v106, v106
    v_cvt_pk_bf16_f32 v123, v102, v103
    v_exp_f32 v107, v107
    v_cvt_pk_bf16_f32 v124, v104, v105
    v_mfma_f32_32x32x16_bf16 v[16:31], a[220:223], v[116:119], v[16:31]
    v_exp_f32 v108, v108
    v_exp_f32 v109, v109
    v_exp_f32 v110, v110
    v_cvt_pk_bf16_f32 v125, v106, v107
    v_exp_f32 v111, v111
    v_cvt_pk_bf16_f32 v126, v108, v109
    v_cvt_pk_bf16_f32 v127, v110, v111
    v_mfma_f32_32x32x16_bf16 v[96:111], a[172:175], v[140:143], 0
    s_waitcnt vmcnt(7)
    v_cmp_gt_u32 vcc, 1, v9
    v_exp_f32 v80, v80
    v_exp_f32 v81, v81
    v_exp_f32 v82, v82
    v_exp_f32 v83, v83
    v_cvt_pk_bf16_f32 v112, v80, v81
    v_mfma_f32_32x32x8_bf16 v[96:111], a[180:181], v[156:157], v[96:111]
    v_exp_f32 v84, v84
    v_exp_f32 v85, v85
    v_exp_f32 v86, v86
    v_cvt_pk_bf16_f32 v113, v82, v83
    v_exp_f32 v87, v87
    v_cvt_pk_bf16_f32 v114, v84, v85
    v_mfma_f32_32x32x16_bf16 v[32:47], a[216:219], v[120:123], v[32:47]
    s_cbranch_vccnz spin6
back6:
    v_exp_f32 v88, v88
    v_exp_f32 v89, v89
    v_exp_f32 v90, v90
    v_cvt_pk_bf16_f32 v115, v86, v87
    v_exp_f32 v91, v91
    v_cvt_pk_bf16_f32 v116, v88, v89
    v_mfma_f32_32x32x16_bf16 v[32:47], a[220:223], v[124:127], v[32:47]
    v_exp_f32 v92, v92
    v_exp_f32 v93, v93
    v_exp_f32 v94, v94
    v_cvt_pk_bf16_f32 v117, v90, v91
    v_exp_f32 v95, v95
    v_cvt_pk_bf16_f32 v118, v92, v93
    v_cvt_pk_bf16_f32 v119, v94, v95
    v_mfma_f32_32x32x16_bf16 v[80:95], a[172:175], v[128:131], 0
    buffer_load_dwordx4 v237, s[56:59], s43 offen offset:0 nt lds
    buffer_load_dwordx4 v238, s[56:59], s43 offen offset:1024 nt lds
    buffer_load_dwordx4 v239, s[56:59], s43 offen offset:2048 nt lds
    buffer_load_dwordx4 v240, s[56:59], s43 offen offset:3072 nt lds
    v_exp_f32 v96, v96
    v_exp_f32 v97, v97
    v_exp_f32 v98, v98
    v_exp_f32 v99, v99
    v_cvt_pk_bf16_f32 v120, v96, v97
    v_mfma_f32_32x32x8_bf16 v[80:95], a[180:181], v[144:145], v[80:95]
    v_exp_f32 v100, v100
    v_exp_f32 v101, v101
    v_exp_f32 v102, v102
    v_cvt_pk_bf16_f32 v121, v98, v99
    v_exp_f32 v103, v103
    v_cvt_pk_bf16_f32 v122, v100, v101
    v_mfma_f32_32x32x16_bf16 v[48:63], a[224:227], v[112:115], v[48:63]
    s_add_u32 s43, s43, s39
    v_exp_f32 v104, v104
    v_exp_f32 v105, v105
    v_exp_f32 v106, v106
    v_cvt_pk_bf16_f32 v123, v102, v103
    v_exp_f32 v107, v107
    v_cvt_pk_bf16_f32 v124, v104, v105
    v_mfma_f32_32x32x16_bf16 v[48:63], a[228:231], v[116:119], v[48:63]
    s_add_u32 m0, m0, 16384
    v_exp_f32 v108, v108
    v_exp_f32 v109, v109
    v_exp_f32 v110, v110
    v_cvt_pk_bf16_f32 v125, v106, v107
    v_exp_f32 v111, v111
    v_cvt_pk_bf16_f32 v126, v108, v109
    v_cvt_pk_bf16_f32 v127, v110, v111
    v_mfma_f32_32x32x16_bf16 v[96:111], a[172:175], v[132:135], 0
    s_add_u32 s30, s30, 16384
    v_exp_f32 v80, v80
    v_exp_f32 v81, v81
    v_exp_f32 v82, v82
    v_exp_f32 v83, v83
    v_cvt_pk_bf16_f32 v112, v80, v81
    v_mfma_f32_32x32x8_bf16 v[96:111], a[180:181], v[148:149], v[96:111]
    v_exp_f32 v84, v84
    v_exp_f32 v85, v85
    v_exp_f32 v86, v86
    v_cvt_pk_bf16_f32 v113, v82, v83
    v_exp_f32 v87, v87
    v_cvt_pk_bf16_f32 v114, v84, v85
    v_mfma_f32_32x32x16_bf16 v[64:79], a[224:227], v[120:123], v[64:79]
    s_xor_b32 s28, s30, s31
    v_exp_f32 v88, v88
    v_exp_f32 v89, v89
    v_exp_f32 v90, v90
    v_cvt_pk_bf16_f32 v115, v86, v87
    v_exp_f32 v91, v91
    v_cvt_pk_bf16_f32 v116, v88, v89
    v_mfma_f32_32x32x16_bf16 v[64:79], a[228:231], v[124:127], v[64:79]
    buffer_load_dwordx2 a[160:161], v2, s[52:55], s28 offen
    buffer_load_dwordx4 a[152:155], v1, s[52:55], s28 offen offset:512
    buffer_load_dwordx4 a[156:159], v1, s[52:55], s28 offen offset:1536
    buffer_load_dwordx4 a[192:195], v3, s[52:55], s28 offen offset:0
    buffer_load_dwordx4 a[196:199], v3, s[52:55], s28 offen offset:592
    buffer_load_dwordx4 a[200:203], v3, s[52:55], s28 offen offset:1184
    buffer_load_dwordx4 a[204:207], v3, s[52:55], s28 offen offset:1776
    buffer_load_dword v246, v245, s[88:91], s47 offen sc1
    v_exp_f32 v92, v92
    v_exp_f32 v93, v93
    v_exp_f32 v94, v94
    v_cvt_pk_bf16_f32 v117, v90, v91
    v_exp_f32 v95, v95
    v_cvt_pk_bf16_f32 v118, v92, v93
    v_cvt_pk_bf16_f32 v119, v94, v95
    v_mfma_f32_32x32x16_bf16 v[80:95], a[176:179], v[136:139], 0
    v_exp_f32 v96, v96
    v_exp_f32 v97, v97
    v_exp_f32 v98, v98
    v_exp_f32 v99, v99
    v_cvt_pk_bf16_f32 v120, v96, v97
    v_mfma_f32_32x32x8_bf16 v[80:95], a[180:181], v[154:155], v[80:95]
    v_exp_f32 v100, v100
    v_exp_f32 v101, v101
    v_exp_f32 v102, v102
    v_cvt_pk_bf16_f32 v121, v98, v99
    v_exp_f32 v103, v103
    v_cvt_pk_bf16_f32 v122, v100, v101
    v_mfma_f32_32x32x16_bf16 v[16:31], a[224:227], v[112:115], v[16:31]
    v_exp_f32 v104, v104
    v_exp_f32 v105, v105
    v_exp_f32 v106, v106
    v_cvt_pk_bf16_f32 v123, v102, v103
    v_exp_f32 v107, v107
    v_cvt_pk_bf16_f32 v124, v104, v105
    v_mfma_f32_32x32x16_bf16 v[16:31], a[228:231], v[116:119], v[16:31]
    v_exp_f32 v108, v108
    v_exp_f32 v109, v109
    v_exp_f32 v110, v110
    v_cvt_pk_bf16_f32 v125, v106, v107
    v_exp_f32 v111, v111
    v_cvt_pk_bf16_f32 v126, v108, v109
    v_cvt_pk_bf16_f32 v127, v110, v111
    v_mfma_f32_32x32x16_bf16 v[96:111], a[176:179], v[140:143], 0
    buffer_load_dwordx4 v237, s[56:59], s43 offen offset:0 nt lds
    buffer_load_dwordx4 v238, s[56:59], s43 offen offset:1024 nt lds
    buffer_load_dwordx4 v239, s[56:59], s43 offen offset:2048 nt lds
    buffer_load_dwordx4 v240, s[56:59], s43 offen offset:3072 nt lds
    v_exp_f32 v80, v80
    v_exp_f32 v81, v81
    v_exp_f32 v82, v82
    v_exp_f32 v83, v83
    v_cvt_pk_bf16_f32 v112, v80, v81
    v_mfma_f32_32x32x8_bf16 v[96:111], a[180:181], v[158:159], v[96:111]
    v_exp_f32 v84, v84
    v_exp_f32 v85, v85
    v_exp_f32 v86, v86
    v_cvt_pk_bf16_f32 v113, v82, v83
    v_exp_f32 v87, v87
    v_cvt_pk_bf16_f32 v114, v84, v85
    v_mfma_f32_32x32x16_bf16 v[32:47], a[224:227], v[120:123], v[32:47]
    s_add_u32 s43, s43, s39
    v_exp_f32 v88, v88
    v_exp_f32 v89, v89
    v_exp_f32 v90, v90
    v_cvt_pk_bf16_f32 v115, v86, v87
    v_exp_f32 v91, v91
    v_cvt_pk_bf16_f32 v116, v88, v89
    v_mfma_f32_32x32x16_bf16 v[32:47], a[228:231], v[124:127], v[32:47]
    s_add_u32 m0, m0, 16384
    v_exp_f32 v92, v92
    v_exp_f32 v93, v93
    v_exp_f32 v94, v94
    v_cvt_pk_bf16_f32 v117, v90, v91
    v_exp_f32 v95, v95
    v_cvt_pk_bf16_f32 v118, v92, v93
    v_cvt_pk_bf16_f32 v119, v94, v95
    v_mfma_f32_32x32x16_bf16 v[80:95], a[176:179], v[128:131], 0
    buffer_load_dwordx2 a[170:171], v173, s[52:55], s28 offen
    buffer_load_dwordx4 a[162:165], v172, s[52:55], s28 offen offset:512
    buffer_load_dwordx4 a[166:169], v172, s[52:55], s28 offen offset:1536
    buffer_load_dwordx4 a[208:211], v174, s[52:55], s28 offen offset:0
    buffer_load_dwordx4 a[212:215], v174, s[52:55], s28 offen offset:592
    buffer_load_dwordx4 a[216:219], v174, s[52:55], s28 offen offset:1184
    buffer_load_dwordx4 a[220:223], v174, s[52:55], s28 offen offset:1776
    v_exp_f32 v96, v96
    v_exp_f32 v97, v97
    v_exp_f32 v98, v98
    v_exp_f32 v99, v99
    v_cvt_pk_bf16_f32 v120, v96, v97
    v_mfma_f32_32x32x8_bf16 v[80:95], a[180:181], v[146:147], v[80:95]
    v_exp_f32 v100, v100
    v_exp_f32 v101, v101
    v_exp_f32 v102, v102
    v_cvt_pk_bf16_f32 v121, v98, v99
    v_exp_f32 v103, v103
    v_cvt_pk_bf16_f32 v122, v100, v101
    v_mfma_f32_32x32x16_bf16 v[48:63], a[232:235], v[112:115], v[48:63]
    v_exp_f32 v104, v104
    v_exp_f32 v105, v105
    v_exp_f32 v106, v106
    v_cvt_pk_bf16_f32 v123, v102, v103
    v_exp_f32 v107, v107
    v_cvt_pk_bf16_f32 v124, v104, v105
    v_mfma_f32_32x32x16_bf16 v[48:63], a[236:239], v[116:119], v[48:63]
    v_exp_f32 v108, v108
    v_exp_f32 v109, v109
    v_exp_f32 v110, v110
    v_cvt_pk_bf16_f32 v125, v106, v107
    v_exp_f32 v111, v111
    v_cvt_pk_bf16_f32 v126, v108, v109
    v_cvt_pk_bf16_f32 v127, v110, v111
    v_mfma_f32_32x32x16_bf16 v[96:111], a[176:179], v[132:135], 0
    v_exp_f32 v80, v80
    v_exp_f32 v81, v81
    v_exp_f32 v82, v82
    v_exp_f32 v83, v83
    v_cvt_pk_bf16_f32 v112, v80, v81
    v_mfma_f32_32x32x8_bf16 v[96:111], a[180:181], v[150:151], v[96:111]
    v_exp_f32 v84, v84
    v_exp_f32 v85, v85
    v_exp_f32 v86, v86
    v_cvt_pk_bf16_f32 v113, v82, v83
    v_exp_f32 v87, v87
    v_cvt_pk_bf16_f32 v114, v84, v85
    v_mfma_f32_32x32x16_bf16 v[64:79], a[232:235], v[120:123], v[64:79]
    v_exp_f32 v88, v88
    v_exp_f32 v89, v89
    v_exp_f32 v90, v90
    v_cvt_pk_bf16_f32 v115, v86, v87
    v_exp_f32 v91, v91
    v_cvt_pk_bf16_f32 v116, v88, v89
    v_mfma_f32_32x32x16_bf16 v[64:79], a[236:239], v[124:127], v[64:79]
    s_waitcnt vmcnt(23)
    v_exp_f32 v92, v92
    v_exp_f32 v93, v93
    v_exp_f32 v94, v94
    v_cvt_pk_bf16_f32 v117, v90, v91
    v_exp_f32 v95, v95
    v_cvt_pk_bf16_f32 v118, v92, v93
    v_cvt_pk_bf16_f32 v119, v94, v95
    v_mfma_f32_32x32x16_bf16 v[80:95], a[182:185], v[136:139], 0
    v_exp_f32 v96, v96
    v_exp_f32 v97, v97
    v_exp_f32 v98, v98
    v_exp_f32 v99, v99
    v_cvt_pk_bf16_f32 v120, v96, v97
    v_mfma_f32_32x32x8_bf16 v[80:95], a[190:191], v[152:153], v[80:95]
    v_exp_f32 v100, v100
    v_exp_f32 v101, v101
    v_exp_f32 v102, v102
    v_cvt_pk_bf16_f32 v121, v98, v99
    v_exp_f32 v103, v103
    v_cvt_pk_bf16_f32 v122, v100, v101
    v_mfma_f32_32x32x16_bf16 v[16:31], a[232:235], v[112:115], v[16:31]
    v_exp_f32 v104, v104
    v_exp_f32 v105, v105
    v_exp_f32 v106, v106
    v_cvt_pk_bf16_f32 v123, v102, v103
    v_exp_f32 v107, v107
    v_cvt_pk_bf16_f32 v124, v104, v105
    v_mfma_f32_32x32x16_bf16 v[16:31], a[236:239], v[116:119], v[16:31]
    v_exp_f32 v108, v108
    v_exp_f32 v109, v109
    v_exp_f32 v110, v110
    v_cvt_pk_bf16_f32 v125, v106, v107
    v_exp_f32 v111, v111
    v_cvt_pk_bf16_f32 v126, v108, v109
    v_cvt_pk_bf16_f32 v127, v110, v111
    v_mfma_f32_32x32x16_bf16 v[96:111], a[182:185], v[140:143], 0
    buffer_load_dwordx4 v237, s[56:59], s43 offen offset:0 nt lds
    buffer_load_dwordx4 v238, s[56:59], s43 offen offset:1024 nt lds
    buffer_load_dwordx4 v239, s[56:59], s43 offen offset:2048 nt lds
    buffer_load_dwordx4 v240, s[56:59], s43 offen offset:3072 nt lds
    v_exp_f32 v80, v80
    v_exp_f32 v81, v81
    v_exp_f32 v82, v82
    v_exp_f32 v83, v83
    v_cvt_pk_bf16_f32 v112, v80, v81
    v_mfma_f32_32x32x8_bf16 v[96:111], a[190:191], v[156:157], v[96:111]
    v_exp_f32 v84, v84
    v_exp_f32 v85, v85
    v_exp_f32 v86, v86
    v_cvt_pk_bf16_f32 v113, v82, v83
    v_exp_f32 v87, v87
    v_cvt_pk_bf16_f32 v114, v84, v85
    v_mfma_f32_32x32x16_bf16 v[32:47], a[232:235], v[120:123], v[32:47]
    s_add_u32 s43, s43, s39
    v_exp_f32 v88, v88
    v_exp_f32 v89, v89
    v_exp_f32 v90, v90
    v_cvt_pk_bf16_f32 v115, v86, v87
    v_exp_f32 v91, v91
    v_cvt_pk_bf16_f32 v116, v88, v89
    v_mfma_f32_32x32x16_bf16 v[32:47], a[236:239], v[124:127], v[32:47]
    s_add_u32 m0, m0, 16384
    v_exp_f32 v92, v92
    v_exp_f32 v93, v93
    v_exp_f32 v94, v94
    v_cvt_pk_bf16_f32 v117, v90, v91
    v_exp_f32 v95, v95
    v_cvt_pk_bf16_f32 v118, v92, v93
    v_cvt_pk_bf16_f32 v119, v94, v95
    v_mfma_f32_32x32x16_bf16 v[80:95], a[182:185], v[128:131], 0
    s_add_u32 s30, s30, 16384
    v_exp_f32 v96, v96
    v_exp_f32 v97, v97
    v_exp_f32 v98, v98
    v_exp_f32 v99, v99
    v_cvt_pk_bf16_f32 v120, v96, v97
    v_mfma_f32_32x32x8_bf16 v[80:95], a[190:191], v[144:145], v[80:95]
    v_exp_f32 v100, v100
    v_exp_f32 v101, v101
    v_exp_f32 v102, v102
    v_cvt_pk_bf16_f32 v121, v98, v99
    v_exp_f32 v103, v103
    v_cvt_pk_bf16_f32 v122, v100, v101
    v_mfma_f32_32x32x16_bf16 v[48:63], a[240:243], v[112:115], v[48:63]
    s_xor_b32 s28, s30, s31
    v_exp_f32 v104, v104
    v_exp_f32 v105, v105
    v_exp_f32 v106, v106
    v_cvt_pk_bf16_f32 v123, v102, v103
    v_exp_f32 v107, v107
    v_cvt_pk_bf16_f32 v124, v104, v105
    v_mfma_f32_32x32x16_bf16 v[48:63], a[244:247], v[116:119], v[48:63]
    buffer_load_dwordx2 a[180:181], v2, s[52:55], s28 offen
    buffer_load_dwordx4 a[172:175], v1, s[52:55], s28 offen offset:512
    buffer_load_dwordx4 a[176:179], v1, s[52:55], s28 offen offset:1536
    buffer_load_dwordx4 a[224:227], v3, s[52:55], s28 offen offset:0
    buffer_load_dwordx4 a[228:231], v3, s[52:55], s28 offen offset:592
    buffer_load_dwordx4 a[232:235], v3, s[52:55], s28 offen offset:1184
    buffer_load_dwordx4 a[236:239], v3, s[52:55], s28 offen offset:1776
    v_exp_f32 v108, v108
    v_exp_f32 v109, v109
    v_exp_f32 v110, v110
    v_cvt_pk_bf16_f32 v125, v106, v107
    v_exp_f32 v111, v111
    v_cvt_pk_bf16_f32 v126, v108, v109
    v_cvt_pk_bf16_f32 v127, v110, v111
    v_mfma_f32_32x32x16_bf16 v[96:111], a[182:185], v[132:135], 0
    v_exp_f32 v80, v80
    v_exp_f32 v81, v81
    v_exp_f32 v82, v82
    v_exp_f32 v83, v83
    v_cvt_pk_bf16_f32 v112, v80, v81
    v_mfma_f32_32x32x8_bf16 v[96:111], a[190:191], v[148:149], v[96:111]
    v_exp_f32 v84, v84
    v_exp_f32 v85, v85
    v_exp_f32 v86, v86
    v_cvt_pk_bf16_f32 v113, v82, v83
    v_exp_f32 v87, v87
    v_cvt_pk_bf16_f32 v114, v84, v85
    v_mfma_f32_32x32x16_bf16 v[64:79], a[240:243], v[120:123], v[64:79]
    v_exp_f32 v88, v88
    v_exp_f32 v89, v89
    v_exp_f32 v90, v90
    v_cvt_pk_bf16_f32 v115, v86, v87
    v_exp_f32 v91, v91
    v_cvt_pk_bf16_f32 v116, v88, v89
    v_mfma_f32_32x32x16_bf16 v[64:79], a[244:247], v[124:127], v[64:79]
    v_exp_f32 v92, v92
    v_exp_f32 v93, v93
    v_exp_f32 v94, v94
    v_cvt_pk_bf16_f32 v117, v90, v91
    v_exp_f32 v95, v95
    v_cvt_pk_bf16_f32 v118, v92, v93
    v_cvt_pk_bf16_f32 v119, v94, v95
    v_mfma_f32_32x32x16_bf16 v[80:95], a[186:189], v[136:139], 0
    s_waitcnt vmcnt(22)
    v_cmp_gt_u32 vcc, s84, v246
    v_exp_f32 v96, v96
    v_exp_f32 v97, v97
    v_exp_f32 v98, v98
    v_exp_f32 v99, v99
    v_cvt_pk_bf16_f32 v120, v96, v97
    v_mfma_f32_32x32x8_bf16 v[80:95], a[190:191], v[154:155], v[80:95]
    v_exp_f32 v100, v100
    v_exp_f32 v101, v101
    v_exp_f32 v102, v102
    v_cvt_pk_bf16_f32 v121, v98, v99
    v_exp_f32 v103, v103
    v_cvt_pk_bf16_f32 v122, v100, v101
    v_mfma_f32_32x32x16_bf16 v[16:31], a[240:243], v[112:115], v[16:31]
    s_cbranch_vccnz spin7
back7:
    v_exp_f32 v104, v104
    v_exp_f32 v105, v105
    v_exp_f32 v106, v106
    v_cvt_pk_bf16_f32 v123, v102, v103
    v_exp_f32 v107, v107
    v_cvt_pk_bf16_f32 v124, v104, v105
    v_mfma_f32_32x32x16_bf16 v[16:31], a[244:247], v[116:119], v[16:31]
    v_exp_f32 v108, v108
    v_exp_f32 v109, v109
    v_exp_f32 v110, v110
    v_cvt_pk_bf16_f32 v125, v106, v107
    v_exp_f32 v111, v111
    v_cvt_pk_bf16_f32 v126, v108, v109
    v_cvt_pk_bf16_f32 v127, v110, v111
    v_mfma_f32_32x32x16_bf16 v[96:111], a[186:189], v[140:143], 0
    buffer_load_dwordx4 v237, s[56:59], s43 offen offset:0 nt lds
    buffer_load_dwordx4 v238, s[56:59], s43 offen offset:1024 nt lds
    buffer_load_dwordx4 v239, s[56:59], s43 offen offset:2048 nt lds
    buffer_load_dwordx4 v240, s[56:59], s43 offen offset:3072 nt lds
    v_exp_f32 v80, v80
    v_exp_f32 v81, v81
    v_exp_f32 v82, v82
    v_exp_f32 v83, v83
    v_cvt_pk_bf16_f32 v112, v80, v81
    v_mfma_f32_32x32x8_bf16 v[96:111], a[190:191], v[158:159], v[96:111]
    v_exp_f32 v84, v84
    v_exp_f32 v85, v85
    v_exp_f32 v86, v86
    v_cvt_pk_bf16_f32 v113, v82, v83
    v_exp_f32 v87, v87
    v_cvt_pk_bf16_f32 v114, v84, v85
    v_mfma_f32_32x32x16_bf16 v[32:47], a[240:243], v[120:123], v[32:47]
    s_add_u32 s43, s43, s39
    v_exp_f32 v88, v88
    v_exp_f32 v89, v89
    v_exp_f32 v90, v90
    v_cvt_pk_bf16_f32 v115, v86, v87
    v_exp_f32 v91, v91
    v_cvt_pk_bf16_f32 v116, v88, v89
    v_mfma_f32_32x32x16_bf16 v[32:47], a[244:247], v[124:127], v[32:47]
    s_add_u32 m0, m0, 16384
    v_exp_f32 v92, v92
    v_exp_f32 v93, v93
    v_exp_f32 v94, v94
    v_cvt_pk_bf16_f32 v117, v90, v91
    v_exp_f32 v95, v95
    v_cvt_pk_bf16_f32 v118, v92, v93
    v_cvt_pk_bf16_f32 v119, v94, v95
    v_mfma_f32_32x32x16_bf16 v[80:95], a[186:189], v[128:131], 0
    s_add_u32 m0, s34, 131072
    v_exp_f32 v96, v96
    v_exp_f32 v97, v97
    v_exp_f32 v98, v98
    v_exp_f32 v99, v99
    v_cvt_pk_bf16_f32 v120, v96, v97
    v_mfma_f32_32x32x8_bf16 v[80:95], a[190:191], v[146:147], v[80:95]
    v_exp_f32 v100, v100
    v_exp_f32 v101, v101
    v_exp_f32 v102, v102
    v_cvt_pk_bf16_f32 v121, v98, v99
    v_exp_f32 v103, v103
    v_cvt_pk_bf16_f32 v122, v100, v101
    v_mfma_f32_32x32x16_bf16 v[48:63], a[248:251], v[112:115], v[48:63]
    v_exp_f32 v104, v104
    v_exp_f32 v105, v105
    v_exp_f32 v106, v106
    v_cvt_pk_bf16_f32 v123, v102, v103
    v_exp_f32 v107, v107
    v_cvt_pk_bf16_f32 v124, v104, v105
    v_mfma_f32_32x32x16_bf16 v[48:63], a[252:255], v[116:119], v[48:63]
    v_exp_f32 v108, v108
    v_exp_f32 v109, v109
    v_exp_f32 v110, v110
    v_cvt_pk_bf16_f32 v125, v106, v107
    v_exp_f32 v111, v111
    v_cvt_pk_bf16_f32 v126, v108, v109
    v_cvt_pk_bf16_f32 v127, v110, v111
att_l0:
    v_mfma_f32_32x32x16_bf16 v[96:111], a[186:189], v[132:135], 0
    v_exp_f32 v80, v80
    v_exp_f32 v81, v81
    v_exp_f32 v82, v82
    v_exp_f32 v83, v83
    v_cvt_pk_bf16_f32 v112, v80, v81
    v_mfma_f32_32x32x8_bf16 v[96:111], a[190:191], v[150:151], v[96:111]
    v_exp_f32 v84, v84
    v_exp_f32 v85, v85
    v_exp_f32 v86, v86
    v_cvt_pk_bf16_f32 v113, v82, v83
    v_exp_f32 v87, v87
    v_cvt_pk_bf16_f32 v114, v84, v85
    v_mfma_f32_32x32x16_bf16 v[64:79], a[248:251], v[120:123], v[64:79]
    v_exp_f32 v88, v88
    v_exp_f32 v89, v89
    v_exp_f32 v90, v90
    v_cvt_pk_bf16_f32 v115, v86, v87
    v_exp_f32 v91, v91
    v_cvt_pk_bf16_f32 v116, v88, v89
    v_mfma_f32_32x32x16_bf16 v[64:79], a[252:255], v[124:127], v[64:79]
    s_waitcnt vmcnt(26)
    v_exp_f32 v92, v92
    v_exp_f32 v93, v93
    v_exp_f32 v94, v94
    v_cvt_pk_bf16_f32 v117, v90, v91
    v_exp_f32 v95, v95
    v_cvt_pk_bf16_f32 v118, v92, v93
    v_cvt_pk_bf16_f32 v119, v94, v95
    v_mfma_f32_32x32x16_bf16 v[80:95], a[152:155], v[136:139], 0
    v_exp_f32 v96, v96
    v_exp_f32 v97, v97
    v_exp_f32 v98, v98
    v_exp_f32 v99, v99
    v_cvt_pk_bf16_f32 v120, v96, v97
    v_mfma_f32_32x32x8_bf16 v[80:95], a[160:161], v[152:153], v[80:95]
    v_exp_f32 v100, v100
    v_exp_f32 v101, v101
    v_exp_f32 v102, v102
    v_cvt_pk_bf16_f32 v121, v98, v99
    v_exp_f32 v103, v103
    v_cvt_pk_bf16_f32 v122, v100, v101
    v_mfma_f32_32x32x16_bf16 v[16:31], a[248:251], v[112:115], v[16:31]
    v_exp_f32 v104, v104
    v_exp_f32 v105, v105
    v_exp_f32 v106, v106
    v_cvt_pk_bf16_f32 v123, v102, v103
    v_exp_f32 v107, v107
    v_cvt_pk_bf16_f32 v124, v104, v105
    v_mfma_f32_32x32x16_bf16 v[16:31], a[252:255], v[116:119], v[16:31]
    v_exp_f32 v108, v108
    v_exp_f32 v109, v109
    v_exp_f32 v110, v110
    v_cvt_pk_bf16_f32 v125, v106, v107
    v_exp_f32 v111, v111
    v_cvt_pk_bf16_f32 v126, v108, v109
    v_cvt_pk_bf16_f32 v127, v110, v111
    v_mfma_f32_32x32x16_bf16 v[96:111], a[152:155], v[140:143], 0
    v_exp_f32 v80, v80
    v_exp_f32 v81, v81
    v_exp_f32 v82, v82
    v_exp_f32 v83, v83
    v_cvt_pk_bf16_f32 v112, v80, v81
    v_mfma_f32_32x32x8_bf16 v[96:111], a[160:161], v[156:157], v[96:111]
    v_exp_f32 v84, v84
    v_exp_f32 v85, v85
    v_exp_f32 v86, v86
    v_cvt_pk_bf16_f32 v113, v82, v83
    v_exp_f32 v87, v87
    v_cvt_pk_bf16_f32 v114, v84, v85
    v_mfma_f32_32x32x16_bf16 v[32:47], a[248:251], v[120:123], v[32:47]
    v_exp_f32 v88, v88
    v_exp_f32 v89, v89
    v_exp_f32 v90, v90
    v_cvt_pk_bf16_f32 v115, v86, v87
    v_exp_f32 v91, v91
    v_cvt_pk_bf16_f32 v116, v88, v89
    v_mfma_f32_32x32x16_bf16 v[32:47], a[252:255], v[124:127], v[32:47]
    v_exp_f32 v92, v92
    v_exp_f32 v93, v93
    v_exp_f32 v94, v94
    v_cvt_pk_bf16_f32 v117, v90, v91
    v_exp_f32 v95, v95
    v_cvt_pk_bf16_f32 v118, v92, v93
    v_cvt_pk_bf16_f32 v119, v94, v95
    v_mfma_f32_32x32x16_bf16 v[80:95], a[152:155], v[128:131], 0
    buffer_load_dwordx2 a[190:191], v173, s[52:55], s28 offen
    buffer_load_dwordx4 a[182:185], v172, s[52:55], s28 offen offset:512
    buffer_load_dwordx4 a[186:189], v172, s[52:55], s28 offen offset:1536
    buffer_load_dwordx4 a[240:243], v174, s[52:55], s28 offen offset:0
    buffer_load_dwordx4 a[244:247], v174, s[52:55], s28 offen offset:592
    buffer_load_dwordx4 a[248:251], v174, s[52:55], s28 offen offset:1184
    buffer_load_dwordx4 a[252:255], v174, s[52:55], s28 offen offset:1776
    buffer_load_dword v243, v241, s[88:91], s42 offen sc1
    v_exp_f32 v96, v96
    v_exp_f32 v97, v97
    v_exp_f32 v98, v98
    v_exp_f32 v99, v99
    v_cvt_pk_bf16_f32 v120, v96, v97
    v_mfma_f32_32x32x8_bf16 v[80:95], a[160:161], v[144:145], v[80:95]
    v_exp_f32 v100, v100
    v_exp_f32 v101, v101
    v_exp_f32 v102, v102
    v_cvt_pk_bf16_f32 v121, v98, v99
    v_exp_f32 v103, v103
    v_cvt_pk_bf16_f32 v122, v100, v101
    v_mfma_f32_32x32x16_bf16 v[48:63], a[192:195], v[112:115], v[48:63]
    v_exp_f32 v104, v104
    v_exp_f32 v105, v105
    v_exp_f32 v106, v106
    v_cvt_pk_bf16_f32 v123, v102, v103
    v_exp_f32 v107, v107
    v_cvt_pk_bf16_f32 v124, v104, v105
    v_mfma_f32_32x32x16_bf16 v[48:63], a[196:199], v[116:119], v[48:63]
    v_exp_f32 v108, v108
    v_exp_f32 v109, v109
    v_exp_f32 v110, v110
    v_cvt_pk_bf16_f32 v125, v106, v107
    v_exp_f32 v111, v111
    v_cvt_pk_bf16_f32 v126, v108, v109
    v_cvt_pk_bf16_f32 v127, v110, v111
    v_mfma_f32_32x32x16_bf16 v[96:111], a[152:155], v[132:135], 0
    v_exp_f32 v80, v80
    v_exp_f32 v81, v81
    v_exp_f32 v82, v82
    v_exp_f32 v83, v83
    v_cvt_pk_bf16_f32 v112, v80, v81
    v_mfma_f32_32x32x8_bf16 v[96:111], a[160:161], v[148:149], v[96:111]
    v_exp_f32 v84, v84
    v_exp_f32 v85, v85
    v_exp_f32 v86, v86
    v_cvt_pk_bf16_f32 v113, v82, v83
    v_exp_f32 v87, v87
    v_cvt_pk_bf16_f32 v114, v84, v85
    v_mfma_f32_32x32x16_bf16 v[64:79], a[192:195], v[120:123], v[64:79]
    s_cmp_eq_u32 s33, s101
    v_exp_f32 v88, v88
    v_exp_f32 v89, v89
    v_exp_f32 v90, v90
    v_cvt_pk_bf16_f32 v115, v86, v87
    v_exp_f32 v91, v91
    v_cvt_pk_bf16_f32 v116, v88, v89
    v_mfma_f32_32x32x16_bf16 v[64:79], a[196:199], v[124:127], v[64:79]
    s_cbranch_scc1 pack_blk
hook3:
    v_exp_f32 v92, v92
    v_exp_f32 v93, v93
    v_exp_f32 v94, v94
    v_cvt_pk_bf16_f32 v117, v90, v91
    v_exp_f32 v95, v95
    v_cvt_pk_bf16_f32 v118, v92, v93
    v_cvt_pk_bf16_f32 v119, v94, v95
    v_mfma_f32_32x32x16_bf16 v[80:95], a[156:159], v[136:139], 0
    v_exp_f32 v96, v96
    v_exp_f32 v97, v97
    v_exp_f32 v98, v98
    v_exp_f32 v99, v99
    v_cvt_pk_bf16_f32 v120, v96, v97
    v_mfma_f32_32x32x8_bf16 v[80:95], a[160:161], v[154:155], v[80:95]
    v_exp_f32 v100, v100
    v_exp_f32 v101, v101
    v_exp_f32 v102, v102
    v_cvt_pk_bf16_f32 v121, v98, v99
    v_exp_f32 v103, v103
    v_cvt_pk_bf16_f32 v122, v100, v101
    v_mfma_f32_32x32x16_bf16 v[16:31], a[192:195], v[112:115], v[16:31]
    v_exp_f32 v104, v104
    v_exp_f32 v105, v105
    v_exp_f32 v106, v106
    v_cvt_pk_bf16_f32 v123, v102, v103
    v_exp_f32 v107, v107
    v_cvt_pk_bf16_f32 v124, v104, v105
    v_mfma_f32_32x32x16_bf16 v[16:31], a[196:199], v[116:119], v[16:31]
    v_exp_f32 v108, v108
    v_exp_f32 v109, v109
    v_exp_f32 v110, v110
    v_cvt_pk_bf16_f32 v125, v106, v107
    v_exp_f32 v111, v111
    v_cvt_pk_bf16_f32 v126, v108, v109
    v_cvt_pk_bf16_f32 v127, v110, v111
    v_mfma_f32_32x32x16_bf16 v[96:111], a[156:159], v[140:143], 0
    v_exp_f32 v80, v80
    v_exp_f32 v81, v81
    v_exp_f32 v82, v82
    v_exp_f32 v83, v83
    v_cvt_pk_bf16_f32 v112, v80, v81
    v_mfma_f32_32x32x8_bf16 v[96:111], a[160:161], v[158:159], v[96:111]
    v_exp_f32 v84, v84
    v_exp_f32 v85, v85
    v_exp_f32 v86, v86
    v_cvt_pk_bf16_f32 v113, v82, v83
    v_exp_f32 v87, v87
    v_cvt_pk_bf16_f32 v114, v84, v85
    v_mfma_f32_32x32x16_bf16 v[32:47], a[192:195], v[120:123], v[32:47]
    v_exp_f32 v88, v88
    v_exp_f32 v89, v89
    v_exp_f32 v90, v90
    v_cvt_pk_bf16_f32 v115, v86, v87
    v_exp_f32 v91, v91
    v_cvt_pk_bf16_f32 v116, v88, v89
    v_mfma_f32_32x32x16_bf16 v[32:47], a[196:199], v[124:127], v[32:47]
    v_exp_f32 v92, v92
    v_exp_f32 v93, v93
    v_exp_f32 v94, v94
    v_cvt_pk_bf16_f32 v117, v90, v91
    v_exp_f32 v95, v95
    v_cvt_pk_bf16_f32 v118, v92, v93
    v_cvt_pk_bf16_f32 v119, v94, v95
    v_mfma_f32_32x32x16_bf16 v[80:95], a[156:159], v[128:131], 0
    v_exp_f32 v96, v96
    v_exp_f32 v97, v97
    v_exp_f32 v98, v98
    v_exp_f32 v99, v99
    v_cvt_pk_bf16_f32 v120, v96, v97
    v_mfma_f32_32x32x8_bf16 v[80:95], a[160:161], v[146:147], v[80:95]
    v_exp_f32 v100, v100
    v_exp_f32 v101, v101
    v_exp_f32 v102, v102
    v_cvt_pk_bf16_f32 v121, v98, v99
    v_exp_f32 v103, v103
    v_cvt_pk_bf16_f32 v122, v100, v101
    v_mfma_f32_32x32x16_bf16 v[48:63], a[200:203], v[112:115], v[48:63]
    v_exp_f32 v104, v104
    v_exp_f32 v105, v105
    v_exp_f32 v106, v106
    v_cvt_pk_bf16_f32 v123, v102, v103
    v_exp_f32 v107, v107
    v_cvt_pk_bf16_f32 v124, v104, v105
    v_mfma_f32_32x32x16_bf16 v[48:63], a[204:207], v[116:119], v[48:63]
    v_exp_f32 v108, v108
    v_exp_f32 v109, v109
    v_exp_f32 v110, v110
    v_cvt_pk_bf16_f32 v125, v106, v107
    v_exp_f32 v111, v111
    v_cvt_pk_bf16_f32 v126, v108, v109
    v_cvt_pk_bf16_f32 v127, v110, v111
    v_mfma_f32_32x32x16_bf16 v[96:111], a[156:159], v[132:135], 0
    v_exp_f32 v80, v80
    v_exp_f32 v81, v81
    v_exp_f32 v82, v82
    v_exp_f32 v83, v83
    v_cvt_pk_bf16_f32 v112, v80, v81
    v_mfma_f32_32x32x8_bf16 v[96:111], a[160:161], v[150:151], v[96:111]
    v_exp_f32 v84, v84
    v_exp_f32 v85, v85
    v_exp_f32 v86, v86
    v_cvt_pk_bf16_f32 v113, v82, v83
    v_exp_f32 v87, v87
    v_cvt_pk_bf16_f32 v114, v84, v85
    v_mfma_f32_32x32x16_bf16 v[64:79], a[200:203], v[120:123], v[64:79]
    v_exp_f32 v88, v88
    v_exp_f32 v89, v89
    v_exp_f32 v90, v90
    v_cvt_pk_bf16_f32 v115, v86, v87
    v_exp_f32 v91, v91
    v_cvt_pk_bf16_f32 v116, v88, v89
    v_mfma_f32_32x32x16_bf16 v[64:79], a[204:207], v[124:127], v[64:79]
    s_waitcnt vmcnt(23)
    v_exp_f32 v92, v92
    v_exp_f32 v93, v93
    v_exp_f32 v94, v94
    v_cvt_pk_bf16_f32 v117, v90, v91
    v_exp_f32 v95, v95
    v_cvt_pk_bf16_f32 v118, v92, v93
    v_cvt_pk_bf16_f32 v119, v94, v95
    v_mfma_f32_32x32x16_bf16 v[80:95], a[162:165], v[136:139], 0
    v_exp_f32 v96, v96
    v_exp_f32 v97, v97
    v_exp_f32 v98, v98
    v_exp_f32 v99, v99
    v_cvt_pk_bf16_f32 v120, v96, v97
    v_mfma_f32_32x32x8_bf16 v[80:95], a[170:171], v[152:153], v[80:95]
    v_exp_f32 v100, v100
    v_exp_f32 v101, v101
    v_exp_f32 v102, v102
    v_cvt_pk_bf16_f32 v121, v98, v99
    v_exp_f32 v103, v103
    v_cvt_pk_bf16_f32 v122, v100, v101
    v_mfma_f32_32x32x16_bf16 v[16:31], a[200:203], v[112:115], v[16:31]
    s_cmp_eq_u32 s33, s86
    v_exp_f32 v104, v104
    v_exp_f32 v105, v105
    v_exp_f32 v106, v106
    v_cvt_pk_bf16_f32 v123, v102, v103
    v_exp_f32 v107, v107
    v_cvt_pk_bf16_f32 v124, v104, v105
    v_mfma_f32_32x32x16_bf16 v[16:31], a[204:207], v[116:119], v[16:31]
    s_cbranch_scc1 pack_bar0
hook5:
    v_exp_f32 v108, v108
    v_exp_f32 v109, v109
    v_exp_f32 v110, v110
    v_cvt_pk_bf16_f32 v125, v106, v107
    v_exp_f32 v111, v111
    v_cvt_pk_bf16_f32 v126, v108, v109
    v_cvt_pk_bf16_f32 v127, v110, v111
    v_mfma_f32_32x32x16_bf16 v[96:111], a[162:165], v[140:143], 0
    v_exp_f32 v80, v80
    v_exp_f32 v81, v81
    v_exp_f32 v82, v82
    v_exp_f32 v83, v83
    v_cvt_pk_bf16_f32 v112, v80, v81
    v_mfma_f32_32x32x8_bf16 v[96:111], a[170:171], v[156:157], v[96:111]
    v_exp_f32 v84, v84
    v_exp_f32 v85, v85
    v_exp_f32 v86, v86
    v_cvt_pk_bf16_f32 v113, v82, v83
    v_exp_f32 v87, v87
    v_cvt_pk_bf16_f32 v114, v84, v85
    v_mfma_f32_32x32x16_bf16 v[32:47], a[200:203], v[120:123], v[32:47]
    v_exp_f32 v88, v88
    v_exp_f32 v89, v89
    v_exp_f32 v90, v90
    v_cvt_pk_bf16_f32 v115, v86, v87
    v_exp_f32 v91, v91
    v_cvt_pk_bf16_f32 v116, v88, v89
    v_mfma_f32_32x32x16_bf16 v[32:47], a[204:207], v[124:127], v[32:47]
    v_exp_f32 v92, v92
    v_exp_f32 v93, v93
    v_exp_f32 v94, v94
    v_cvt_pk_bf16_f32 v117, v90, v91
    v_exp_f32 v95, v95
    v_cvt_pk_bf16_f32 v118, v92, v93
    v_cvt_pk_bf16_f32 v119, v94, v95
    v_mfma_f32_32x32x16_bf16 v[80:95], a[162:165], v[128:131], 0
    s_add_u32 s30, s30, 16384
    v_exp_f32 v96, v96
    v_exp_f32 v97, v97
    v_exp_f32 v98, v98
    v_exp_f32 v99, v99
    v_cvt_pk_bf16_f32 v120, v96, v97
    v_mfma_f32_32x32x8_bf16 v[80:95], a[170:171], v[144:145], v[80:95]
    v_exp_f32 v100, v100
    v_exp_f32 v101, v101
    v_exp_f32 v102, v102
    v_cvt_pk_bf16_f32 v121, v98, v99
    v_exp_f32 v103, v103
    v_cvt_pk_bf16_f32 v122, v100, v101
    v_mfma_f32_32x32x16_bf16 v[48:63], a[208:211], v[112:115], v[48:63]
    s_xor_b32 s28, s30, s31
    v_exp_f32 v104, v104
    v_exp_f32 v105, v105
    v_exp_f32 v106, v106
    v_cvt_pk_bf16_f32 v123, v102, v103
    v_exp_f32 v107, v107
    v_cvt_pk_bf16_f32 v124, v104, v105
    v_mfma_f32_32x32x16_bf16 v[48:63], a[212:215], v[116:119], v[48:63]
    buffer_load_dwordx2 a[160:161], v2, s[52:55], s28 offen
    buffer_load_dwordx4 a[152:155], v1, s[52:55], s28 offen offset:512
    buffer_load_dwordx4 a[156:159], v1, s[52:55], s28 offen offset:1536
    buffer_load_dwordx4 a[192:195], v3, s[52:55], s28 offen offset:0
    buffer_load_dwordx4 a[196:199], v3, s[52:55], s28 offen offset:592
    buffer_load_dwordx4 a[200:203], v3, s[52:55], s28 offen offset:1184
    buffer_load_dwordx4 a[204:207], v3, s[52:55], s28 offen offset:1776
    v_exp_f32 v108, v108
    v_exp_f32 v109, v109
    v_exp_f32 v110, v110
    v_cvt_pk_bf16_f32 v125, v106, v107
    v_exp_f32 v111, v111
    v_cvt_pk_bf16_f32 v126, v108, v109
    v_cvt_pk_bf16_f32 v127, v110, v111
    v_mfma_f32_32x32x16_bf16 v[96:111], a[162:165], v[132:135], 0
    v_exp_f32 v80, v80
    v_exp_f32 v81, v81
    v_exp_f32 v82, v82
    v_exp_f32 v83, v83
    v_cvt_pk_bf16_f32 v112, v80, v81
    v_mfma_f32_32x32x8_bf16 v[96:111], a[170:171], v[148:149], v[96:111]
    v_exp_f32 v84, v84
    v_exp_f32 v85, v85
    v_exp_f32 v86, v86
    v_cvt_pk_bf16_f32 v113, v82, v83
    v_exp_f32 v87, v87
    v_cvt_pk_bf16_f32 v114, v84, v85
    v_mfma_f32_32x32x16_bf16 v[64:79], a[208:211], v[120:123], v[64:79]
    s_cmp_eq_u32 s33, s98
    v_exp_f32 v88, v88
    v_exp_f32 v89, v89
    v_exp_f32 v90, v90
    v_cvt_pk_bf16_f32 v115, v86, v87
    v_exp_f32 v91, v91
    v_cvt_pk_bf16_f32 v116, v88, v89
    v_mfma_f32_32x32x16_bf16 v[64:79], a[212:215], v[124:127], v[64:79]
    s_cbranch_scc1 pack_blk
hook0:
    v_exp_f32 v92, v92
    v_exp_f32 v93, v93
    v_exp_f32 v94, v94
    v_cvt_pk_bf16_f32 v117, v90, v91
    v_exp_f32 v95, v95
    v_cvt_pk_bf16_f32 v118, v92, v93
    v_cvt_pk_bf16_f32 v119, v94, v95
    v_mfma_f32_32x32x16_bf16 v[80:95], a[166:169], v[136:139], 0
    v_exp_f32 v96, v96
    v_exp_f32 v97, v97
    v_exp_f32 v98, v98
    v_exp_f32 v99, v99
    v_cvt_pk_bf16_f32 v120, v96, v97
    v_mfma_f32_32x32x8_bf16 v[80:95], a[170:171], v[154:155], v[80:95]
    v_exp_f32 v100, v100
    v_exp_f32 v101, v101
    v_exp_f32 v102, v102
    v_cvt_pk_bf16_f32 v121, v98, v99
    v_exp_f32 v103, v103
    v_cvt_pk_bf16_f32 v122, v100, v101
    v_mfma_f32_32x32x16_bf16 v[16:31], a[208:211], v[112:115], v[16:31]
    v_exp_f32 v104, v104
    v_exp_f32 v105, v105
    v_exp_f32 v106, v106
    v_cvt_pk_bf16_f32 v123, v102, v103
    v_exp_f32 v107, v107
    v_cvt_pk_bf16_f32 v124, v104, v105
    v_mfma_f32_32x32x16_bf16 v[16:31], a[212:215], v[116:119], v[16:31]
    v_exp_f32 v108, v108
    v_exp_f32 v109, v109
    v_exp_f32 v110, v110
    v_cvt_pk_bf16_f32 v125, v106, v107
    v_exp_f32 v111, v111
    v_cvt_pk_bf16_f32 v126, v108, v109
    v_cvt_pk_bf16_f32 v127, v110, v111
    v_mfma_f32_32x32x16_bf16 v[96:111], a[166:169], v[140:143], 0
    v_exp_f32 v80, v80
    v_exp_f32 v81, v81
    v_exp_f32 v82, v82
    v_exp_f32 v83, v83
    v_cvt_pk_bf16_f32 v112, v80, v81
    v_mfma_f32_32x32x8_bf16 v[96:111], a[170:171], v[158:159], v[96:111]
    v_exp_f32 v84, v84
    v_exp_f32 v85, v85
    v_exp_f32 v86, v86
    v_cvt_pk_bf16_f32 v113, v82, v83
    v_exp_f32 v87, v87
    v_cvt_pk_bf16_f32 v114, v84, v85
    v_mfma_f32_32x32x16_bf16 v[32:47], a[208:211], v[120:123], v[32:47]
    v_exp_f32 v88, v88
    v_exp_f32 v89, v89
    v_exp_f32 v90, v90
    v_cvt_pk_bf16_f32 v115, v86, v87
    v_exp_f32 v91, v91
    v_cvt_pk_bf16_f32 v116, v88, v89
    v_mfma_f32_32x32x16_bf16 v[32:47], a[212:215], v[124:127], v[32:47]
    v_exp_f32 v92, v92
    v_exp_f32 v93, v93
    v_exp_f32 v94, v94
    v_cvt_pk_bf16_f32 v117, v90, v91
    v_exp_f32 v95, v95
    v_cvt_pk_bf16_f32 v118, v92, v93
    v_cvt_pk_bf16_f32 v119, v94, v95
    v_mfma_f32_32x32x16_bf16 v[80:95], a[166:169], v[128:131], 0
    s_waitcnt vmcnt(7)
    v_cmp_gt_u32 vcc, s83, v243
    v_exp_f32 v96, v96
    v_exp_f32 v97, v97
    v_exp_f32 v98, v98
    v_exp_f32 v99, v99
    v_cvt_pk_bf16_f32 v120, v96, v97
    v_mfma_f32_32x32x8_bf16 v[80:95], a[170:171], v[146:147], v[80:95]
    v_exp_f32 v100, v100
    v_exp_f32 v101, v101
    v_exp_f32 v102, v102
    v_cvt_pk_bf16_f32 v121, v98, v99
    v_exp_f32 v103, v103
    v_cvt_pk_bf16_f32 v122, v100, v101
    v_mfma_f32_32x32x16_bf16 v[48:63], a[216:219], v[112:115], v[48:63]
    s_cbranch_vccnz spin8
back8:
    v_exp_f32 v104, v104
    v_exp_f32 v105, v105
    v_exp_f32 v106, v106
    v_cvt_pk_bf16_f32 v123, v102, v103
    v_exp_f32 v107, v107
    v_cvt_pk_bf16_f32 v124, v104, v105
    v_mfma_f32_32x32x16_bf16 v[48:63], a[220:223], v[116:119], v[48:63]
    v_exp_f32 v108, v108
    v_exp_f32 v109, v109
    v_exp_f32 v110, v110
    v_cvt_pk_bf16_f32 v125, v106, v107
    v_exp_f32 v111, v111
    v_cvt_pk_bf16_f32 v126, v108, v109
    v_cvt_pk_bf16_f32 v127, v110, v111
    v_mfma_f32_32x32x16_bf16 v[96:111], a[166:169], v[132:135], 0
    v_exp_f32 v80, v80
    v_exp_f32 v81, v81
    v_exp_f32 v82, v82
    v_exp_f32 v83, v83
    v_cvt_pk_bf16_f32 v112, v80, v81
    v_mfma_f32_32x32x8_bf16 v[96:111], a[170:171], v[150:151], v[96:111]
    v_exp_f32 v84, v84
    v_exp_f32 v85, v85
    v_exp_f32 v86, v86
    v_cvt_pk_bf16_f32 v113, v82, v83
    v_exp_f32 v87, v87
    v_cvt_pk_bf16_f32 v114, v84, v85
    v_mfma_f32_32x32x16_bf16 v[64:79], a[216:219], v[120:123], v[64:79]
    v_exp_f32 v88, v88
    v_exp_f32 v89, v89
    v_exp_f32 v90, v90
    v_cvt_pk_bf16_f32 v115, v86, v87
    v_exp_f32 v91, v91
    v_cvt_pk_bf16_f32 v116, v88, v89
    v_mfma_f32_32x32x16_bf16 v[64:79], a[220:223], v[124:127], v[64:79]
    v_exp_f32 v92, v92
    v_exp_f32 v93, v93
    v_exp_f32 v94, v94
    v_cvt_pk_bf16_f32 v117, v90, v91
    v_exp_f32 v95, v95
    v_cvt_pk_bf16_f32 v118, v92, v93
    v_cvt_pk_bf16_f32 v119, v94, v95
    v_mfma_f32_32x32x16_bf16 v[80:95], a[172:175], v[136:139], 0
    v_exp_f32 v96, v96
    v_exp_f32 v97, v97
    v_exp_f32 v98, v98
    v_exp_f32 v99, v99
    v_cvt_pk_bf16_f32 v120, v96, v97
    v_mfma_f32_32x32x8_bf16 v[80:95], a[180:181], v[152:153], v[80:95]
    v_exp_f32 v100, v100
    v_exp_f32 v101, v101
    v_exp_f32 v102, v102
    v_cvt_pk_bf16_f32 v121, v98, v99
    v_exp_f32 v103, v103
    v_cvt_pk_bf16_f32 v122, v100, v101
    v_mfma_f32_32x32x16_bf16 v[16:31], a[216:219], v[112:115], v[16:31]
    v_exp_f32 v104, v104
    v_exp_f32 v105, v105
    v_exp_f32 v106, v106
    v_cvt_pk_bf16_f32 v123, v102, v103
    v_exp_f32 v107, v107
    v_cvt_pk_bf16_f32 v124, v104, v105
    v_mfma_f32_32x32x16_bf16 v[16:31], a[220:223], v[116:119], v[16:31]
    v_exp_f32 v108, v108
    v_exp_f32 v109, v109
    v_exp_f32 v110, v110
    v_cvt_pk_bf16_f32 v125, v106, v107
    v_exp_f32 v111, v111
    v_cvt_pk_bf16_f32 v126, v108, v109
    v_cvt_pk_bf16_f32 v127, v110, v111
    v_mfma_f32_32x32x16_bf16 v[96:111], a[172:175], v[140:143], 0
    v_exp_f32 v80, v80
    v_exp_f32 v81, v81
    v_exp_f32 v82, v82
    v_exp_f32 v83, v83
    v_cvt_pk_bf16_f32 v112, v80, v81
    v_mfma_f32_32x32x8_bf16 v[96:111], a[180:181], v[156:157], v[96:111]
    v_exp_f32 v84, v84
    v_exp_f32 v85, v85
    v_exp_f32 v86, v86
    v_cvt_pk_bf16_f32 v113, v82, v83
    v_exp_f32 v87, v87
    v_cvt_pk_bf16_f32 v114, v84, v85
    v_mfma_f32_32x32x16_bf16 v[32:47], a[216:219], v[120:123], v[32:47]
    s_cmp_eq_u32 s33, s46
    v_exp_f32 v88, v88
    v_exp_f32 v89, v89
    v_exp_f32 v90, v90
    v_cvt_pk_bf16_f32 v115, v86, v87
    v_exp_f32 v91, v91
    v_cvt_pk_bf16_f32 v116, v88, v89
    v_mfma_f32_32x32x16_bf16 v[32:47], a[220:223], v[124:127], v[32:47]
    s_cbranch_scc1 pack_bar
hook4:
    v_exp_f32 v92, v92
    v_exp_f32 v93, v93
    v_exp_f32 v94, v94
    v_cvt_pk_bf16_f32 v117, v90, v91
    v_exp_f32 v95, v95
    v_cvt_pk_bf16_f32 v118, v92, v93
    v_cvt_pk_bf16_f32 v119, v94, v95
    v_mfma_f32_32x32x16_bf16 v[80:95], a[172:175], v[128:131], 0
    buffer_load_dwordx2 a[170:171], v173, s[52:55], s28 offen
    buffer_load_dwordx4 a[162:165], v172, s[52:55], s28 offen offset:512
    buffer_load_dwordx4 a[166:169], v172, s[52:55], s28 offen offset:1536
    buffer_load_dwordx4 a[208:211], v174, s[52:55], s28 offen offset:0
    buffer_load_dwordx4 a[212:215], v174, s[52:55], s28 offen offset:592
    buffer_load_dwordx4 a[216:219], v174, s[52:55], s28 offen offset:1184
    buffer_load_dwordx4 a[220:223], v174, s[52:55], s28 offen offset:1776
    v_exp_f32 v96, v96
    v_exp_f32 v97, v97
    v_exp_f32 v98, v98
    v_exp_f32 v99, v99
    v_cvt_pk_bf16_f32 v120, v96, v97
    v_mfma_f32_32x32x8_bf16 v[80:95], a[180:181], v[144:145], v[80:95]
    v_exp_f32 v100, v100
    v_exp_f32 v101, v101
    v_exp_f32 v102, v102
    v_cvt_pk_bf16_f32 v121, v98, v99
    v_exp_f32 v103, v103
    v_cvt_pk_bf16_f32 v122, v100, v101
    v_mfma_f32_32x32x16_bf16 v[48:63], a[224:227], v[112:115], v[48:63]
    v_exp_f32 v104, v104
    v_exp_f32 v105, v105
    v_exp_f32 v106, v106
    v_cvt_pk_bf16_f32 v123, v102, v103
    v_exp_f32 v107, v107
    v_cvt_pk_bf16_f32 v124, v104, v105
    v_mfma_f32_32x32x16_bf16 v[48:63], a[228:231], v[116:119], v[48:63]
    v_exp_f32 v108, v108
    v_exp_f32 v109, v109
    v_exp_f32 v110, v110
    v_cvt_pk_bf16_f32 v125, v106, v107
    v_exp_f32 v111, v111
    v_cvt_pk_bf16_f32 v126, v108, v109
    v_cvt_pk_bf16_f32 v127, v110, v111
    v_mfma_f32_32x32x16_bf16 v[96:111], a[172:175], v[132:135], 0
    v_exp_f32 v80, v80
    v_exp_f32 v81, v81
    v_exp_f32 v82, v82
    v_exp_f32 v83, v83
    v_cvt_pk_bf16_f32 v112, v80, v81
    v_mfma_f32_32x32x8_bf16 v[96:111], a[180:181], v[148:149], v[96:111]
    v_exp_f32 v84, v84
    v_exp_f32 v85, v85
    v_exp_f32 v86, v86
    v_cvt_pk_bf16_f32 v113, v82, v83
    v_exp_f32 v87, v87
    v_cvt_pk_bf16_f32 v114, v84, v85
    v_mfma_f32_32x32x16_bf16 v[64:79], a[224:227], v[120:123], v[64:79]
    s_cmp_eq_u32 s33, s99
    v_exp_f32 v88, v88
    v_exp_f32 v89, v89
    v_exp_f32 v90, v90
    v_cvt_pk_bf16_f32 v115, v86, v87
    v_exp_f32 v91, v91
    v_cvt_pk_bf16_f32 v116, v88, v89
    v_mfma_f32_32x32x16_bf16 v[64:79], a[228:231], v[124:127], v[64:79]
    s_cbranch_scc1 pack_blk
hook1:
    v_exp_f32 v92, v92
    v_exp_f32 v93, v93
    v_exp_f32 v94, v94
    v_cvt_pk_bf16_f32 v117, v90, v91
    v_exp_f32 v95, v95
    v_cvt_pk_bf16_f32 v118, v92, v93
    v_cvt_pk_bf16_f32 v119, v94, v95
    v_mfma_f32_32x32x16_bf16 v[80:95], a[176:179], v[136:139], 0
    buffer_load_dwordx4 v1, s[4:7], s35 offen offset:0 sc1 lds
    buffer_load_dwordx4 v1, s[4:7], s35 offen offset:1024 sc1 lds
    buffer_load_dwordx4 v1, s[4:7], s35 offen offset:2048 sc1 lds
    buffer_load_dwordx4 v1, s[4:7], s35 offen offset:3072 sc1 lds
    v_exp_f32 v96, v96
    v_exp_f32 v97, v97
    v_exp_f32 v98, v98
    v_exp_f32 v99, v99
    v_cvt_pk_bf16_f32 v120, v96, v97
    v_mfma_f32_32x32x8_bf16 v[80:95], a[180:181], v[154:155], v[80:95]
    v_exp_f32 v100, v100
    v_exp_f32 v101, v101
    v_exp_f32 v102, v102
    v_cvt_pk_bf16_f32 v121, v98, v99
    v_exp_f32 v103, v103
    v_cvt_pk_bf16_f32 v122, v100, v101
    v_mfma_f32_32x32x16_bf16 v[16:31], a[224:227], v[112:115], v[16:31]
    s_sub_u32 s35, s35, 16384
    v_exp_f32 v104, v104
    v_exp_f32 v105, v105
    v_exp_f32 v106, v106
    v_cvt_pk_bf16_f32 v123, v102, v103
    v_exp_f32 v107, v107
    v_cvt_pk_bf16_f32 v124, v104, v105
    v_mfma_f32_32x32x16_bf16 v[16:31], a[228:231], v[116:119], v[16:31]
    s_sub_u32 m0, m0, 16384
    v_exp_f32 v108, v108
    v_exp_f32 v109, v109
    v_exp_f32 v110, v110
    v_cvt_pk_bf16_f32 v125, v106, v107
    v_exp_f32 v111, v111
    v_cvt_pk_bf16_f32 v126, v108, v109
    v_cvt_pk_bf16_f32 v127, v110, v111
    v_mfma_f32_32x32x16_bf16 v[96:111], a[176:179], v[140:143], 0
    v_exp_f32 v80, v80
    v_exp_f32 v81, v81
    v_exp_f32 v82, v82
    v_exp_f32 v83, v83
    v_cvt_pk_bf16_f32 v112, v80, v81
    v_mfma_f32_32x32x8_bf16 v[96:111], a[180:181], v[158:159], v[96:111]
    v_exp_f32 v84, v84
    v_exp_f32 v85, v85
    v_exp_f32 v86, v86
    v_cvt_pk_bf16_f32 v113, v82, v83
    v_exp_f32 v87, v87
    v_cvt_pk_bf16_f32 v114, v84, v85
    v_mfma_f32_32x32x16_bf16 v[32:47], a[224:227], v[120:123], v[32:47]
    v_exp_f32 v88, v88
    v_exp_f32 v89, v89
    v_exp_f32 v90, v90
    v_cvt_pk_bf16_f32 v115, v86, v87
    v_exp_f32 v91, v91
    v_cvt_pk_bf16_f32 v116, v88, v89
    v_mfma_f32_32x32x16_bf16 v[32:47], a[228:231], v[124:127], v[32:47]
    v_exp_f32 v92, v92
    v_exp_f32 v93, v93
    v_exp_f32 v94, v94
    v_cvt_pk_bf16_f32 v117, v90, v91
    v_exp_f32 v95, v95
    v_cvt_pk_bf16_f32 v118, v92, v93
    v_cvt_pk_bf16_f32 v119, v94, v95
    v_mfma_f32_32x32x16_bf16 v[80:95], a[176:179], v[128:131], 0
    buffer_load_dwordx4 v1, s[4:7], s35 offen offset:0 sc1 lds
    buffer_load_dwordx4 v1, s[4:7], s35 offen offset:1024 sc1 lds
    buffer_load_dwordx4 v1, s[4:7], s35 offen offset:2048 sc1 lds
    buffer_load_dwordx4 v1, s[4:7], s35 offen offset:3072 sc1 lds
    v_exp_f32 v96, v96
    v_exp_f32 v97, v97
    v_exp_f32 v98, v98
    v_exp_f32 v99, v99
    v_cvt_pk_bf16_f32 v120, v96, v97
    v_mfma_f32_32x32x8_bf16 v[80:95], a[180:181], v[146:147], v[80:95]
    v_exp_f32 v100, v100
    v_exp_f32 v101, v101
    v_exp_f32 v102, v102
    v_cvt_pk_bf16_f32 v121, v98, v99
    v_exp_f32 v103, v103
    v_cvt_pk_bf16_f32 v122, v100, v101
    v_mfma_f32_32x32x16_bf16 v[48:63], a[232:235], v[112:115], v[48:63]
    s_sub_u32 s35, s35, 16384
    v_exp_f32 v104, v104
    v_exp_f32 v105, v105
    v_exp_f32 v106, v106
    v_cvt_pk_bf16_f32 v123, v102, v103
    v_exp_f32 v107, v107
    v_cvt_pk_bf16_f32 v124, v104, v105
    v_mfma_f32_32x32x16_bf16 v[48:63], a[236:239], v[116:119], v[48:63]
    s_sub_u32 m0, m0, 16384
    v_exp_f32 v108, v108
    v_exp_f32 v109, v109
    v_exp_f32 v110, v110
    v_cvt_pk_bf16_f32 v125, v106, v107
    v_exp_f32 v111, v111
    v_cvt_pk_bf16_f32 v126, v108, v109
    v_cvt_pk_bf16_f32 v127, v110, v111
    v_mfma_f32_32x32x16_bf16 v[96:111], a[176:179], v[132:135], 0
    v_exp_f32 v80, v80
    v_exp_f32 v81, v81
    v_exp_f32 v82, v82
    v_exp_f32 v83, v83
    v_cvt_pk_bf16_f32 v112, v80, v81
    v_mfma_f32_32x32x8_bf16 v[96:111], a[180:181], v[150:151], v[96:111]
    v_exp_f32 v84, v84
    v_exp_f32 v85, v85
    v_exp_f32 v86, v86
    v_cvt_pk_bf16_f32 v113, v82, v83
    v_exp_f32 v87, v87
    v_cvt_pk_bf16_f32 v114, v84, v85
    v_mfma_f32_32x32x16_bf16 v[64:79], a[232:235], v[120:123], v[64:79]
    v_exp_f32 v88, v88
    v_exp_f32 v89, v89
    v_exp_f32 v90, v90
    v_cvt_pk_bf16_f32 v115, v86, v87
    v_exp_f32 v91, v91
    v_cvt_pk_bf16_f32 v116, v88, v89
    v_mfma_f32_32x32x16_bf16 v[64:79], a[236:239], v[124:127], v[64:79]
    v_exp_f32 v92, v92
    v_exp_f32 v93, v93
    v_exp_f32 v94, v94
    v_cvt_pk_bf16_f32 v117, v90, v91
    v_exp_f32 v95, v95
    v_cvt_pk_bf16_f32 v118, v92, v93
    v_cvt_pk_bf16_f32 v119, v94, v95
    v_mfma_f32_32x32x16_bf16 v[80:95], a[182:185], v[136:139], 0
    buffer_load_dwordx4 v1, s[4:7], s35 offen offset:0 sc1 lds
    buffer_load_dwordx4 v1, s[4:7], s35 offen offset:1024 sc1 lds
    buffer_load_dwordx4 v1, s[4:7], s35 offen offset:2048 sc1 lds
    buffer_load_dwordx4 v1, s[4:7], s35 offen offset:3072 sc1 lds
    v_exp_f32 v96, v96
    v_exp_f32 v97, v97
    v_exp_f32 v98, v98
    v_exp_f32 v99, v99
    v_cvt_pk_bf16_f32 v120, v96, v97
    v_mfma_f32_32x32x8_bf16 v[80:95], a[190:191], v[152:153], v[80:95]
    v_exp_f32 v100, v100
    v_exp_f32 v101, v101
    v_exp_f32 v102, v102
    v_cvt_pk_bf16_f32 v121, v98, v99
    v_exp_f32 v103, v103
    v_cvt_pk_bf16_f32 v122, v100, v101
    v_mfma_f32_32x32x16_bf16 v[16:31], a[232:235], v[112:115], v[16:31]
    s_sub_u32 s35, s35, 16384
    v_exp_f32 v104, v104
    v_exp_f32 v105, v105
    v_exp_f32 v106, v106
    v_cvt_pk_bf16_f32 v123, v102, v103
    v_exp_f32 v107, v107
    v_cvt_pk_bf16_f32 v124, v104, v105
    v_mfma_f32_32x32x16_bf16 v[16:31], a[236:239], v[116:119], v[16:31]
    s_sub_u32 m0, m0, 16384
    v_exp_f32 v108, v108
    v_exp_f32 v109, v109
    v_exp_f32 v110, v110
    v_cvt_pk_bf16_f32 v125, v106, v107
    v_exp_f32 v111, v111
    v_cvt_pk_bf16_f32 v126, v108, v109
    v_cvt_pk_bf16_f32 v127, v110, v111
    v_mfma_f32_32x32x16_bf16 v[96:111], a[182:185], v[140:143], 0
    v_exp_f32 v80, v80
    v_exp_f32 v81, v81
    v_exp_f32 v82, v82
    v_exp_f32 v83, v83
    v_cvt_pk_bf16_f32 v112, v80, v81
    v_mfma_f32_32x32x8_bf16 v[96:111], a[190:191], v[156:157], v[96:111]
    v_exp_f32 v84, v84
    v_exp_f32 v85, v85
    v_exp_f32 v86, v86
    v_cvt_pk_bf16_f32 v113, v82, v83
    v_exp_f32 v87, v87
    v_cvt_pk_bf16_f32 v114, v84, v85
    v_mfma_f32_32x32x16_bf16 v[32:47], a[232:235], v[120:123], v[32:47]
    v_exp_f32 v88, v88
    v_exp_f32 v89, v89
    v_exp_f32 v90, v90
    v_cvt_pk_bf16_f32 v115, v86, v87
    v_exp_f32 v91, v91
    v_cvt_pk_bf16_f32 v116, v88, v89
    v_mfma_f32_32x32x16_bf16 v[32:47], a[236:239], v[124:127], v[32:47]
    v_exp_f32 v92, v92
    v_exp_f32 v93, v93
    v_exp_f32 v94, v94
    v_cvt_pk_bf16_f32 v117, v90, v91
    v_exp_f32 v95, v95
    v_cvt_pk_bf16_f32 v118, v92, v93
    v_cvt_pk_bf16_f32 v119, v94, v95
    v_mfma_f32_32x32x16_bf16 v[80:95], a[182:185], v[128:131], 0
    s_add_u32 s30, s30, 16384
    v_exp_f32 v96, v96
    v_exp_f32 v97, v97
    v_exp_f32 v98, v98
    v_exp_f32 v99, v99
    v_cvt_pk_bf16_f32 v120, v96, v97
    v_mfma_f32_32x32x8_bf16 v[80:95], a[190:191], v[144:145], v[80:95]
    v_exp_f32 v100, v100
    v_exp_f32 v101, v101
    v_exp_f32 v102, v102
    v_cvt_pk_bf16_f32 v121, v98, v99
    v_exp_f32 v103, v103
    v_cvt_pk_bf16_f32 v122, v100, v101
    v_mfma_f32_32x32x16_bf16 v[48:63], a[240:243], v[112:115], v[48:63]
    s_xor_b32 s28, s30, s31
    v_exp_f32 v104, v104
    v_exp_f32 v105, v105
    v_exp_f32 v106, v106
    v_cvt_pk_bf16_f32 v123, v102, v103
    v_exp_f32 v107, v107
    v_cvt_pk_bf16_f32 v124, v104, v105
    v_mfma_f32_32x32x16_bf16 v[48:63], a[244:247], v[116:119], v[48:63]
    buffer_load_dwordx2 a[180:181], v2, s[52:55], s28 offen
    buffer_load_dwordx4 a[172:175], v1, s[52:55], s28 offen offset:512
    buffer_load_dwordx4 a[176:179], v1, s[52:55], s28 offen offset:1536
    buffer_load_dwordx4 a[224:227], v3, s[52:55], s28 offen offset:0
    buffer_load_dwordx4 a[228:231], v3, s[52:55], s28 offen offset:592
    buffer_load_dwordx4 a[232:235], v3, s[52:55], s28 offen offset:1184
    buffer_load_dwordx4 a[236:239], v3, s[52:55], s28 offen offset:1776
    v_exp_f32 v108, v108
    v_exp_f32 v109, v109
    v_exp_f32 v110, v110
    v_cvt_pk_bf16_f32 v125, v106, v107
    v_exp_f32 v111, v111
    v_cvt_pk_bf16_f32 v126, v108, v109
    v_cvt_pk_bf16_f32 v127, v110, v111
    v_mfma_f32_32x32x16_bf16 v[96:111], a[182:185], v[132:135], 0
    v_exp_f32 v80, v80
    v_exp_f32 v81, v81
    v_exp_f32 v82, v82
    v_exp_f32 v83, v83
    v_cvt_pk_bf16_f32 v112, v80, v81
    v_mfma_f32_32x32x8_bf16 v[96:111], a[190:191], v[148:149], v[96:111]
    v_exp_f32 v84, v84
    v_exp_f32 v85, v85
    v_exp_f32 v86, v86
    v_cvt_pk_bf16_f32 v113, v82, v83
    v_exp_f32 v87, v87
    v_cvt_pk_bf16_f32 v114, v84, v85
    v_mfma_f32_32x32x16_bf16 v[64:79], a[240:243], v[120:123], v[64:79]
    s_cmp_eq_u32 s33, s100
    v_exp_f32 v88, v88
    v_exp_f32 v89, v89
    v_exp_f32 v90, v90
    v_cvt_pk_bf16_f32 v115, v86, v87
    v_exp_f32 v91, v91
    v_cvt_pk_bf16_f32 v116, v88, v89
    v_mfma_f32_32x32x16_bf16 v[64:79], a[244:247], v[124:127], v[64:79]
    s_cbranch_scc1 pack_blk
hook2:
    v_exp_f32 v92, v92
    v_exp_f32 v93, v93
    v_exp_f32 v94, v94
    v_cvt_pk_bf16_f32 v117, v90, v91
    v_exp_f32 v95, v95
    v_cvt_pk_bf16_f32 v118, v92, v93
    v_cvt_pk_bf16_f32 v119, v94, v95
    v_mfma_f32_32x32x16_bf16 v[80:95], a[186:189], v[136:139], 0
    s_cmp_eq_u32 s33, 2
    v_exp_f32 v96, v96
    v_exp_f32 v97, v97
    v_exp_f32 v98, v98
    v_exp_f32 v99, v99
    v_cvt_pk_bf16_f32 v120, v96, v97
    v_mfma_f32_32x32x8_bf16 v[80:95], a[190:191], v[154:155], v[80:95]
    v_exp_f32 v100, v100
    v_exp_f32 v101, v101
    v_exp_f32 v102, v102
    v_cvt_pk_bf16_f32 v121, v98, v99
    v_exp_f32 v103, v103
    v_cvt_pk_bf16_f32 v122, v100, v101
    v_mfma_f32_32x32x16_bf16 v[16:31], a[240:243], v[112:115], v[16:31]
    s_cmov_b32 s35, s38
    v_exp_f32 v104, v104
    v_exp_f32 v105, v105
    v_exp_f32 v106, v106
    v_cvt_pk_bf16_f32 v123, v102, v103
    v_exp_f32 v107, v107
    v_cvt_pk_bf16_f32 v124, v104, v105
    v_mfma_f32_32x32x16_bf16 v[16:31], a[244:247], v[116:119], v[16:31]
    s_cmov_b32 m0, s32
    v_exp_f32 v108, v108
    v_exp_f32 v109, v109
    v_exp_f32 v110, v110
    v_cvt_pk_bf16_f32 v125, v106, v107
    v_exp_f32 v111, v111
    v_cvt_pk_bf16_f32 v126, v108, v109
    v_cvt_pk_bf16_f32 v127, v110, v111
    v_mfma_f32_32x32x16_bf16 v[96:111], a[186:189], v[140:143], 0
    s_cmov_b32 s83, s84
    v_exp_f32 v80, v80
    v_exp_f32 v81, v81
    v_exp_f32 v82, v82
    v_exp_f32 v83, v83
    v_cvt_pk_bf16_f32 v112, v80, v81
    v_mfma_f32_32x32x8_bf16 v[96:111], a[190:191], v[158:159], v[96:111]
    v_exp_f32 v84, v84
    v_exp_f32 v85, v85
    v_exp_f32 v86, v86
    v_cvt_pk_bf16_f32 v113, v82, v83
    v_exp_f32 v87, v87
    v_cvt_pk_bf16_f32 v114, v84, v85
    v_mfma_f32_32x32x16_bf16 v[32:47], a[240:243], v[120:123], v[32:47]
    s_cmov_b32 s42, s12
    v_exp_f32 v88, v88
    v_exp_f32 v89, v89
    v_exp_f32 v90, v90
    v_cvt_pk_bf16_f32 v115, v86, v87
    v_exp_f32 v91, v91
    v_cvt_pk_bf16_f32 v116, v88, v89
    v_mfma_f32_32x32x16_bf16 v[32:47], a[244:247], v[124:127], v[32:47]
    v_exp_f32 v92, v92
    v_exp_f32 v93, v93
    v_exp_f32 v94, v94
    v_cvt_pk_bf16_f32 v117, v90, v91
    v_exp_f32 v95, v95
    v_cvt_pk_bf16_f32 v118, v92, v93
    v_cvt_pk_bf16_f32 v119, v94, v95
    v_mfma_f32_32x32x16_bf16 v[80:95], a[186:189], v[128:131], 0
    s_sub_u32 s33, s33, 1
    v_exp_f32 v96, v96
    v_exp_f32 v97, v97
    v_exp_f32 v98, v98
    v_exp_f32 v99, v99
    v_cvt_pk_bf16_f32 v120, v96, v97
    v_mfma_f32_32x32x8_bf16 v[80:95], a[190:191], v[146:147], v[80:95]
    v_exp_f32 v100, v100
    v_exp_f32 v101, v101
    v_exp_f32 v102, v102
    v_cvt_pk_bf16_f32 v121, v98, v99
    v_exp_f32 v103, v103
    v_cvt_pk_bf16_f32 v122, v100, v101
    v_mfma_f32_32x32x16_bf16 v[48:63], a[248:251], v[112:115], v[48:63]
    s_cmp_lg_u32 s33, 0
    v_exp_f32 v104, v104
    v_exp_f32 v105, v105
    v_exp_f32 v106, v106
    v_cvt_pk_bf16_f32 v123, v102, v103
    v_exp_f32 v107, v107
    v_cvt_pk_bf16_f32 v124, v104, v105
    v_mfma_f32_32x32x16_bf16 v[48:63], a[252:255], v[116:119], v[48:63]
    v_exp_f32 v108, v108
    v_exp_f32 v109, v109
    v_exp_f32 v110, v110
    v_cvt_pk_bf16_f32 v125, v106, v107
    v_exp_f32 v111, v111
    v_cvt_pk_bf16_f32 v126, v108, v109
    v_cvt_pk_bf16_f32 v127, v110, v111
    s_cbranch_scc1 att_l0
    v_mfma_f32_32x32x16_bf16 v[96:111], a[186:189], v[132:135], 0
    s_load_dwordx2 s[56:57], s[0:1], 0
    v_cmp_eq_u32 s[18:19], 2, v243
    v_exp_f32 v80, v80
    v_exp_f32 v81, v81
    v_exp_f32 v82, v82
    v_exp_f32 v83, v83
    v_cvt_pk_bf16_f32 v112, v80, v81
    v_mfma_f32_32x32x8_bf16 v[96:111], a[190:191], v[150:151], v[96:111]
    v_exp_f32 v84, v84
    v_exp_f32 v85, v85
    v_exp_f32 v86, v86
    v_cvt_pk_bf16_f32 v113, v82, v83
    v_exp_f32 v87, v87
    v_cvt_pk_bf16_f32 v114, v84, v85
    v_mfma_f32_32x32x16_bf16 v[64:79], a[248:251], v[120:123], v[64:79]
    ds_write_b128 v224, v[48:51] offset:0
    ds_write_b128 v224, v[52:55] offset:1024
    ds_write_b64 v225, v[56:57] offset:2048
    v_exp_f32 v88, v88
    v_exp_f32 v89, v89
    v_exp_f32 v90, v90
    v_cvt_pk_bf16_f32 v115, v86, v87
    v_exp_f32 v91, v91
    v_cvt_pk_bf16_f32 v116, v88, v89
    v_mfma_f32_32x32x16_bf16 v[64:79], a[252:255], v[124:127], v[64:79]
    s_xor_b32 s20, s19, s23
    v_exp_f32 v92, v92
    v_exp_f32 v93, v93
    v_exp_f32 v94, v94
    v_cvt_pk_bf16_f32 v117, v90, v91
    v_exp_f32 v95, v95
    v_cvt_pk_bf16_f32 v118, v92, v93
    v_cvt_pk_bf16_f32 v119, v94, v95
    v_exp_f32 v96, v96
    v_exp_f32 v97, v97
    v_exp_f32 v98, v98
    v_exp_f32 v99, v99
    v_cvt_pk_bf16_f32 v120, v96, v97
    v_mfma_f32_32x32x16_bf16 v[16:31], a[248:251], v[112:115], v[16:31]
    ds_write_b128 v224, v[64:67] offset:2560
    ds_write_b128 v224, v[68:71] offset:3584
    ds_write_b64 v225, v[72:73] offset:4608
    v_exp_f32 v100, v100
    v_exp_f32 v101, v101
    v_exp_f32 v102, v102
    v_cvt_pk_bf16_f32 v121, v98, v99
    v_exp_f32 v103, v103
    v_cvt_pk_bf16_f32 v122, v100, v101
    v_exp_f32 v104, v104
    v_exp_f32 v105, v105
    v_exp_f32 v106, v106
    v_mfma_f32_32x32x16_bf16 v[16:31], a[252:255], v[116:119], v[16:31]
    s_cmp_eq_u32 s13, 0
    v_cvt_pk_bf16_f32 v123, v102, v103
    v_exp_f32 v107, v107
    v_cvt_pk_bf16_f32 v124, v104, v105
    v_exp_f32 v108, v108
    v_exp_f32 v109, v109
    v_exp_f32 v110, v110
    v_cvt_pk_bf16_f32 v125, v106, v107
    v_exp_f32 v111, v111
    v_cvt_pk_bf16_f32 v126, v108, v109
    v_cvt_pk_bf16_f32 v127, v110, v111
    s_waitcnt lgkmcnt(0)
    s_barrier
    v_mfma_f32_32x32x16_bf16 v[32:47], a[248:251], v[120:123], v[32:47]
    ds_read_b64 v[184:185], v227 offset:2048
    ds_read_b64 v[200:201], v227 offset:4608
    ds_read_b128 v[176:179], v226 offset:0
    ds_read_b128 v[180:183], v226 offset:1024
    ds_read_b128 v[192:195], v226 offset:2560
    ds_read_b128 v[196:199], v226 offset:3584
    v_mfma_f32_32x32x16_bf16 v[32:47], a[252:255], v[124:127], v[32:47]
    s_cmov_b32 s82, s20
    s_lshr_b32 s20, s82, s21
    s_and_b32 s20, s20, 1
    s_lshl_b32 s20, s20, 13
    s_add_u32 s66, s66, s20
    s_add_u32 s68, s68, s20
    s_add_u32 s67, s66, 0x10000
    s_lshr_b32 s24, s82, s22
    s_and_b32 s24, s24, 1
    s_lshl_b32 s24, s24, 13
    s_mul_i32 s20, s24, s13
    s_add_u32 s70, s70, s20
    s_add_u32 s26, s26, s20
    s_add_u32 s71, s71, s20
    s_mov_b32 s58, 2359296
    s_cmp_lg_u32 s13, 0
    s_cmov_b32 s56, s48
    s_cmov_b32 s57, s49
    s_cmov_b32 s58, s50
    s_waitcnt lgkmcnt(5)
    v_pk_add_f32 v[24:25], v[24:25], v[184:185]
    s_waitcnt lgkmcnt(4)
    v_pk_add_f32 v[40:41], v[40:41], v[200:201]
    v_subrev_u32 v8, 0x2b800000, v25
    v_subrev_u32 v9, 0x2b800000, v41
    v_max_u32 v8, v8, v9
    v_cmp_lt_u32 vcc, 0x28000000, v8
    s_waitcnt lgkmcnt(3)
    v_pk_add_f32 v[16:17], v[16:17], v[176:177]
    v_pk_add_f32 v[18:19], v[18:19], v[178:179]
    s_waitcnt lgkmcnt(2)
    v_pk_add_f32 v[20:21], v[20:21], v[180:181]
    v_pk_add_f32 v[22:23], v[22:23], v[182:183]
    s_waitcnt lgkmcnt(1)
    v_pk_add_f32 v[32:33], v[32:33], v[192:193]
    v_pk_add_f32 v[34:35], v[34:35], v[194:195]
    s_waitcnt lgkmcnt(0)
    v_pk_add_f32 v[36:37], v[36:37], v[196:197]
    v_pk_add_f32 v[38:39], v[38:39], v[198:199]
    s_cbranch_vccnz att_exact
att_norm:
    v_rcp_f32 v26, v25
    v_rcp_f32 v42, v41
    v_pk_mul_f32 v[16:17], v[16:17], v[26:27] op_sel_hi:[1,0]
    v_pk_mul_f32 v[18:19], v[18:19], v[26:27] op_sel_hi:[1,0]
    v_pk_mul_f32 v[20:21], v[20:21], v[26:27] op_sel_hi:[1,0]
    v_pk_mul_f32 v[22:23], v[22:23], v[26:27] op_sel_hi:[1,0]
    v_mul_f32 v24, v24, v26
    v_cvt_pk_bf16_f32 v176, v16, v17
    v_cvt_pk_bf16_f32 v177, v18, v19
    v_cvt_pk_bf16_f32 v178, v20, v21
    v_cvt_pk_bf16_f32 v179, v22, v23
    buffer_store_dwordx4 v[176:179], v228, s[48:51], s66 offen sc1
    v_pk_mul_f32 v[32:33], v[32:33], v[42:43] op_sel_hi:[1,0]
    v_pk_mul_f32 v[34:35], v[34:35], v[42:43] op_sel_hi:[1,0]
    v_pk_mul_f32 v[36:37], v[36:37], v[42:43] op_sel_hi:[1,0]
    v_pk_mul_f32 v[38:39], v[38:39], v[42:43] op_sel_hi:[1,0]
    v_mul_f32 v40, v40, v42
    v_cvt_pk_bf16_f32 v192, v32, v33
    v_cvt_pk_bf16_f32 v193, v34, v35
    v_cvt_pk_bf16_f32 v194, v36, v37
    v_cvt_pk_bf16_f32 v195, v38, v39
    buffer_store_dwordx4 v[192:195], v228, s[48:51], s67 offen sc1
    v_permlane32_swap_b32 v24, v40
    v_cvt_pk_bf16_f32 v14, v24, v40
    buffer_store_dword v14, v229, s[48:51], s68 offen sc1
    buffer_load_dwordx4 v[160:163], v247, s[56:59], s70 offen sc1
    buffer_load_dwordx4 v[164:167], v247, s[56:59], s26 offen sc1
    buffer_load_dwordx2 v[168:169], v231, s[56:59], s71 offen sc1
    s_lshr_b32 s20, s82, 16
    s_and_b32 s20, s20, 1
    s_lshl_b32 s20, s20, 13
    s_add_u32 s69, s69, s20
    s_add_u32 s74, s74, s20
    s_add_u32 s79, s79, s20
    s_add_u32 s80, s80, s20
    s_add_u32 s75, s75, s24
    s_add_u32 s76, s76, s24
    s_add_u32 s78, s78, s24
    s_add_u32 s72, s72, s24
    s_add_u32 s27, s27, s24
    s_add_u32 s73, s73, s24
    s_mul_i32 s18, s3, 9216
    s_add_u32 s20, s37, s18
    s_add_u32 s20, s20, 73728
    s_mul_i32 s19, s3, 6144
    s_add_u32 s21, s37, s19
    s_add_u32 s21, s21, 49152
    ds_read_b128 a[0:3], v234 offset:0
    ds_read_b128 a[4:7], v234 offset:1024
    ds_read_b128 a[8:11], v234 offset:2048
    ds_read_b128 a[12:15], v234 offset:3072
    ds_read_b128 a[16:19], v234 offset:4096
    ds_read_b128 a[20:23], v234 offset:5120
    ds_read_b128 a[24:27], v234 offset:6144
    ds_read_b128 a[28:31], v234 offset:7168
    ds_read_b128 a[32:35], v234 offset:8192
    ds_read_b128 a[36:39], v234 offset:9216
    ds_read_b128 a[40:43], v234 offset:10240
    ds_read_b128 a[44:47], v234 offset:11264
    ds_read_b128 a[48:51], v234 offset:12288
    ds_read_b128 a[52:55], v234 offset:13312
    ds_read_b128 a[56:59], v234 offset:14336
    ds_read_b128 a[60:63], v234 offset:15360
    ds_read_b128 a[64:67], v234 offset:16384
    ds_read_b128 a[68:71], v234 offset:17408
    ds_read_b128 a[72:75], v234 offset:18432
    ds_read_b128 a[76:79], v234 offset:19456
    ds_read_b128 a[80:83], v234 offset:20480
    ds_read_b128 a[84:87], v234 offset:21504
    ds_read_b128 a[88:91], v234 offset:22528
    ds_read_b128 a[92:95], v234 offset:23552
    ds_read_b128 a[96:99], v234 offset:24576
    ds_read_b128 a[100:103], v234 offset:25600
    ds_read_b128 a[104:107], v234 offset:26624
    ds_read_b128 a[108:111], v234 offset:27648
    ds_read_b128 a[112:115], v234 offset:28672
    ds_read_b128 a[116:119], v234 offset:29696
    ds_read_b128 a[120:123], v234 offset:30720
    ds_read_b128 a[124:127], v234 offset:31744
    ds_read_b128 a[128:131], v234 offset:32768
    ds_read_b128 a[132:135], v234 offset:33792
    ds_read_b128 a[136:139], v234 offset:34816
    ds_read_b128 a[140:143], v234 offset:35840
    s_waitcnt vmcnt(3)
    buffer_store_dword v242, v219, s[88:91], s69 offen sc1
    ds_read_b128 a[144:147], v234 offset:36864
    ds_read_b128 a[148:151], v234 offset:37888
    ds_read_b128 a[152:155], v234 offset:38912
    ds_read_b128 a[156:159], v234 offset:39936
    ds_read_b128 a[160:163], v234 offset:40960
    ds_read_b128 a[164:167], v234 offset:41984
    ds_read_b128 a[168:171], v234 offset:43008
    ds_read_b128 a[172:175], v234 offset:44032
    ds_read_b128 a[176:179], v234 offset:45056
    ds_read_b128 a[180:183], v234 offset:46080
    ds_read_b128 a[184:187], v234 offset:47104
    ds_read_b128 a[188:191], v234 offset:48128
    ds_read_b128 a[192:195], v234 offset:49152
    ds_read_b128 a[196:199], v234 offset:50176
    ds_read_b128 a[200:203], v235 offset:18432
    ds_read_b128 a[204:207], v235 offset:19456
    ds_read_b128 a[208:211], v235 offset:20480
    ds_read_b128 a[212:215], v235 offset:21504
    ds_read_b128 a[216:219], v235 offset:22528
    ds_read_b128 a[220:223], v235 offset:23552
    ds_read_b128 a[224:227], v235 offset:24576
    ds_read_b128 a[228:231], v235 offset:25600
    ds_read_b128 a[232:235], v235 offset:26624
    ds_read_b128 a[236:239], v235 offset:27648
    ds_read_b128 v[88:91], v235 offset:28672
    ds_read_b128 v[92:95], v235 offset:29696
    ds_read_b128 v[96:99], v235 offset:30720
    ds_read_b128 v[100:103], v235 offset:31744
    ds_read_b128 v[104:107], v235 offset:32768
    ds_read_b128 v[108:111], v235 offset:33792
    ds_read_b128 v[112:115], v235 offset:34816
    ds_read_b128 v[116:119], v235 offset:35840
    ds_read_b128 v[120:123], v235 offset:36864
    ds_read_b128 v[124:127], v235 offset:37888
    s_cmp_lg_u32 s3, 0
    s_cbranch_scc1 opoll_skip
spin9:
    buffer_load_dword v9, v232, s[88:91], s74 offen sc1
    s_sub_u32 s14, s14, 1
    s_cbranch_scc1 spin9_out
    s_waitcnt vmcnt(0)
    v_cmp_gt_u32 vcc, 1, v9
    s_nop 0
    s_cbranch_vccnz spin9
back9:
opoll_skip:
    s_waitcnt lgkmcnt(0)
    s_barrier
    buffer_load_dwordx4 v[16:19], v1, s[48:51], s75 offen offset:0 sc1
    buffer_load_dwordx4 v[20:23], v1, s[48:51], s75 offen offset:1024 sc1
    buffer_load_dwordx4 v[24:27], v1, s[48:51], s75 offen offset:2048 sc1
    buffer_load_dwordx4 v[28:31], v1, s[48:51], s75 offen offset:3072 sc1
    s_add_u32 s75, s75, 4096
    buffer_load_dwordx4 v[32:35], v1, s[48:51], s75 offen offset:0 sc1
    buffer_load_dwordx4 v[36:39], v1, s[48:51], s75 offen offset:1024 sc1
    buffer_load_dwordx4 v[40:43], v1, s[48:51], s75 offen offset:2048 sc1
    buffer_load_dwordx4 v[44:47], v1, s[48:51], s75 offen offset:3072 sc1
    s_add_u32 s75, s75, 12288
    s_waitcnt vmcnt(11)
    v_lshlrev_b32 v176, 16, v160
    v_and_b32 v177, 0xffff0000, v160
    v_lshlrev_b32 v178, 16, v161
    v_and_b32 v179, 0xffff0000, v161
    v_lshlrev_b32 v180, 16, v162
    v_and_b32 v181, 0xffff0000, v162
    v_lshlrev_b32 v182, 16, v163
    v_and_b32 v183, 0xffff0000, v163
    s_waitcnt vmcnt(10)
    v_lshlrev_b32 v184, 16, v164
    v_and_b32 v185, 0xffff0000, v164
    v_lshlrev_b32 v186, 16, v165
    v_and_b32 v187, 0xffff0000, v165
    v_lshlrev_b32 v188, 16, v166
    v_and_b32 v189, 0xffff0000, v166
    v_lshlrev_b32 v190, 16, v167
    v_and_b32 v191, 0xffff0000, v167
    s_waitcnt vmcnt(9)
    v_lshlrev_b32 v192, 16, v168
    v_and_b32 v193, 0xffff0000, v168
    v_lshlrev_b32 v194, 16, v169
    v_and_b32 v195, 0xffff0000, v169
    s_waitcnt vmcnt(7)
    v_mfma_f32_16x16x32_bf16 v[176:179], a[0:3], v[16:19], v[176:179]
    buffer_load_dwordx4 v[48:51], v1, s[48:51], s75 offen offset:0 sc1
    v_mfma_f32_16x16x32_bf16 v[180:183], a[4:7], v[16:19], v[180:183]
    buffer_load_dwordx4 v[52:55], v1, s[48:51], s75 offen offset:1024 sc1
    v_mfma_f32_16x16x32_bf16 v[184:187], a[8:11], v[16:19], v[184:187]
    v_mfma_f32_16x16x32_bf16 v[188:191], a[12:15], v[16:19], v[188:191]
    buffer_load_dwordx4 v[56:59], v1, s[48:51], s75 offen offset:2048 sc1
    v_mfma_f32_16x16x32_bf16 v[192:195], a[16:19], v[16:19], v[192:195]
    buffer_load_dwordx4 v[60:63], v1, s[48:51], s75 offen offset:3072 sc1
    s_waitcnt vmcnt(10)
    v_mfma_f32_16x16x32_bf16 v[176:179], a[20:23], v[20:23], v[176:179]
    v_mfma_f32_16x16x32_bf16 v[180:183], a[24:27], v[20:23], v[180:183]
    s_add_u32 s75, s75, 4096
    v_mfma_f32_16x16x32_bf16 v[184:187], a[28:31], v[20:23], v[184:187]
    buffer_load_dwordx4 v[64:67], v1, s[48:51], s75 offen offset:0 sc1
    v_mfma_f32_16x16x32_bf16 v[188:191], a[32:35], v[20:23], v[188:191]
    v_mfma_f32_16x16x32_bf16 v[192:195], a[36:39], v[20:23], v[192:195]
    buffer_load_dwordx4 v[68:71], v1, s[48:51], s75 offen offset:1024 sc1
    s_waitcnt vmcnt(11)
    v_mfma_f32_16x16x32_bf16 v[176:179], a[40:43], v[24:27], v[176:179]
    v_mfma_f32_16x16x32_bf16 v[180:183], a[44:47], v[24:27], v[180:183]
    buffer_load_dwordx4 v[72:75], v1, s[48:51], s75 offen offset:2048 sc1
    v_mfma_f32_16x16x32_bf16 v[184:187], a[48:51], v[24:27], v[184:187]
    buffer_load_dwordx4 v[76:79], v1, s[48:51], s75 offen offset:3072 sc1
    v_mfma_f32_16x16x32_bf16 v[188:191], a[52:55], v[24:27], v[188:191]
    v_mfma_f32_16x16x32_bf16 v[192:195], a[56:59], v[24:27], v[192:195]
    s_add_u32 s75, s75, 4096
    s_waitcnt vmcnt(12)
    v_mfma_f32_16x16x32_bf16 v[176:179], a[60:63], v[28:31], v[176:179]
    buffer_load_dword v80, v233, s[48:51], s76 offen offset:0 sc1
    v_mfma_f32_16x16x32_bf16 v[180:183], a[64:67], v[28:31], v[180:183]
    v_mfma_f32_16x16x32_bf16 v[184:187], a[68:71], v[28:31], v[184:187]
    buffer_load_dword v81, v233, s[48:51], s76 offen offset:256 sc1
    v_mfma_f32_16x16x32_bf16 v[188:191], a[72:75], v[28:31], v[188:191]
    buffer_load_dword v82, v233, s[48:51], s76 offen offset:512 sc1
    v_mfma_f32_16x16x32_bf16 v[192:195], a[76:79], v[28:31], v[192:195]
    s_waitcnt vmcnt(14)
    v_mfma_f32_16x16x32_bf16 v[176:179], a[80:83], v[32:35], v[176:179]
    buffer_load_dword v83, v233, s[48:51], s76 offen offset:768 sc1
    v_mfma_f32_16x16x32_bf16 v[180:183], a[84:87], v[32:35], v[180:183]
    v_mfma_f32_16x16x32_bf16 v[184:187], a[88:91], v[32:35], v[184:187]
    s_add_u32 s76, s76, 4096
    v_mfma_f32_16x16x32_bf16 v[188:191], a[92:95], v[32:35], v[188:191]
    buffer_load_dword v84, v233, s[48:51], s76 offen offset:0 sc1
    v_mfma_f32_16x16x32_bf16 v[192:195], a[96:99], v[32:35], v[192:195]
    s_waitcnt vmcnt(15)
    v_mfma_f32_16x16x32_bf16 v[176:179], a[100:103], v[36:39], v[176:179]
    buffer_load_dword v85, v233, s[48:51], s76 offen offset:256 sc1
    v_mfma_f32_16x16x32_bf16 v[180:183], a[104:107], v[36:39], v[180:183]
    buffer_load_dword v86, v233, s[48:51], s76 offen offset:512 sc1
    v_mfma_f32_16x16x32_bf16 v[184:187], a[108:111], v[36:39], v[184:187]
    v_mfma_f32_16x16x32_bf16 v[188:191], a[112:115], v[36:39], v[188:191]
    buffer_load_dword v87, v233, s[48:51], s76 offen offset:768 sc1
    v_mfma_f32_16x16x32_bf16 v[192:195], a[116:119], v[36:39], v[192:195]
    s_waitcnt vmcnt(17)
    v_mfma_f32_16x16x32_bf16 v[176:179], a[120:123], v[40:43], v[176:179]
    s_add_u32 m0, s18, 73728
    v_mfma_f32_16x16x32_bf16 v[180:183], a[124:127], v[40:43], v[180:183]
    v_mfma_f32_16x16x32_bf16 v[184:187], a[128:131], v[40:43], v[184:187]
    buffer_load_dwordx4 v1, s[4:7], s20 offen offset:0 sc1 lds
    v_mfma_f32_16x16x32_bf16 v[188:191], a[132:135], v[40:43], v[188:191]
    v_mfma_f32_16x16x32_bf16 v[192:195], a[136:139], v[40:43], v[192:195]
    buffer_load_dwordx4 v1, s[4:7], s20 offen offset:1024 sc1 lds
    s_waitcnt vmcnt(18)
    v_mfma_f32_16x16x32_bf16 v[176:179], a[140:143], v[44:47], v[176:179]
    v_mfma_f32_16x16x32_bf16 v[180:183], a[144:147], v[44:47], v[180:183]
    v_mfma_f32_16x16x32_bf16 v[184:187], a[148:151], v[44:47], v[184:187]
    buffer_load_dwordx4 v1, s[4:7], s20 offen offset:2048 sc1 lds
    v_mfma_f32_16x16x32_bf16 v[188:191], a[152:155], v[44:47], v[188:191]
    v_mfma_f32_16x16x32_bf16 v[192:195], a[156:159], v[44:47], v[192:195]
    s_add_u32 s20, s20, 3072
    s_waitcnt vmcnt(18)
    v_mfma_f32_16x16x32_bf16 v[176:179], a[160:163], v[48:51], v[176:179]
    v_mfma_f32_16x16x32_bf16 v[180:183], a[164:167], v[48:51], v[180:183]
    v_mfma_f32_16x16x32_bf16 v[184:187], a[168:171], v[48:51], v[184:187]
    s_add_u32 m0, s18, 76800
    v_mfma_f32_16x16x32_bf16 v[188:191], a[172:175], v[48:51], v[188:191]
    v_mfma_f32_16x16x32_bf16 v[192:195], a[176:179], v[48:51], v[192:195]
    buffer_load_dwordx4 v1, s[4:7], s20 offen offset:0 sc1 lds
    s_waitcnt vmcnt(18)
    v_mfma_f32_16x16x32_bf16 v[176:179], a[180:183], v[52:55], v[176:179]
    v_mfma_f32_16x16x32_bf16 v[180:183], a[184:187], v[52:55], v[180:183]
    buffer_load_dwordx4 v1, s[4:7], s20 offen offset:1024 sc1 lds
    v_mfma_f32_16x16x32_bf16 v[184:187], a[188:191], v[52:55], v[184:187]
    v_mfma_f32_16x16x32_bf16 v[188:191], a[192:195], v[52:55], v[188:191]
    v_mfma_f32_16x16x32_bf16 v[192:195], a[196:199], v[52:55], v[192:195]
    buffer_load_dwordx4 v1, s[4:7], s20 offen offset:2048 sc1 lds
    s_waitcnt vmcnt(19)
    v_mfma_f32_16x16x32_bf16 v[176:179], a[200:203], v[56:59], v[176:179]
    v_mfma_f32_16x16x32_bf16 v[180:183], a[204:207], v[56:59], v[180:183]
    s_add_u32 s20, s20, 3072
    v_mfma_f32_16x16x32_bf16 v[184:187], a[208:211], v[56:59], v[184:187]
    v_mfma_f32_16x16x32_bf16 v[188:191], a[212:215], v[56:59], v[188:191]
    v_mfma_f32_16x16x32_bf16 v[192:195], a[216:219], v[56:59], v[192:195]
    s_add_u32 m0, s18, 79872
    s_waitcnt vmcnt(18)
    v_mfma_f32_16x16x32_bf16 v[176:179], a[220:223], v[60:63], v[176:179]
    v_mfma_f32_16x16x32_bf16 v[180:183], a[224:227], v[60:63], v[180:183]
    buffer_load_dwordx4 v1, s[4:7], s20 offen offset:0 sc1 lds
    v_mov_b32 v8, 0
    v_mfma_f32_16x16x32_bf16 v[184:187], a[228:231], v[60:63], v[184:187]
    v_mov_b32 v9, 0
    v_mfma_f32_16x16x32_bf16 v[188:191], a[232:235], v[60:63], v[188:191]
    buffer_load_dwordx4 v1, s[4:7], s20 offen offset:1024 sc1 lds
    v_mov_b32 v10, 0
    v_mfma_f32_16x16x32_bf16 v[192:195], a[236:239], v[60:63], v[192:195]
    v_mov_b32 v11, 0
    s_waitcnt vmcnt(19)
    v_mfma_f32_16x16x32_bf16 v[176:179], v[88:91], v[64:67], v[176:179]
    ds_read_b128 v[128:131], v235 offset:38912
    v_mfma_f32_16x16x32_bf16 v[180:183], v[92:95], v[64:67], v[180:183]
    buffer_load_dwordx4 v1, s[4:7], s20 offen offset:2048 sc1 lds
    ds_read_b128 v[132:135], v235 offset:39936
    v_mfma_f32_16x16x32_bf16 v[184:187], v[96:99], v[64:67], v[184:187]
    ds_read_b128 v[136:139], v235 offset:40960
    v_mfma_f32_16x16x32_bf16 v[188:191], v[100:103], v[64:67], v[188:191]
    s_add_u32 s20, s20, 30720
    ds_read_b128 v[140:143], v235 offset:41984
    v_mfma_f32_16x16x32_bf16 v[192:195], v[104:107], v[64:67], v[192:195]
    ds_read_b128 v[144:147], v235 offset:43008
    s_waitcnt vmcnt(19)
    v_mfma_f32_16x16x32_bf16 v[176:179], v[108:111], v[68:71], v[176:179]
    ds_read_b128 v[88:91], v235 offset:44032
    v_mfma_f32_16x16x32_bf16 v[180:183], v[112:115], v[68:71], v[180:183]
    ds_read_b128 v[92:95], v235 offset:45056
    v_mfma_f32_16x16x32_bf16 v[184:187], v[116:119], v[68:71], v[184:187]
    ds_read_b128 v[96:99], v235 offset:46080
    v_mfma_f32_16x16x32_bf16 v[188:191], v[120:123], v[68:71], v[188:191]
    ds_read_b128 v[100:103], v235 offset:47104
    v_mfma_f32_16x16x32_bf16 v[192:195], v[124:127], v[68:71], v[192:195]
    ds_read_b128 v[104:107], v235 offset:48128
    s_waitcnt vmcnt(18) lgkmcnt(9)
    v_mfma_f32_16x16x32_bf16 v[176:179], v[128:131], v[72:75], v[176:179]
    ds_read_b128 v[108:111], v235 offset:49152
    s_waitcnt lgkmcnt(9)
    v_mfma_f32_16x16x32_bf16 v[180:183], v[132:135], v[72:75], v[180:183]
    ds_read_b128 v[112:115], v235 offset:50176
    s_waitcnt lgkmcnt(9)
    v_mfma_f32_16x16x32_bf16 v[184:187], v[136:139], v[72:75], v[184:187]
    ds_read_b128 v[116:119], v235 offset:51200
    s_waitcnt lgkmcnt(9)
    v_mfma_f32_16x16x32_bf16 v[188:191], v[140:143], v[72:75], v[188:191]
    ds_read_b128 v[120:123], v235 offset:52224
    s_waitcnt lgkmcnt(9)
    v_mfma_f32_16x16x32_bf16 v[192:195], v[144:147], v[72:75], v[192:195]
    ds_read_b128 v[124:127], v235 offset:53248
    s_waitcnt vmcnt(17) lgkmcnt(9)
    v_mfma_f32_16x16x32_bf16 v[176:179], v[88:91], v[76:79], v[176:179]
    ds_read_b128 v[128:131], v235 offset:54272
    s_waitcnt lgkmcnt(9)
    v_mfma_f32_16x16x32_bf16 v[180:183], v[92:95], v[76:79], v[180:183]
    ds_read_b128 v[132:135], v235 offset:55296
    s_waitcnt lgkmcnt(9)
    v_mfma_f32_16x16x32_bf16 v[184:187], v[96:99], v[76:79], v[184:187]
    ds_read_b128 v[136:139], v235 offset:56320
    s_waitcnt lgkmcnt(9)
    v_mfma_f32_16x16x32_bf16 v[188:191], v[100:103], v[76:79], v[188:191]
    ds_read_b128 v[140:143], v235 offset:57344
    s_waitcnt lgkmcnt(9)
    v_mfma_f32_16x16x32_bf16 v[192:195], v[104:107], v[76:79], v[192:195]
    ds_read_b128 v[144:147], v235 offset:58368
    s_waitcnt vmcnt(13) lgkmcnt(9)
    v_mfma_f32_16x16x32_bf16 v[176:179], v[108:111], v[80:83], v[176:179]
    s_waitcnt lgkmcnt(8)
    v_mfma_f32_16x16x32_bf16 v[180:183], v[112:115], v[80:83], v[180:183]
    s_waitcnt lgkmcnt(7)
    v_mfma_f32_16x16x32_bf16 v[184:187], v[116:119], v[80:83], v[184:187]
    s_waitcnt lgkmcnt(6)
    v_mfma_f32_16x16x32_bf16 v[188:191], v[120:123], v[80:83], v[188:191]
    s_waitcnt lgkmcnt(5)
    v_mfma_f32_16x16x32_bf16 v[192:195], v[124:127], v[80:83], v[192:195]
    s_waitcnt vmcnt(9) lgkmcnt(4)
    v_mfma_f32_16x16x32_bf16 v[176:179], v[128:131], v[84:87], v[176:179]
    s_waitcnt lgkmcnt(3)
    v_mfma_f32_16x16x32_bf16 v[180:183], v[132:135], v[84:87], v[180:183]
    s_waitcnt lgkmcnt(2)
    v_mfma_f32_16x16x32_bf16 v[184:187], v[136:139], v[84:87], v[184:187]
    s_waitcnt lgkmcnt(1)
    v_mfma_f32_16x16x32_bf16 v[188:191], v[140:143], v[84:87], v[188:191]
    s_waitcnt lgkmcnt(0)
    v_mfma_f32_16x16x32_bf16 v[192:195], v[144:147], v[84:87], v[192:195]
    v_cvt_pk_bf16_f32 v200, v176, v177
    v_cvt_pk_bf16_f32 v201, v178, v179
    v_cvt_pk_bf16_f32 v202, v180, v181
    v_cvt_pk_bf16_f32 v203, v182, v183
    buffer_store_dwordx4 v[200:203], v1, s[48:51], s72 offen sc1
    v_cvt_pk_bf16_f32 v204, v184, v185
    v_cvt_pk_bf16_f32 v205, v186, v187
    v_cvt_pk_bf16_f32 v206, v188, v189
    v_cvt_pk_bf16_f32 v207, v190, v191
    buffer_store_dwordx4 v[204:207], v1, s[48:51], s27 offen sc1
    s_cmp_eq_u32 s77, 0
    s_cbranch_scc1 oproj_nohalf
    v_cvt_pk_bf16_f32 v208, v192, v193
    v_cvt_pk_bf16_f32 v209, v194, v195
    v_cvt_pk_bf16_f32 v210, v192, v193
    v_cvt_pk_bf16_f32 v211, v194, v195
    v_pk_add_f32 v[8:9], v[8:9], v[192:193]
    v_pk_fma_f32 v[10:11], v[192:193], v[192:193], v[10:11]
    v_permlane16_swap_b32 v208, v210
    v_permlane16_swap_b32 v209, v211
    buffer_store_dwordx4 v[208:211], v230, s[48:51], s73 offen sc1
    v_pk_add_f32 v[8:9], v[8:9], v[194:195]
    v_pk_fma_f32 v[10:11], v[194:195], v[194:195], v[10:11]
oproj_nohalf:
    v_pk_add_f32 v[8:9], v[8:9], v[176:177]
    v_pk_fma_f32 v[10:11], v[176:177], v[176:177], v[10:11]
    v_pk_add_f32 v[8:9], v[8:9], v[178:179]
    v_pk_fma_f32 v[10:11], v[178:179], v[178:179], v[10:11]
    v_pk_add_f32 v[8:9], v[8:9], v[180:181]
    v_pk_fma_f32 v[10:11], v[180:181], v[180:181], v[10:11]
    v_pk_add_f32 v[8:9], v[8:9], v[182:183]
    v_pk_fma_f32 v[10:11], v[182:183], v[182:183], v[10:11]
    v_pk_add_f32 v[8:9], v[8:9], v[184:185]
    v_pk_fma_f32 v[10:11], v[184:185], v[184:185], v[10:11]
    v_pk_add_f32 v[8:9], v[8:9], v[186:187]
    v_pk_fma_f32 v[10:11], v[186:187], v[186:187], v[10:11]
    v_pk_add_f32 v[8:9], v[8:9], v[188:189]
    v_pk_fma_f32 v[10:11], v[188:189], v[188:189], v[10:11]
    v_pk_add_f32 v[8:9], v[8:9], v[190:191]
    v_pk_fma_f32 v[10:11], v[190:191], v[190:191], v[10:11]
    v_add_f32 v8, v8, v9
    v_add_f32 v9, v10, v11
    v_mov_b32 v10, v8
    v_mov_b32 v11, v9
    s_nop 0
    v_permlane16_swap_b32 v8, v10
    v_permlane16_swap_b32 v9, v11
    v_add_f32 v8, v8, v10
    v_add_f32 v9, v9, v11
    v_mov_b32 v10, v8
    v_mov_b32 v11, v9
    s_nop 0
    v_permlane32_swap_b32 v8, v10
    v_permlane32_swap_b32 v9, v11
    v_add_f32 v8, v8, v10
    v_add_f32 v9, v9, v11
    buffer_store_dwordx2 v[8:9], v236, s[48:51], s78 offen sc1
    s_cmp_eq_u32 s13, 0
    s_cselect_b32 s85, s11, 1073741824
    s_and_b32 s15, s10, 15
    s_lshr_b32 s65, s82, s15
    s_and_b32 s65, s65, 1
    s_lshl_b32 s65, s65, 13
    s_lshl_b32 s15, s15, 21
    s_add_u32 s65, s65, s15
    s_add_u32 s24, s65, 0x1b0000
    s_add_u32 s25, s24, 34816
    s_add_u32 s26, s24, 69632
    s_add_u32 s27, s24, 104448
    s_add_u32 s22, s65, 0x1fc000
    v_and_b32 v7, 7, v0
    v_mul_u32_u24 v6, 128, v7
    v_mul_u32_u24 v7, 128, v7
    v_add_u32 v3, 49152, v1
    v_add_u32 v4, 98304, v1
    v_and_b32 v5, 15, v0
    v_lshlrev_b32 v5, 2, v5
    s_cmp_lg_u32 s3, 0
    s_cmov_b32 s79, 1073741824
    s_waitcnt vmcnt(0)
    s_barrier
    buffer_store_dword v242, v219, s[88:91], s79 offen sc1
    s_add_u32 m0, s19, 49152
    s_nop 0
    buffer_load_dwordx4 v1, s[4:7], s21 offen offset:0 sc1 lds
    buffer_load_dwordx4 v1, s[4:7], s21 offen offset:1024 sc1 lds
    buffer_load_dwordx4 v1, s[4:7], s21 offen offset:2048 sc1 lds
    s_add_u32 s21, s21, 3072
    s_add_u32 m0, s19, 52224
    s_nop 0
    buffer_load_dwordx4 v1, s[4:7], s21 offen offset:0 sc1 lds
    buffer_load_dwordx4 v1, s[4:7], s21 offen offset:1024 sc1 lds
    buffer_load_dwordx4 v1, s[4:7], s21 offen offset:2048 sc1 lds
    ds_read_b128 v[16:19], v1 offset:0
    ds_read_b128 v[20:23], v1 offset:1024
    ds_read_b128 v[24:27], v1 offset:2048
spin10:
    buffer_load_dword v9, v6, s[88:91], s80 offen sc1
    s_sub_u32 s14, s14, 1
    s_cbranch_scc1 spin10_out
    s_waitcnt vmcnt(0)
    v_cmp_gt_u32 vcc, 1, v9
    s_nop 0
    s_cbranch_vccnz spin10
back10:
    buffer_load_dwordx4 a[0:3], v1, s[48:51], s24 offen offset:0 sc1
    buffer_load_dwordx4 a[4:7], v1, s[48:51], s25 offen offset:0 sc1
    buffer_load_dwordx4 a[8:11], v1, s[48:51], s26 offen offset:0 sc1
    buffer_load_dwordx4 a[12:15], v1, s[48:51], s27 offen offset:0 sc1
    buffer_load_dwordx4 a[16:19], v1, s[48:51], s24 offen offset:1024 sc1
    buffer_load_dwordx4 a[20:23], v1, s[48:51], s25 offen offset:1024 sc1
    buffer_load_dwordx4 a[24:27], v1, s[48:51], s26 offen offset:1024 sc1
    buffer_load_dwordx4 a[28:31], v1, s[48:51], s27 offen offset:1024 sc1
    buffer_load_dwordx4 a[32:35], v1, s[48:51], s24 offen offset:2048 sc1
    s_waitcnt lgkmcnt(0)
    s_waitcnt vmcnt(8)
    v_mfma_f32_16x16x32_bf16 v[48:51], v[16:19], a[0:3], 0
    buffer_load_dwordx4 a[36:39], v1, s[48:51], s25 offen offset:2048 sc1
    ds_read_b128 v[28:31], v1 offset:3072
    s_waitcnt vmcnt(8)
    v_mfma_f32_16x16x32_bf16 v[56:59], v[16:19], a[4:7], 0
    ds_read_b128 v[32:35], v1 offset:4096
    s_waitcnt vmcnt(7)
    v_mfma_f32_16x16x32_bf16 v[64:67], v[16:19], a[8:11], 0
    s_waitcnt vmcnt(6)
    v_mfma_f32_16x16x32_bf16 v[72:75], v[16:19], a[12:15], 0
    buffer_load_dwordx4 a[40:43], v1, s[48:51], s26 offen offset:2048 sc1
    ds_read_b128 v[36:39], v1 offset:5120
    v_mfma_f32_16x16x32_bf16 v[52:55], v[20:23], a[0:3], 0
    s_lshr_b32 s44, s9, 3
    v_mfma_f32_16x16x32_bf16 v[60:63], v[20:23], a[4:7], 0
    v_mfma_f32_16x16x32_bf16 v[68:71], v[20:23], a[8:11], 0
    v_mfma_f32_16x16x32_bf16 v[76:79], v[20:23], a[12:15], 0
    s_add_u32 s27, s27, 10240
    v_mfma_f32_16x16x32_bf16 v[80:83], v[24:27], a[0:3], 0
    s_and_b32 s45, s9, 7
    v_mfma_f32_16x16x32_bf16 v[88:91], v[24:27], a[4:7], 0
    v_mfma_f32_16x16x32_bf16 v[96:99], v[24:27], a[8:11], 0
    buffer_load_dwordx4 a[44:47], v1, s[48:51], s27 offen offset:0 sc1
    v_mfma_f32_16x16x32_bf16 v[104:107], v[24:27], a[12:15], 0
    s_waitcnt lgkmcnt(0)
    v_mfma_f32_16x16x32_bf16 v[84:87], v[28:31], a[0:3], 0
    s_lshl_b32 s23, s44, 16
    ds_read_b128 v[16:19], v1 offset:6144
    v_mfma_f32_16x16x32_bf16 v[92:95], v[28:31], a[4:7], 0
    ds_read_b128 v[20:23], v1 offset:7168
    v_mfma_f32_16x16x32_bf16 v[100:103], v[28:31], a[8:11], 0
    buffer_load_dwordx4 a[48:51], v1, s[48:51], s24 offen offset:3072 sc1
    v_mfma_f32_16x16x32_bf16 v[108:111], v[28:31], a[12:15], 0
    ds_read_b128 v[24:27], v1 offset:8192
    v_mfma_f32_16x16x32_bf16 v[112:115], v[32:35], a[0:3], 0
    v_mfma_f32_16x16x32_bf16 v[120:123], v[32:35], a[4:7], 0
    s_add_u32 s24, s24, 4096
    s_lshl_b32 s28, s45, 10
    v_mfma_f32_16x16x32_bf16 v[128:131], v[32:35], a[8:11], 0
    v_mfma_f32_16x16x32_bf16 v[136:139], v[32:35], a[12:15], 0
    v_mfma_f32_16x16x32_bf16 v[116:119], v[36:39], a[0:3], 0
    v_mfma_f32_16x16x32_bf16 v[124:127], v[36:39], a[4:7], 0
    s_add_u32 s28, s28, s23
    buffer_load_dwordx4 a[64:67], v1, s[48:51], s24 offen offset:0 sc1
    v_mfma_f32_16x16x32_bf16 v[132:135], v[36:39], a[8:11], 0
    s_waitcnt vmcnt(6)
    v_mfma_f32_16x16x32_bf16 v[140:143], v[36:39], a[12:15], 0
    s_waitcnt lgkmcnt(0)
    v_mfma_f32_16x16x32_bf16 v[48:51], v[16:19], a[16:19], v[48:51]
    buffer_load_dwordx4 a[80:83], v1, s[48:51], s24 offen offset:1024 sc1
    ds_read_b128 v[28:31], v1 offset:9216
    v_mfma_f32_16x16x32_bf16 v[56:59], v[16:19], a[20:23], v[56:59]
    s_add_u32 s28, s28, s65
    ds_read_b128 v[32:35], v1 offset:10240
    v_mfma_f32_16x16x32_bf16 v[64:67], v[16:19], a[24:27], v[64:67]
    v_mfma_f32_16x16x32_bf16 v[72:75], v[16:19], a[28:31], v[72:75]
    ds_read_b128 v[36:39], v1 offset:11264
    v_mfma_f32_16x16x32_bf16 v[52:55], v[20:23], a[16:19], v[52:55]
    buffer_load_dwordx4 a[52:55], v1, s[48:51], s25 offen offset:3072 sc1
    v_mfma_f32_16x16x32_bf16 v[60:63], v[20:23], a[20:23], v[60:63]
    v_mfma_f32_16x16x32_bf16 v[68:71], v[20:23], a[24:27], v[68:71]
    s_and_b32 s46, s45, 1
    v_mfma_f32_16x16x32_bf16 v[76:79], v[20:23], a[28:31], v[76:79]
    s_add_u32 s25, s25, 4096
    v_mfma_f32_16x16x32_bf16 v[80:83], v[24:27], a[16:19], v[80:83]
    v_mfma_f32_16x16x32_bf16 v[88:91], v[24:27], a[20:23], v[88:91]
    v_mfma_f32_16x16x32_bf16 v[96:99], v[24:27], a[24:27], v[96:99]
    s_lshr_b32 s45, s45, 1
    v_mfma_f32_16x16x32_bf16 v[104:107], v[24:27], a[28:31], v[104:107]
    s_waitcnt lgkmcnt(0)
    buffer_load_dwordx4 a[68:71], v1, s[48:51], s25 offen offset:0 sc1
    v_mfma_f32_16x16x32_bf16 v[84:87], v[28:31], a[16:19], v[84:87]
    ds_read_b128 v[16:19], v1 offset:12288
    v_mfma_f32_16x16x32_bf16 v[92:95], v[28:31], a[20:23], v[92:95]
    ds_read_b128 v[20:23], v1 offset:13312
    v_mfma_f32_16x16x32_bf16 v[100:103], v[28:31], a[24:27], v[100:103]
    s_lshl_b32 s36, s44, 12
    buffer_load_dwordx4 a[84:87], v1, s[48:51], s25 offen offset:1024 sc1
    v_mfma_f32_16x16x32_bf16 v[108:111], v[28:31], a[28:31], v[108:111]
    ds_read_b128 v[24:27], v1 offset:14336
    v_mfma_f32_16x16x32_bf16 v[112:115], v[32:35], a[16:19], v[112:115]
    v_mfma_f32_16x16x32_bf16 v[120:123], v[32:35], a[20:23], v[120:123]
    v_mfma_f32_16x16x32_bf16 v[128:131], v[32:35], a[24:27], v[128:131]
    buffer_load_dwordx4 a[56:59], v1, s[48:51], s26 offen offset:3072 sc1
    v_mfma_f32_16x16x32_bf16 v[136:139], v[32:35], a[28:31], v[136:139]
    s_and_b32 s15, s36, 0xffffe000
    v_mfma_f32_16x16x32_bf16 v[116:119], v[36:39], a[16:19], v[116:119]
    v_mfma_f32_16x16x32_bf16 v[124:127], v[36:39], a[20:23], v[124:127]
    v_mfma_f32_16x16x32_bf16 v[132:135], v[36:39], a[24:27], v[132:135]
    s_waitcnt vmcnt(7)
    s_add_u32 s26, s26, 12288
    v_mfma_f32_16x16x32_bf16 v[140:143], v[36:39], a[28:31], v[140:143]
    s_waitcnt lgkmcnt(0)
    s_add_u32 s36, s36, s15
    v_mfma_f32_16x16x32_bf16 v[48:51], v[16:19], a[32:35], v[48:51]
    ds_read_b128 v[28:31], v1 offset:15360
    v_mfma_f32_16x16x32_bf16 v[56:59], v[16:19], a[36:39], v[56:59]
    buffer_load_dwordx4 a[72:75], v1, s[48:51], s26 offen offset:0 sc1
    ds_read_b128 v[32:35], v1 offset:16384
    v_mfma_f32_16x16x32_bf16 v[64:67], v[16:19], a[40:43], v[64:67]
    v_mfma_f32_16x16x32_bf16 v[72:75], v[16:19], a[44:47], v[72:75]
    s_add_u32 s36, s36, 262144
    ds_read_b128 v[36:39], v1 offset:17408
    v_mfma_f32_16x16x32_bf16 v[52:55], v[20:23], a[32:35], v[52:55]
    v_mfma_f32_16x16x32_bf16 v[60:63], v[20:23], a[36:39], v[60:63]
    buffer_load_dwordx4 a[88:91], v1, s[48:51], s26 offen offset:1024 sc1
    v_mfma_f32_16x16x32_bf16 v[68:71], v[20:23], a[40:43], v[68:71]
    v_mfma_f32_16x16x32_bf16 v[76:79], v[20:23], a[44:47], v[76:79]
    v_mfma_f32_16x16x32_bf16 v[80:83], v[24:27], a[32:35], v[80:83]
    s_lshl_b32 s32, s45, 10
    buffer_load_dwordx4 a[60:63], v1, s[48:51], s27 offen offset:1024 sc1
    v_mfma_f32_16x16x32_bf16 v[88:91], v[24:27], a[36:39], v[88:91]
    v_mfma_f32_16x16x32_bf16 v[96:99], v[24:27], a[40:43], v[96:99]
    v_mfma_f32_16x16x32_bf16 v[104:107], v[24:27], a[44:47], v[104:107]
    s_waitcnt lgkmcnt(0)
    v_mfma_f32_16x16x32_bf16 v[84:87], v[28:31], a[32:35], v[84:87]
    s_lshl_b32 s29, s46, 9
    buffer_load_dwordx4 a[76:79], v1, s[48:51], s27 offen offset:2048 sc1
    ds_read_b128 v[16:19], v1 offset:18432
    v_mfma_f32_16x16x32_bf16 v[92:95], v[28:31], a[36:39], v[92:95]
    ds_read_b128 v[20:23], v1 offset:24576
    v_mfma_f32_16x16x32_bf16 v[100:103], v[28:31], a[40:43], v[100:103]
    v_mfma_f32_16x16x32_bf16 v[108:111], v[28:31], a[44:47], v[108:111]
    buffer_load_dwordx4 a[92:95], v1, s[48:51], s27 offen offset:3072 sc1
    ds_read_b128 v[24:27], v1 offset:30720
    v_mfma_f32_16x16x32_bf16 v[112:115], v[32:35], a[32:35], v[112:115]
    s_add_u32 s32, s32, s29
    v_mfma_f32_16x16x32_bf16 v[120:123], v[32:35], a[36:39], v[120:123]
    v_mfma_f32_16x16x32_bf16 v[128:131], v[32:35], a[40:43], v[128:131]
    v_mfma_f32_16x16x32_bf16 v[136:139], v[32:35], a[44:47], v[136:139]
    buffer_load_dwordx4 a[96:99], v1, s[48:51], s24 offen offset:2048 sc1
    v_mfma_f32_16x16x32_bf16 v[116:119], v[36:39], a[32:35], v[116:119]
    v_mfma_f32_16x16x32_bf16 v[124:127], v[36:39], a[36:39], v[124:127]
    s_add_u32 s32, s32, s36
    v_mfma_f32_16x16x32_bf16 v[132:135], v[36:39], a[40:43], v[132:135]
    s_waitcnt vmcnt(10)
    buffer_load_dwordx4 a[112:115], v1, s[48:51], s24 offen offset:3072 sc1
    v_mfma_f32_16x16x32_bf16 v[140:143], v[36:39], a[44:47], v[140:143]
    s_waitcnt lgkmcnt(0)
    v_mfma_f32_16x16x32_bf16 v[48:51], v[16:19], a[48:51], v[48:51]
    ds_read_b128 v[28:31], v1 offset:19456
    v_mfma_f32_16x16x32_bf16 v[48:51], v[20:23], a[64:67], v[48:51]
    s_waitcnt vmcnt(8)
    s_add_u32 s32, s32, s65
    ds_read_b128 v[32:35], v1 offset:25600
    v_mfma_f32_16x16x32_bf16 v[48:51], v[24:27], a[80:83], v[48:51]
    s_add_u32 s24, s24, 12288
    v_mfma_f32_16x16x32_bf16 v[56:59], v[16:19], a[52:55], v[56:59]
    ds_read_b128 v[36:39], v1 offset:31744
    v_mfma_f32_16x16x32_bf16 v[56:59], v[20:23], a[68:71], v[56:59]
    s_waitcnt vmcnt(5)
    v_mfma_f32_16x16x32_bf16 v[56:59], v[24:27], a[84:87], v[56:59]
    buffer_load_dwordx4 a[128:131], v1, s[48:51], s24 offen offset:0 sc1
    v_mfma_f32_16x16x32_bf16 v[64:67], v[16:19], a[56:59], v[64:67]
    s_add_u32 s29, s28, 294912
    v_mfma_f32_16x16x32_bf16 v[64:67], v[20:23], a[72:75], v[64:67]
    s_waitcnt vmcnt(3)
    v_mfma_f32_16x16x32_bf16 v[64:67], v[24:27], a[88:91], v[64:67]
    v_mfma_f32_16x16x32_bf16 v[72:75], v[16:19], a[60:63], v[72:75]
    s_add_u32 s25, s25, 10240
    v_mfma_f32_16x16x32_bf16 v[72:75], v[20:23], a[76:79], v[72:75]
    s_add_u32 s30, s29, 294912
    v_mfma_f32_16x16x32_bf16 v[72:75], v[24:27], a[92:95], v[72:75]
    s_waitcnt lgkmcnt(0)
    v_mfma_f32_16x16x32_bf16 v[52:55], v[28:31], a[48:51], v[52:55]
    ds_read_b128 v[16:19], v1 offset:20480
    v_mfma_f32_16x16x32_bf16 v[52:55], v[32:35], a[64:67], v[52:55]
    buffer_load_dwordx4 a[100:103], v1, s[48:51], s25 offen offset:0 sc1
    ds_read_b128 v[20:23], v1 offset:26624
    v_mfma_f32_16x16x32_bf16 v[52:55], v[36:39], a[80:83], v[52:55]
    s_add_u32 s31, s30, 294912
    v_mfma_f32_16x16x32_bf16 v[60:63], v[28:31], a[52:55], v[60:63]
    ds_read_b128 v[24:27], v1 offset:32768
    v_mfma_f32_16x16x32_bf16 v[60:63], v[32:35], a[68:71], v[60:63]
    buffer_load_dwordx4 a[116:119], v1, s[48:51], s25 offen offset:1024 sc1
    v_mfma_f32_16x16x32_bf16 v[60:63], v[36:39], a[84:87], v[60:63]
    v_mfma_f32_16x16x32_bf16 v[68:71], v[28:31], a[56:59], v[68:71]
    v_mfma_f32_16x16x32_bf16 v[68:71], v[32:35], a[72:75], v[68:71]
    s_add_u32 s33, s32, 589824
    v_mfma_f32_16x16x32_bf16 v[68:71], v[36:39], a[88:91], v[68:71]
    buffer_load_dwordx4 a[132:135], v1, s[48:51], s25 offen offset:2048 sc1
    v_mfma_f32_16x16x32_bf16 v[76:79], v[28:31], a[60:63], v[76:79]
    v_mfma_f32_16x16x32_bf16 v[76:79], v[32:35], a[76:79], v[76:79]
    v_mfma_f32_16x16x32_bf16 v[76:79], v[36:39], a[92:95], v[76:79]
    s_waitcnt lgkmcnt(0)
    buffer_load_dwordx4 a[104:107], v1, s[48:51], s26 offen offset:2048 sc1
    v_lshrrev_b32 v10, 5, v0
    v_mfma_f32_16x16x32_bf16 v[80:83], v[16:19], a[48:51], v[80:83]
    ds_read_b128 v[28:31], v1 offset:21504
    v_mfma_f32_16x16x32_bf16 v[80:83], v[20:23], a[64:67], v[80:83]
    ds_read_b128 v[32:35], v1 offset:27648
    v_mfma_f32_16x16x32_bf16 v[80:83], v[24:27], a[80:83], v[80:83]
    v_mfma_f32_16x16x32_bf16 v[88:91], v[16:19], a[52:55], v[88:91]
    buffer_load_dwordx4 a[120:123], v1, s[48:51], s26 offen offset:3072 sc1
    ds_read_b128 v[36:39], v1 offset:33792
    v_mfma_f32_16x16x32_bf16 v[88:91], v[20:23], a[68:71], v[88:91]
    buffer_load_dwordx2 v[144:145], v2, s[48:51], s22 offen offset:0 sc1
    v_lshlrev_b32 v10, 8, v10
    v_mfma_f32_16x16x32_bf16 v[88:91], v[24:27], a[84:87], v[88:91]
    v_mfma_f32_16x16x32_bf16 v[96:99], v[16:19], a[56:59], v[96:99]
    s_add_u32 s26, s26, 4096
    v_mfma_f32_16x16x32_bf16 v[96:99], v[20:23], a[72:75], v[96:99]
    v_mfma_f32_16x16x32_bf16 v[96:99], v[24:27], a[88:91], v[96:99]
    v_lshl_add_u32 v10, v5, 2, v10
    v_mfma_f32_16x16x32_bf16 v[104:107], v[16:19], a[60:63], v[104:107]
    v_mfma_f32_16x16x32_bf16 v[104:107], v[20:23], a[76:79], v[104:107]
    buffer_load_dwordx4 a[136:139], v1, s[48:51], s26 offen offset:0 sc1
    v_mfma_f32_16x16x32_bf16 v[104:107], v[24:27], a[92:95], v[104:107]
    s_waitcnt lgkmcnt(0)
    v_mfma_f32_16x16x32_bf16 v[84:87], v[28:31], a[48:51], v[84:87]
    ds_read_b128 v[16:19], v1 offset:22528
    v_bfe_u32 v11, v0, 4, 1
    v_mfma_f32_16x16x32_bf16 v[84:87], v[32:35], a[64:67], v[84:87]
    s_add_u32 s27, s27, 4096
    ds_read_b128 v[20:23], v1 offset:28672
    v_mfma_f32_16x16x32_bf16 v[84:87], v[36:39], a[80:83], v[84:87]
    v_mfma_f32_16x16x32_bf16 v[92:95], v[28:31], a[52:55], v[92:95]
    ds_read_b128 v[24:27], v1 offset:34816
    v_mfma_f32_16x16x32_bf16 v[92:95], v[32:35], a[68:71], v[92:95]
    buffer_load_dwordx2 v[146:147], v2, s[48:51], s22 offen offset:512 sc1
    v_mul_u32_u24 v6, 294912, v11
    v_mfma_f32_16x16x32_bf16 v[92:95], v[36:39], a[84:87], v[92:95]
    buffer_load_dwordx4 a[108:111], v1, s[48:51], s27 offen offset:0 sc1
    v_mfma_f32_16x16x32_bf16 v[100:103], v[28:31], a[56:59], v[100:103]
    v_mfma_f32_16x16x32_bf16 v[100:103], v[32:35], a[72:75], v[100:103]
    v_mfma_f32_16x16x32_bf16 v[100:103], v[36:39], a[88:91], v[100:103]
    buffer_load_dwordx4 a[124:127], v1, s[48:51], s27 offen offset:1024 sc1
    v_mfma_f32_16x16x32_bf16 v[108:111], v[28:31], a[60:63], v[108:111]
    v_add_u32 v10, v10, v6
    v_mfma_f32_16x16x32_bf16 v[108:111], v[32:35], a[76:79], v[108:111]
    v_mfma_f32_16x16x32_bf16 v[108:111], v[36:39], a[92:95], v[108:111]
    s_waitcnt lgkmcnt(0)
    v_mfma_f32_16x16x32_bf16 v[112:115], v[16:19], a[48:51], v[112:115]
    buffer_load_dwordx4 a[140:143], v1, s[48:51], s27 offen offset:2048 sc1
    ds_read_b128 v[28:31], v1 offset:23552
    v_mfma_f32_16x16x32_bf16 v[112:115], v[20:23], a[64:67], v[112:115]
    s_lshl_b32 s16, s8, 1
    ds_read_b128 v[32:35], v1 offset:29696
    v_mfma_f32_16x16x32_bf16 v[112:115], v[24:27], a[80:83], v[112:115]
    v_mfma_f32_16x16x32_bf16 v[120:123], v[16:19], a[52:55], v[120:123]
    ds_read_b128 v[36:39], v1 offset:35840
    v_mfma_f32_16x16x32_bf16 v[120:123], v[20:23], a[68:71], v[120:123]
    buffer_load_dwordx4 a[144:147], v1, s[48:51], s24 offen offset:1024 sc1
    v_mfma_f32_16x16x32_bf16 v[120:123], v[24:27], a[84:87], v[120:123]
    s_add_u32 s46, s46, s16
    buffer_load_dwordx2 v[148:149], v2, s[48:51], s22 offen offset:1024 sc1
    v_mfma_f32_16x16x32_bf16 v[128:131], v[16:19], a[56:59], v[128:131]
    v_mfma_f32_16x16x32_bf16 v[128:131], v[20:23], a[72:75], v[128:131]
    buffer_load_dwordx4 a[160:163], v1, s[48:51], s24 offen offset:2048 sc1
    v_mfma_f32_16x16x32_bf16 v[128:131], v[24:27], a[88:91], v[128:131]
    v_mfma_f32_16x16x32_bf16 v[136:139], v[16:19], a[60:63], v[136:139]
    v_mfma_f32_16x16x32_bf16 v[136:139], v[20:23], a[76:79], v[136:139]
    s_lshl_b32 s46, s46, 2
    v_mfma_f32_16x16x32_bf16 v[136:139], v[24:27], a[92:95], v[136:139]
    s_waitcnt lgkmcnt(0)
    buffer_load_dwordx4 a[176:179], v1, s[48:51], s24 offen offset:3072 sc1
    v_mfma_f32_16x16x32_bf16 v[116:119], v[28:31], a[48:51], v[116:119]
    s_barrier
    v_mfma_f32_16x16x32_bf16 v[116:119], v[32:35], a[64:67], v[116:119]
    ds_read_b128 v[16:19], v1 offset:36864
    v_mfma_f32_16x16x32_bf16 v[116:119], v[36:39], a[80:83], v[116:119]
    s_add_u32 s46, s46, s3
    buffer_load_dwordx4 a[148:151], v1, s[48:51], s25 offen offset:3072 sc1
    ds_read_b128 v[20:23], v1 offset:43008
    v_mfma_f32_16x16x32_bf16 v[124:127], v[28:31], a[52:55], v[124:127]
    v_mfma_f32_16x16x32_bf16 v[124:127], v[32:35], a[68:71], v[124:127]
    ds_read_b128 v[24:27], v3 offset:0
    v_mfma_f32_16x16x32_bf16 v[124:127], v[36:39], a[84:87], v[124:127]
    buffer_load_dwordx2 v[150:151], v2, s[48:51], s22 offen offset:1536 sc1
    v_mfma_f32_16x16x32_bf16 v[132:135], v[28:31], a[56:59], v[132:135]
    s_add_u32 s25, s25, 4096
    s_lshr_b32 s16, s46, 1
    v_mfma_f32_16x16x32_bf16 v[132:135], v[32:35], a[72:75], v[132:135]
    v_mfma_f32_16x16x32_bf16 v[132:135], v[36:39], a[88:91], v[132:135]
    v_mfma_f32_16x16x32_bf16 v[140:143], v[28:31], a[60:63], v[140:143]
    buffer_load_dwordx4 a[164:167], v1, s[48:51], s25 offen offset:0 sc1
    v_mfma_f32_16x16x32_bf16 v[140:143], v[32:35], a[76:79], v[140:143]
    s_waitcnt vmcnt(18)
    v_mfma_f32_16x16x32_bf16 v[140:143], v[36:39], a[92:95], v[140:143]
    s_waitcnt lgkmcnt(0)
    s_and_b32 s15, s16, 15
    v_mfma_f32_16x16x32_bf16 v[48:51], v[16:19], a[96:99], v[48:51]
    ds_read_b128 v[28:31], v1 offset:37888
    v_mfma_f32_16x16x32_bf16 v[48:51], v[20:23], a[112:115], v[48:51]
    s_waitcnt vmcnt(15)
    buffer_load_dwordx4 a[180:183], v1, s[48:51], s25 offen offset:1024 sc1
    ds_read_b128 v[32:35], v1 offset:44032
    v_mfma_f32_16x16x32_bf16 v[48:51], v[24:27], a[128:131], v[48:51]
    v_mfma_f32_16x16x32_bf16 v[56:59], v[16:19], a[100:103], v[56:59]
    s_lshr_b32 s64, s82, s15
    ds_read_b128 v[36:39], v3 offset:1024
    v_mfma_f32_16x16x32_bf16 v[56:59], v[20:23], a[116:119], v[56:59]
    s_waitcnt vmcnt(12)
    buffer_load_dwordx4 a[152:155], v1, s[48:51], s26 offen offset:1024 sc1
    v_mfma_f32_16x16x32_bf16 v[56:59], v[24:27], a[132:135], v[56:59]
    v_mfma_f32_16x16x32_bf16 v[64:67], v[16:19], a[104:107], v[64:67]
    buffer_load_dwordx2 v[152:153], v2, s[48:51], s22 offen offset:2048 sc1
    v_mfma_f32_16x16x32_bf16 v[64:67], v[20:23], a[120:123], v[64:67]
    s_waitcnt vmcnt(10)
    v_mfma_f32_16x16x32_bf16 v[64:67], v[24:27], a[136:139], v[64:67]
    s_and_b32 s64, s64, 1
    buffer_load_dwordx4 a[168:171], v1, s[48:51], s26 offen offset:2048 sc1
    v_mfma_f32_16x16x32_bf16 v[72:75], v[16:19], a[108:111], v[72:75]
    v_mfma_f32_16x16x32_bf16 v[72:75], v[20:23], a[124:127], v[72:75]
    v_mfma_f32_16x16x32_bf16 v[72:75], v[24:27], a[140:143], v[72:75]
    s_waitcnt lgkmcnt(0)
    buffer_load_dwordx4 a[184:187], v1, s[48:51], s26 offen offset:3072 sc1
    v_mfma_f32_16x16x32_bf16 v[52:55], v[28:31], a[96:99], v[52:55]
    s_lshl_b32 s64, s64, 13
    ds_read_b128 v[16:19], v1 offset:38912
    v_mfma_f32_16x16x32_bf16 v[52:55], v[32:35], a[112:115], v[52:55]
    ds_read_b128 v[20:23], v1 offset:45056
    v_mfma_f32_16x16x32_bf16 v[52:55], v[36:39], a[128:131], v[52:55]
    v_mfma_f32_16x16x32_bf16 v[60:63], v[28:31], a[100:103], v[60:63]
    buffer_load_dwordx4 a[156:159], v1, s[48:51], s27 offen offset:3072 sc1
    ds_read_b128 v[24:27], v3 offset:2048
    v_mfma_f32_16x16x32_bf16 v[60:63], v[32:35], a[116:119], v[60:63]
    s_lshl_b32 s15, s15, 21
    v_mfma_f32_16x16x32_bf16 v[60:63], v[36:39], a[132:135], v[60:63]
    v_mfma_f32_16x16x32_bf16 v[68:71], v[28:31], a[104:107], v[68:71]
    buffer_load_dwordx2 v[154:155], v2, s[48:51], s22 offen offset:2560 sc1
    v_mfma_f32_16x16x32_bf16 v[68:71], v[32:35], a[120:123], v[68:71]
    s_add_u32 s27, s27, 12288
    v_mfma_f32_16x16x32_bf16 v[68:71], v[36:39], a[136:139], v[68:71]
    v_mfma_f32_16x16x32_bf16 v[76:79], v[28:31], a[108:111], v[76:79]
    s_add_u32 s64, s64, s15
    v_mfma_f32_16x16x32_bf16 v[76:79], v[32:35], a[124:127], v[76:79]
    buffer_load_dwordx4 a[172:175], v1, s[48:51], s27 offen offset:0 sc1
    v_mfma_f32_16x16x32_bf16 v[76:79], v[36:39], a[140:143], v[76:79]
    s_waitcnt lgkmcnt(0)
    v_mfma_f32_16x16x32_bf16 v[80:83], v[16:19], a[96:99], v[80:83]
    ds_read_b128 v[28:31], v1 offset:39936
    v_mfma_f32_16x16x32_bf16 v[80:83], v[20:23], a[112:115], v[80:83]
    s_and_b32 s38, s3, 1
    ds_read_b128 v[32:35], v1 offset:46080
    v_mfma_f32_16x16x32_bf16 v[80:83], v[24:27], a[128:131], v[80:83]
    buffer_load_dwordx4 a[188:191], v1, s[48:51], s27 offen offset:1024 sc1
    v_mfma_f32_16x16x32_bf16 v[88:91], v[16:19], a[100:103], v[88:91]
    ds_read_b128 v[36:39], v3 offset:3072
    v_mfma_f32_16x16x32_bf16 v[88:91], v[20:23], a[116:119], v[88:91]
    v_mfma_f32_16x16x32_bf16 v[88:91], v[24:27], a[132:135], v[88:91]
    s_add_u32 s24, s24, 4096
    s_mul_i32 s38, s38, 589824
    v_mfma_f32_16x16x32_bf16 v[96:99], v[16:19], a[104:107], v[96:99]
    v_mfma_f32_16x16x32_bf16 v[96:99], v[20:23], a[120:123], v[96:99]
    buffer_load_dwordx2 v[156:157], v2, s[48:51], s22 offen offset:3072 sc1
    v_mfma_f32_16x16x32_bf16 v[96:99], v[24:27], a[136:139], v[96:99]
    v_mfma_f32_16x16x32_bf16 v[104:107], v[16:19], a[108:111], v[104:107]
    buffer_load_dwordx4 a[192:195], v1, s[48:51], s24 offen offset:0 sc1
    v_mfma_f32_16x16x32_bf16 v[104:107], v[20:23], a[124:127], v[104:107]
    s_add_u32 s38, s38, s64
    v_mfma_f32_16x16x32_bf16 v[104:107], v[24:27], a[140:143], v[104:107]
    s_waitcnt lgkmcnt(0)
    v_mfma_f32_16x16x32_bf16 v[84:87], v[28:31], a[96:99], v[84:87]
    buffer_load_dwordx4 a[208:211], v1, s[48:51], s24 offen offset:1024 sc1
    ds_read_b128 v[16:19], v1 offset:40960
    v_mfma_f32_16x16x32_bf16 v[84:87], v[32:35], a[112:115], v[84:87]
    ds_read_b128 v[20:23], v1 offset:47104
    v_mfma_f32_16x16x32_bf16 v[84:87], v[36:39], a[128:131], v[84:87]
    s_add_u32 s34, s38, s36
    v_mfma_f32_16x16x32_bf16 v[92:95], v[28:31], a[100:103], v[92:95]
    ds_read_b128 v[24:27], v3 offset:4096
    v_mfma_f32_16x16x32_bf16 v[92:95], v[32:35], a[116:119], v[92:95]
    buffer_load_dwordx4 a[224:227], v1, s[48:51], s24 offen offset:2048 sc1
    v_mfma_f32_16x16x32_bf16 v[92:95], v[36:39], a[132:135], v[92:95]
    v_mfma_f32_16x16x32_bf16 v[100:103], v[28:31], a[104:107], v[100:103]
    s_add_u32 s35, s34, 294912
    v_mfma_f32_16x16x32_bf16 v[100:103], v[32:35], a[120:123], v[100:103]
    buffer_load_dwordx4 a[196:199], v1, s[48:51], s25 offen offset:2048 sc1
    v_mfma_f32_16x16x32_bf16 v[100:103], v[36:39], a[136:139], v[100:103]
    buffer_load_dwordx2 v[158:159], v2, s[48:51], s22 offen offset:3584 sc1
    v_mfma_f32_16x16x32_bf16 v[108:111], v[28:31], a[108:111], v[108:111]
    v_mfma_f32_16x16x32_bf16 v[108:111], v[32:35], a[124:127], v[108:111]
    v_mfma_f32_16x16x32_bf16 v[108:111], v[36:39], a[140:143], v[108:111]
    s_waitcnt lgkmcnt(0)
    s_add_u32 s38, s38, s23
    buffer_load_dwordx4 a[212:215], v1, s[48:51], s25 offen offset:3072 sc1
    v_mfma_f32_16x16x32_bf16 v[112:115], v[16:19], a[96:99], v[112:115]
    ds_read_b128 v[28:31], v1 offset:41984
    v_mfma_f32_16x16x32_bf16 v[112:115], v[20:23], a[112:115], v[112:115]
    ds_read_b128 v[32:35], v1 offset:48128
    v_mfma_f32_16x16x32_bf16 v[112:115], v[24:27], a[128:131], v[112:115]
    s_add_u32 s25, s25, 12288
    v_mfma_f32_16x16x32_bf16 v[120:123], v[16:19], a[100:103], v[120:123]
    s_add_u32 s39, s38, 294912
    ds_read_b128 v[36:39], v3 offset:5120
    v_mfma_f32_16x16x32_bf16 v[120:123], v[20:23], a[116:119], v[120:123]
    v_mfma_f32_16x16x32_bf16 v[120:123], v[24:27], a[132:135], v[120:123]
    v_mfma_f32_16x16x32_bf16 v[128:131], v[16:19], a[104:107], v[128:131]
    buffer_load_dwordx4 a[228:231], v1, s[48:51], s25 offen offset:0 sc1
    v_mfma_f32_16x16x32_bf16 v[128:131], v[20:23], a[120:123], v[128:131]
    s_lshl_b32 s47, s44, 2
    v_mfma_f32_16x16x32_bf16 v[128:131], v[24:27], a[136:139], v[128:131]
    v_mfma_f32_16x16x32_bf16 v[136:139], v[16:19], a[108:111], v[136:139]
    v_mfma_f32_16x16x32_bf16 v[136:139], v[20:23], a[124:127], v[136:139]
    s_add_u32 s26, s26, 12288
    v_mfma_f32_16x16x32_bf16 v[136:139], v[24:27], a[140:143], v[136:139]
    s_waitcnt lgkmcnt(0)
    v_mfma_f32_16x16x32_bf16 v[116:119], v[28:31], a[96:99], v[116:119]
    s_add_u32 s47, s47, s45
    ds_read_b128 v[16:19], v3 offset:6144
    v_mfma_f32_16x16x32_bf16 v[116:119], v[32:35], a[112:115], v[116:119]
    buffer_load_dwordx4 a[200:203], v1, s[48:51], s26 offen offset:0 sc1
    ds_read_b128 v[20:23], v3 offset:12288
    v_mfma_f32_16x16x32_bf16 v[116:119], v[36:39], a[128:131], v[116:119]
    v_mfma_f32_16x16x32_bf16 v[124:127], v[28:31], a[100:103], v[124:127]
    ds_read_b128 v[24:27], v3 offset:18432
    v_mfma_f32_16x16x32_bf16 v[124:127], v[32:35], a[116:119], v[124:127]
    s_mul_i32 s40, s47, 331776
    v_mfma_f32_16x16x32_bf16 v[124:127], v[36:39], a[132:135], v[124:127]
    buffer_load_dwordx4 a[216:219], v1, s[48:51], s26 offen offset:1024 sc1
    v_mfma_f32_16x16x32_bf16 v[132:135], v[28:31], a[104:107], v[132:135]
    v_mfma_f32_16x16x32_bf16 v[132:135], v[32:35], a[120:123], v[132:135]
    v_mfma_f32_16x16x32_bf16 v[132:135], v[36:39], a[136:139], v[132:135]
    s_add_u32 s40, s40, 0xe20000
    buffer_load_dwordx4 a[232:235], v1, s[48:51], s26 offen offset:2048 sc1
    v_mfma_f32_16x16x32_bf16 v[140:143], v[28:31], a[108:111], v[140:143]
    v_mfma_f32_16x16x32_bf16 v[140:143], v[32:35], a[124:127], v[140:143]
    s_waitcnt vmcnt(23)
    v_mfma_f32_16x16x32_bf16 v[140:143], v[36:39], a[140:143], v[140:143]
    s_waitcnt lgkmcnt(0)
    v_mfma_f32_16x16x32_bf16 v[48:51], v[16:19], a[144:147], v[48:51]
    buffer_load_dwordx4 a[204:207], v1, s[48:51], s27 offen offset:2048 sc1
    ds_read_b128 v[28:31], v3 offset:7168
    v_mfma_f32_16x16x32_bf16 v[48:51], v[20:23], a[160:163], v[48:51]
    s_waitcnt vmcnt(20)
    s_lshr_b32 s66, s82, 16
    ds_read_b128 v[32:35], v3 offset:13312
    v_mfma_f32_16x16x32_bf16 v[48:51], v[24:27], a[176:179], v[48:51]
    v_mfma_f32_16x16x32_bf16 v[56:59], v[16:19], a[148:151], v[56:59]
    buffer_load_dwordx4 a[220:223], v1, s[48:51], s27 offen offset:3072 sc1
    ds_read_b128 v[36:39], v3 offset:19456
    v_mfma_f32_16x16x32_bf16 v[56:59], v[20:23], a[164:167], v[56:59]
    s_waitcnt vmcnt(17)
    v_mfma_f32_16x16x32_bf16 v[56:59], v[24:27], a[180:183], v[56:59]
    s_and_b32 s66, s66, 1
    v_mfma_f32_16x16x32_bf16 v[64:67], v[16:19], a[152:155], v[64:67]
    v_mfma_f32_16x16x32_bf16 v[64:67], v[20:23], a[168:171], v[64:67]
    s_waitcnt vmcnt(13)
    s_add_u32 s27, s27, 4096
    v_mfma_f32_16x16x32_bf16 v[64:67], v[24:27], a[184:187], v[64:67]
    v_mfma_f32_16x16x32_bf16 v[72:75], v[16:19], a[156:159], v[72:75]
    v_mfma_f32_16x16x32_bf16 v[72:75], v[20:23], a[172:175], v[72:75]
    s_lshl_b32 s66, s66, 13
    buffer_load_dwordx4 a[236:239], v1, s[48:51], s27 offen offset:0 sc1
    v_mfma_f32_16x16x32_bf16 v[72:75], v[24:27], a[188:191], v[72:75]
    s_waitcnt lgkmcnt(0)
    v_mfma_f32_16x16x32_bf16 v[52:55], v[28:31], a[144:147], v[52:55]
    ds_read_b128 v[16:19], v3 offset:8192
    v_mfma_f32_16x16x32_bf16 v[52:55], v[32:35], a[160:163], v[52:55]
    ds_read_b128 v[20:23], v3 offset:14336
    v_mfma_f32_16x16x32_bf16 v[52:55], v[36:39], a[176:179], v[52:55]
    s_and_b32 s16, s10, 15
    buffer_load_dwordx4 a[240:243], v1, s[48:51], s24 offen offset:3072 sc1
    v_mfma_f32_16x16x32_bf16 v[60:63], v[28:31], a[148:151], v[60:63]
    ds_read_b128 v[24:27], v3 offset:20480
    v_mfma_f32_16x16x32_bf16 v[60:63], v[32:35], a[164:167], v[60:63]
    v_mfma_f32_16x16x32_bf16 v[60:63], v[36:39], a[180:183], v[60:63]
    s_add_u32 s24, s24, 12288
    v_mfma_f32_16x16x32_bf16 v[68:71], v[28:31], a[152:155], v[68:71]
    s_lshl_b32 s16, s16, 5
    v_mfma_f32_16x16x32_bf16 v[68:71], v[32:35], a[168:171], v[68:71]
    v_mfma_f32_16x16x32_bf16 v[68:71], v[36:39], a[184:187], v[68:71]
    v_mfma_f32_16x16x32_bf16 v[76:79], v[28:31], a[156:159], v[76:79]
    buffer_load_dwordx4 v[224:227], v1, s[48:51], s24 offen offset:0 sc1
    v_mfma_f32_16x16x32_bf16 v[76:79], v[32:35], a[172:175], v[76:79]
    v_mfma_f32_16x16x32_bf16 v[76:79], v[36:39], a[188:191], v[76:79]
    s_waitcnt lgkmcnt(0)
    s_add_u32 s16, s16, s9
    v_mfma_f32_16x16x32_bf16 v[80:83], v[16:19], a[144:147], v[80:83]
    ds_read_b128 v[28:31], v3 offset:9216
    v_mfma_f32_16x16x32_bf16 v[80:83], v[20:23], a[160:163], v[80:83]
    buffer_load_dwordx4 v[240:243], v1, s[48:51], s24 offen offset:1024 sc1
    ds_read_b128 v[32:35], v3 offset:15360
    v_mfma_f32_16x16x32_bf16 v[80:83], v[24:27], a[176:179], v[80:83]
    v_mfma_f32_16x16x32_bf16 v[88:91], v[16:19], a[148:151], v[88:91]
    s_mul_i32 s16, s16, 128
    ds_read_b128 v[36:39], v3 offset:21504
    v_mfma_f32_16x16x32_bf16 v[88:91], v[20:23], a[164:167], v[88:91]
    buffer_load_dwordx4 a[244:247], v1, s[48:51], s25 offen offset:1024 sc1
    v_mfma_f32_16x16x32_bf16 v[88:91], v[24:27], a[180:183], v[88:91]
    v_mfma_f32_16x16x32_bf16 v[96:99], v[16:19], a[152:155], v[96:99]
    v_mfma_f32_16x16x32_bf16 v[96:99], v[20:23], a[168:171], v[96:99]
    s_and_b32 s15, s16, 0xffffe000
    v_mfma_f32_16x16x32_bf16 v[96:99], v[24:27], a[184:187], v[96:99]
    buffer_load_dwordx4 v[228:231], v1, s[48:51], s25 offen offset:2048 sc1
    v_mfma_f32_16x16x32_bf16 v[104:107], v[16:19], a[156:159], v[104:107]
    v_mfma_f32_16x16x32_bf16 v[104:107], v[20:23], a[172:175], v[104:107]
    v_mfma_f32_16x16x32_bf16 v[104:107], v[24:27], a[188:191], v[104:107]
    s_waitcnt lgkmcnt(0)
    buffer_load_dwordx4 v[244:247], v1, s[48:51], s25 offen offset:3072 sc1
    v_mfma_f32_16x16x32_bf16 v[84:87], v[28:31], a[144:147], v[84:87]
    s_add_u32 s16, s16, s15
    ds_read_b128 v[16:19], v3 offset:10240
    v_mfma_f32_16x16x32_bf16 v[84:87], v[32:35], a[160:163], v[84:87]
    ds_read_b128 v[20:23], v3 offset:16384
    v_mfma_f32_16x16x32_bf16 v[84:87], v[36:39], a[176:179], v[84:87]
    v_mfma_f32_16x16x32_bf16 v[92:95], v[28:31], a[148:151], v[92:95]
    buffer_load_dwordx4 a[248:251], v1, s[48:51], s26 offen offset:3072 sc1
    ds_read_b128 v[24:27], v3 offset:22528
    v_mfma_f32_16x16x32_bf16 v[92:95], v[32:35], a[164:167], v[92:95]
    s_add_u32 s16, s16, 327680
    v_mfma_f32_16x16x32_bf16 v[92:95], v[36:39], a[180:183], v[92:95]
    v_mfma_f32_16x16x32_bf16 v[100:103], v[28:31], a[152:155], v[100:103]
    s_add_u32 s26, s26, 4096
    v_mfma_f32_16x16x32_bf16 v[100:103], v[32:35], a[168:171], v[100:103]
    v_mfma_f32_16x16x32_bf16 v[100:103], v[36:39], a[184:187], v[100:103]
    s_add_u32 s16, s16, s66
    v_mfma_f32_16x16x32_bf16 v[108:111], v[28:31], a[156:159], v[108:111]
    v_mfma_f32_16x16x32_bf16 v[108:111], v[32:35], a[172:175], v[108:111]
    buffer_load_dwordx4 v[232:235], v1, s[48:51], s26 offen offset:0 sc1
    v_mfma_f32_16x16x32_bf16 v[108:111], v[36:39], a[188:191], v[108:111]
    s_waitcnt lgkmcnt(0)
    v_mfma_f32_16x16x32_bf16 v[112:115], v[16:19], a[144:147], v[112:115]
    ds_read_b128 v[28:31], v3 offset:11264
    v_mfma_f32_16x16x32_bf16 v[112:115], v[20:23], a[160:163], v[112:115]
    s_bfe_u32 s17, s46, 0x40001
    buffer_load_dwordx4 v[248:251], v1, s[48:51], s26 offen offset:1024 sc1
    ds_read_b128 v[32:35], v3 offset:17408
    v_mfma_f32_16x16x32_bf16 v[112:115], v[24:27], a[176:179], v[112:115]
    v_mfma_f32_16x16x32_bf16 v[120:123], v[16:19], a[148:151], v[120:123]
    ds_read_b128 v[36:39], v3 offset:23552
    v_mfma_f32_16x16x32_bf16 v[120:123], v[20:23], a[164:167], v[120:123]
    v_mfma_f32_16x16x32_bf16 v[120:123], v[24:27], a[180:183], v[120:123]
    s_lshl_b32 s17, s17, 2
    buffer_load_dwordx4 a[252:255], v1, s[48:51], s27 offen offset:1024 sc1
    v_mfma_f32_16x16x32_bf16 v[128:131], v[16:19], a[152:155], v[128:131]
    v_mfma_f32_16x16x32_bf16 v[128:131], v[20:23], a[168:171], v[128:131]
    v_mfma_f32_16x16x32_bf16 v[128:131], v[24:27], a[184:187], v[128:131]
    buffer_load_dwordx4 v[236:239], v1, s[48:51], s27 offen offset:2048 sc1
    v_mfma_f32_16x16x32_bf16 v[136:139], v[16:19], a[156:159], v[136:139]
    s_add_u32 s17, s17, s44
    v_mfma_f32_16x16x32_bf16 v[136:139], v[20:23], a[172:175], v[136:139]
    v_mfma_f32_16x16x32_bf16 v[136:139], v[24:27], a[188:191], v[136:139]
    s_waitcnt lgkmcnt(0)
    v_mfma_f32_16x16x32_bf16 v[116:119], v[28:31], a[144:147], v[116:119]
    buffer_load_dwordx4 v[252:255], v1, s[48:51], s27 offen offset:3072 sc1
    ds_read_b128 v[16:19], v3 offset:24576
    v_mfma_f32_16x16x32_bf16 v[116:119], v[32:35], a[160:163], v[116:119]
    ds_read_b128 v[20:23], v3 offset:30720
    v_mfma_f32_16x16x32_bf16 v[116:119], v[36:39], a[176:179], v[116:119]
    s_mul_i32 s17, s17, 1024
    v_mfma_f32_16x16x32_bf16 v[124:127], v[28:31], a[148:151], v[124:127]
    ds_read_b128 v[24:27], v3 offset:36864
    v_mfma_f32_16x16x32_bf16 v[124:127], v[32:35], a[164:167], v[124:127]
    s_add_u32 m0, s18, 110592
    v_mfma_f32_16x16x32_bf16 v[124:127], v[36:39], a[180:183], v[124:127]
    v_mfma_f32_16x16x32_bf16 v[132:135], v[28:31], a[152:155], v[132:135]
    s_and_b32 s15, s17, 0xffffe000
    v_mfma_f32_16x16x32_bf16 v[132:135], v[32:35], a[168:171], v[132:135]
    buffer_load_dwordx4 v1, s[4:7], s20 offen offset:0 sc1 lds
    v_mfma_f32_16x16x32_bf16 v[132:135], v[36:39], a[184:187], v[132:135]
    v_mfma_f32_16x16x32_bf16 v[140:143], v[28:31], a[156:159], v[140:143]
    v_mfma_f32_16x16x32_bf16 v[140:143], v[32:35], a[172:175], v[140:143]
    s_waitcnt vmcnt(23)
    s_add_u32 s17, s17, s15
    buffer_load_dwordx4 v1, s[4:7], s20 offen offset:1024 sc1 lds
    v_mfma_f32_16x16x32_bf16 v[140:143], v[36:39], a[188:191], v[140:143]
    s_waitcnt lgkmcnt(0)
    v_mfma_f32_16x16x32_bf16 v[48:51], v[16:19], a[192:195], v[48:51]
    ds_read_b128 v[28:31], v3 offset:25600
    v_mfma_f32_16x16x32_bf16 v[48:51], v[20:23], a[208:211], v[48:51]
    s_waitcnt vmcnt(20)
    buffer_load_dwordx4 v1, s[4:7], s20 offen offset:2048 sc1 lds
    ds_read_b128 v[32:35], v3 offset:31744
    v_mfma_f32_16x16x32_bf16 v[48:51], v[24:27], a[224:227], v[48:51]
    v_mfma_f32_16x16x32_bf16 v[56:59], v[16:19], a[196:199], v[56:59]
    s_add_u32 s17, s17, 327680
    ds_read_b128 v[36:39], v3 offset:37888
    v_mfma_f32_16x16x32_bf16 v[56:59], v[20:23], a[212:215], v[56:59]
    s_waitcnt vmcnt(18)
    s_add_u32 s20, s20, 3072
    v_mfma_f32_16x16x32_bf16 v[56:59], v[24:27], a[228:231], v[56:59]
    v_mfma_f32_16x16x32_bf16 v[64:67], v[16:19], a[200:203], v[64:67]
    v_mfma_f32_16x16x32_bf16 v[64:67], v[20:23], a[216:219], v[64:67]
    s_waitcnt vmcnt(15)
    s_add_u32 s17, s17, s66
    v_mfma_f32_16x16x32_bf16 v[64:67], v[24:27], a[232:235], v[64:67]
    s_add_u32 m0, s18, 113664
    v_mfma_f32_16x16x32_bf16 v[72:75], v[16:19], a[204:207], v[72:75]
    v_mfma_f32_16x16x32_bf16 v[72:75], v[20:23], a[220:223], v[72:75]
    v_mfma_f32_16x16x32_bf16 v[72:75], v[24:27], a[236:239], v[72:75]
    s_waitcnt lgkmcnt(0)
    buffer_load_dwordx4 v1, s[4:7], s20 offen offset:0 sc1 lds
    v_mfma_f32_16x16x32_bf16 v[52:55], v[28:31], a[192:195], v[52:55]
    ds_read_b128 v[16:19], v3 offset:26624
    v_mfma_f32_16x16x32_bf16 v[52:55], v[32:35], a[208:211], v[52:55]
    ds_read_b128 v[20:23], v3 offset:32768
    v_mfma_f32_16x16x32_bf16 v[52:55], v[36:39], a[224:227], v[52:55]
    buffer_load_dwordx4 v1, s[4:7], s20 offen offset:1024 sc1 lds
    v_mfma_f32_16x16x32_bf16 v[60:63], v[28:31], a[196:199], v[60:63]
    ds_read_b128 v[24:27], v3 offset:38912
    v_mfma_f32_16x16x32_bf16 v[60:63], v[32:35], a[212:215], v[60:63]
    v_mfma_f32_16x16x32_bf16 v[60:63], v[36:39], a[228:231], v[60:63]
    buffer_load_dwordx4 v1, s[4:7], s20 offen offset:2048 sc1 lds
    v_mfma_f32_16x16x32_bf16 v[68:71], v[28:31], a[200:203], v[68:71]
    v_mfma_f32_16x16x32_bf16 v[68:71], v[32:35], a[216:219], v[68:71]
    v_mfma_f32_16x16x32_bf16 v[68:71], v[36:39], a[232:235], v[68:71]
    s_add_u32 s20, s20, 3072
    v_mfma_f32_16x16x32_bf16 v[76:79], v[28:31], a[204:207], v[76:79]
    v_mfma_f32_16x16x32_bf16 v[76:79], v[32:35], a[220:223], v[76:79]
    v_mfma_f32_16x16x32_bf16 v[76:79], v[36:39], a[236:239], v[76:79]
    s_waitcnt lgkmcnt(0)
    v_mfma_f32_16x16x32_bf16 v[80:83], v[16:19], a[192:195], v[80:83]
    s_add_u32 m0, s18, 116736
    ds_read_b128 v[28:31], v3 offset:27648
    v_mfma_f32_16x16x32_bf16 v[80:83], v[20:23], a[208:211], v[80:83]
    ds_read_b128 v[32:35], v3 offset:33792
    v_mfma_f32_16x16x32_bf16 v[80:83], v[24:27], a[224:227], v[80:83]
    v_mfma_f32_16x16x32_bf16 v[88:91], v[16:19], a[196:199], v[88:91]
    buffer_load_dwordx4 v1, s[4:7], s20 offen offset:0 sc1 lds
    ds_read_b128 v[36:39], v3 offset:39936
    v_mfma_f32_16x16x32_bf16 v[88:91], v[20:23], a[212:215], v[88:91]
    v_mfma_f32_16x16x32_bf16 v[88:91], v[24:27], a[228:231], v[88:91]
    v_mfma_f32_16x16x32_bf16 v[96:99], v[16:19], a[200:203], v[96:99]
    buffer_load_dwordx4 v1, s[4:7], s20 offen offset:1024 sc1 lds
    v_mfma_f32_16x16x32_bf16 v[96:99], v[20:23], a[216:219], v[96:99]
    v_mfma_f32_16x16x32_bf16 v[96:99], v[24:27], a[232:235], v[96:99]
    v_mfma_f32_16x16x32_bf16 v[104:107], v[16:19], a[204:207], v[104:107]
    buffer_load_dwordx4 v1, s[4:7], s20 offen offset:2048 sc1 lds
    v_mfma_f32_16x16x32_bf16 v[104:107], v[20:23], a[220:223], v[104:107]
    v_mfma_f32_16x16x32_bf16 v[104:107], v[24:27], a[236:239], v[104:107]
    s_waitcnt lgkmcnt(0)
    v_mfma_f32_16x16x32_bf16 v[84:87], v[28:31], a[192:195], v[84:87]
    s_add_u32 s20, s20, 30720
    ds_read_b128 v[16:19], v3 offset:28672
    v_mfma_f32_16x16x32_bf16 v[84:87], v[32:35], a[208:211], v[84:87]
    ds_read_b128 v[20:23], v3 offset:34816
    v_mfma_f32_16x16x32_bf16 v[84:87], v[36:39], a[224:227], v[84:87]
    v_mfma_f32_16x16x32_bf16 v[92:95], v[28:31], a[196:199], v[92:95]
    ds_read_b128 v[24:27], v3 offset:40960
    v_mfma_f32_16x16x32_bf16 v[92:95], v[32:35], a[212:215], v[92:95]
    v_mfma_f32_16x16x32_bf16 v[92:95], v[36:39], a[228:231], v[92:95]
    v_mfma_f32_16x16x32_bf16 v[100:103], v[28:31], a[200:203], v[100:103]
    v_add_f32 v144, v144, v146
    v_mfma_f32_16x16x32_bf16 v[100:103], v[32:35], a[216:219], v[100:103]
    v_add_f32 v145, v145, v147
    v_mfma_f32_16x16x32_bf16 v[100:103], v[36:39], a[232:235], v[100:103]
    v_add_f32 v144, v144, v148
    v_mfma_f32_16x16x32_bf16 v[108:111], v[28:31], a[204:207], v[108:111]
    v_mfma_f32_16x16x32_bf16 v[108:111], v[32:35], a[220:223], v[108:111]
    v_add_f32 v145, v145, v149
    v_mfma_f32_16x16x32_bf16 v[108:111], v[36:39], a[236:239], v[108:111]
    s_waitcnt lgkmcnt(0)
    v_add_f32 v144, v144, v150
    v_mfma_f32_16x16x32_bf16 v[112:115], v[16:19], a[192:195], v[112:115]
    ds_read_b128 v[28:31], v3 offset:29696
    v_mfma_f32_16x16x32_bf16 v[112:115], v[20:23], a[208:211], v[112:115]
    ds_read_b128 v[32:35], v3 offset:35840
    v_add_f32 v145, v145, v151
    v_mfma_f32_16x16x32_bf16 v[112:115], v[24:27], a[224:227], v[112:115]
    v_add_f32 v144, v144, v152
    v_mfma_f32_16x16x32_bf16 v[120:123], v[16:19], a[196:199], v[120:123]
    ds_read_b128 v[36:39], v3 offset:41984
    v_add_f32 v145, v145, v153
    v_mfma_f32_16x16x32_bf16 v[120:123], v[20:23], a[212:215], v[120:123]
    v_mfma_f32_16x16x32_bf16 v[120:123], v[24:27], a[228:231], v[120:123]
    v_add_f32 v144, v144, v154
    v_mfma_f32_16x16x32_bf16 v[128:131], v[16:19], a[200:203], v[128:131]
    v_add_f32 v145, v145, v155
    v_mfma_f32_16x16x32_bf16 v[128:131], v[20:23], a[216:219], v[128:131]
    v_mfma_f32_16x16x32_bf16 v[128:131], v[24:27], a[232:235], v[128:131]
    v_add_f32 v144, v144, v156
    v_mfma_f32_16x16x32_bf16 v[136:139], v[16:19], a[204:207], v[136:139]
    v_add_f32 v145, v145, v157
    v_mfma_f32_16x16x32_bf16 v[136:139], v[20:23], a[220:223], v[136:139]
    v_add_f32 v144, v144, v158
    v_mfma_f32_16x16x32_bf16 v[136:139], v[24:27], a[236:239], v[136:139]
    s_waitcnt lgkmcnt(0)
    v_mfma_f32_16x16x32_bf16 v[116:119], v[28:31], a[192:195], v[116:119]
    ds_read_b128 v[16:19], v3 offset:43008
    v_add_f32 v145, v145, v159
    v_mfma_f32_16x16x32_bf16 v[116:119], v[32:35], a[208:211], v[116:119]
    ds_read_b128 v[20:23], v4 offset:0
    v_mul_f32 v144, 0x3ae38e39, v144
    v_mfma_f32_16x16x32_bf16 v[116:119], v[36:39], a[224:227], v[116:119]
    v_mfma_f32_16x16x32_bf16 v[124:127], v[28:31], a[196:199], v[124:127]
    ds_read_b128 v[24:27], v4 offset:6144
    v_mul_f32 v145, 0x3ae38e39, v145
    v_mfma_f32_16x16x32_bf16 v[124:127], v[32:35], a[212:215], v[124:127]
    v_fma_f32 v145, -v144, v144, v145
    v_mfma_f32_16x16x32_bf16 v[124:127], v[36:39], a[228:231], v[124:127]
    v_max_f32 v145, 0, v145
    v_mfma_f32_16x16x32_bf16 v[132:135], v[28:31], a[200:203], v[132:135]
    v_mfma_f32_16x16x32_bf16 v[132:135], v[32:35], a[216:219], v[132:135]
    v_add_f32 v145, 0x3727c5ac, v145
    v_mfma_f32_16x16x32_bf16 v[132:135], v[36:39], a[232:235], v[132:135]
    v_rsq_f32 v144, v145
    v_mfma_f32_16x16x32_bf16 v[140:143], v[28:31], a[204:207], v[140:143]
    v_mfma_f32_16x16x32_bf16 v[140:143], v[32:35], a[220:223], v[140:143]
    s_waitcnt vmcnt(18)
    v_mfma_f32_16x16x32_bf16 v[140:143], v[36:39], a[236:239], v[140:143]
    s_waitcnt lgkmcnt(0)
    v_mul_f32 v144, 0xbfb8aa3b, v144
    v_mfma_f32_16x16x32_bf16 v[48:51], v[16:19], a[240:243], v[48:51]
    ds_read_b128 v[28:31], v3 offset:44032
    v_mfma_f32_16x16x32_bf16 v[48:51], v[20:23], v[224:227], v[48:51]
    s_waitcnt vmcnt(15)
    ds_read_b128 v[32:35], v4 offset:1024
    v_mfma_f32_16x16x32_bf16 v[48:51], v[24:27], v[240:243], v[48:51]
    ds_bpermute_b32 v176, v5, v144 offset:0
    v_mfma_f32_16x16x32_bf16 v[56:59], v[16:19], a[244:247], v[56:59]
    ds_read_b128 v[36:39], v4 offset:7168
    v_mfma_f32_16x16x32_bf16 v[56:59], v[20:23], v[228:231], v[56:59]
    s_waitcnt vmcnt(12)
    ds_bpermute_b32 v180, v5, v145 offset:0
    v_mfma_f32_16x16x32_bf16 v[56:59], v[24:27], v[244:247], v[56:59]
    ds_bpermute_b32 v177, v5, v144 offset:64
    v_mfma_f32_16x16x32_bf16 v[64:67], v[16:19], a[248:251], v[64:67]
    ds_bpermute_b32 v181, v5, v145 offset:64
    v_mfma_f32_16x16x32_bf16 v[64:67], v[20:23], v[232:235], v[64:67]
    s_waitcnt vmcnt(9)
    ds_bpermute_b32 v178, v5, v144 offset:128
    v_mfma_f32_16x16x32_bf16 v[64:67], v[24:27], v[248:251], v[64:67]
    ds_bpermute_b32 v182, v5, v145 offset:128
    v_mfma_f32_16x16x32_bf16 v[72:75], v[16:19], a[252:255], v[72:75]
    ds_bpermute_b32 v179, v5, v144 offset:192
    v_mfma_f32_16x16x32_bf16 v[72:75], v[20:23], v[236:239], v[72:75]
    ds_bpermute_b32 v183, v5, v145 offset:192
    v_mfma_f32_16x16x32_bf16 v[72:75], v[24:27], v[252:255], v[72:75]
    s_waitcnt lgkmcnt(0)
    v_mfma_f32_16x16x32_bf16 v[52:55], v[28:31], a[240:243], v[52:55]
    ds_read_b128 v[16:19], v3 offset:45056
    v_mfma_f32_16x16x32_bf16 v[52:55], v[32:35], v[224:227], v[52:55]
    ds_read_b128 v[20:23], v4 offset:2048
    v_mfma_f32_16x16x32_bf16 v[52:55], v[36:39], v[240:243], v[52:55]
    v_mfma_f32_16x16x32_bf16 v[60:63], v[28:31], a[244:247], v[60:63]
    ds_read_b128 v[24:27], v4 offset:8192
    v_mfma_f32_16x16x32_bf16 v[60:63], v[32:35], v[228:231], v[60:63]
    v_mfma_f32_16x16x32_bf16 v[60:63], v[36:39], v[244:247], v[60:63]
    v_mfma_f32_16x16x32_bf16 v[68:71], v[28:31], a[248:251], v[68:71]
    v_mul_f32 v184, v48, v176
    v_mul_f32 v185, v49, v176
    v_mfma_f32_16x16x32_bf16 v[68:71], v[32:35], v[232:235], v[68:71]
    v_exp_f32 v184, v184
    v_mfma_f32_16x16x32_bf16 v[68:71], v[36:39], v[248:251], v[68:71]
    v_exp_f32 v185, v185
    v_mfma_f32_16x16x32_bf16 v[76:79], v[28:31], a[252:255], v[76:79]
    v_mul_f32 v186, v50, v176
    v_mul_f32 v187, v51, v176
    v_mfma_f32_16x16x32_bf16 v[76:79], v[32:35], v[236:239], v[76:79]
    v_exp_f32 v186, v186
    v_mfma_f32_16x16x32_bf16 v[76:79], v[36:39], v[252:255], v[76:79]
    s_waitcnt lgkmcnt(0)
    v_exp_f32 v187, v187
    v_mfma_f32_16x16x32_bf16 v[80:83], v[16:19], a[240:243], v[80:83]
    ds_read_b128 v[28:31], v3 offset:46080
    v_mul_f32 v48, v48, v52
    v_mfma_f32_16x16x32_bf16 v[80:83], v[20:23], v[224:227], v[80:83]
    ds_read_b128 v[32:35], v4 offset:3072
    v_mul_f32 v49, v49, v53
    v_mfma_f32_16x16x32_bf16 v[80:83], v[24:27], v[240:243], v[80:83]
    v_mul_f32 v50, v50, v54
    v_mul_f32 v51, v51, v55
    v_mfma_f32_16x16x32_bf16 v[88:91], v[16:19], a[244:247], v[88:91]
    ds_read_b128 v[36:39], v4 offset:9216
    v_fma_f32 v184, v184, v180, v180
    v_mfma_f32_16x16x32_bf16 v[88:91], v[20:23], v[228:231], v[88:91]
    v_rcp_f32 v184, v184
    v_mfma_f32_16x16x32_bf16 v[88:91], v[24:27], v[244:247], v[88:91]
    v_fma_f32 v185, v185, v180, v180
    v_fma_f32 v186, v186, v180, v180
    v_mfma_f32_16x16x32_bf16 v[96:99], v[16:19], a[248:251], v[96:99]
    v_rcp_f32 v185, v185
    v_mfma_f32_16x16x32_bf16 v[96:99], v[20:23], v[232:235], v[96:99]
    v_rcp_f32 v186, v186
    v_mfma_f32_16x16x32_bf16 v[96:99], v[24:27], v[248:251], v[96:99]
    v_fma_f32 v187, v187, v180, v180
    v_mul_f32 v48, v48, v184
    v_mfma_f32_16x16x32_bf16 v[104:107], v[16:19], a[252:255], v[104:107]
    v_rcp_f32 v187, v187
    v_mfma_f32_16x16x32_bf16 v[104:107], v[20:23], v[236:239], v[104:107]
    v_mul_f32 v49, v49, v185
    v_mul_f32 v50, v50, v186
    v_mfma_f32_16x16x32_bf16 v[104:107], v[24:27], v[252:255], v[104:107]
    s_waitcnt lgkmcnt(0)
    v_mul_f32 v51, v51, v187
    v_cvt_pk_bf16_f32 v200, v48, v49
    v_mfma_f32_16x16x32_bf16 v[84:87], v[28:31], a[240:243], v[84:87]
    ds_read_b128 v[16:19], v3 offset:47104
    v_cvt_pk_bf16_f32 v201, v50, v51
    v_mfma_f32_16x16x32_bf16 v[84:87], v[32:35], v[224:227], v[84:87]
    ds_read_b128 v[20:23], v4 offset:4096
    v_mul_f32 v188, v56, v177
    v_mfma_f32_16x16x32_bf16 v[84:87], v[36:39], v[240:243], v[84:87]
    v_exp_f32 v188, v188
    v_mfma_f32_16x16x32_bf16 v[92:95], v[28:31], a[244:247], v[92:95]
    ds_read_b128 v[24:27], v4 offset:10240
    v_mul_f32 v189, v57, v177
    v_mfma_f32_16x16x32_bf16 v[92:95], v[32:35], v[228:231], v[92:95]
    s_add_u32 m0, s18, 0
    v_exp_f32 v189, v189
    v_mfma_f32_16x16x32_bf16 v[92:95], v[36:39], v[244:247], v[92:95]
    v_mul_f32 v190, v58, v177
    v_mul_f32 v191, v59, v177
    v_mfma_f32_16x16x32_bf16 v[100:103], v[28:31], a[248:251], v[100:103]
    v_exp_f32 v190, v190
    v_mfma_f32_16x16x32_bf16 v[100:103], v[32:35], v[232:235], v[100:103]
    buffer_load_dwordx4 v1, s[4:7], s20 offen offset:0 sc1 lds
    v_mul_f32 v56, v56, v60
    v_mfma_f32_16x16x32_bf16 v[100:103], v[36:39], v[248:251], v[100:103]
    v_exp_f32 v191, v191
    v_mfma_f32_16x16x32_bf16 v[108:111], v[28:31], a[252:255], v[108:111]
    v_mul_f32 v57, v57, v61
    v_mul_f32 v58, v58, v62
    v_mfma_f32_16x16x32_bf16 v[108:111], v[32:35], v[236:239], v[108:111]
    buffer_load_dwordx4 v1, s[4:7], s20 offen offset:1024 sc1 lds
    v_mul_f32 v59, v59, v63
    v_mfma_f32_16x16x32_bf16 v[108:111], v[36:39], v[252:255], v[108:111]
    s_waitcnt lgkmcnt(0)
    v_fma_f32 v188, v188, v181, v181
    v_fma_f32 v189, v189, v181, v181
    v_mfma_f32_16x16x32_bf16 v[112:115], v[16:19], a[240:243], v[112:115]
    ds_read_b128 v[28:31], v3 offset:48128
    v_fma_f32 v190, v190, v181, v181
    v_mfma_f32_16x16x32_bf16 v[112:115], v[20:23], v[224:227], v[112:115]
    buffer_load_dwordx4 v1, s[4:7], s20 offen offset:2048 sc1 lds
    ds_read_b128 v[32:35], v4 offset:5120
    v_mfma_f32_16x16x32_bf16 v[112:115], v[24:27], v[240:243], v[112:115]
    v_rcp_f32 v188, v188
    v_mfma_f32_16x16x32_bf16 v[120:123], v[16:19], a[244:247], v[120:123]
    ds_read_b128 v[36:39], v4 offset:11264
    v_fma_f32 v191, v191, v181, v181
    v_mfma_f32_16x16x32_bf16 v[120:123], v[20:23], v[228:231], v[120:123]
    s_add_u32 s20, s20, 3072
    v_rcp_f32 v189, v189
    v_mfma_f32_16x16x32_bf16 v[120:123], v[24:27], v[244:247], v[120:123]
    v_rcp_f32 v190, v190
    v_mfma_f32_16x16x32_bf16 v[128:131], v[16:19], a[248:251], v[128:131]
    v_rcp_f32 v191, v191
    v_mfma_f32_16x16x32_bf16 v[128:131], v[20:23], v[232:235], v[128:131]
    v_mul_f32 v56, v56, v188
    v_mul_f32 v57, v57, v189
    v_mfma_f32_16x16x32_bf16 v[128:131], v[24:27], v[248:251], v[128:131]
    s_add_u32 m0, s18, 3072
    v_mul_f32 v58, v58, v190
    v_mul_f32 v59, v59, v191
    v_mfma_f32_16x16x32_bf16 v[136:139], v[16:19], a[252:255], v[136:139]
    v_cvt_pk_bf16_f32 v204, v56, v57
    v_cvt_pk_bf16_f32 v205, v58, v59
    v_mfma_f32_16x16x32_bf16 v[136:139], v[20:23], v[236:239], v[136:139]
    v_mul_f32 v184, v64, v178
    v_mul_f32 v185, v65, v178
    v_mfma_f32_16x16x32_bf16 v[136:139], v[24:27], v[252:255], v[136:139]
    s_waitcnt lgkmcnt(0)
    buffer_load_dwordx4 v1, s[4:7], s20 offen offset:0 sc1 lds
    v_mul_f32 v186, v66, v178
    v_mfma_f32_16x16x32_bf16 v[116:119], v[28:31], a[240:243], v[116:119]
    s_waitcnt vmcnt(4)
    s_barrier
    v_mfma_f32_16x16x32_bf16 v[116:119], v[32:35], v[224:227], v[116:119]
    ds_read_b128 v[16:19], v4 offset:12288
    v_mul_f32 v187, v67, v178
    v_mfma_f32_16x16x32_bf16 v[116:119], v[36:39], v[240:243], v[116:119]
    buffer_load_dwordx4 v1, s[4:7], s20 offen offset:1024 sc1 lds
    ds_read_b128 v[20:23], v4 offset:14336
    v_mfma_f32_16x16x32_bf16 v[124:127], v[28:31], a[244:247], v[124:127]
    ds_read_b128 v[24:27], v4 offset:16384
    v_mul_f32 v64, v64, v68
    v_mfma_f32_16x16x32_bf16 v[124:127], v[32:35], v[228:231], v[124:127]
    ds_read_b128 v[40:43], v4 offset:18432
    v_mul_f32 v65, v65, v69
    v_mfma_f32_16x16x32_bf16 v[124:127], v[36:39], v[244:247], v[124:127]
    buffer_load_dwordx4 v1, s[4:7], s20 offen offset:2048 sc1 lds
    ds_read_b128 v[44:47], v4 offset:20480
    v_mfma_f32_16x16x32_bf16 v[132:135], v[28:31], a[248:251], v[132:135]
    ds_read_b128 v[12:15], v4 offset:22528
    v_mul_f32 v66, v66, v70
    v_mfma_f32_16x16x32_bf16 v[132:135], v[32:35], v[232:235], v[132:135]
    v_exp_f32 v184, v184
    v_mfma_f32_16x16x32_bf16 v[132:135], v[36:39], v[248:251], v[132:135]
    s_add_u32 s20, s20, 3072
    v_exp_f32 v185, v185
    v_mfma_f32_16x16x32_bf16 v[140:143], v[28:31], a[252:255], v[140:143]
    v_exp_f32 v186, v186
    v_mfma_f32_16x16x32_bf16 v[140:143], v[32:35], v[236:239], v[140:143]
    v_exp_f32 v187, v187
    v_mfma_f32_16x16x32_bf16 v[140:143], v[36:39], v[252:255], v[140:143]
    s_waitcnt lgkmcnt(0)
    v_mul_f32 v67, v67, v71
    v_fma_f32 v184, v184, v182, v182
    v_mfma_f32_16x16x32_bf16 v[144:147], v[16:19], a[0:3], 0
    s_add_u32 m0, s18, 6144
    ds_read_b128 v[28:31], v4 offset:13312
    v_fma_f32 v185, v185, v182, v182
    v_mfma_f32_16x16x32_bf16 v[144:147], v[20:23], a[16:19], v[144:147]
    v_rcp_f32 v184, v184
    v_mfma_f32_16x16x32_bf16 v[144:147], v[24:27], a[32:35], v[144:147]
    ds_read_b128 v[32:35], v4 offset:15360
    v_fma_f32 v186, v186, v182, v182
    v_mfma_f32_16x16x32_bf16 v[144:147], v[40:43], a[48:51], v[144:147]
    buffer_load_dwordx4 v1, s[4:7], s20 offen offset:0 sc1 lds
    v_fma_f32 v187, v187, v182, v182
    v_mfma_f32_16x16x32_bf16 v[144:147], v[44:47], a[64:67], v[144:147]
    v_rcp_f32 v185, v185
    v_mfma_f32_16x16x32_bf16 v[144:147], v[12:15], a[80:83], v[144:147]
    ds_read_b128 v[36:39], v4 offset:17408
    v_mul_f32 v64, v64, v184
    v_mfma_f32_16x16x32_bf16 v[152:155], v[16:19], a[4:7], 0
    buffer_load_dwordx4 v1, s[4:7], s20 offen offset:1024 sc1 lds
    v_mul_f32 v65, v65, v185
    v_mfma_f32_16x16x32_bf16 v[152:155], v[20:23], a[20:23], v[152:155]
    v_rcp_f32 v186, v186
    v_mfma_f32_16x16x32_bf16 v[152:155], v[24:27], a[36:39], v[152:155]
    ds_read_b128 v[220:223], v4 offset:19456
    v_mul_f32 v66, v66, v186
    v_mfma_f32_16x16x32_bf16 v[152:155], v[40:43], a[52:55], v[152:155]
    buffer_load_dwordx4 v1, s[4:7], s20 offen offset:2048 sc1 lds
    v_cvt_pk_bf16_f32 v208, v64, v65
    v_mfma_f32_16x16x32_bf16 v[152:155], v[44:47], a[68:71], v[152:155]
    v_rcp_f32 v187, v187
    v_mfma_f32_16x16x32_bf16 v[152:155], v[12:15], a[84:87], v[152:155]
    ds_read_b128 v[192:195], v4 offset:21504
    v_mul_f32 v67, v67, v187
    v_mfma_f32_16x16x32_bf16 v[160:163], v[16:19], a[8:11], 0
    s_add_u32 s20, s20, 30720
    v_cvt_pk_bf16_f32 v209, v66, v67
    v_mul_f32 v188, v72, v179
    v_mfma_f32_16x16x32_bf16 v[160:163], v[20:23], a[24:27], v[160:163]
    v_exp_f32 v188, v188
    v_mfma_f32_16x16x32_bf16 v[160:163], v[24:27], a[40:43], v[160:163]
    ds_read_b128 v[196:199], v4 offset:23552
    v_mul_f32 v189, v73, v179
    v_mfma_f32_16x16x32_bf16 v[160:163], v[40:43], a[56:59], v[160:163]
    v_exp_f32 v189, v189
    v_mfma_f32_16x16x32_bf16 v[160:163], v[44:47], a[72:75], v[160:163]
    s_add_u32 m0, s18, 36864
    v_mul_f32 v190, v74, v179
    v_mul_f32 v191, v75, v179
    v_mfma_f32_16x16x32_bf16 v[160:163], v[12:15], a[88:91], v[160:163]
    v_exp_f32 v190, v190
    v_mfma_f32_16x16x32_bf16 v[168:171], v[16:19], a[12:15], 0
    v_exp_f32 v191, v191
    v_mfma_f32_16x16x32_bf16 v[168:171], v[20:23], a[28:31], v[168:171]
    buffer_load_dwordx4 v1, s[4:7], s20 offen offset:0 sc1 lds
    v_mul_f32 v72, v72, v76
    v_mfma_f32_16x16x32_bf16 v[168:171], v[24:27], a[44:47], v[168:171]
    v_mul_f32 v73, v73, v77
    v_mul_f32 v74, v74, v78
    v_mfma_f32_16x16x32_bf16 v[168:171], v[40:43], a[60:63], v[168:171]
    v_mul_f32 v75, v75, v79
    v_fma_f32 v188, v188, v183, v183
    v_mfma_f32_16x16x32_bf16 v[168:171], v[44:47], a[76:79], v[168:171]
    buffer_load_dwordx4 v1, s[4:7], s20 offen offset:1024 sc1 lds
    v_fma_f32 v189, v189, v183, v183
    v_mfma_f32_16x16x32_bf16 v[168:171], v[12:15], a[92:95], v[168:171]
    s_waitcnt lgkmcnt(0)
    v_rcp_f32 v188, v188
    v_mfma_f32_16x16x32_bf16 v[148:151], v[28:31], a[0:3], 0
    ds_read_b128 v[16:19], v4 offset:24576
    v_fma_f32 v190, v190, v183, v183
    v_mfma_f32_16x16x32_bf16 v[148:151], v[32:35], a[16:19], v[148:151]
    buffer_load_dwordx4 v1, s[4:7], s20 offen offset:2048 sc1 lds
    v_fma_f32 v191, v191, v183, v183
    v_mfma_f32_16x16x32_bf16 v[148:151], v[36:39], a[32:35], v[148:151]
    ds_read_b128 v[20:23], v4 offset:26624
    v_mul_f32 v72, v72, v188
    v_mfma_f32_16x16x32_bf16 v[148:151], v[220:223], a[48:51], v[148:151]
    v_rcp_f32 v189, v189
    v_mfma_f32_16x16x32_bf16 v[148:151], v[192:195], a[64:67], v[148:151]
    s_add_u32 s20, s20, 3072
    v_rcp_f32 v190, v190
    v_mfma_f32_16x16x32_bf16 v[148:151], v[196:199], a[80:83], v[148:151]
    ds_read_b128 v[24:27], v4 offset:28672
    v_mul_f32 v73, v73, v189
    v_mfma_f32_16x16x32_bf16 v[156:159], v[28:31], a[4:7], 0
    v_rcp_f32 v191, v191
    v_mfma_f32_16x16x32_bf16 v[156:159], v[32:35], a[20:23], v[156:159]
    v_mul_f32 v74, v74, v190
    v_mul_f32 v75, v75, v191
    v_mfma_f32_16x16x32_bf16 v[156:159], v[36:39], a[36:39], v[156:159]
    s_add_u32 m0, s18, 39936
    ds_read_b128 v[40:43], v4 offset:30720
    v_cvt_pk_bf16_f32 v212, v72, v73
    v_mfma_f32_16x16x32_bf16 v[156:159], v[220:223], a[52:55], v[156:159]
    v_cvt_pk_bf16_f32 v213, v74, v75
    v_mul_f32 v184, v80, v176
    v_mfma_f32_16x16x32_bf16 v[156:159], v[192:195], a[68:71], v[156:159]
    v_exp_f32 v184, v184
    v_mfma_f32_16x16x32_bf16 v[156:159], v[196:199], a[84:87], v[156:159]
    buffer_load_dwordx4 v1, s[4:7], s20 offen offset:0 sc1 lds
    ds_read_b128 v[44:47], v4 offset:32768
    v_mfma_f32_16x16x32_bf16 v[164:167], v[28:31], a[8:11], 0
    v_mul_f32 v185, v81, v176
    v_mul_f32 v186, v82, v176
    v_mfma_f32_16x16x32_bf16 v[164:167], v[32:35], a[24:27], v[164:167]
    v_exp_f32 v185, v185
    v_mfma_f32_16x16x32_bf16 v[164:167], v[36:39], a[40:43], v[164:167]
    buffer_load_dwordx4 v1, s[4:7], s20 offen offset:1024 sc1 lds
    ds_read_b128 v[12:15], v4 offset:34816
    v_mfma_f32_16x16x32_bf16 v[164:167], v[220:223], a[56:59], v[164:167]
    v_exp_f32 v186, v186
    v_mfma_f32_16x16x32_bf16 v[164:167], v[192:195], a[72:75], v[164:167]
    v_mul_f32 v187, v83, v176
    v_mul_f32 v80, v80, v84
    v_mfma_f32_16x16x32_bf16 v[164:167], v[196:199], a[88:91], v[164:167]
    buffer_load_dwordx4 v1, s[4:7], s20 offen offset:2048 sc1 lds
    v_mul_f32 v81, v81, v85
    v_mfma_f32_16x16x32_bf16 v[172:175], v[28:31], a[12:15], 0
    v_exp_f32 v187, v187
    v_mfma_f32_16x16x32_bf16 v[172:175], v[32:35], a[28:31], v[172:175]
    v_mul_f32 v82, v82, v86
    v_mul_f32 v83, v83, v87
    v_mfma_f32_16x16x32_bf16 v[172:175], v[36:39], a[44:47], v[172:175]
    s_add_u32 s20, s20, 3072
    v_fma_f32 v184, v184, v180, v180
    v_fma_f32 v185, v185, v180, v180
    v_mfma_f32_16x16x32_bf16 v[172:175], v[220:223], a[60:63], v[172:175]
    v_rcp_f32 v184, v184
    v_mfma_f32_16x16x32_bf16 v[172:175], v[192:195], a[76:79], v[172:175]
    v_rcp_f32 v185, v185
    v_mfma_f32_16x16x32_bf16 v[172:175], v[196:199], a[92:95], v[172:175]
    s_waitcnt lgkmcnt(0)
    v_fma_f32 v186, v186, v180, v180
    v_fma_f32 v187, v187, v180, v180
    v_mfma_f32_16x16x32_bf16 v[144:147], v[16:19], a[96:99], v[144:147]
    s_add_u32 m0, s18, 43008
    ds_read_b128 v[28:31], v4 offset:25600
    v_mul_f32 v80, v80, v184
    v_mfma_f32_16x16x32_bf16 v[144:147], v[20:23], a[112:115], v[144:147]
    v_rcp_f32 v186, v186
    v_mfma_f32_16x16x32_bf16 v[144:147], v[24:27], a[128:131], v[144:147]
    ds_read_b128 v[32:35], v4 offset:27648
    v_mul_f32 v81, v81, v185
    v_mfma_f32_16x16x32_bf16 v[144:147], v[40:43], a[144:147], v[144:147]
    buffer_load_dwordx4 v1, s[4:7], s20 offen offset:0 sc1 lds
    v_mul_f32 v82, v82, v186
    v_mfma_f32_16x16x32_bf16 v[144:147], v[44:47], a[160:163], v[144:147]
    v_rcp_f32 v187, v187
    v_mfma_f32_16x16x32_bf16 v[144:147], v[12:15], a[176:179], v[144:147]
    ds_read_b128 v[36:39], v4 offset:29696
    v_mul_f32 v83, v83, v187
    v_mfma_f32_16x16x32_bf16 v[152:155], v[16:19], a[100:103], v[152:155]
    buffer_load_dwordx4 v1, s[4:7], s20 offen offset:1024 sc1 lds
    v_cvt_pk_bf16_f32 v202, v80, v81
    v_mfma_f32_16x16x32_bf16 v[152:155], v[20:23], a[116:119], v[152:155]
    v_cvt_pk_bf16_f32 v203, v82, v83
    v_mul_f32 v188, v88, v177
    v_mfma_f32_16x16x32_bf16 v[152:155], v[24:27], a[132:135], v[152:155]
    ds_read_b128 v[220:223], v4 offset:31744
    v_mul_f32 v189, v89, v177
    v_mfma_f32_16x16x32_bf16 v[152:155], v[40:43], a[148:151], v[152:155]
    buffer_load_dwordx4 v1, s[4:7], s20 offen offset:2048 sc1 lds
    v_mul_f32 v190, v90, v177
    v_mfma_f32_16x16x32_bf16 v[152:155], v[44:47], a[164:167], v[152:155]
    buffer_store_dwordx4 v[200:203], v1, s[48:51], s28 offen sc1
    v_mfma_f32_16x16x32_bf16 v[152:155], v[12:15], a[180:183], v[152:155]
    s_add_u32 s28, s28, 16384
    ds_read_b128 v[192:195], v4 offset:33792
    v_mul_f32 v191, v91, v177
    v_mfma_f32_16x16x32_bf16 v[160:163], v[16:19], a[104:107], v[160:163]
    s_add_u32 s20, s20, 30720
    v_exp_f32 v188, v188
    v_mfma_f32_16x16x32_bf16 v[160:163], v[20:23], a[120:123], v[160:163]
    v_exp_f32 v189, v189
    v_mfma_f32_16x16x32_bf16 v[160:163], v[24:27], a[136:139], v[160:163]
    ds_read_b128 v[196:199], v4 offset:35840
    v_mul_f32 v88, v88, v92
    v_mfma_f32_16x16x32_bf16 v[160:163], v[40:43], a[152:155], v[160:163]
    v_exp_f32 v190, v190
    v_mfma_f32_16x16x32_bf16 v[160:163], v[44:47], a[168:171], v[160:163]
    s_add_u32 m0, s18, 73728
    v_exp_f32 v191, v191
    v_mfma_f32_16x16x32_bf16 v[160:163], v[12:15], a[184:187], v[160:163]
    v_mul_f32 v89, v89, v93
    v_mul_f32 v90, v90, v94
    v_mfma_f32_16x16x32_bf16 v[168:171], v[16:19], a[108:111], v[168:171]
    v_mul_f32 v91, v91, v95
    v_fma_f32 v188, v188, v181, v181
    v_mfma_f32_16x16x32_bf16 v[168:171], v[20:23], a[124:127], v[168:171]
    v_rcp_f32 v188, v188
    v_mfma_f32_16x16x32_bf16 v[168:171], v[24:27], a[140:143], v[168:171]
    buffer_load_dwordx4 v1, s[4:7], s20 offen offset:0 sc1 lds
    v_fma_f32 v189, v189, v181, v181
    v_mfma_f32_16x16x32_bf16 v[168:171], v[40:43], a[156:159], v[168:171]
    v_rcp_f32 v189, v189
    v_mfma_f32_16x16x32_bf16 v[168:171], v[44:47], a[172:175], v[168:171]
    v_fma_f32 v190, v190, v181, v181
    v_fma_f32 v191, v191, v181, v181
    v_mfma_f32_16x16x32_bf16 v[168:171], v[12:15], a[188:191], v[168:171]
    s_waitcnt lgkmcnt(0)
    v_rcp_f32 v190, v190
    v_mfma_f32_16x16x32_bf16 v[148:151], v[28:31], a[96:99], v[148:151]
    buffer_load_dwordx4 v1, s[4:7], s20 offen offset:1024 sc1 lds
    ds_read_b128 v[16:19], v4 offset:36864
    v_mfma_f32_16x16x32_bf16 v[148:151], v[32:35], a[112:115], v[148:151]
    v_rcp_f32 v191, v191
    v_mfma_f32_16x16x32_bf16 v[148:151], v[36:39], a[128:131], v[148:151]
    ds_read_b128 v[20:23], v4 offset:38912
    v_mul_f32 v88, v88, v188
    v_mfma_f32_16x16x32_bf16 v[148:151], v[220:223], a[144:147], v[148:151]
    v_mul_f32 v89, v89, v189
    v_mul_f32 v90, v90, v190
    v_mfma_f32_16x16x32_bf16 v[148:151], v[192:195], a[160:163], v[148:151]
    v_mul_f32 v91, v91, v191
    v_cvt_pk_bf16_f32 v206, v88, v89
    v_mfma_f32_16x16x32_bf16 v[148:151], v[196:199], a[176:179], v[148:151]
    buffer_load_dwordx4 v1, s[4:7], s20 offen offset:2048 sc1 lds
    ds_read_b128 v[24:27], v4 offset:40960
    v_mfma_f32_16x16x32_bf16 v[156:159], v[28:31], a[100:103], v[156:159]
    v_cvt_pk_bf16_f32 v207, v90, v91
    v_mul_f32 v184, v96, v178
    v_mfma_f32_16x16x32_bf16 v[156:159], v[32:35], a[116:119], v[156:159]
    buffer_store_dwordx4 v[204:207], v1, s[48:51], s29 offen sc1
    v_mfma_f32_16x16x32_bf16 v[156:159], v[36:39], a[132:135], v[156:159]
    s_add_u32 s29, s29, 16384
    ds_read_b128 v[40:43], v4 offset:43008
    v_mul_f32 v185, v97, v178
    v_mfma_f32_16x16x32_bf16 v[156:159], v[220:223], a[148:151], v[156:159]
    s_add_u32 s20, s20, 3072
    v_exp_f32 v184, v184
    v_mfma_f32_16x16x32_bf16 v[156:159], v[192:195], a[164:167], v[156:159]
    v_exp_f32 v185, v185
    v_mfma_f32_16x16x32_bf16 v[156:159], v[196:199], a[180:183], v[156:159]
    ds_read_b128 v[44:47], v4 offset:45056
    v_mul_f32 v186, v98, v178
    v_mfma_f32_16x16x32_bf16 v[164:167], v[28:31], a[104:107], v[164:167]
    v_exp_f32 v186, v186
    v_mfma_f32_16x16x32_bf16 v[164:167], v[32:35], a[120:123], v[164:167]
    v_mul_f32 v187, v99, v178
    v_mul_f32 v96, v96, v100
    v_mfma_f32_16x16x32_bf16 v[164:167], v[36:39], a[136:139], v[164:167]
    s_add_u32 m0, s18, 76800
    ds_read_b128 v[12:15], v4 offset:47104
    v_mul_f32 v97, v97, v101
    v_mfma_f32_16x16x32_bf16 v[164:167], v[220:223], a[152:155], v[164:167]
    v_exp_f32 v187, v187
    v_mfma_f32_16x16x32_bf16 v[164:167], v[192:195], a[168:171], v[164:167]
    v_mul_f32 v98, v98, v102
    v_mul_f32 v99, v99, v103
    v_mfma_f32_16x16x32_bf16 v[164:167], v[196:199], a[184:187], v[164:167]
    v_fma_f32 v184, v184, v182, v182
    v_fma_f32 v185, v185, v182, v182
    v_mfma_f32_16x16x32_bf16 v[172:175], v[28:31], a[108:111], v[172:175]
    buffer_load_dwordx4 v1, s[4:7], s20 offen offset:0 sc1 lds
    v_fma_f32 v186, v186, v182, v182
    v_mfma_f32_16x16x32_bf16 v[172:175], v[32:35], a[124:127], v[172:175]
    v_rcp_f32 v184, v184
    v_mfma_f32_16x16x32_bf16 v[172:175], v[36:39], a[140:143], v[172:175]
    v_rcp_f32 v185, v185
    v_mfma_f32_16x16x32_bf16 v[172:175], v[220:223], a[156:159], v[172:175]
    v_rcp_f32 v186, v186
    v_mfma_f32_16x16x32_bf16 v[172:175], v[192:195], a[172:175], v[172:175]
    buffer_load_dwordx4 v1, s[4:7], s20 offen offset:1024 sc1 lds
    v_fma_f32 v187, v187, v182, v182
    v_mfma_f32_16x16x32_bf16 v[172:175], v[196:199], a[188:191], v[172:175]
    s_waitcnt lgkmcnt(0)
    v_rcp_f32 v187, v187
    v_mfma_f32_16x16x32_bf16 v[144:147], v[16:19], a[192:195], v[144:147]
    ds_read_b128 v[28:31], v4 offset:37888
    v_mul_f32 v96, v96, v184
    v_mfma_f32_16x16x32_bf16 v[144:147], v[20:23], a[208:211], v[144:147]
    v_mul_f32 v97, v97, v185
    v_mul_f32 v98, v98, v186
    v_mfma_f32_16x16x32_bf16 v[144:147], v[24:27], a[224:227], v[144:147]
    ds_read_b128 v[32:35], v4 offset:39936
    v_mul_f32 v99, v99, v187
    v_mfma_f32_16x16x32_bf16 v[144:147], v[40:43], a[240:243], v[144:147]
    buffer_load_dwordx4 v1, s[4:7], s20 offen offset:2048 sc1 lds
    v_cvt_pk_bf16_f32 v210, v96, v97
    v_mfma_f32_16x16x32_bf16 v[144:147], v[44:47], v[224:227], v[144:147]
    v_cvt_pk_bf16_f32 v211, v98, v99
    v_mul_f32 v188, v104, v179
    v_mfma_f32_16x16x32_bf16 v[144:147], v[12:15], v[240:243], v[144:147]
    ds_read_b128 v[36:39], v4 offset:41984
    v_mul_f32 v189, v105, v179
    v_mfma_f32_16x16x32_bf16 v[152:155], v[16:19], a[196:199], v[152:155]
    buffer_store_dwordx4 v[208:211], v1, s[48:51], s30 offen sc1
    v_mfma_f32_16x16x32_bf16 v[152:155], v[20:23], a[212:215], v[152:155]
    s_add_u32 s20, s20, 3072
    v_exp_f32 v188, v188
    v_mfma_f32_16x16x32_bf16 v[152:155], v[24:27], a[228:231], v[152:155]
    s_add_u32 s30, s30, 16384
    ds_read_b128 v[220:223], v4 offset:44032
    v_mul_f32 v190, v106, v179
    v_mfma_f32_16x16x32_bf16 v[152:155], v[40:43], a[244:247], v[152:155]
    v_exp_f32 v189, v189
    v_mfma_f32_16x16x32_bf16 v[152:155], v[44:47], v[228:231], v[152:155]
    v_exp_f32 v190, v190
    v_mfma_f32_16x16x32_bf16 v[152:155], v[12:15], v[244:247], v[152:155]
    ds_read_b128 v[192:195], v4 offset:46080
    v_mul_f32 v191, v107, v179
    v_mfma_f32_16x16x32_bf16 v[160:163], v[16:19], a[200:203], v[160:163]
    s_add_u32 m0, s18, 79872
    v_exp_f32 v191, v191
    v_mfma_f32_16x16x32_bf16 v[160:163], v[20:23], a[216:219], v[160:163]
    v_mul_f32 v104, v104, v108
    v_mul_f32 v105, v105, v109
    v_mfma_f32_16x16x32_bf16 v[160:163], v[24:27], a[232:235], v[160:163]
    ds_read_b128 v[196:199], v4 offset:48128
    v_mul_f32 v106, v106, v110
    v_mfma_f32_16x16x32_bf16 v[160:163], v[40:43], a[248:251], v[160:163]
    v_mul_f32 v107, v107, v111
    v_fma_f32 v188, v188, v183, v183
    v_mfma_f32_16x16x32_bf16 v[160:163], v[44:47], v[232:235], v[160:163]
    buffer_load_dwordx4 v1, s[4:7], s20 offen offset:0 sc1 lds
    v_fma_f32 v189, v189, v183, v183
    v_mfma_f32_16x16x32_bf16 v[160:163], v[12:15], v[248:251], v[160:163]
    v_rcp_f32 v188, v188
    v_mfma_f32_16x16x32_bf16 v[168:171], v[16:19], a[204:207], v[168:171]
    v_rcp_f32 v189, v189
    v_mfma_f32_16x16x32_bf16 v[168:171], v[20:23], a[220:223], v[168:171]
    v_fma_f32 v190, v190, v183, v183
    v_fma_f32 v191, v191, v183, v183
    v_mfma_f32_16x16x32_bf16 v[168:171], v[24:27], a[236:239], v[168:171]
    buffer_load_dwordx4 v1, s[4:7], s20 offen offset:1024 sc1 lds
    v_mul_f32 v104, v104, v188
    v_mfma_f32_16x16x32_bf16 v[168:171], v[40:43], a[252:255], v[168:171]
    v_rcp_f32 v190, v190
    v_mfma_f32_16x16x32_bf16 v[168:171], v[44:47], v[236:239], v[168:171]
    v_rcp_f32 v191, v191
    v_mfma_f32_16x16x32_bf16 v[168:171], v[12:15], v[252:255], v[168:171]
    s_waitcnt lgkmcnt(0)
    v_mul_f32 v105, v105, v189
    v_mul_f32 v106, v106, v190
    v_mfma_f32_16x16x32_bf16 v[148:151], v[28:31], a[192:195], v[148:151]
    s_waitcnt vmcnt(11)
    s_barrier
    v_mfma_f32_16x16x32_bf16 v[148:151], v[32:35], a[208:211], v[148:151]
    buffer_load_dwordx4 v1, s[4:7], s20 offen offset:2048 sc1 lds
    ds_read_b128 v[16:19], v1 offset:0
    v_mfma_f32_16x16x32_bf16 v[148:151], v[36:39], a[224:227], v[148:151]
    v_mul_f32 v107, v107, v191
    v_cvt_pk_bf16_f32 v214, v104, v105
    v_mfma_f32_16x16x32_bf16 v[148:151], v[220:223], a[240:243], v[148:151]
    ds_read_b128 v[20:23], v1 offset:2048
    v_cvt_pk_bf16_f32 v215, v106, v107
    v_mfma_f32_16x16x32_bf16 v[148:151], v[192:195], v[224:227], v[148:151]
    buffer_store_dwordx4 v[212:215], v1, s[48:51], s31 offen sc1
    v_mfma_f32_16x16x32_bf16 v[148:151], v[196:199], v[240:243], v[148:151]
    s_add_u32 s20, s20, 30720
    s_add_u32 s31, s31, 16384
    v_mul_f32 v184, v112, v176
    v_mfma_f32_16x16x32_bf16 v[156:159], v[28:31], a[196:199], v[156:159]
    ds_read_b128 v[24:27], v1 offset:4096
    v_mul_f32 v185, v113, v176
    v_mfma_f32_16x16x32_bf16 v[156:159], v[32:35], a[212:215], v[156:159]
    v_exp_f32 v184, v184
    v_mfma_f32_16x16x32_bf16 v[156:159], v[36:39], a[228:231], v[156:159]
    v_exp_f32 v185, v185
    v_mfma_f32_16x16x32_bf16 v[156:159], v[220:223], a[244:247], v[156:159]
    ds_read_b128 v[40:43], v1 offset:6144
    v_mul_f32 v186, v114, v176
    v_mfma_f32_16x16x32_bf16 v[156:159], v[192:195], v[228:231], v[156:159]
    s_add_u32 m0, s18, 110592
    v_exp_f32 v186, v186
    v_mfma_f32_16x16x32_bf16 v[156:159], v[196:199], v[244:247], v[156:159]
    v_mul_f32 v187, v115, v176
    v_mul_f32 v112, v112, v116
    v_mfma_f32_16x16x32_bf16 v[164:167], v[28:31], a[200:203], v[164:167]
    ds_read_b128 v[44:47], v1 offset:8192
    v_mul_f32 v113, v113, v117
    v_mfma_f32_16x16x32_bf16 v[164:167], v[32:35], a[216:219], v[164:167]
    v_exp_f32 v187, v187
    v_mfma_f32_16x16x32_bf16 v[164:167], v[36:39], a[232:235], v[164:167]
    buffer_load_dwordx4 v1, s[4:7], s20 offen offset:0 sc1 lds
    v_mul_f32 v114, v114, v118
    v_mfma_f32_16x16x32_bf16 v[164:167], v[220:223], a[248:251], v[164:167]
    ds_read_b128 v[12:15], v1 offset:10240
    v_mul_f32 v115, v115, v119
    v_mfma_f32_16x16x32_bf16 v[164:167], v[192:195], v[232:235], v[164:167]
    v_fma_f32 v184, v184, v180, v180
    v_fma_f32 v185, v185, v180, v180
    v_mfma_f32_16x16x32_bf16 v[164:167], v[196:199], v[248:251], v[164:167]
    v_rcp_f32 v184, v184
    v_mfma_f32_16x16x32_bf16 v[172:175], v[28:31], a[204:207], v[172:175]
    buffer_load_dwordx4 v1, s[4:7], s20 offen offset:1024 sc1 lds
    v_fma_f32 v186, v186, v180, v180
    v_mfma_f32_16x16x32_bf16 v[172:175], v[32:35], a[220:223], v[172:175]
    v_rcp_f32 v185, v185
    v_mfma_f32_16x16x32_bf16 v[172:175], v[36:39], a[236:239], v[172:175]
    v_rcp_f32 v186, v186
    v_mfma_f32_16x16x32_bf16 v[172:175], v[220:223], a[252:255], v[172:175]
    v_fma_f32 v187, v187, v180, v180
    v_mul_f32 v112, v112, v184
    v_mfma_f32_16x16x32_bf16 v[172:175], v[192:195], v[236:239], v[172:175]
    v_rcp_f32 v187, v187
    v_mfma_f32_16x16x32_bf16 v[172:175], v[196:199], v[252:255], v[172:175]
    s_waitcnt lgkmcnt(0)
    buffer_load_dwordx4 v1, s[4:7], s20 offen offset:2048 sc1 lds
    v_mul_f32 v113, v113, v185
    v_mfma_f32_16x16x32_bf16 v[48:51], v[16:19], a[0:3], 0
    ds_read_b128 v[28:31], v1 offset:1024
    v_mul_f32 v114, v114, v186
    v_mfma_f32_16x16x32_bf16 v[48:51], v[20:23], a[16:19], v[48:51]
    v_mul_f32 v115, v115, v187
    v_cvt_pk_bf16_f32 v200, v112, v113
    v_mfma_f32_16x16x32_bf16 v[48:51], v[24:27], a[32:35], v[48:51]
    ds_read_b128 v[32:35], v1 offset:3072
    v_cvt_pk_bf16_f32 v201, v114, v115
    v_mfma_f32_16x16x32_bf16 v[48:51], v[40:43], a[48:51], v[48:51]
    s_add_u32 s20, s20, 3072
    v_mul_f32 v188, v120, v177
    v_mul_f32 v189, v121, v177
    v_mfma_f32_16x16x32_bf16 v[48:51], v[44:47], a[64:67], v[48:51]
    v_exp_f32 v188, v188
    v_mfma_f32_16x16x32_bf16 v[48:51], v[12:15], a[80:83], v[48:51]
    ds_read_b128 v[36:39], v1 offset:5120
    v_mul_f32 v190, v122, v177
    v_mfma_f32_16x16x32_bf16 v[56:59], v[16:19], a[4:7], 0
    v_exp_f32 v189, v189
    v_mfma_f32_16x16x32_bf16 v[56:59], v[20:23], a[20:23], v[56:59]
    v_exp_f32 v190, v190
    v_mfma_f32_16x16x32_bf16 v[56:59], v[24:27], a[36:39], v[56:59]
    s_add_u32 m0, s18, 113664
    ds_read_b128 v[220:223], v1 offset:7168
    v_mul_f32 v191, v123, v177
    v_mfma_f32_16x16x32_bf16 v[56:59], v[40:43], a[52:55], v[56:59]
    v_exp_f32 v191, v191
    v_mfma_f32_16x16x32_bf16 v[56:59], v[44:47], a[68:71], v[56:59]
    v_mul_f32 v120, v120, v124
    v_mul_f32 v121, v121, v125
    v_mfma_f32_16x16x32_bf16 v[56:59], v[12:15], a[84:87], v[56:59]
    ds_read_b128 v[192:195], v1 offset:9216
    v_mul_f32 v122, v122, v126
    v_mfma_f32_16x16x32_bf16 v[64:67], v[16:19], a[8:11], 0
    buffer_load_dwordx4 v1, s[4:7], s20 offen offset:0 sc1 lds
    v_mul_f32 v123, v123, v127
    v_mfma_f32_16x16x32_bf16 v[64:67], v[20:23], a[24:27], v[64:67]
    v_fma_f32 v188, v188, v181, v181
    v_fma_f32 v189, v189, v181, v181
    v_mfma_f32_16x16x32_bf16 v[64:67], v[24:27], a[40:43], v[64:67]
    ds_read_b128 v[196:199], v1 offset:11264
    v_fma_f32 v190, v190, v181, v181
    v_mfma_f32_16x16x32_bf16 v[64:67], v[40:43], a[56:59], v[64:67]
    v_rcp_f32 v188, v188
    v_mfma_f32_16x16x32_bf16 v[64:67], v[44:47], a[72:75], v[64:67]
    buffer_load_dwordx4 v1, s[4:7], s20 offen offset:1024 sc1 lds
    v_fma_f32 v191, v191, v181, v181
    v_mfma_f32_16x16x32_bf16 v[64:67], v[12:15], a[88:91], v[64:67]
    v_rcp_f32 v189, v189
    v_mfma_f32_16x16x32_bf16 v[72:75], v[16:19], a[12:15], 0
    v_rcp_f32 v190, v190
    v_mfma_f32_16x16x32_bf16 v[72:75], v[20:23], a[28:31], v[72:75]
    v_rcp_f32 v191, v191
    v_mfma_f32_16x16x32_bf16 v[72:75], v[24:27], a[44:47], v[72:75]
    v_mul_f32 v120, v120, v188
    v_mul_f32 v121, v121, v189
    v_mfma_f32_16x16x32_bf16 v[72:75], v[40:43], a[60:63], v[72:75]
    buffer_load_dwordx4 v1, s[4:7], s20 offen offset:2048 sc1 lds
    v_mul_f32 v122, v122, v190
    v_mfma_f32_16x16x32_bf16 v[72:75], v[44:47], a[76:79], v[72:75]
    v_mul_f32 v123, v123, v191
    v_cvt_pk_bf16_f32 v202, v120, v121
    v_mfma_f32_16x16x32_bf16 v[72:75], v[12:15], a[92:95], v[72:75]
    s_waitcnt lgkmcnt(0)
    v_cvt_pk_bf16_f32 v203, v122, v123
    v_permlane16_swap_b32 v200, v202
    v_mfma_f32_16x16x32_bf16 v[52:55], v[28:31], a[0:3], 0
    ds_read_b128 v[16:19], v1 offset:12288
    v_permlane16_swap_b32 v201, v203
    v_mfma_f32_16x16x32_bf16 v[52:55], v[32:35], a[16:19], v[52:55]
    s_add_u32 s20, s20, 3072
    buffer_store_dwordx4 v[200:203], v10, s[48:51], s32 offen sc1
    v_mfma_f32_16x16x32_bf16 v[52:55], v[36:39], a[32:35], v[52:55]
    ds_read_b128 v[20:23], v1 offset:14336
    v_mul_f32 v184, v128, v178
    v_mfma_f32_16x16x32_bf16 v[52:55], v[220:223], a[48:51], v[52:55]
    v_exp_f32 v184, v184
    v_mfma_f32_16x16x32_bf16 v[52:55], v[192:195], a[64:67], v[52:55]
    v_mul_f32 v185, v129, v178
    v_mul_f32 v186, v130, v178
    v_mfma_f32_16x16x32_bf16 v[52:55], v[196:199], a[80:83], v[52:55]
    ds_read_b128 v[24:27], v1 offset:16384
    v_mul_f32 v187, v131, v178
    v_mfma_f32_16x16x32_bf16 v[60:63], v[28:31], a[4:7], 0
    s_add_u32 m0, s18, 116736
    v_exp_f32 v185, v185
    v_mfma_f32_16x16x32_bf16 v[60:63], v[32:35], a[20:23], v[60:63]
    v_exp_f32 v186, v186
    v_mfma_f32_16x16x32_bf16 v[60:63], v[36:39], a[36:39], v[60:63]
    ds_read_b128 v[40:43], v1 offset:18432
    v_mul_f32 v128, v128, v132
    v_mfma_f32_16x16x32_bf16 v[60:63], v[220:223], a[52:55], v[60:63]
    v_exp_f32 v187, v187
    v_mfma_f32_16x16x32_bf16 v[60:63], v[192:195], a[68:71], v[60:63]
    buffer_load_dwordx4 v1, s[4:7], s20 offen offset:0 sc1 lds
    v_mul_f32 v129, v129, v133
    v_mfma_f32_16x16x32_bf16 v[60:63], v[196:199], a[84:87], v[60:63]
    ds_read_b128 v[44:47], v1 offset:20480
    v_mul_f32 v130, v130, v134
    v_mfma_f32_16x16x32_bf16 v[68:71], v[28:31], a[8:11], 0
    v_mul_f32 v131, v131, v135
    v_fma_f32 v184, v184, v182, v182
    v_mfma_f32_16x16x32_bf16 v[68:71], v[32:35], a[24:27], v[68:71]
    v_rcp_f32 v184, v184
    v_mfma_f32_16x16x32_bf16 v[68:71], v[36:39], a[40:43], v[68:71]
    buffer_load_dwordx4 v1, s[4:7], s20 offen offset:1024 sc1 lds
    ds_read_b128 v[12:15], v1 offset:22528
    v_mfma_f32_16x16x32_bf16 v[68:71], v[220:223], a[56:59], v[68:71]
    v_fma_f32 v185, v185, v182, v182
    v_fma_f32 v186, v186, v182, v182
    v_mfma_f32_16x16x32_bf16 v[68:71], v[192:195], a[72:75], v[68:71]
    v_rcp_f32 v185, v185
    v_mfma_f32_16x16x32_bf16 v[68:71], v[196:199], a[88:91], v[68:71]
    v_rcp_f32 v186, v186
    v_mfma_f32_16x16x32_bf16 v[76:79], v[28:31], a[12:15], 0
    v_fma_f32 v187, v187, v182, v182
    v_mul_f32 v128, v128, v184
    v_mfma_f32_16x16x32_bf16 v[76:79], v[32:35], a[28:31], v[76:79]
    buffer_load_dwordx4 v1, s[4:7], s20 offen offset:2048 sc1 lds
    v_mul_f32 v129, v129, v185
    v_mfma_f32_16x16x32_bf16 v[76:79], v[36:39], a[44:47], v[76:79]
    v_rcp_f32 v187, v187
    v_mfma_f32_16x16x32_bf16 v[76:79], v[220:223], a[60:63], v[76:79]
    v_mul_f32 v130, v130, v186
    v_mul_f32 v131, v131, v187
    v_mfma_f32_16x16x32_bf16 v[76:79], v[192:195], a[76:79], v[76:79]
    v_cvt_pk_bf16_f32 v204, v128, v129
    v_cvt_pk_bf16_f32 v205, v130, v131
    v_mfma_f32_16x16x32_bf16 v[76:79], v[196:199], a[92:95], v[76:79]
    s_waitcnt lgkmcnt(0)
    s_add_u32 s20, s20, 30720
    v_mul_f32 v188, v136, v179
    v_mfma_f32_16x16x32_bf16 v[48:51], v[16:19], a[96:99], v[48:51]
    ds_read_b128 v[28:31], v1 offset:13312
    v_mul_f32 v189, v137, v179
    v_mfma_f32_16x16x32_bf16 v[48:51], v[20:23], a[112:115], v[48:51]
    v_exp_f32 v188, v188
    v_mfma_f32_16x16x32_bf16 v[48:51], v[24:27], a[128:131], v[48:51]
    ds_read_b128 v[32:35], v1 offset:15360
    v_mul_f32 v190, v138, v179
    v_mfma_f32_16x16x32_bf16 v[48:51], v[40:43], a[144:147], v[48:51]
    v_exp_f32 v189, v189
    v_mfma_f32_16x16x32_bf16 v[48:51], v[44:47], a[160:163], v[48:51]
    v_exp_f32 v190, v190
    v_mfma_f32_16x16x32_bf16 v[48:51], v[12:15], a[176:179], v[48:51]
    ds_read_b128 v[36:39], v1 offset:17408
    v_mul_f32 v191, v139, v179
    v_mfma_f32_16x16x32_bf16 v[56:59], v[16:19], a[100:103], v[56:59]
    v_exp_f32 v191, v191
    v_mfma_f32_16x16x32_bf16 v[56:59], v[20:23], a[116:119], v[56:59]
    v_mul_f32 v136, v136, v140
    v_mul_f32 v137, v137, v141
    v_mfma_f32_16x16x32_bf16 v[56:59], v[24:27], a[132:135], v[56:59]
    ds_read_b128 v[220:223], v1 offset:19456
    v_mul_f32 v138, v138, v142
    v_mfma_f32_16x16x32_bf16 v[56:59], v[40:43], a[148:151], v[56:59]
    v_mul_f32 v139, v139, v143
    v_fma_f32 v188, v188, v183, v183
    v_mfma_f32_16x16x32_bf16 v[56:59], v[44:47], a[164:167], v[56:59]
    v_rcp_f32 v188, v188
    v_mfma_f32_16x16x32_bf16 v[56:59], v[12:15], a[180:183], v[56:59]
    ds_read_b128 v[192:195], v1 offset:21504
    v_fma_f32 v189, v189, v183, v183
    v_mfma_f32_16x16x32_bf16 v[64:67], v[16:19], a[104:107], v[64:67]
    v_rcp_f32 v189, v189
    v_mfma_f32_16x16x32_bf16 v[64:67], v[20:23], a[120:123], v[64:67]
    v_fma_f32 v190, v190, v183, v183
    v_fma_f32 v191, v191, v183, v183
    v_mfma_f32_16x16x32_bf16 v[64:67], v[24:27], a[136:139], v[64:67]
    ds_read_b128 v[196:199], v1 offset:23552
    v_mul_f32 v136, v136, v188
    v_mfma_f32_16x16x32_bf16 v[64:67], v[40:43], a[152:155], v[64:67]
    v_rcp_f32 v190, v190
    v_mfma_f32_16x16x32_bf16 v[64:67], v[44:47], a[168:171], v[64:67]
    v_rcp_f32 v191, v191
    v_mfma_f32_16x16x32_bf16 v[64:67], v[12:15], a[184:187], v[64:67]
    v_mul_f32 v137, v137, v189
    v_mul_f32 v138, v138, v190
    v_mfma_f32_16x16x32_bf16 v[72:75], v[16:19], a[108:111], v[72:75]
    v_mul_f32 v139, v139, v191
    v_cvt_pk_bf16_f32 v206, v136, v137
    v_mfma_f32_16x16x32_bf16 v[72:75], v[20:23], a[124:127], v[72:75]
    v_cvt_pk_bf16_f32 v207, v138, v139
    v_permlane16_swap_b32 v204, v206
    v_mfma_f32_16x16x32_bf16 v[72:75], v[24:27], a[140:143], v[72:75]
    v_permlane16_swap_b32 v205, v207
    v_mul_f32 v184, v144, v176
    v_mfma_f32_16x16x32_bf16 v[72:75], v[40:43], a[156:159], v[72:75]
    buffer_store_dwordx4 v[204:207], v10, s[48:51], s33 offen sc1
    v_mfma_f32_16x16x32_bf16 v[72:75], v[44:47], a[172:175], v[72:75]
    v_exp_f32 v184, v184
    v_mfma_f32_16x16x32_bf16 v[72:75], v[12:15], a[188:191], v[72:75]
    s_waitcnt lgkmcnt(0)
    v_mul_f32 v185, v145, v176
    v_mul_f32 v186, v146, v176
    v_mfma_f32_16x16x32_bf16 v[52:55], v[28:31], a[96:99], v[52:55]
    ds_read_b128 v[16:19], v1 offset:24576
    v_mul_f32 v187, v147, v176
    v_mfma_f32_16x16x32_bf16 v[52:55], v[32:35], a[112:115], v[52:55]
    v_exp_f32 v185, v185
    v_mfma_f32_16x16x32_bf16 v[52:55], v[36:39], a[128:131], v[52:55]
    ds_read_b128 v[20:23], v1 offset:26624
    v_mul_f32 v144, v144, v148
    v_mfma_f32_16x16x32_bf16 v[52:55], v[220:223], a[144:147], v[52:55]
    v_exp_f32 v186, v186
    v_mfma_f32_16x16x32_bf16 v[52:55], v[192:195], a[160:163], v[52:55]
    v_exp_f32 v187, v187
    v_mfma_f32_16x16x32_bf16 v[52:55], v[196:199], a[176:179], v[52:55]
    ds_read_b128 v[24:27], v1 offset:28672
    v_mul_f32 v145, v145, v149
    v_mfma_f32_16x16x32_bf16 v[60:63], v[28:31], a[100:103], v[60:63]
    v_mul_f32 v146, v146, v150
    v_mul_f32 v147, v147, v151
    v_mfma_f32_16x16x32_bf16 v[60:63], v[32:35], a[116:119], v[60:63]
    v_fma_f32 v184, v184, v180, v180
    v_fma_f32 v185, v185, v180, v180
    v_mfma_f32_16x16x32_bf16 v[60:63], v[36:39], a[132:135], v[60:63]
    ds_read_b128 v[40:43], v1 offset:30720
    v_fma_f32 v186, v186, v180, v180
    v_mfma_f32_16x16x32_bf16 v[60:63], v[220:223], a[148:151], v[60:63]
    v_rcp_f32 v184, v184
    v_mfma_f32_16x16x32_bf16 v[60:63], v[192:195], a[164:167], v[60:63]
    v_rcp_f32 v185, v185
    v_mfma_f32_16x16x32_bf16 v[60:63], v[196:199], a[180:183], v[60:63]
    ds_read_b128 v[44:47], v1 offset:32768
    v_fma_f32 v187, v187, v180, v180
    v_mfma_f32_16x16x32_bf16 v[68:71], v[28:31], a[104:107], v[68:71]
    v_rcp_f32 v186, v186
    v_mfma_f32_16x16x32_bf16 v[68:71], v[32:35], a[120:123], v[68:71]
    v_rcp_f32 v187, v187
    v_mfma_f32_16x16x32_bf16 v[68:71], v[36:39], a[136:139], v[68:71]
    ds_read_b128 v[12:15], v1 offset:34816
    v_mul_f32 v144, v144, v184
    v_mfma_f32_16x16x32_bf16 v[68:71], v[220:223], a[152:155], v[68:71]
    v_mul_f32 v145, v145, v185
    v_mul_f32 v146, v146, v186
    v_mfma_f32_16x16x32_bf16 v[68:71], v[192:195], a[168:171], v[68:71]
    v_mul_f32 v147, v147, v187
    v_cvt_pk_bf16_f32 v200, v144, v145
    v_mfma_f32_16x16x32_bf16 v[68:71], v[196:199], a[184:187], v[68:71]
    v_cvt_pk_bf16_f32 v201, v146, v147
    v_mul_f32 v188, v152, v177
    v_mfma_f32_16x16x32_bf16 v[76:79], v[28:31], a[108:111], v[76:79]
    v_exp_f32 v188, v188
    v_mfma_f32_16x16x32_bf16 v[76:79], v[32:35], a[124:127], v[76:79]
    v_mul_f32 v189, v153, v177
    v_mul_f32 v190, v154, v177
    v_mfma_f32_16x16x32_bf16 v[76:79], v[36:39], a[140:143], v[76:79]
    v_exp_f32 v189, v189
    v_mfma_f32_16x16x32_bf16 v[76:79], v[220:223], a[156:159], v[76:79]
    v_exp_f32 v190, v190
    v_mfma_f32_16x16x32_bf16 v[76:79], v[192:195], a[172:175], v[76:79]
    v_mul_f32 v191, v155, v177
    v_mul_f32 v152, v152, v156
    v_mfma_f32_16x16x32_bf16 v[76:79], v[196:199], a[188:191], v[76:79]
    s_waitcnt lgkmcnt(0)
    v_exp_f32 v191, v191
    v_mfma_f32_16x16x32_bf16 v[48:51], v[16:19], a[192:195], v[48:51]
    ds_read_b128 v[28:31], v1 offset:25600
    v_mul_f32 v153, v153, v157
    v_mfma_f32_16x16x32_bf16 v[48:51], v[20:23], a[208:211], v[48:51]
    v_mul_f32 v154, v154, v158
    v_mul_f32 v155, v155, v159
    v_mfma_f32_16x16x32_bf16 v[48:51], v[24:27], a[224:227], v[48:51]
    ds_read_b128 v[32:35], v1 offset:27648
    v_fma_f32 v188, v188, v181, v181
    v_mfma_f32_16x16x32_bf16 v[48:51], v[40:43], a[240:243], v[48:51]
    v_rcp_f32 v188, v188
    v_mfma_f32_16x16x32_bf16 v[48:51], v[44:47], v[224:227], v[48:51]
    v_fma_f32 v189, v189, v181, v181
    v_fma_f32 v190, v190, v181, v181
    v_mfma_f32_16x16x32_bf16 v[48:51], v[12:15], v[240:243], v[48:51]
    ds_read_b128 v[36:39], v1 offset:29696
    v_fma_f32 v191, v191, v181, v181
    v_mfma_f32_16x16x32_bf16 v[56:59], v[16:19], a[196:199], v[56:59]
    v_rcp_f32 v189, v189
    v_mfma_f32_16x16x32_bf16 v[56:59], v[20:23], a[212:215], v[56:59]
    v_rcp_f32 v190, v190
    v_mfma_f32_16x16x32_bf16 v[56:59], v[24:27], a[228:231], v[56:59]
    ds_read_b128 v[220:223], v1 offset:31744
    v_mul_f32 v152, v152, v188
    v_mfma_f32_16x16x32_bf16 v[56:59], v[40:43], a[244:247], v[56:59]
    v_rcp_f32 v191, v191
    v_mfma_f32_16x16x32_bf16 v[56:59], v[44:47], v[228:231], v[56:59]
    v_mul_f32 v153, v153, v189
    v_mul_f32 v154, v154, v190
    v_mfma_f32_16x16x32_bf16 v[56:59], v[12:15], v[244:247], v[56:59]
    ds_read_b128 v[192:195], v1 offset:33792
    v_mul_f32 v155, v155, v191
    v_mfma_f32_16x16x32_bf16 v[64:67], v[16:19], a[200:203], v[64:67]
    v_cvt_pk_bf16_f32 v204, v152, v153
    v_cvt_pk_bf16_f32 v205, v154, v155
    v_mfma_f32_16x16x32_bf16 v[64:67], v[20:23], a[216:219], v[64:67]
    v_mul_f32 v184, v160, v178
    v_mul_f32 v185, v161, v178
    v_mfma_f32_16x16x32_bf16 v[64:67], v[24:27], a[232:235], v[64:67]
    ds_read_b128 v[196:199], v1 offset:35840
    v_mul_f32 v186, v162, v178
    v_mfma_f32_16x16x32_bf16 v[64:67], v[40:43], a[248:251], v[64:67]
    v_exp_f32 v184, v184
    v_mfma_f32_16x16x32_bf16 v[64:67], v[44:47], v[232:235], v[64:67]
    v_exp_f32 v185, v185
    v_mfma_f32_16x16x32_bf16 v[64:67], v[12:15], v[248:251], v[64:67]
    v_exp_f32 v186, v186
    v_mfma_f32_16x16x32_bf16 v[72:75], v[16:19], a[204:207], v[72:75]
    v_mul_f32 v187, v163, v178
    v_mul_f32 v160, v160, v164
    v_mfma_f32_16x16x32_bf16 v[72:75], v[20:23], a[220:223], v[72:75]
    v_exp_f32 v187, v187
    v_mfma_f32_16x16x32_bf16 v[72:75], v[24:27], a[236:239], v[72:75]
    v_mul_f32 v161, v161, v165
    v_mul_f32 v162, v162, v166
    v_mfma_f32_16x16x32_bf16 v[72:75], v[40:43], a[252:255], v[72:75]
    v_mul_f32 v163, v163, v167
    v_fma_f32 v184, v184, v182, v182
    v_mfma_f32_16x16x32_bf16 v[72:75], v[44:47], v[236:239], v[72:75]
    v_rcp_f32 v184, v184
    v_mfma_f32_16x16x32_bf16 v[72:75], v[12:15], v[252:255], v[72:75]
    s_waitcnt lgkmcnt(0)
    v_fma_f32 v185, v185, v182, v182
    v_fma_f32 v186, v186, v182, v182
    v_mfma_f32_16x16x32_bf16 v[52:55], v[28:31], a[192:195], v[52:55]
    ds_read_b128 v[16:19], v1 offset:36864
    v_fma_f32 v187, v187, v182, v182
    v_mfma_f32_16x16x32_bf16 v[52:55], v[32:35], a[208:211], v[52:55]
    v_rcp_f32 v185, v185
    v_mfma_f32_16x16x32_bf16 v[52:55], v[36:39], a[224:227], v[52:55]
    ds_read_b128 v[20:23], v1 offset:38912
    v_mul_f32 v160, v160, v184
    v_mfma_f32_16x16x32_bf16 v[52:55], v[220:223], a[240:243], v[52:55]
    v_rcp_f32 v186, v186
    v_mfma_f32_16x16x32_bf16 v[52:55], v[192:195], v[224:227], v[52:55]
    v_rcp_f32 v187, v187
    v_mfma_f32_16x16x32_bf16 v[52:55], v[196:199], v[240:243], v[52:55]
    ds_read_b128 v[24:27], v1 offset:40960
    v_mul_f32 v161, v161, v185
    v_mfma_f32_16x16x32_bf16 v[60:63], v[28:31], a[196:199], v[60:63]
    v_mul_f32 v162, v162, v186
    v_mul_f32 v163, v163, v187
    v_mfma_f32_16x16x32_bf16 v[60:63], v[32:35], a[212:215], v[60:63]
    v_cvt_pk_bf16_f32 v208, v160, v161
    v_cvt_pk_bf16_f32 v209, v162, v163
    v_mfma_f32_16x16x32_bf16 v[60:63], v[36:39], a[228:231], v[60:63]
    ds_read_b128 v[40:43], v1 offset:43008
    v_mul_f32 v188, v168, v179
    v_mfma_f32_16x16x32_bf16 v[60:63], v[220:223], a[244:247], v[60:63]
    v_exp_f32 v188, v188
    v_mfma_f32_16x16x32_bf16 v[60:63], v[192:195], v[228:231], v[60:63]
    v_mul_f32 v189, v169, v179
    v_mul_f32 v190, v170, v179
    v_mfma_f32_16x16x32_bf16 v[60:63], v[196:199], v[244:247], v[60:63]
    ds_read_b128 v[44:47], v1 offset:45056
    v_mul_f32 v191, v171, v179
    v_mfma_f32_16x16x32_bf16 v[68:71], v[28:31], a[200:203], v[68:71]
    v_exp_f32 v189, v189
    v_mfma_f32_16x16x32_bf16 v[68:71], v[32:35], a[216:219], v[68:71]
    v_exp_f32 v190, v190
    v_mfma_f32_16x16x32_bf16 v[68:71], v[36:39], a[232:235], v[68:71]
    ds_read_b128 v[12:15], v1 offset:47104
    v_mul_f32 v168, v168, v172
    v_mfma_f32_16x16x32_bf16 v[68:71], v[220:223], a[248:251], v[68:71]
    v_exp_f32 v191, v191
    v_mfma_f32_16x16x32_bf16 v[68:71], v[192:195], v[232:235], v[68:71]
    v_mul_f32 v169, v169, v173
    v_mul_f32 v170, v170, v174
    v_mfma_f32_16x16x32_bf16 v[68:71], v[196:199], v[248:251], v[68:71]
    v_mul_f32 v171, v171, v175
    v_fma_f32 v188, v188, v183, v183
    v_mfma_f32_16x16x32_bf16 v[76:79], v[28:31], a[204:207], v[76:79]
    v_rcp_f32 v188, v188
    v_mfma_f32_16x16x32_bf16 v[76:79], v[32:35], a[220:223], v[76:79]
    v_fma_f32 v189, v189, v183, v183
    v_fma_f32 v190, v190, v183, v183
    v_mfma_f32_16x16x32_bf16 v[76:79], v[36:39], a[236:239], v[76:79]
    v_rcp_f32 v189, v189
    v_mfma_f32_16x16x32_bf16 v[76:79], v[220:223], a[252:255], v[76:79]
    v_rcp_f32 v190, v190
    v_mfma_f32_16x16x32_bf16 v[76:79], v[192:195], v[236:239], v[76:79]
    v_fma_f32 v191, v191, v183, v183
    v_mul_f32 v168, v168, v188
    v_mfma_f32_16x16x32_bf16 v[76:79], v[196:199], v[252:255], v[76:79]
    s_waitcnt lgkmcnt(0)
    v_rcp_f32 v191, v191
    v_mfma_f32_16x16x32_bf16 v[80:83], v[16:19], a[0:3], 0
    ds_read_b128 v[28:31], v1 offset:37888
    v_mul_f32 v169, v169, v189
    v_mfma_f32_16x16x32_bf16 v[80:83], v[20:23], a[16:19], v[80:83]
    v_mul_f32 v170, v170, v190
    v_mul_f32 v171, v171, v191
    v_mfma_f32_16x16x32_bf16 v[80:83], v[24:27], a[32:35], v[80:83]
    ds_read_b128 v[32:35], v1 offset:39936
    v_cvt_pk_bf16_f32 v212, v168, v169
    v_mfma_f32_16x16x32_bf16 v[80:83], v[40:43], a[48:51], v[80:83]
    v_cvt_pk_bf16_f32 v213, v170, v171
    v_mul_f32 v184, v48, v176
    v_mfma_f32_16x16x32_bf16 v[80:83], v[44:47], a[64:67], v[80:83]
    v_exp_f32 v184, v184
    v_mfma_f32_16x16x32_bf16 v[80:83], v[12:15], a[80:83], v[80:83]
    ds_read_b128 v[36:39], v1 offset:41984
    v_mul_f32 v185, v49, v176
    v_mfma_f32_16x16x32_bf16 v[88:91], v[16:19], a[4:7], 0
    v_exp_f32 v185, v185
    v_mfma_f32_16x16x32_bf16 v[88:91], v[20:23], a[20:23], v[88:91]
    v_mul_f32 v186, v50, v176
    v_mul_f32 v187, v51, v176
    v_mfma_f32_16x16x32_bf16 v[88:91], v[24:27], a[36:39], v[88:91]
    ds_read_b128 v[220:223], v1 offset:44032
    v_mul_f32 v48, v48, v52
    v_mfma_f32_16x16x32_bf16 v[88:91], v[40:43], a[52:55], v[88:91]
    v_exp_f32 v186, v186
    v_mfma_f32_16x16x32_bf16 v[88:91], v[44:47], a[68:71], v[88:91]
    v_exp_f32 v187, v187
    v_mfma_f32_16x16x32_bf16 v[88:91], v[12:15], a[84:87], v[88:91]
    ds_read_b128 v[192:195], v1 offset:46080
    v_mul_f32 v49, v49, v53
    v_mfma_f32_16x16x32_bf16 v[96:99], v[16:19], a[8:11], 0
    v_mul_f32 v50, v50, v54
    v_mul_f32 v51, v51, v55
    v_mfma_f32_16x16x32_bf16 v[96:99], v[20:23], a[24:27], v[96:99]
    v_fma_f32 v184, v184, v180, v180
    v_fma_f32 v185, v185, v180, v180
    v_mfma_f32_16x16x32_bf16 v[96:99], v[24:27], a[40:43], v[96:99]
    ds_read_b128 v[196:199], v1 offset:48128
    v_fma_f32 v186, v186, v180, v180
    v_mfma_f32_16x16x32_bf16 v[96:99], v[40:43], a[56:59], v[96:99]
    v_rcp_f32 v184, v184
    v_mfma_f32_16x16x32_bf16 v[96:99], v[44:47], a[72:75], v[96:99]
    v_rcp_f32 v185, v185
    v_mfma_f32_16x16x32_bf16 v[96:99], v[12:15], a[88:91], v[96:99]
    v_rcp_f32 v186, v186
    v_mfma_f32_16x16x32_bf16 v[104:107], v[16:19], a[12:15], 0
    v_fma_f32 v187, v187, v180, v180
    v_mul_f32 v48, v48, v184
    v_mfma_f32_16x16x32_bf16 v[104:107], v[20:23], a[28:31], v[104:107]
    v_rcp_f32 v187, v187
    v_mfma_f32_16x16x32_bf16 v[104:107], v[24:27], a[44:47], v[104:107]
    v_mul_f32 v49, v49, v185
    v_mul_f32 v50, v50, v186
    v_mfma_f32_16x16x32_bf16 v[104:107], v[40:43], a[60:63], v[104:107]
    v_mul_f32 v51, v51, v187
    v_cvt_pk_bf16_f32 v202, v48, v49
    v_mfma_f32_16x16x32_bf16 v[104:107], v[44:47], a[76:79], v[104:107]
    v_cvt_pk_bf16_f32 v203, v50, v51
    v_mul_f32 v188, v56, v177
    v_mfma_f32_16x16x32_bf16 v[104:107], v[12:15], a[92:95], v[104:107]
    s_waitcnt lgkmcnt(0)
    buffer_store_dwordx4 v[200:203], v1, s[48:51], s28 offen sc1
    v_mfma_f32_16x16x32_bf16 v[84:87], v[28:31], a[0:3], 0
    s_add_u32 s28, s28, 16384
    ds_read_b128 v[16:19], v3 offset:0
    v_mul_f32 v189, v57, v177
    v_mfma_f32_16x16x32_bf16 v[84:87], v[32:35], a[16:19], v[84:87]
    v_exp_f32 v188, v188
    v_mfma_f32_16x16x32_bf16 v[84:87], v[36:39], a[32:35], v[84:87]
    ds_read_b128 v[20:23], v3 offset:2048
    v_mul_f32 v190, v58, v177
    v_mfma_f32_16x16x32_bf16 v[84:87], v[220:223], a[48:51], v[84:87]
    v_exp_f32 v189, v189
    v_mfma_f32_16x16x32_bf16 v[84:87], v[192:195], a[64:67], v[84:87]
    v_exp_f32 v190, v190
    v_mfma_f32_16x16x32_bf16 v[84:87], v[196:199], a[80:83], v[84:87]
    ds_read_b128 v[24:27], v3 offset:4096
    v_mul_f32 v191, v59, v177
    v_mfma_f32_16x16x32_bf16 v[92:95], v[28:31], a[4:7], 0
    v_exp_f32 v191, v191
    v_mfma_f32_16x16x32_bf16 v[92:95], v[32:35], a[20:23], v[92:95]
    v_mul_f32 v56, v56, v60
    v_mul_f32 v57, v57, v61
    v_mfma_f32_16x16x32_bf16 v[92:95], v[36:39], a[36:39], v[92:95]
    ds_read_b128 v[40:43], v3 offset:6144
    v_mul_f32 v58, v58, v62
    v_mfma_f32_16x16x32_bf16 v[92:95], v[220:223], a[52:55], v[92:95]
    v_mul_f32 v59, v59, v63
    v_fma_f32 v188, v188, v181, v181
    v_mfma_f32_16x16x32_bf16 v[92:95], v[192:195], a[68:71], v[92:95]
    v_rcp_f32 v188, v188
    v_mfma_f32_16x16x32_bf16 v[92:95], v[196:199], a[84:87], v[92:95]
    ds_read_b128 v[44:47], v3 offset:8192
    v_fma_f32 v189, v189, v181, v181
    v_mfma_f32_16x16x32_bf16 v[100:103], v[28:31], a[8:11], 0
    v_rcp_f32 v189, v189
    v_mfma_f32_16x16x32_bf16 v[100:103], v[32:35], a[24:27], v[100:103]
    v_fma_f32 v190, v190, v181, v181
    v_fma_f32 v191, v191, v181, v181
    v_mfma_f32_16x16x32_bf16 v[100:103], v[36:39], a[40:43], v[100:103]
    ds_read_b128 v[12:15], v3 offset:10240
    v_mul_f32 v56, v56, v188
    v_mfma_f32_16x16x32_bf16 v[100:103], v[220:223], a[56:59], v[100:103]
    v_rcp_f32 v190, v190
    v_mfma_f32_16x16x32_bf16 v[100:103], v[192:195], a[72:75], v[100:103]
    v_rcp_f32 v191, v191
    v_mfma_f32_16x16x32_bf16 v[100:103], v[196:199], a[88:91], v[100:103]
    v_mul_f32 v57, v57, v189
    v_mul_f32 v58, v58, v190
    v_mfma_f32_16x16x32_bf16 v[108:111], v[28:31], a[12:15], 0
    v_mul_f32 v59, v59, v191
    v_cvt_pk_bf16_f32 v206, v56, v57
    v_mfma_f32_16x16x32_bf16 v[108:111], v[32:35], a[28:31], v[108:111]
    v_cvt_pk_bf16_f32 v207, v58, v59
    v_mul_f32 v184, v64, v178
    v_mfma_f32_16x16x32_bf16 v[108:111], v[36:39], a[44:47], v[108:111]
    buffer_store_dwordx4 v[204:207], v1, s[48:51], s29 offen sc1
    v_mfma_f32_16x16x32_bf16 v[108:111], v[220:223], a[60:63], v[108:111]
    s_add_u32 s29, s29, 16384
    v_exp_f32 v184, v184
    v_mfma_f32_16x16x32_bf16 v[108:111], v[192:195], a[76:79], v[108:111]
    v_mul_f32 v185, v65, v178
    v_mul_f32 v186, v66, v178
    v_mfma_f32_16x16x32_bf16 v[108:111], v[196:199], a[92:95], v[108:111]
    s_waitcnt lgkmcnt(0)
    v_exp_f32 v185, v185
    v_mfma_f32_16x16x32_bf16 v[80:83], v[16:19], a[96:99], v[80:83]
    ds_read_b128 v[28:31], v3 offset:1024
    v_mul_f32 v187, v67, v178
    v_mfma_f32_16x16x32_bf16 v[80:83], v[20:23], a[112:115], v[80:83]
    v_exp_f32 v186, v186
    v_mfma_f32_16x16x32_bf16 v[80:83], v[24:27], a[128:131], v[80:83]
    ds_read_b128 v[32:35], v3 offset:3072
    v_mul_f32 v64, v64, v68
    v_mfma_f32_16x16x32_bf16 v[80:83], v[40:43], a[144:147], v[80:83]
    v_exp_f32 v187, v187
    v_mfma_f32_16x16x32_bf16 v[80:83], v[44:47], a[160:163], v[80:83]
    v_mul_f32 v65, v65, v69
    v_mul_f32 v66, v66, v70
    v_mfma_f32_16x16x32_bf16 v[80:83], v[12:15], a[176:179], v[80:83]
    ds_read_b128 v[36:39], v3 offset:5120
    v_mul_f32 v67, v67, v71
    v_mfma_f32_16x16x32_bf16 v[88:91], v[16:19], a[100:103], v[88:91]
    v_fma_f32 v184, v184, v182, v182
    v_fma_f32 v185, v185, v182, v182
    v_mfma_f32_16x16x32_bf16 v[88:91], v[20:23], a[116:119], v[88:91]
    v_rcp_f32 v184, v184
    v_mfma_f32_16x16x32_bf16 v[88:91], v[24:27], a[132:135], v[88:91]
    ds_read_b128 v[220:223], v3 offset:7168
    v_fma_f32 v186, v186, v182, v182
    v_mfma_f32_16x16x32_bf16 v[88:91], v[40:43], a[148:151], v[88:91]
    v_rcp_f32 v185, v185
    v_mfma_f32_16x16x32_bf16 v[88:91], v[44:47], a[164:167], v[88:91]
    v_rcp_f32 v186, v186
    v_mfma_f32_16x16x32_bf16 v[88:91], v[12:15], a[180:183], v[88:91]
    ds_read_b128 v[192:195], v3 offset:9216
    v_fma_f32 v187, v187, v182, v182
    v_mfma_f32_16x16x32_bf16 v[96:99], v[16:19], a[104:107], v[96:99]
    v_rcp_f32 v187, v187
    v_mfma_f32_16x16x32_bf16 v[96:99], v[20:23], a[120:123], v[96:99]
    v_mul_f32 v64, v64, v184
    v_mul_f32 v65, v65, v185
    v_mfma_f32_16x16x32_bf16 v[96:99], v[24:27], a[136:139], v[96:99]
    ds_read_b128 v[196:199], v3 offset:11264
    v_mul_f32 v66, v66, v186
    v_mfma_f32_16x16x32_bf16 v[96:99], v[40:43], a[152:155], v[96:99]
    v_mul_f32 v67, v67, v187
    v_cvt_pk_bf16_f32 v210, v64, v65
    v_mfma_f32_16x16x32_bf16 v[96:99], v[44:47], a[168:171], v[96:99]
    v_cvt_pk_bf16_f32 v211, v66, v67
    v_mul_f32 v188, v72, v179
    v_mfma_f32_16x16x32_bf16 v[96:99], v[12:15], a[184:187], v[96:99]
    buffer_store_dwordx4 v[208:211], v1, s[48:51], s30 offen sc1
    v_mfma_f32_16x16x32_bf16 v[104:107], v[16:19], a[108:111], v[104:107]
    s_add_u32 s30, s30, 16384
    v_exp_f32 v188, v188
    v_mfma_f32_16x16x32_bf16 v[104:107], v[20:23], a[124:127], v[104:107]
    v_mul_f32 v189, v73, v179
    v_mul_f32 v190, v74, v179
    v_mfma_f32_16x16x32_bf16 v[104:107], v[24:27], a[140:143], v[104:107]
    v_exp_f32 v189, v189
    v_mfma_f32_16x16x32_bf16 v[104:107], v[40:43], a[156:159], v[104:107]
    v_exp_f32 v190, v190
    v_mfma_f32_16x16x32_bf16 v[104:107], v[44:47], a[172:175], v[104:107]
    v_mul_f32 v191, v75, v179
    v_mul_f32 v72, v72, v76
    v_mfma_f32_16x16x32_bf16 v[104:107], v[12:15], a[188:191], v[104:107]
    s_waitcnt lgkmcnt(0)
    v_exp_f32 v191, v191
    v_mfma_f32_16x16x32_bf16 v[84:87], v[28:31], a[96:99], v[84:87]
    ds_read_b128 v[16:19], v3 offset:12288
    v_mul_f32 v73, v73, v77
    v_mfma_f32_16x16x32_bf16 v[84:87], v[32:35], a[112:115], v[84:87]
    v_mul_f32 v74, v74, v78
    v_mul_f32 v75, v75, v79
    v_mfma_f32_16x16x32_bf16 v[84:87], v[36:39], a[128:131], v[84:87]
    ds_read_b128 v[20:23], v3 offset:14336
    v_fma_f32 v188, v188, v183, v183
    v_mfma_f32_16x16x32_bf16 v[84:87], v[220:223], a[144:147], v[84:87]
    v_rcp_f32 v188, v188
    v_mfma_f32_16x16x32_bf16 v[84:87], v[192:195], a[160:163], v[84:87]
    v_fma_f32 v189, v189, v183, v183
    v_fma_f32 v190, v190, v183, v183
    v_mfma_f32_16x16x32_bf16 v[84:87], v[196:199], a[176:179], v[84:87]
    ds_read_b128 v[24:27], v3 offset:16384
    v_fma_f32 v191, v191, v183, v183
    v_mfma_f32_16x16x32_bf16 v[92:95], v[28:31], a[100:103], v[92:95]
    v_rcp_f32 v189, v189
    v_mfma_f32_16x16x32_bf16 v[92:95], v[32:35], a[116:119], v[92:95]
    v_rcp_f32 v190, v190
    v_mfma_f32_16x16x32_bf16 v[92:95], v[36:39], a[132:135], v[92:95]
    ds_read_b128 v[40:43], v3 offset:18432
    v_mul_f32 v72, v72, v188
    v_mfma_f32_16x16x32_bf16 v[92:95], v[220:223], a[148:151], v[92:95]
    v_rcp_f32 v191, v191
    v_mfma_f32_16x16x32_bf16 v[92:95], v[192:195], a[164:167], v[92:95]
    v_mul_f32 v73, v73, v189
    v_mul_f32 v74, v74, v190
    v_mfma_f32_16x16x32_bf16 v[92:95], v[196:199], a[180:183], v[92:95]
    ds_read_b128 v[44:47], v3 offset:20480
    v_mul_f32 v75, v75, v191
    v_mfma_f32_16x16x32_bf16 v[100:103], v[28:31], a[104:107], v[100:103]
    v_cvt_pk_bf16_f32 v214, v72, v73
    v_cvt_pk_bf16_f32 v215, v74, v75
    v_mfma_f32_16x16x32_bf16 v[100:103], v[32:35], a[120:123], v[100:103]
    buffer_store_dwordx4 v[212:215], v1, s[48:51], s31 offen sc1
    v_mfma_f32_16x16x32_bf16 v[100:103], v[36:39], a[136:139], v[100:103]
    s_add_u32 s31, s31, 16384
    ds_read_b128 v[12:15], v3 offset:22528
    v_mfma_f32_16x16x32_bf16 v[100:103], v[220:223], a[152:155], v[100:103]
    v_mfma_f32_16x16x32_bf16 v[100:103], v[192:195], a[168:171], v[100:103]
    v_mfma_f32_16x16x32_bf16 v[100:103], v[196:199], a[184:187], v[100:103]
    v_mfma_f32_16x16x32_bf16 v[108:111], v[28:31], a[108:111], v[108:111]
    v_mfma_f32_16x16x32_bf16 v[108:111], v[32:35], a[124:127], v[108:111]
    v_mfma_f32_16x16x32_bf16 v[108:111], v[36:39], a[140:143], v[108:111]
    v_mfma_f32_16x16x32_bf16 v[108:111], v[220:223], a[156:159], v[108:111]
    v_mfma_f32_16x16x32_bf16 v[108:111], v[192:195], a[172:175], v[108:111]
    v_mfma_f32_16x16x32_bf16 v[108:111], v[196:199], a[188:191], v[108:111]
    s_waitcnt lgkmcnt(0)
    v_mfma_f32_16x16x32_bf16 v[80:83], v[16:19], a[192:195], v[80:83]
    ds_read_b128 v[28:31], v3 offset:13312
    v_mfma_f32_16x16x32_bf16 v[80:83], v[20:23], a[208:211], v[80:83]
    v_mfma_f32_16x16x32_bf16 v[80:83], v[24:27], a[224:227], v[80:83]
    ds_read_b128 v[32:35], v3 offset:15360
    v_mfma_f32_16x16x32_bf16 v[80:83], v[40:43], a[240:243], v[80:83]
    v_mfma_f32_16x16x32_bf16 v[80:83], v[44:47], v[224:227], v[80:83]
    v_mfma_f32_16x16x32_bf16 v[80:83], v[12:15], v[240:243], v[80:83]
    ds_read_b128 v[36:39], v3 offset:17408
    v_mfma_f32_16x16x32_bf16 v[88:91], v[16:19], a[196:199], v[88:91]
    v_mfma_f32_16x16x32_bf16 v[88:91], v[20:23], a[212:215], v[88:91]
    v_mfma_f32_16x16x32_bf16 v[88:91], v[24:27], a[228:231], v[88:91]
    ds_read_b128 v[220:223], v3 offset:19456
    v_mfma_f32_16x16x32_bf16 v[88:91], v[40:43], a[244:247], v[88:91]
    v_mfma_f32_16x16x32_bf16 v[88:91], v[44:47], v[228:231], v[88:91]
    v_mfma_f32_16x16x32_bf16 v[88:91], v[12:15], v[244:247], v[88:91]
    ds_read_b128 v[192:195], v3 offset:21504
    v_mfma_f32_16x16x32_bf16 v[96:99], v[16:19], a[200:203], v[96:99]
    v_mfma_f32_16x16x32_bf16 v[96:99], v[20:23], a[216:219], v[96:99]
    v_mfma_f32_16x16x32_bf16 v[96:99], v[24:27], a[232:235], v[96:99]
    ds_read_b128 v[196:199], v3 offset:23552
    v_mfma_f32_16x16x32_bf16 v[96:99], v[40:43], a[248:251], v[96:99]
    v_mfma_f32_16x16x32_bf16 v[96:99], v[44:47], v[232:235], v[96:99]
    v_mfma_f32_16x16x32_bf16 v[96:99], v[12:15], v[248:251], v[96:99]
    v_mfma_f32_16x16x32_bf16 v[104:107], v[16:19], a[204:207], v[104:107]
    v_mfma_f32_16x16x32_bf16 v[104:107], v[20:23], a[220:223], v[104:107]
    v_mfma_f32_16x16x32_bf16 v[104:107], v[24:27], a[236:239], v[104:107]
    v_mfma_f32_16x16x32_bf16 v[104:107], v[40:43], a[252:255], v[104:107]
    v_mfma_f32_16x16x32_bf16 v[104:107], v[44:47], v[236:239], v[104:107]
    v_mfma_f32_16x16x32_bf16 v[104:107], v[12:15], v[252:255], v[104:107]
    s_waitcnt lgkmcnt(0)
    v_mfma_f32_16x16x32_bf16 v[84:87], v[28:31], a[192:195], v[84:87]
    s_waitcnt vmcnt(16)
    s_barrier
    v_mfma_f32_16x16x32_bf16 v[84:87], v[32:35], a[208:211], v[84:87]
    s_add_u32 m0, s18, 0
    ds_read_b128 v[16:19], v3 offset:24576
    v_mfma_f32_16x16x32_bf16 v[84:87], v[36:39], a[224:227], v[84:87]
    v_mfma_f32_16x16x32_bf16 v[84:87], v[220:223], a[240:243], v[84:87]
    ds_read_b128 v[20:23], v3 offset:26624
    v_mfma_f32_16x16x32_bf16 v[84:87], v[192:195], v[224:227], v[84:87]
    v_mfma_f32_16x16x32_bf16 v[84:87], v[196:199], v[240:243], v[84:87]
    buffer_load_dwordx4 v1, s[4:7], s20 offen offset:0 sc1 lds
    v_mfma_f32_16x16x32_bf16 v[92:95], v[28:31], a[196:199], v[92:95]
    ds_read_b128 v[24:27], v3 offset:28672
    v_mfma_f32_16x16x32_bf16 v[92:95], v[32:35], a[212:215], v[92:95]
    v_mfma_f32_16x16x32_bf16 v[92:95], v[36:39], a[228:231], v[92:95]
    v_mfma_f32_16x16x32_bf16 v[92:95], v[220:223], a[244:247], v[92:95]
    buffer_load_dwordx4 v1, s[4:7], s20 offen offset:1024 sc1 lds
    ds_read_b128 v[40:43], v3 offset:30720
    v_mfma_f32_16x16x32_bf16 v[92:95], v[192:195], v[228:231], v[92:95]
    v_mul_f32 v184, v80, v176
    v_mul_f32 v185, v81, v176
    v_mfma_f32_16x16x32_bf16 v[92:95], v[196:199], v[244:247], v[92:95]
    v_exp_f32 v184, v184
    v_mfma_f32_16x16x32_bf16 v[100:103], v[28:31], a[200:203], v[100:103]
    ds_read_b128 v[44:47], v3 offset:32768
    v_mul_f32 v186, v82, v176
    v_mfma_f32_16x16x32_bf16 v[100:103], v[32:35], a[216:219], v[100:103]
    v_exp_f32 v185, v185
    v_mfma_f32_16x16x32_bf16 v[100:103], v[36:39], a[232:235], v[100:103]
    buffer_load_dwordx4 v1, s[4:7], s20 offen offset:2048 sc1 lds
    v_mul_f32 v187, v83, v176
    v_mfma_f32_16x16x32_bf16 v[100:103], v[220:223], a[248:251], v[100:103]
    ds_read_b128 v[12:15], v3 offset:34816
    v_mul_f32 v80, v80, v84
    v_mfma_f32_16x16x32_bf16 v[100:103], v[192:195], v[232:235], v[100:103]
    v_exp_f32 v186, v186
    v_mfma_f32_16x16x32_bf16 v[100:103], v[196:199], v[248:251], v[100:103]
    v_exp_f32 v187, v187
    v_mfma_f32_16x16x32_bf16 v[108:111], v[28:31], a[204:207], v[108:111]
    s_add_u32 s20, s20, 3072
    v_mul_f32 v81, v81, v85
    v_mul_f32 v82, v82, v86
    v_mfma_f32_16x16x32_bf16 v[108:111], v[32:35], a[220:223], v[108:111]
    v_mul_f32 v83, v83, v87
    v_fma_f32 v184, v184, v180, v180
    v_mfma_f32_16x16x32_bf16 v[108:111], v[36:39], a[236:239], v[108:111]
    v_rcp_f32 v184, v184
    v_mfma_f32_16x16x32_bf16 v[108:111], v[220:223], a[252:255], v[108:111]
    v_fma_f32 v185, v185, v180, v180
    v_fma_f32 v186, v186, v180, v180
    v_mfma_f32_16x16x32_bf16 v[108:111], v[192:195], v[236:239], v[108:111]
    v_rcp_f32 v185, v185
    v_mfma_f32_16x16x32_bf16 v[108:111], v[196:199], v[252:255], v[108:111]
    s_waitcnt lgkmcnt(0)
    s_add_u32 m0, s18, 3072
    v_fma_f32 v187, v187, v180, v180
    v_mfma_f32_16x16x32_bf16 v[112:115], v[16:19], a[0:3], 0
    ds_read_b128 v[28:31], v3 offset:25600
    v_mul_f32 v80, v80, v184
    v_mfma_f32_16x16x32_bf16 v[112:115], v[20:23], a[16:19], v[112:115]
    v_rcp_f32 v186, v186
    v_mfma_f32_16x16x32_bf16 v[112:115], v[24:27], a[32:35], v[112:115]
    ds_read_b128 v[32:35], v3 offset:27648
    v_mul_f32 v81, v81, v185
    v_mfma_f32_16x16x32_bf16 v[112:115], v[40:43], a[48:51], v[112:115]
    buffer_load_dwordx4 v1, s[4:7], s20 offen offset:0 sc1 lds
    v_mul_f32 v82, v82, v186
    v_mfma_f32_16x16x32_bf16 v[112:115], v[44:47], a[64:67], v[112:115]
    v_rcp_f32 v187, v187
    v_mfma_f32_16x16x32_bf16 v[112:115], v[12:15], a[80:83], v[112:115]
    ds_read_b128 v[36:39], v3 offset:29696
    v_mul_f32 v83, v83, v187
    v_mfma_f32_16x16x32_bf16 v[120:123], v[16:19], a[4:7], 0
    v_cvt_pk_bf16_f32 v200, v80, v81
    v_cvt_pk_bf16_f32 v201, v82, v83
    v_mfma_f32_16x16x32_bf16 v[120:123], v[20:23], a[20:23], v[120:123]
    buffer_load_dwordx4 v1, s[4:7], s20 offen offset:1024 sc1 lds
    v_mul_f32 v188, v88, v177
    v_mfma_f32_16x16x32_bf16 v[120:123], v[24:27], a[36:39], v[120:123]
    ds_read_b128 v[220:223], v3 offset:31744
    v_mul_f32 v189, v89, v177
    v_mfma_f32_16x16x32_bf16 v[120:123], v[40:43], a[52:55], v[120:123]
    v_exp_f32 v188, v188
    v_mfma_f32_16x16x32_bf16 v[120:123], v[44:47], a[68:71], v[120:123]
    v_exp_f32 v189, v189
    v_mfma_f32_16x16x32_bf16 v[120:123], v[12:15], a[84:87], v[120:123]
    ds_read_b128 v[192:195], v3 offset:33792
    v_mul_f32 v190, v90, v177
    v_mfma_f32_16x16x32_bf16 v[128:131], v[16:19], a[8:11], 0
    buffer_load_dwordx4 v1, s[4:7], s20 offen offset:2048 sc1 lds
    v_mul_f32 v191, v91, v177
    v_mfma_f32_16x16x32_bf16 v[128:131], v[20:23], a[24:27], v[128:131]
    v_exp_f32 v190, v190
    v_mfma_f32_16x16x32_bf16 v[128:131], v[24:27], a[40:43], v[128:131]
    ds_read_b128 v[196:199], v3 offset:35840
    v_mul_f32 v88, v88, v92
    v_mfma_f32_16x16x32_bf16 v[128:131], v[40:43], a[56:59], v[128:131]
    v_exp_f32 v191, v191
    v_mfma_f32_16x16x32_bf16 v[128:131], v[44:47], a[72:75], v[128:131]
    s_add_u32 s20, s20, 3072
    v_mul_f32 v89, v89, v93
    v_mul_f32 v90, v90, v94
    v_mfma_f32_16x16x32_bf16 v[128:131], v[12:15], a[88:91], v[128:131]
    v_mul_f32 v91, v91, v95
    v_fma_f32 v188, v188, v181, v181
    v_mfma_f32_16x16x32_bf16 v[136:139], v[16:19], a[12:15], 0
    v_rcp_f32 v188, v188
    v_mfma_f32_16x16x32_bf16 v[136:139], v[20:23], a[28:31], v[136:139]
    v_fma_f32 v189, v189, v181, v181
    v_fma_f32 v190, v190, v181, v181
    v_mfma_f32_16x16x32_bf16 v[136:139], v[24:27], a[44:47], v[136:139]
    v_rcp_f32 v189, v189
    v_mfma_f32_16x16x32_bf16 v[136:139], v[40:43], a[60:63], v[136:139]
    s_add_u32 m0, s18, 6144
    v_rcp_f32 v190, v190
    v_mfma_f32_16x16x32_bf16 v[136:139], v[44:47], a[76:79], v[136:139]
    v_fma_f32 v191, v191, v181, v181
    v_mul_f32 v88, v88, v188
    v_mfma_f32_16x16x32_bf16 v[136:139], v[12:15], a[92:95], v[136:139]
    s_waitcnt lgkmcnt(0)
    v_rcp_f32 v191, v191
    v_mfma_f32_16x16x32_bf16 v[116:119], v[28:31], a[0:3], 0
    ds_read_b128 v[16:19], v3 offset:36864
    v_mul_f32 v89, v89, v189
    v_mfma_f32_16x16x32_bf16 v[116:119], v[32:35], a[16:19], v[116:119]
    buffer_load_dwordx4 v1, s[4:7], s20 offen offset:0 sc1 lds
    v_mul_f32 v90, v90, v190
    v_mfma_f32_16x16x32_bf16 v[116:119], v[36:39], a[32:35], v[116:119]
    ds_read_b128 v[20:23], v3 offset:38912
    v_mul_f32 v91, v91, v191
    v_mfma_f32_16x16x32_bf16 v[116:119], v[220:223], a[48:51], v[116:119]
    v_cvt_pk_bf16_f32 v204, v88, v89
    v_cvt_pk_bf16_f32 v205, v90, v91
    v_mfma_f32_16x16x32_bf16 v[116:119], v[192:195], a[64:67], v[116:119]
    v_mul_f32 v184, v96, v178
    v_mul_f32 v185, v97, v178
    v_mfma_f32_16x16x32_bf16 v[116:119], v[196:199], a[80:83], v[116:119]
    buffer_load_dwordx4 v1, s[4:7], s20 offen offset:1024 sc1 lds
    ds_read_b128 v[24:27], v3 offset:40960
    v_mfma_f32_16x16x32_bf16 v[124:127], v[28:31], a[4:7], 0
    s_waitcnt vmcnt(8)
    v_exp_f32 v184, v184
    v_mfma_f32_16x16x32_bf16 v[124:127], v[32:35], a[20:23], v[124:127]
    v_exp_f32 v185, v185
    v_mfma_f32_16x16x32_bf16 v[124:127], v[36:39], a[36:39], v[124:127]
    ds_read_b128 v[40:43], v3 offset:43008
    v_mov_b32 v8, 1
    v_mfma_f32_16x16x32_bf16 v[124:127], v[220:223], a[52:55], v[124:127]
    v_mul_f32 v186, v98, v178
    v_mul_f32 v187, v99, v178
    v_mfma_f32_16x16x32_bf16 v[124:127], v[192:195], a[68:71], v[124:127]
    buffer_store_dword v8, v219, s[88:91], s16 offen sc1
    v_mul_f32 v96, v96, v100
    v_mfma_f32_16x16x32_bf16 v[124:127], v[196:199], a[84:87], v[124:127]
    buffer_load_dwordx4 v1, s[4:7], s20 offen offset:2048 sc1 lds
    ds_read_b128 v[44:47], v3 offset:45056
    v_mfma_f32_16x16x32_bf16 v[132:135], v[28:31], a[8:11], 0
    v_exp_f32 v186, v186
    v_mfma_f32_16x16x32_bf16 v[132:135], v[32:35], a[24:27], v[132:135]
    v_exp_f32 v187, v187
    v_mfma_f32_16x16x32_bf16 v[132:135], v[36:39], a[40:43], v[132:135]
    s_add_u32 s20, s20, 30720
    ds_read_b128 v[12:15], v3 offset:47104
    v_mul_f32 v97, v97, v101
    v_mfma_f32_16x16x32_bf16 v[132:135], v[220:223], a[56:59], v[132:135]
    v_mul_f32 v98, v98, v102
    v_mul_f32 v99, v99, v103
    v_mfma_f32_16x16x32_bf16 v[132:135], v[192:195], a[72:75], v[132:135]
    v_fma_f32 v184, v184, v182, v182
    v_fma_f32 v185, v185, v182, v182
    v_mfma_f32_16x16x32_bf16 v[132:135], v[196:199], a[88:91], v[132:135]
    v_rcp_f32 v184, v184
    v_mfma_f32_16x16x32_bf16 v[140:143], v[28:31], a[12:15], 0
    v_rcp_f32 v185, v185
    v_mfma_f32_16x16x32_bf16 v[140:143], v[32:35], a[28:31], v[140:143]
    s_add_u32 s20, s40, s18
    v_fma_f32 v186, v186, v182, v182
    v_fma_f32 v187, v187, v182, v182
    v_mfma_f32_16x16x32_bf16 v[140:143], v[36:39], a[44:47], v[140:143]
    v_rcp_f32 v186, v186
    v_mfma_f32_16x16x32_bf16 v[140:143], v[220:223], a[60:63], v[140:143]
    v_rcp_f32 v187, v187
    v_mfma_f32_16x16x32_bf16 v[140:143], v[192:195], a[76:79], v[140:143]
    v_mul_f32 v96, v96, v184
    v_mul_f32 v97, v97, v185
    v_mfma_f32_16x16x32_bf16 v[140:143], v[196:199], a[92:95], v[140:143]
    s_waitcnt lgkmcnt(0)
    s_add_u32 m0, s18, 36864
    v_mul_f32 v98, v98, v186
    v_mfma_f32_16x16x32_bf16 v[112:115], v[16:19], a[96:99], v[112:115]
    ds_read_b128 v[28:31], v3 offset:37888
    v_mul_f32 v99, v99, v187
    v_mfma_f32_16x16x32_bf16 v[112:115], v[20:23], a[112:115], v[112:115]
    v_cvt_pk_bf16_f32 v208, v96, v97
    v_cvt_pk_bf16_f32 v209, v98, v99
    v_mfma_f32_16x16x32_bf16 v[112:115], v[24:27], a[128:131], v[112:115]
    ds_read_b128 v[32:35], v3 offset:39936
    v_mul_f32 v188, v104, v179
    v_mfma_f32_16x16x32_bf16 v[112:115], v[40:43], a[144:147], v[112:115]
    buffer_load_dwordx4 v1, s[4:7], s20 offen offset:0 sc1 lds
    v_mul_f32 v189, v105, v179
    v_mfma_f32_16x16x32_bf16 v[112:115], v[44:47], a[160:163], v[112:115]
    v_exp_f32 v188, v188
    v_mfma_f32_16x16x32_bf16 v[112:115], v[12:15], a[176:179], v[112:115]
    ds_read_b128 v[36:39], v3 offset:41984
    v_mul_f32 v190, v106, v179
    v_mfma_f32_16x16x32_bf16 v[120:123], v[16:19], a[100:103], v[120:123]
    v_exp_f32 v189, v189
    v_mfma_f32_16x16x32_bf16 v[120:123], v[20:23], a[116:119], v[120:123]
    buffer_load_dwordx4 v1, s[4:7], s20 offen offset:1024 sc1 lds
    v_mul_f32 v191, v107, v179
    v_mfma_f32_16x16x32_bf16 v[120:123], v[24:27], a[132:135], v[120:123]
    ds_read_b128 v[220:223], v3 offset:44032
    v_mul_f32 v104, v104, v108
    v_mfma_f32_16x16x32_bf16 v[120:123], v[40:43], a[148:151], v[120:123]
    v_exp_f32 v190, v190
    v_mfma_f32_16x16x32_bf16 v[120:123], v[44:47], a[164:167], v[120:123]
    v_exp_f32 v191, v191
    v_mfma_f32_16x16x32_bf16 v[120:123], v[12:15], a[180:183], v[120:123]
    buffer_load_dwordx4 v1, s[4:7], s20 offen offset:2048 sc1 lds
    ds_read_b128 v[192:195], v3 offset:46080
    v_mfma_f32_16x16x32_bf16 v[128:131], v[16:19], a[104:107], v[128:131]
    v_mul_f32 v105, v105, v109
    v_mul_f32 v106, v106, v110
    v_mfma_f32_16x16x32_bf16 v[128:131], v[20:23], a[120:123], v[128:131]
    v_mul_f32 v107, v107, v111
    v_fma_f32 v188, v188, v183, v183
    v_mfma_f32_16x16x32_bf16 v[128:131], v[24:27], a[136:139], v[128:131]
    ds_read_b128 v[196:199], v3 offset:48128
    v_fma_f32 v189, v189, v183, v183
    v_mfma_f32_16x16x32_bf16 v[128:131], v[40:43], a[152:155], v[128:131]
    s_add_u32 s20, s20, 3072
    v_rcp_f32 v188, v188
    v_mfma_f32_16x16x32_bf16 v[128:131], v[44:47], a[168:171], v[128:131]
    v_rcp_f32 v189, v189
    v_mfma_f32_16x16x32_bf16 v[128:131], v[12:15], a[184:187], v[128:131]
    v_fma_f32 v190, v190, v183, v183
    v_fma_f32 v191, v191, v183, v183
    v_mfma_f32_16x16x32_bf16 v[136:139], v[16:19], a[108:111], v[136:139]
    v_rcp_f32 v190, v190
    v_mfma_f32_16x16x32_bf16 v[136:139], v[20:23], a[124:127], v[136:139]
    s_add_u32 m0, s18, 39936
    v_rcp_f32 v191, v191
    v_mfma_f32_16x16x32_bf16 v[136:139], v[24:27], a[140:143], v[136:139]
    v_mul_f32 v104, v104, v188
    v_mul_f32 v105, v105, v189
    v_mfma_f32_16x16x32_bf16 v[136:139], v[40:43], a[156:159], v[136:139]
    v_mul_f32 v106, v106, v190
    v_mul_f32 v107, v107, v191
    v_mfma_f32_16x16x32_bf16 v[136:139], v[44:47], a[172:175], v[136:139]
    v_cvt_pk_bf16_f32 v212, v104, v105
    v_cvt_pk_bf16_f32 v213, v106, v107
    v_mfma_f32_16x16x32_bf16 v[136:139], v[12:15], a[188:191], v[136:139]
    s_waitcnt lgkmcnt(0)
    buffer_load_dwordx4 v1, s[4:7], s20 offen offset:0 sc1 lds
    v_mfma_f32_16x16x32_bf16 v[116:119], v[28:31], a[96:99], v[116:119]
    ds_read_b128 v[16:19], v4 offset:0
    v_mfma_f32_16x16x32_bf16 v[116:119], v[32:35], a[112:115], v[116:119]
    v_mfma_f32_16x16x32_bf16 v[116:119], v[36:39], a[128:131], v[116:119]
    ds_read_b128 v[20:23], v4 offset:2048
    v_mfma_f32_16x16x32_bf16 v[116:119], v[220:223], a[144:147], v[116:119]
    v_mfma_f32_16x16x32_bf16 v[116:119], v[192:195], a[160:163], v[116:119]
    buffer_load_dwordx4 v1, s[4:7], s20 offen offset:1024 sc1 lds
    v_mfma_f32_16x16x32_bf16 v[116:119], v[196:199], a[176:179], v[116:119]
    ds_read_b128 v[24:27], v4 offset:4096
    v_mfma_f32_16x16x32_bf16 v[124:127], v[28:31], a[100:103], v[124:127]
    v_mfma_f32_16x16x32_bf16 v[124:127], v[32:35], a[116:119], v[124:127]
    v_mfma_f32_16x16x32_bf16 v[124:127], v[36:39], a[132:135], v[124:127]
    buffer_load_dwordx4 v1, s[4:7], s20 offen offset:2048 sc1 lds
    ds_read_b128 v[40:43], v4 offset:6144
    v_mfma_f32_16x16x32_bf16 v[124:127], v[220:223], a[148:151], v[124:127]
    v_mfma_f32_16x16x32_bf16 v[124:127], v[192:195], a[164:167], v[124:127]
    v_mfma_f32_16x16x32_bf16 v[124:127], v[196:199], a[180:183], v[124:127]
    ds_read_b128 v[44:47], v4 offset:8192
    v_mfma_f32_16x16x32_bf16 v[132:135], v[28:31], a[104:107], v[132:135]
    s_add_u32 s20, s20, 3072
    v_mfma_f32_16x16x32_bf16 v[132:135], v[32:35], a[120:123], v[132:135]
    v_mfma_f32_16x16x32_bf16 v[132:135], v[36:39], a[136:139], v[132:135]
    ds_read_b128 v[12:15], v4 offset:10240
    v_mfma_f32_16x16x32_bf16 v[132:135], v[220:223], a[152:155], v[132:135]
    v_mfma_f32_16x16x32_bf16 v[132:135], v[192:195], a[168:171], v[132:135]
    s_add_u32 m0, s18, 43008
    v_mfma_f32_16x16x32_bf16 v[132:135], v[196:199], a[184:187], v[132:135]
    v_mfma_f32_16x16x32_bf16 v[140:143], v[28:31], a[108:111], v[140:143]
    v_mfma_f32_16x16x32_bf16 v[140:143], v[32:35], a[124:127], v[140:143]
    v_mfma_f32_16x16x32_bf16 v[140:143], v[36:39], a[140:143], v[140:143]
    buffer_load_dwordx4 v1, s[4:7], s20 offen offset:0 sc1 lds
    v_mfma_f32_16x16x32_bf16 v[140:143], v[220:223], a[156:159], v[140:143]
    v_mfma_f32_16x16x32_bf16 v[140:143], v[192:195], a[172:175], v[140:143]
    v_mfma_f32_16x16x32_bf16 v[140:143], v[196:199], a[188:191], v[140:143]
    s_waitcnt lgkmcnt(0)
    v_mfma_f32_16x16x32_bf16 v[112:115], v[16:19], a[192:195], v[112:115]
    buffer_load_dwordx4 v1, s[4:7], s20 offen offset:1024 sc1 lds
    ds_read_b128 v[28:31], v4 offset:1024
    v_mfma_f32_16x16x32_bf16 v[112:115], v[20:23], a[208:211], v[112:115]
    v_mfma_f32_16x16x32_bf16 v[112:115], v[24:27], a[224:227], v[112:115]
    ds_read_b128 v[32:35], v4 offset:3072
    v_mfma_f32_16x16x32_bf16 v[112:115], v[40:43], a[240:243], v[112:115]
    v_mfma_f32_16x16x32_bf16 v[112:115], v[44:47], v[224:227], v[112:115]
    buffer_load_dwordx4 v1, s[4:7], s20 offen offset:2048 sc1 lds
    v_mfma_f32_16x16x32_bf16 v[112:115], v[12:15], v[240:243], v[112:115]
    ds_read_b128 v[36:39], v4 offset:5120
    v_mfma_f32_16x16x32_bf16 v[120:123], v[16:19], a[196:199], v[120:123]
    v_mfma_f32_16x16x32_bf16 v[120:123], v[20:23], a[212:215], v[120:123]
    v_mfma_f32_16x16x32_bf16 v[120:123], v[24:27], a[228:231], v[120:123]
    s_add_u32 s20, s20, 30720
    ds_read_b128 v[220:223], v4 offset:7168
    v_mfma_f32_16x16x32_bf16 v[120:123], v[40:43], a[244:247], v[120:123]
    v_mfma_f32_16x16x32_bf16 v[120:123], v[44:47], v[228:231], v[120:123]
    v_mfma_f32_16x16x32_bf16 v[120:123], v[12:15], v[244:247], v[120:123]
    ds_read_b128 v[192:195], v4 offset:9216
    v_mfma_f32_16x16x32_bf16 v[128:131], v[16:19], a[200:203], v[128:131]
    v_mfma_f32_16x16x32_bf16 v[128:131], v[20:23], a[216:219], v[128:131]
    v_mfma_f32_16x16x32_bf16 v[128:131], v[24:27], a[232:235], v[128:131]
    ds_read_b128 v[196:199], v4 offset:11264
    v_mfma_f32_16x16x32_bf16 v[128:131], v[40:43], a[248:251], v[128:131]
    v_mfma_f32_16x16x32_bf16 v[128:131], v[44:47], v[232:235], v[128:131]
    v_mfma_f32_16x16x32_bf16 v[128:131], v[12:15], v[248:251], v[128:131]
    v_mfma_f32_16x16x32_bf16 v[136:139], v[16:19], a[204:207], v[136:139]
    buffer_load_dword v9, v7, s[88:91], s17 offen sc1
    v_mfma_f32_16x16x32_bf16 v[136:139], v[20:23], a[220:223], v[136:139]
    v_mfma_f32_16x16x32_bf16 v[136:139], v[24:27], a[236:239], v[136:139]
    v_mfma_f32_16x16x32_bf16 v[136:139], v[40:43], a[252:255], v[136:139]
    v_mfma_f32_16x16x32_bf16 v[136:139], v[44:47], v[236:239], v[136:139]
    v_mfma_f32_16x16x32_bf16 v[136:139], v[12:15], v[252:255], v[136:139]
    s_waitcnt lgkmcnt(0)
    v_mfma_f32_16x16x32_bf16 v[116:119], v[28:31], a[192:195], v[116:119]
    s_barrier
    v_mfma_f32_16x16x32_bf16 v[116:119], v[32:35], a[208:211], v[116:119]
    s_add_u32 m0, s18, 73728
    ds_read_b128 v[16:19], v4 offset:12288
    v_mfma_f32_16x16x32_bf16 v[116:119], v[36:39], a[224:227], v[116:119]
    v_mfma_f32_16x16x32_bf16 v[116:119], v[220:223], a[240:243], v[116:119]
    ds_read_b128 v[20:23], v4 offset:14336
    v_mfma_f32_16x16x32_bf16 v[116:119], v[192:195], v[224:227], v[116:119]
    v_mfma_f32_16x16x32_bf16 v[116:119], v[196:199], v[240:243], v[116:119]
    buffer_load_dwordx4 v1, s[4:7], s20 offen offset:0 sc1 lds
    v_mfma_f32_16x16x32_bf16 v[124:127], v[28:31], a[196:199], v[124:127]
    ds_read_b128 v[24:27], v4 offset:16384
    v_mfma_f32_16x16x32_bf16 v[124:127], v[32:35], a[212:215], v[124:127]
    v_mfma_f32_16x16x32_bf16 v[124:127], v[36:39], a[228:231], v[124:127]
    v_mfma_f32_16x16x32_bf16 v[124:127], v[220:223], a[244:247], v[124:127]
    buffer_load_dwordx4 v1, s[4:7], s20 offen offset:1024 sc1 lds
    ds_read_b128 v[40:43], v4 offset:18432
    v_mfma_f32_16x16x32_bf16 v[124:127], v[192:195], v[228:231], v[124:127]
    v_mul_f32 v184, v112, v176
    v_mul_f32 v185, v113, v176
    v_mfma_f32_16x16x32_bf16 v[124:127], v[196:199], v[244:247], v[124:127]
    v_exp_f32 v184, v184
    v_mfma_f32_16x16x32_bf16 v[132:135], v[28:31], a[200:203], v[132:135]
    ds_read_b128 v[44:47], v4 offset:20480
    v_mul_f32 v186, v114, v176
    v_mfma_f32_16x16x32_bf16 v[132:135], v[32:35], a[216:219], v[132:135]
    v_exp_f32 v185, v185
    v_mfma_f32_16x16x32_bf16 v[132:135], v[36:39], a[232:235], v[132:135]
    buffer_load_dwordx4 v1, s[4:7], s20 offen offset:2048 sc1 lds
    v_mul_f32 v187, v115, v176
    v_mfma_f32_16x16x32_bf16 v[132:135], v[220:223], a[248:251], v[132:135]
    ds_read_b128 v[12:15], v4 offset:22528
    v_mul_f32 v112, v112, v116
    v_mfma_f32_16x16x32_bf16 v[132:135], v[192:195], v[232:235], v[132:135]
    v_exp_f32 v186, v186
    v_mfma_f32_16x16x32_bf16 v[132:135], v[196:199], v[248:251], v[132:135]
    v_exp_f32 v187, v187
    v_mfma_f32_16x16x32_bf16 v[140:143], v[28:31], a[204:207], v[140:143]
    s_add_u32 s20, s20, 3072
    v_mul_f32 v113, v113, v117
    v_mul_f32 v114, v114, v118
    v_mfma_f32_16x16x32_bf16 v[140:143], v[32:35], a[220:223], v[140:143]
    v_mul_f32 v115, v115, v119
    v_fma_f32 v184, v184, v180, v180
    v_mfma_f32_16x16x32_bf16 v[140:143], v[36:39], a[236:239], v[140:143]
    v_rcp_f32 v184, v184
    v_mfma_f32_16x16x32_bf16 v[140:143], v[220:223], a[252:255], v[140:143]
    v_fma_f32 v185, v185, v180, v180
    v_fma_f32 v186, v186, v180, v180
    v_mfma_f32_16x16x32_bf16 v[140:143], v[192:195], v[236:239], v[140:143]
    v_rcp_f32 v185, v185
    v_mfma_f32_16x16x32_bf16 v[140:143], v[196:199], v[252:255], v[140:143]
    s_waitcnt lgkmcnt(0)
    s_add_u32 m0, s18, 76800
    v_fma_f32 v187, v187, v180, v180
    v_mfma_f32_16x16x32_bf16 v[144:147], v[16:19], a[0:3], 0
    ds_read_b128 v[28:31], v4 offset:13312
    v_mul_f32 v112, v112, v184
    v_mfma_f32_16x16x32_bf16 v[144:147], v[20:23], a[16:19], v[144:147]
    v_rcp_f32 v186, v186
    v_mfma_f32_16x16x32_bf16 v[144:147], v[24:27], a[32:35], v[144:147]
    ds_read_b128 v[32:35], v4 offset:15360
    v_mul_f32 v113, v113, v185
    v_mfma_f32_16x16x32_bf16 v[144:147], v[40:43], a[48:51], v[144:147]
    buffer_load_dwordx4 v1, s[4:7], s20 offen offset:0 sc1 lds
    v_mul_f32 v114, v114, v186
    v_mfma_f32_16x16x32_bf16 v[144:147], v[44:47], a[64:67], v[144:147]
    v_rcp_f32 v187, v187
    v_mfma_f32_16x16x32_bf16 v[144:147], v[12:15], a[80:83], v[144:147]
    ds_read_b128 v[36:39], v4 offset:17408
    v_mul_f32 v115, v115, v187
    v_mfma_f32_16x16x32_bf16 v[152:155], v[16:19], a[4:7], 0
    v_cvt_pk_bf16_f32 v202, v112, v113
    v_cvt_pk_bf16_f32 v203, v114, v115
    v_mfma_f32_16x16x32_bf16 v[152:155], v[20:23], a[20:23], v[152:155]
    buffer_load_dwordx4 v1, s[4:7], s20 offen offset:1024 sc1 lds
    v_mul_f32 v188, v120, v177
    v_mfma_f32_16x16x32_bf16 v[152:155], v[24:27], a[36:39], v[152:155]
    ds_read_b128 v[220:223], v4 offset:19456
    v_mul_f32 v189, v121, v177
    v_mfma_f32_16x16x32_bf16 v[152:155], v[40:43], a[52:55], v[152:155]
    buffer_store_dwordx4 v[200:203], v1, s[48:51], s28 offen sc1
    v_mfma_f32_16x16x32_bf16 v[152:155], v[44:47], a[68:71], v[152:155]
    s_add_u32 s28, s28, 16384
    v_exp_f32 v188, v188
    v_mfma_f32_16x16x32_bf16 v[152:155], v[12:15], a[84:87], v[152:155]
    ds_read_b128 v[192:195], v4 offset:21504
    v_mul_f32 v190, v122, v177
    v_mfma_f32_16x16x32_bf16 v[160:163], v[16:19], a[8:11], 0
    buffer_load_dwordx4 v1, s[4:7], s20 offen offset:2048 sc1 lds
    v_mul_f32 v191, v123, v177
    v_mfma_f32_16x16x32_bf16 v[160:163], v[20:23], a[24:27], v[160:163]
    v_exp_f32 v189, v189
    v_mfma_f32_16x16x32_bf16 v[160:163], v[24:27], a[40:43], v[160:163]
    ds_read_b128 v[196:199], v4 offset:23552
    v_mul_f32 v120, v120, v124
    v_mfma_f32_16x16x32_bf16 v[160:163], v[40:43], a[56:59], v[160:163]
    s_waitcnt vmcnt(7)
    v_cmp_gt_u32 vcc, 1, v9
    v_mul_f32 v121, v121, v125
    v_mfma_f32_16x16x32_bf16 v[160:163], v[44:47], a[72:75], v[160:163]
    s_add_u32 s20, s20, 3072
    v_exp_f32 v190, v190
    v_mfma_f32_16x16x32_bf16 v[160:163], v[12:15], a[88:91], v[160:163]
    s_cbranch_vccnz spin11
back11:
    v_exp_f32 v191, v191
    v_mfma_f32_16x16x32_bf16 v[168:171], v[16:19], a[12:15], 0
    v_mul_f32 v122, v122, v126
    v_mul_f32 v123, v123, v127
    v_mfma_f32_16x16x32_bf16 v[168:171], v[20:23], a[28:31], v[168:171]
    v_fma_f32 v188, v188, v181, v181
    v_fma_f32 v189, v189, v181, v181
    v_mfma_f32_16x16x32_bf16 v[168:171], v[24:27], a[44:47], v[168:171]
    buffer_load_dwordx4 v[80:83], v1, s[48:51], s38 offen offset:0 sc1
    v_fma_f32 v190, v190, v181, v181
    v_mfma_f32_16x16x32_bf16 v[168:171], v[40:43], a[60:63], v[168:171]
    s_add_u32 m0, s18, 79872
    v_rcp_f32 v188, v188
    v_mfma_f32_16x16x32_bf16 v[168:171], v[44:47], a[76:79], v[168:171]
    v_rcp_f32 v189, v189
    v_mfma_f32_16x16x32_bf16 v[168:171], v[12:15], a[92:95], v[168:171]
    s_waitcnt lgkmcnt(0)
    v_rcp_f32 v190, v190
    v_mfma_f32_16x16x32_bf16 v[148:151], v[28:31], a[0:3], 0
    ds_read_b128 v[16:19], v4 offset:24576
    v_fma_f32 v191, v191, v181, v181
    v_mfma_f32_16x16x32_bf16 v[148:151], v[32:35], a[16:19], v[148:151]
    buffer_load_dwordx4 v1, s[4:7], s20 offen offset:0 sc1 lds
    v_mul_f32 v120, v120, v188
    v_mfma_f32_16x16x32_bf16 v[148:151], v[36:39], a[32:35], v[148:151]
    ds_read_b128 v[20:23], v4 offset:26624
    v_mul_f32 v121, v121, v189
    v_mfma_f32_16x16x32_bf16 v[148:151], v[220:223], a[48:51], v[148:151]
    v_rcp_f32 v191, v191
    v_mfma_f32_16x16x32_bf16 v[148:151], v[192:195], a[64:67], v[148:151]
    v_mul_f32 v122, v122, v190
    v_mul_f32 v123, v123, v191
    v_mfma_f32_16x16x32_bf16 v[148:151], v[196:199], a[80:83], v[148:151]
    buffer_load_dwordx4 v1, s[4:7], s20 offen offset:1024 sc1 lds
    ds_read_b128 v[24:27], v4 offset:28672
    v_mfma_f32_16x16x32_bf16 v[156:159], v[28:31], a[4:7], 0
    buffer_load_dwordx4 v[84:87], v1, s[48:51], s38 offen offset:1024 sc1
    v_cvt_pk_bf16_f32 v206, v120, v121
    v_mfma_f32_16x16x32_bf16 v[156:159], v[32:35], a[20:23], v[156:159]
    v_cvt_pk_bf16_f32 v207, v122, v123
    v_mul_f32 v184, v128, v178
    v_mfma_f32_16x16x32_bf16 v[156:159], v[36:39], a[36:39], v[156:159]
    ds_read_b128 v[40:43], v4 offset:30720
    v_mul_f32 v185, v129, v178
    v_mfma_f32_16x16x32_bf16 v[156:159], v[220:223], a[52:55], v[156:159]
    buffer_store_dwordx4 v[204:207], v1, s[48:51], s29 offen sc1
    v_mfma_f32_16x16x32_bf16 v[156:159], v[192:195], a[68:71], v[156:159]
    s_add_u32 s29, s29, 16384
    buffer_load_dwordx4 v1, s[4:7], s20 offen offset:2048 sc1 lds
    v_mul_f32 v186, v130, v178
    v_mfma_f32_16x16x32_bf16 v[156:159], v[196:199], a[84:87], v[156:159]
    ds_read_b128 v[44:47], v4 offset:32768
    v_mul_f32 v187, v131, v178
    v_mfma_f32_16x16x32_bf16 v[164:167], v[28:31], a[8:11], 0
    v_exp_f32 v184, v184
    v_mfma_f32_16x16x32_bf16 v[164:167], v[32:35], a[24:27], v[164:167]
    v_exp_f32 v185, v185
    v_mfma_f32_16x16x32_bf16 v[164:167], v[36:39], a[40:43], v[164:167]
    s_add_u32 s20, s20, 30720
    ds_read_b128 v[12:15], v4 offset:34816
    v_mul_f32 v128, v128, v132
    v_mfma_f32_16x16x32_bf16 v[164:167], v[220:223], a[56:59], v[164:167]
    v_exp_f32 v186, v186
    v_mfma_f32_16x16x32_bf16 v[164:167], v[192:195], a[72:75], v[164:167]
    buffer_load_dwordx4 v[88:91], v1, s[48:51], s38 offen offset:2048 sc1
    v_mul_f32 v129, v129, v133
    v_mfma_f32_16x16x32_bf16 v[164:167], v[196:199], a[88:91], v[164:167]
    v_exp_f32 v187, v187
    v_mfma_f32_16x16x32_bf16 v[172:175], v[28:31], a[12:15], 0
    v_mul_f32 v130, v130, v134
    v_mul_f32 v131, v131, v135
    v_mfma_f32_16x16x32_bf16 v[172:175], v[32:35], a[28:31], v[172:175]
    v_fma_f32 v184, v184, v182, v182
    v_fma_f32 v185, v185, v182, v182
    v_mfma_f32_16x16x32_bf16 v[172:175], v[36:39], a[44:47], v[172:175]
    v_rcp_f32 v184, v184
    v_mfma_f32_16x16x32_bf16 v[172:175], v[220:223], a[60:63], v[172:175]
    v_rcp_f32 v185, v185
    v_mfma_f32_16x16x32_bf16 v[172:175], v[192:195], a[76:79], v[172:175]
    v_fma_f32 v186, v186, v182, v182
    v_fma_f32 v187, v187, v182, v182
    v_mfma_f32_16x16x32_bf16 v[172:175], v[196:199], a[92:95], v[172:175]
    s_waitcnt lgkmcnt(0)
    v_rcp_f32 v186, v186
    v_mfma_f32_16x16x32_bf16 v[144:147], v[16:19], a[96:99], v[144:147]
    ds_read_b128 v[28:31], v4 offset:25600
    v_mul_f32 v128, v128, v184
    v_mfma_f32_16x16x32_bf16 v[144:147], v[20:23], a[112:115], v[144:147]
    v_rcp_f32 v187, v187
    v_mfma_f32_16x16x32_bf16 v[144:147], v[24:27], a[128:131], v[144:147]
    buffer_load_dwordx4 v[92:95], v1, s[48:51], s38 offen offset:3072 sc1
    ds_read_b128 v[32:35], v4 offset:27648
    v_mfma_f32_16x16x32_bf16 v[144:147], v[40:43], a[144:147], v[144:147]
    v_mul_f32 v129, v129, v185
    v_mul_f32 v130, v130, v186
    v_mfma_f32_16x16x32_bf16 v[144:147], v[44:47], a[160:163], v[144:147]
    v_mul_f32 v131, v131, v187
    v_cvt_pk_bf16_f32 v210, v128, v129
    v_mfma_f32_16x16x32_bf16 v[144:147], v[12:15], a[176:179], v[144:147]
    ds_read_b128 v[36:39], v4 offset:29696
    v_cvt_pk_bf16_f32 v211, v130, v131
    v_mfma_f32_16x16x32_bf16 v[152:155], v[16:19], a[100:103], v[152:155]
    buffer_store_dwordx4 v[208:211], v1, s[48:51], s30 offen sc1
    v_mfma_f32_16x16x32_bf16 v[152:155], v[20:23], a[116:119], v[152:155]
    s_add_u32 s30, s30, 16384
    v_mul_f32 v188, v136, v179
    v_mul_f32 v189, v137, v179
    v_mfma_f32_16x16x32_bf16 v[152:155], v[24:27], a[132:135], v[152:155]
    ds_read_b128 v[220:223], v4 offset:31744
    v_mul_f32 v190, v138, v179
    v_mfma_f32_16x16x32_bf16 v[152:155], v[40:43], a[148:151], v[152:155]
    v_exp_f32 v188, v188
    v_mfma_f32_16x16x32_bf16 v[152:155], v[44:47], a[164:167], v[152:155]
    v_exp_f32 v189, v189
    v_mfma_f32_16x16x32_bf16 v[152:155], v[12:15], a[180:183], v[152:155]
    ds_read_b128 v[192:195], v4 offset:33792
    v_mul_f32 v191, v139, v179
    v_mfma_f32_16x16x32_bf16 v[160:163], v[16:19], a[104:107], v[160:163]
    buffer_load_dwordx4 v[96:99], v1, s[48:51], s39 offen offset:0 sc1
    v_mul_f32 v136, v136, v140
    v_mfma_f32_16x16x32_bf16 v[160:163], v[20:23], a[120:123], v[160:163]
    v_exp_f32 v190, v190
    v_mfma_f32_16x16x32_bf16 v[160:163], v[24:27], a[136:139], v[160:163]
    ds_read_b128 v[196:199], v4 offset:35840
    v_mul_f32 v137, v137, v141
    v_mfma_f32_16x16x32_bf16 v[160:163], v[40:43], a[152:155], v[160:163]
    v_exp_f32 v191, v191
    v_mfma_f32_16x16x32_bf16 v[160:163], v[44:47], a[168:171], v[160:163]
    v_mul_f32 v138, v138, v142
    v_mul_f32 v139, v139, v143
    v_mfma_f32_16x16x32_bf16 v[160:163], v[12:15], a[184:187], v[160:163]
    v_fma_f32 v188, v188, v183, v183
    v_fma_f32 v189, v189, v183, v183
    v_mfma_f32_16x16x32_bf16 v[168:171], v[16:19], a[108:111], v[168:171]
    v_rcp_f32 v188, v188
    v_mfma_f32_16x16x32_bf16 v[168:171], v[20:23], a[124:127], v[168:171]
    v_rcp_f32 v189, v189
    v_mfma_f32_16x16x32_bf16 v[168:171], v[24:27], a[140:143], v[168:171]
    v_fma_f32 v190, v190, v183, v183
    v_fma_f32 v191, v191, v183, v183
    v_mfma_f32_16x16x32_bf16 v[168:171], v[40:43], a[156:159], v[168:171]
    v_rcp_f32 v190, v190
    v_mfma_f32_16x16x32_bf16 v[168:171], v[44:47], a[172:175], v[168:171]
    buffer_load_dwordx4 v[100:103], v1, s[48:51], s39 offen offset:1024 sc1
    v_mul_f32 v136, v136, v188
    v_mfma_f32_16x16x32_bf16 v[168:171], v[12:15], a[188:191], v[168:171]
    s_waitcnt lgkmcnt(0)
    v_rcp_f32 v191, v191
    v_mfma_f32_16x16x32_bf16 v[148:151], v[28:31], a[96:99], v[148:151]
    ds_read_b128 v[16:19], v4 offset:36864
    v_mul_f32 v137, v137, v189
    v_mfma_f32_16x16x32_bf16 v[148:151], v[32:35], a[112:115], v[148:151]
    v_mul_f32 v138, v138, v190
    v_mul_f32 v139, v139, v191
    v_mfma_f32_16x16x32_bf16 v[148:151], v[36:39], a[128:131], v[148:151]
    ds_read_b128 v[20:23], v4 offset:38912
    v_cvt_pk_bf16_f32 v214, v136, v137
    v_mfma_f32_16x16x32_bf16 v[148:151], v[220:223], a[144:147], v[148:151]
    v_cvt_pk_bf16_f32 v215, v138, v139
    v_mfma_f32_16x16x32_bf16 v[148:151], v[192:195], a[160:163], v[148:151]
    buffer_store_dwordx4 v[212:215], v1, s[48:51], s31 offen sc1
    v_mfma_f32_16x16x32_bf16 v[148:151], v[196:199], a[176:179], v[148:151]
    s_add_u32 s31, s31, 16384
    ds_read_b128 v[24:27], v4 offset:40960
    v_mfma_f32_16x16x32_bf16 v[156:159], v[28:31], a[100:103], v[156:159]
    v_mfma_f32_16x16x32_bf16 v[156:159], v[32:35], a[116:119], v[156:159]
    v_mfma_f32_16x16x32_bf16 v[156:159], v[36:39], a[132:135], v[156:159]
    buffer_load_dwordx4 v[104:107], v1, s[48:51], s39 offen offset:2048 sc1
    ds_read_b128 v[40:43], v4 offset:43008
    v_mfma_f32_16x16x32_bf16 v[156:159], v[220:223], a[148:151], v[156:159]
    v_mfma_f32_16x16x32_bf16 v[156:159], v[192:195], a[164:167], v[156:159]
    v_mfma_f32_16x16x32_bf16 v[156:159], v[196:199], a[180:183], v[156:159]
    ds_read_b128 v[44:47], v4 offset:45056
    v_mfma_f32_16x16x32_bf16 v[164:167], v[28:31], a[104:107], v[164:167]
    v_mfma_f32_16x16x32_bf16 v[164:167], v[32:35], a[120:123], v[164:167]
    v_mfma_f32_16x16x32_bf16 v[164:167], v[36:39], a[136:139], v[164:167]
    ds_read_b128 v[12:15], v4 offset:47104
    v_mfma_f32_16x16x32_bf16 v[164:167], v[220:223], a[152:155], v[164:167]
    v_mfma_f32_16x16x32_bf16 v[164:167], v[192:195], a[168:171], v[164:167]
    v_mfma_f32_16x16x32_bf16 v[164:167], v[196:199], a[184:187], v[164:167]
    v_mfma_f32_16x16x32_bf16 v[172:175], v[28:31], a[108:111], v[172:175]
    buffer_load_dwordx4 v[108:111], v1, s[48:51], s39 offen offset:3072 sc1
    v_mfma_f32_16x16x32_bf16 v[172:175], v[32:35], a[124:127], v[172:175]
    v_mfma_f32_16x16x32_bf16 v[172:175], v[36:39], a[140:143], v[172:175]
    v_mfma_f32_16x16x32_bf16 v[172:175], v[220:223], a[156:159], v[172:175]
    v_mfma_f32_16x16x32_bf16 v[172:175], v[192:195], a[172:175], v[172:175]
    v_mfma_f32_16x16x32_bf16 v[172:175], v[196:199], a[188:191], v[172:175]
    s_waitcnt lgkmcnt(0)
    v_mfma_f32_16x16x32_bf16 v[144:147], v[16:19], a[192:195], v[144:147]
    ds_read_b128 v[28:31], v4 offset:37888
    v_mfma_f32_16x16x32_bf16 v[144:147], v[20:23], a[208:211], v[144:147]
    v_mfma_f32_16x16x32_bf16 v[144:147], v[24:27], a[224:227], v[144:147]
    ds_read_b128 v[32:35], v4 offset:39936
    v_mfma_f32_16x16x32_bf16 v[144:147], v[40:43], a[240:243], v[144:147]
    v_mfma_f32_16x16x32_bf16 v[144:147], v[44:47], v[224:227], v[144:147]
    v_mfma_f32_16x16x32_bf16 v[144:147], v[12:15], v[240:243], v[144:147]
    ds_read_b128 v[36:39], v4 offset:41984
    v_mfma_f32_16x16x32_bf16 v[152:155], v[16:19], a[196:199], v[152:155]
    v_mfma_f32_16x16x32_bf16 v[152:155], v[20:23], a[212:215], v[152:155]
    v_mfma_f32_16x16x32_bf16 v[152:155], v[24:27], a[228:231], v[152:155]
    ds_read_b128 v[220:223], v4 offset:44032
    v_mfma_f32_16x16x32_bf16 v[152:155], v[40:43], a[244:247], v[152:155]
    v_mfma_f32_16x16x32_bf16 v[152:155], v[44:47], v[228:231], v[152:155]
    v_mfma_f32_16x16x32_bf16 v[152:155], v[12:15], v[244:247], v[152:155]
    ds_read_b128 v[192:195], v4 offset:46080
    v_mfma_f32_16x16x32_bf16 v[160:163], v[16:19], a[200:203], v[160:163]
    s_add_u32 s38, s38, 4096
    v_mfma_f32_16x16x32_bf16 v[160:163], v[20:23], a[216:219], v[160:163]
    v_mfma_f32_16x16x32_bf16 v[160:163], v[24:27], a[232:235], v[160:163]
    ds_read_b128 v[196:199], v4 offset:48128
    v_mfma_f32_16x16x32_bf16 v[160:163], v[40:43], a[248:251], v[160:163]
    v_mfma_f32_16x16x32_bf16 v[160:163], v[44:47], v[232:235], v[160:163]
    v_mfma_f32_16x16x32_bf16 v[160:163], v[12:15], v[248:251], v[160:163]
    v_mfma_f32_16x16x32_bf16 v[168:171], v[16:19], a[204:207], v[168:171]
    v_mfma_f32_16x16x32_bf16 v[168:171], v[20:23], a[220:223], v[168:171]
    v_mfma_f32_16x16x32_bf16 v[168:171], v[24:27], a[236:239], v[168:171]
    buffer_load_dwordx4 v[112:115], v1, s[48:51], s38 offen offset:0 sc1
    v_mfma_f32_16x16x32_bf16 v[168:171], v[40:43], a[252:255], v[168:171]
    v_mfma_f32_16x16x32_bf16 v[168:171], v[44:47], v[236:239], v[168:171]
    v_mfma_f32_16x16x32_bf16 v[168:171], v[12:15], v[252:255], v[168:171]
    s_waitcnt lgkmcnt(0)
    v_mfma_f32_16x16x32_bf16 v[148:151], v[28:31], a[192:195], v[148:151]
    s_barrier
    v_mfma_f32_16x16x32_bf16 v[148:151], v[32:35], a[208:211], v[148:151]
    s_add_u32 m0, s18, 110592
    ds_read_b128 v[16:19], v1 offset:0
    v_mfma_f32_16x16x32_bf16 v[148:151], v[36:39], a[224:227], v[148:151]
    v_mfma_f32_16x16x32_bf16 v[148:151], v[220:223], a[240:243], v[148:151]
    ds_read_b128 v[20:23], v1 offset:2048
    v_mfma_f32_16x16x32_bf16 v[148:151], v[192:195], v[224:227], v[148:151]
    buffer_load_dwordx4 v[116:119], v1, s[48:51], s38 offen offset:1024 sc1
    v_mfma_f32_16x16x32_bf16 v[148:151], v[196:199], v[240:243], v[148:151]
    buffer_load_dwordx4 v1, s[4:7], s20 offen offset:0 sc1 lds
    v_mfma_f32_16x16x32_bf16 v[156:159], v[28:31], a[196:199], v[156:159]
    ds_read_b128 v[24:27], v1 offset:4096
    v_mfma_f32_16x16x32_bf16 v[156:159], v[32:35], a[212:215], v[156:159]
    v_mfma_f32_16x16x32_bf16 v[156:159], v[36:39], a[228:231], v[156:159]
    v_mfma_f32_16x16x32_bf16 v[156:159], v[220:223], a[244:247], v[156:159]
    buffer_load_dwordx4 v1, s[4:7], s20 offen offset:1024 sc1 lds
    ds_read_b128 v[40:43], v1 offset:6144
    v_mfma_f32_16x16x32_bf16 v[156:159], v[192:195], v[228:231], v[156:159]
    v_mul_f32 v184, v144, v176
    v_mul_f32 v185, v145, v176
    v_mfma_f32_16x16x32_bf16 v[156:159], v[196:199], v[244:247], v[156:159]
    v_exp_f32 v184, v184
    v_mfma_f32_16x16x32_bf16 v[164:167], v[28:31], a[200:203], v[164:167]
    buffer_load_dwordx4 v[120:123], v1, s[48:51], s38 offen offset:2048 sc1
    ds_read_b128 v[44:47], v1 offset:8192
    v_mfma_f32_16x16x32_bf16 v[164:167], v[32:35], a[216:219], v[164:167]
    v_exp_f32 v185, v185
    v_mfma_f32_16x16x32_bf16 v[164:167], v[36:39], a[232:235], v[164:167]
    buffer_load_dwordx4 v1, s[4:7], s20 offen offset:2048 sc1 lds
    v_mul_f32 v186, v146, v176
    v_mfma_f32_16x16x32_bf16 v[164:167], v[220:223], a[248:251], v[164:167]
    ds_read_b128 v[12:15], v1 offset:10240
    v_mul_f32 v187, v147, v176
    v_mfma_f32_16x16x32_bf16 v[164:167], v[192:195], v[232:235], v[164:167]
    v_exp_f32 v186, v186
    v_mfma_f32_16x16x32_bf16 v[164:167], v[196:199], v[248:251], v[164:167]
    v_exp_f32 v187, v187
    v_mfma_f32_16x16x32_bf16 v[172:175], v[28:31], a[204:207], v[172:175]
    s_add_u32 s20, s20, 3072
    v_mul_f32 v144, v144, v148
    v_mul_f32 v145, v145, v149
    v_mfma_f32_16x16x32_bf16 v[172:175], v[32:35], a[220:223], v[172:175]
    v_mul_f32 v146, v146, v150
    v_mul_f32 v147, v147, v151
    v_mfma_f32_16x16x32_bf16 v[172:175], v[36:39], a[236:239], v[172:175]
    s_waitcnt vmcnt(8)
    buffer_load_dwordx4 v[124:127], v1, s[48:51], s38 offen offset:3072 sc1
    v_fma_f32 v184, v184, v180, v180
    v_mfma_f32_16x16x32_bf16 v[172:175], v[220:223], a[252:255], v[172:175]
    v_rcp_f32 v184, v184
    v_mfma_f32_16x16x32_bf16 v[172:175], v[192:195], v[236:239], v[172:175]
    v_mov_b32 v8, 2
    v_fma_f32 v185, v185, v180, v180
    v_mfma_f32_16x16x32_bf16 v[172:175], v[196:199], v[252:255], v[172:175]
    s_waitcnt lgkmcnt(0)
    s_add_u32 m0, s18, 113664
    v_fma_f32 v186, v186, v180, v180
    v_mfma_f32_16x16x32_bf16 v[48:51], v[16:19], a[0:3], 0
    buffer_store_dword v8, v219, s[88:91], s16 offen sc1
    ds_read_b128 v[28:31], v1 offset:1024
    v_mfma_f32_16x16x32_bf16 v[48:51], v[20:23], a[16:19], v[48:51]
    v_rcp_f32 v185, v185
    v_mfma_f32_16x16x32_bf16 v[48:51], v[24:27], a[32:35], v[48:51]
    ds_read_b128 v[32:35], v1 offset:3072
    v_fma_f32 v187, v187, v180, v180
    v_mfma_f32_16x16x32_bf16 v[48:51], v[40:43], a[48:51], v[48:51]
    buffer_load_dwordx4 v1, s[4:7], s20 offen offset:0 sc1 lds
    v_mul_f32 v144, v144, v184
    v_mfma_f32_16x16x32_bf16 v[48:51], v[44:47], a[64:67], v[48:51]
    s_add_u32 s39, s39, 4096
    v_rcp_f32 v186, v186
    v_mfma_f32_16x16x32_bf16 v[48:51], v[12:15], a[80:83], v[48:51]
    ds_read_b128 v[36:39], v1 offset:5120
    v_mul_f32 v145, v145, v185
    v_mfma_f32_16x16x32_bf16 v[56:59], v[16:19], a[4:7], 0
    v_rcp_f32 v187, v187
    v_mfma_f32_16x16x32_bf16 v[56:59], v[20:23], a[20:23], v[56:59]
    buffer_load_dwordx4 v1, s[4:7], s20 offen offset:1024 sc1 lds
    v_mul_f32 v146, v146, v186
    v_mfma_f32_16x16x32_bf16 v[56:59], v[24:27], a[36:39], v[56:59]
    ds_read_b128 v[220:223], v1 offset:7168
    v_mul_f32 v147, v147, v187
    v_mfma_f32_16x16x32_bf16 v[56:59], v[40:43], a[52:55], v[56:59]
    v_cvt_pk_bf16_f32 v200, v144, v145
    v_cvt_pk_bf16_f32 v201, v146, v147
    v_mfma_f32_16x16x32_bf16 v[56:59], v[44:47], a[68:71], v[56:59]
    v_mul_f32 v188, v152, v177
    v_mul_f32 v189, v153, v177
    v_mfma_f32_16x16x32_bf16 v[56:59], v[12:15], a[84:87], v[56:59]
    ds_read_b128 v[192:195], v1 offset:9216
    v_mul_f32 v190, v154, v177
    v_mfma_f32_16x16x32_bf16 v[64:67], v[16:19], a[8:11], 0
    buffer_load_dwordx4 v[128:131], v1, s[48:51], s39 offen offset:0 sc1
    v_mul_f32 v191, v155, v177
    v_mfma_f32_16x16x32_bf16 v[64:67], v[20:23], a[24:27], v[64:67]
    buffer_load_dwordx4 v1, s[4:7], s20 offen offset:2048 sc1 lds
    v_mul_f32 v152, v152, v156
    v_mfma_f32_16x16x32_bf16 v[64:67], v[24:27], a[40:43], v[64:67]
    ds_read_b128 v[196:199], v1 offset:11264
    v_mul_f32 v153, v153, v157
    v_mfma_f32_16x16x32_bf16 v[64:67], v[40:43], a[56:59], v[64:67]
    v_exp_f32 v188, v188
    v_mfma_f32_16x16x32_bf16 v[64:67], v[44:47], a[72:75], v[64:67]
    s_add_u32 s20, s20, 3072
    v_exp_f32 v189, v189
    v_mfma_f32_16x16x32_bf16 v[64:67], v[12:15], a[88:91], v[64:67]
    v_exp_f32 v190, v190
    v_mfma_f32_16x16x32_bf16 v[72:75], v[16:19], a[12:15], 0
    v_exp_f32 v191, v191
    v_mfma_f32_16x16x32_bf16 v[72:75], v[20:23], a[28:31], v[72:75]
    v_mul_f32 v154, v154, v158
    v_mul_f32 v155, v155, v159
    v_mfma_f32_16x16x32_bf16 v[72:75], v[24:27], a[44:47], v[72:75]
    buffer_load_dwordx4 v[132:135], v1, s[48:51], s39 offen offset:1024 sc1
    v_fma_f32 v188, v188, v181, v181
    v_mfma_f32_16x16x32_bf16 v[72:75], v[40:43], a[60:63], v[72:75]
    s_add_u32 m0, s18, 116736
    v_rcp_f32 v188, v188
    v_mfma_f32_16x16x32_bf16 v[72:75], v[44:47], a[76:79], v[72:75]
    v_fma_f32 v189, v189, v181, v181
    v_fma_f32 v190, v190, v181, v181
    v_mfma_f32_16x16x32_bf16 v[72:75], v[12:15], a[92:95], v[72:75]
    s_waitcnt lgkmcnt(0)
    v_rcp_f32 v189, v189
    v_mfma_f32_16x16x32_bf16 v[52:55], v[28:31], a[0:3], 0
    ds_read_b128 v[16:19], v1 offset:12288
    v_fma_f32 v191, v191, v181, v181
    v_mfma_f32_16x16x32_bf16 v[52:55], v[32:35], a[16:19], v[52:55]
    buffer_load_dwordx4 v1, s[4:7], s20 offen offset:0 sc1 lds
    v_mul_f32 v152, v152, v188
    v_mfma_f32_16x16x32_bf16 v[52:55], v[36:39], a[32:35], v[52:55]
    ds_read_b128 v[20:23], v1 offset:14336
    v_mul_f32 v153, v153, v189
    v_mfma_f32_16x16x32_bf16 v[52:55], v[220:223], a[48:51], v[52:55]
    v_rcp_f32 v190, v190
    v_mfma_f32_16x16x32_bf16 v[52:55], v[192:195], a[64:67], v[52:55]
    buffer_load_dwordx4 v[136:139], v1, s[48:51], s39 offen offset:2048 sc1
    v_mul_f32 v154, v154, v190
    v_mfma_f32_16x16x32_bf16 v[52:55], v[196:199], a[80:83], v[52:55]
    buffer_load_dwordx4 v1, s[4:7], s20 offen offset:1024 sc1 lds
    ds_read_b128 v[24:27], v1 offset:16384
    v_mfma_f32_16x16x32_bf16 v[60:63], v[28:31], a[4:7], 0
    v_rcp_f32 v191, v191
    v_mfma_f32_16x16x32_bf16 v[60:63], v[32:35], a[20:23], v[60:63]
    v_mul_f32 v155, v155, v191
    v_cvt_pk_bf16_f32 v204, v152, v153
    v_mfma_f32_16x16x32_bf16 v[60:63], v[36:39], a[36:39], v[60:63]
    ds_read_b128 v[40:43], v1 offset:18432
    v_cvt_pk_bf16_f32 v205, v154, v155
    v_mfma_f32_16x16x32_bf16 v[60:63], v[220:223], a[52:55], v[60:63]
    v_mul_f32 v184, v160, v178
    v_mul_f32 v185, v161, v178
    v_mfma_f32_16x16x32_bf16 v[60:63], v[192:195], a[68:71], v[60:63]
    buffer_load_dwordx4 v1, s[4:7], s20 offen offset:2048 sc1 lds
    v_mul_f32 v186, v162, v178
    v_mfma_f32_16x16x32_bf16 v[60:63], v[196:199], a[84:87], v[60:63]
    ds_read_b128 v[44:47], v1 offset:20480
    v_mul_f32 v187, v163, v178
    v_mfma_f32_16x16x32_bf16 v[68:71], v[28:31], a[8:11], 0
    buffer_load_dwordx4 v[140:143], v1, s[48:51], s39 offen offset:3072 sc1
    v_mul_f32 v160, v160, v164
    v_mfma_f32_16x16x32_bf16 v[68:71], v[32:35], a[24:27], v[68:71]
    v_exp_f32 v184, v184
    v_mfma_f32_16x16x32_bf16 v[68:71], v[36:39], a[40:43], v[68:71]
    s_add_u32 s20, s20, 30720
    ds_read_b128 v[12:15], v1 offset:22528
    v_mul_f32 v161, v161, v165
    v_mfma_f32_16x16x32_bf16 v[68:71], v[220:223], a[56:59], v[68:71]
    v_exp_f32 v185, v185
    v_mfma_f32_16x16x32_bf16 v[68:71], v[192:195], a[72:75], v[68:71]
    v_exp_f32 v186, v186
    v_mfma_f32_16x16x32_bf16 v[68:71], v[196:199], a[88:91], v[68:71]
    v_exp_f32 v187, v187
    v_mfma_f32_16x16x32_bf16 v[76:79], v[28:31], a[12:15], 0
    v_mul_f32 v162, v162, v166
    v_mul_f32 v163, v163, v167
    v_mfma_f32_16x16x32_bf16 v[76:79], v[32:35], a[28:31], v[76:79]
    v_fma_f32 v184, v184, v182, v182
    v_fma_f32 v185, v185, v182, v182
    v_mfma_f32_16x16x32_bf16 v[76:79], v[36:39], a[44:47], v[76:79]
    v_rcp_f32 v184, v184
    v_mfma_f32_16x16x32_bf16 v[76:79], v[220:223], a[60:63], v[76:79]
    v_rcp_f32 v185, v185
    v_mfma_f32_16x16x32_bf16 v[76:79], v[192:195], a[76:79], v[76:79]
    v_fma_f32 v186, v186, v182, v182
    v_fma_f32 v187, v187, v182, v182
    v_mfma_f32_16x16x32_bf16 v[76:79], v[196:199], a[92:95], v[76:79]
    s_waitcnt lgkmcnt(0)
    v_rcp_f32 v186, v186
    v_mfma_f32_16x16x32_bf16 v[48:51], v[16:19], a[96:99], v[48:51]
    ds_read_b128 v[28:31], v1 offset:13312
    v_mul_f32 v160, v160, v184
    v_mfma_f32_16x16x32_bf16 v[48:51], v[20:23], a[112:115], v[48:51]
    v_rcp_f32 v187, v187
    v_mfma_f32_16x16x32_bf16 v[48:51], v[24:27], a[128:131], v[48:51]
    buffer_load_dwordx4 a[0:3], v1, s[48:51], s34 offen offset:0 sc1
    ds_read_b128 v[32:35], v1 offset:15360
    v_mfma_f32_16x16x32_bf16 v[48:51], v[40:43], a[144:147], v[48:51]
    v_mul_f32 v161, v161, v185
    v_mul_f32 v162, v162, v186
    v_mfma_f32_16x16x32_bf16 v[48:51], v[44:47], a[160:163], v[48:51]
    v_mul_f32 v163, v163, v187
    v_cvt_pk_bf16_f32 v208, v160, v161
    v_mfma_f32_16x16x32_bf16 v[48:51], v[12:15], a[176:179], v[48:51]
    ds_read_b128 v[36:39], v1 offset:17408
    v_cvt_pk_bf16_f32 v209, v162, v163
    v_mfma_f32_16x16x32_bf16 v[56:59], v[16:19], a[100:103], v[56:59]
    v_mul_f32 v188, v168, v179
    v_mul_f32 v189, v169, v179
    v_mfma_f32_16x16x32_bf16 v[56:59], v[20:23], a[116:119], v[56:59]
    buffer_load_dwordx4 a[4:7], v1, s[48:51], s34 offen offset:1024 sc1
    v_mul_f32 v190, v170, v179
    v_mfma_f32_16x16x32_bf16 v[56:59], v[24:27], a[132:135], v[56:59]
    ds_read_b128 v[220:223], v1 offset:19456
    v_mul_f32 v191, v171, v179
    v_mfma_f32_16x16x32_bf16 v[56:59], v[40:43], a[148:151], v[56:59]
    v_exp_f32 v188, v188
    v_mfma_f32_16x16x32_bf16 v[56:59], v[44:47], a[164:167], v[56:59]
    v_exp_f32 v189, v189
    v_mfma_f32_16x16x32_bf16 v[56:59], v[12:15], a[180:183], v[56:59]
    ds_read_b128 v[192:195], v1 offset:21504
    v_mul_f32 v168, v168, v172
    v_mfma_f32_16x16x32_bf16 v[64:67], v[16:19], a[104:107], v[64:67]
    v_exp_f32 v190, v190
    v_mfma_f32_16x16x32_bf16 v[64:67], v[20:23], a[120:123], v[64:67]
    buffer_load_dwordx4 a[8:11], v1, s[48:51], s34 offen offset:2048 sc1
    v_mul_f32 v169, v169, v173
    v_mfma_f32_16x16x32_bf16 v[64:67], v[24:27], a[136:139], v[64:67]
    ds_read_b128 v[196:199], v1 offset:23552
    v_mul_f32 v170, v170, v174
    v_mfma_f32_16x16x32_bf16 v[64:67], v[40:43], a[152:155], v[64:67]
    v_exp_f32 v191, v191
    v_mfma_f32_16x16x32_bf16 v[64:67], v[44:47], a[168:171], v[64:67]
    v_mul_f32 v171, v171, v175
    v_fma_f32 v188, v188, v183, v183
    v_mfma_f32_16x16x32_bf16 v[64:67], v[12:15], a[184:187], v[64:67]
    v_rcp_f32 v188, v188
    v_mfma_f32_16x16x32_bf16 v[72:75], v[16:19], a[108:111], v[72:75]
    buffer_load_dwordx4 a[12:15], v1, s[48:51], s34 offen offset:3072 sc1
    v_fma_f32 v189, v189, v183, v183
    v_mfma_f32_16x16x32_bf16 v[72:75], v[20:23], a[124:127], v[72:75]
    v_rcp_f32 v189, v189
    v_mfma_f32_16x16x32_bf16 v[72:75], v[24:27], a[140:143], v[72:75]
    v_fma_f32 v190, v190, v183, v183
    v_fma_f32 v191, v191, v183, v183
    v_mfma_f32_16x16x32_bf16 v[72:75], v[40:43], a[156:159], v[72:75]
    v_rcp_f32 v190, v190
    v_mfma_f32_16x16x32_bf16 v[72:75], v[44:47], a[172:175], v[72:75]
    v_rcp_f32 v191, v191
    v_mfma_f32_16x16x32_bf16 v[72:75], v[12:15], a[188:191], v[72:75]
    s_waitcnt lgkmcnt(0)
    v_mul_f32 v168, v168, v188
    v_mul_f32 v169, v169, v189
    v_mfma_f32_16x16x32_bf16 v[52:55], v[28:31], a[96:99], v[52:55]
    buffer_load_dwordx4 a[16:19], v1, s[48:51], s35 offen offset:0 sc1
    ds_read_b128 v[16:19], v1 offset:24576
    v_mfma_f32_16x16x32_bf16 v[52:55], v[32:35], a[112:115], v[52:55]
    v_mul_f32 v170, v170, v190
    v_mul_f32 v171, v171, v191
    v_mfma_f32_16x16x32_bf16 v[52:55], v[36:39], a[128:131], v[52:55]
    ds_read_b128 v[20:23], v1 offset:26624
    v_cvt_pk_bf16_f32 v212, v168, v169
    v_mfma_f32_16x16x32_bf16 v[52:55], v[220:223], a[144:147], v[52:55]
    v_cvt_pk_bf16_f32 v213, v170, v171
    v_mfma_f32_16x16x32_bf16 v[52:55], v[192:195], a[160:163], v[52:55]
    v_mfma_f32_16x16x32_bf16 v[52:55], v[196:199], a[176:179], v[52:55]
    buffer_load_dwordx4 a[20:23], v1, s[48:51], s35 offen offset:1024 sc1
    ds_read_b128 v[24:27], v1 offset:28672
    v_mfma_f32_16x16x32_bf16 v[60:63], v[28:31], a[100:103], v[60:63]
    v_mfma_f32_16x16x32_bf16 v[60:63], v[32:35], a[116:119], v[60:63]
    v_mfma_f32_16x16x32_bf16 v[60:63], v[36:39], a[132:135], v[60:63]
    ds_read_b128 v[40:43], v1 offset:30720
    v_mfma_f32_16x16x32_bf16 v[60:63], v[220:223], a[148:151], v[60:63]
    v_mfma_f32_16x16x32_bf16 v[60:63], v[192:195], a[164:167], v[60:63]
    v_mfma_f32_16x16x32_bf16 v[60:63], v[196:199], a[180:183], v[60:63]
    buffer_load_dwordx4 a[24:27], v1, s[48:51], s35 offen offset:2048 sc1
    ds_read_b128 v[44:47], v1 offset:32768
    v_mfma_f32_16x16x32_bf16 v[68:71], v[28:31], a[104:107], v[68:71]
    v_mfma_f32_16x16x32_bf16 v[68:71], v[32:35], a[120:123], v[68:71]
    v_mfma_f32_16x16x32_bf16 v[68:71], v[36:39], a[136:139], v[68:71]
    ds_read_b128 v[12:15], v1 offset:34816
    v_mfma_f32_16x16x32_bf16 v[68:71], v[220:223], a[152:155], v[68:71]
    v_mfma_f32_16x16x32_bf16 v[68:71], v[192:195], a[168:171], v[68:71]
    buffer_load_dwordx4 a[28:31], v1, s[48:51], s35 offen offset:3072 sc1
    v_mfma_f32_16x16x32_bf16 v[68:71], v[196:199], a[184:187], v[68:71]
    v_mfma_f32_16x16x32_bf16 v[76:79], v[28:31], a[108:111], v[76:79]
    v_mfma_f32_16x16x32_bf16 v[76:79], v[32:35], a[124:127], v[76:79]
    v_mfma_f32_16x16x32_bf16 v[76:79], v[36:39], a[140:143], v[76:79]
    v_mfma_f32_16x16x32_bf16 v[76:79], v[220:223], a[156:159], v[76:79]
    v_mfma_f32_16x16x32_bf16 v[76:79], v[192:195], a[172:175], v[76:79]
    s_add_u32 s38, s38, 12288
    v_mfma_f32_16x16x32_bf16 v[76:79], v[196:199], a[188:191], v[76:79]
    s_waitcnt lgkmcnt(0)
    v_mfma_f32_16x16x32_bf16 v[48:51], v[16:19], a[192:195], v[48:51]
    ds_read_b128 v[28:31], v1 offset:25600
    v_mfma_f32_16x16x32_bf16 v[48:51], v[20:23], a[208:211], v[48:51]
    v_mfma_f32_16x16x32_bf16 v[48:51], v[24:27], a[224:227], v[48:51]
    ds_read_b128 v[32:35], v1 offset:27648
    v_mfma_f32_16x16x32_bf16 v[48:51], v[40:43], a[240:243], v[48:51]
    buffer_load_dwordx4 a[32:35], v1, s[48:51], s38 offen offset:0 sc1
    v_mfma_f32_16x16x32_bf16 v[48:51], v[44:47], v[224:227], v[48:51]
    v_mfma_f32_16x16x32_bf16 v[48:51], v[12:15], v[240:243], v[48:51]
    ds_read_b128 v[36:39], v1 offset:29696
    v_mfma_f32_16x16x32_bf16 v[56:59], v[16:19], a[196:199], v[56:59]
    v_mfma_f32_16x16x32_bf16 v[56:59], v[20:23], a[212:215], v[56:59]
    v_mfma_f32_16x16x32_bf16 v[56:59], v[24:27], a[228:231], v[56:59]
    ds_read_b128 v[220:223], v1 offset:31744
    v_mfma_f32_16x16x32_bf16 v[56:59], v[40:43], a[244:247], v[56:59]
    buffer_load_dwordx4 a[36:39], v1, s[48:51], s38 offen offset:1024 sc1
    v_mfma_f32_16x16x32_bf16 v[56:59], v[44:47], v[228:231], v[56:59]
    v_mfma_f32_16x16x32_bf16 v[56:59], v[12:15], v[244:247], v[56:59]
    ds_read_b128 v[192:195], v1 offset:33792
    v_mfma_f32_16x16x32_bf16 v[64:67], v[16:19], a[200:203], v[64:67]
    v_mfma_f32_16x16x32_bf16 v[64:67], v[20:23], a[216:219], v[64:67]
    v_mfma_f32_16x16x32_bf16 v[64:67], v[24:27], a[232:235], v[64:67]
    buffer_load_dwordx4 a[40:43], v1, s[48:51], s38 offen offset:2048 sc1
    ds_read_b128 v[196:199], v1 offset:35840
    v_mfma_f32_16x16x32_bf16 v[64:67], v[40:43], a[248:251], v[64:67]
    v_mfma_f32_16x16x32_bf16 v[64:67], v[44:47], v[232:235], v[64:67]
    v_mfma_f32_16x16x32_bf16 v[64:67], v[12:15], v[248:251], v[64:67]
    v_mfma_f32_16x16x32_bf16 v[72:75], v[16:19], a[204:207], v[72:75]
    v_mfma_f32_16x16x32_bf16 v[72:75], v[20:23], a[220:223], v[72:75]
    v_mfma_f32_16x16x32_bf16 v[72:75], v[24:27], a[236:239], v[72:75]
    buffer_load_dwordx4 a[44:47], v1, s[48:51], s38 offen offset:3072 sc1
    v_mfma_f32_16x16x32_bf16 v[72:75], v[40:43], a[252:255], v[72:75]
    v_mfma_f32_16x16x32_bf16 v[72:75], v[44:47], v[236:239], v[72:75]
    v_mfma_f32_16x16x32_bf16 v[72:75], v[12:15], v[252:255], v[72:75]
    s_waitcnt lgkmcnt(0)
    v_mfma_f32_16x16x32_bf16 v[52:55], v[28:31], a[192:195], v[52:55]
    s_barrier
    v_mfma_f32_16x16x32_bf16 v[52:55], v[32:35], a[208:211], v[52:55]
    s_add_u32 s39, s39, 12288
    s_add_u32 m0, s18, 0
    ds_read_b128 a[128:131], v1 offset:36864
    v_mfma_f32_16x16x32_bf16 v[52:55], v[36:39], a[224:227], v[52:55]
    ds_read_b128 a[132:135], v1 offset:46080
    v_mfma_f32_16x16x32_bf16 v[52:55], v[220:223], a[240:243], v[52:55]
    ds_read_b128 a[136:139], v3 offset:6144
    v_mfma_f32_16x16x32_bf16 v[52:55], v[192:195], v[224:227], v[52:55]
    ds_read_b128 a[140:143], v3 offset:15360
    v_mfma_f32_16x16x32_bf16 v[52:55], v[196:199], v[240:243], v[52:55]
    buffer_load_dwordx4 v1, s[4:7], s20 offen offset:0 sc1 lds
    ds_read_b128 a[144:147], v1 offset:37888
    v_mfma_f32_16x16x32_bf16 v[60:63], v[28:31], a[196:199], v[60:63]
    ds_read_b128 a[148:151], v1 offset:47104
    v_mfma_f32_16x16x32_bf16 v[60:63], v[32:35], a[212:215], v[60:63]
    buffer_load_dwordx4 a[48:51], v1, s[48:51], s39 offen offset:0 sc1
    ds_read_b128 a[152:155], v3 offset:7168
    v_mfma_f32_16x16x32_bf16 v[60:63], v[36:39], a[228:231], v[60:63]
    ds_read_b128 a[156:159], v3 offset:16384
    v_mfma_f32_16x16x32_bf16 v[60:63], v[220:223], a[244:247], v[60:63]
    v_mul_f32 v184, v48, v176
    v_mul_f32 v185, v49, v176
    v_mfma_f32_16x16x32_bf16 v[60:63], v[192:195], v[228:231], v[60:63]
    buffer_load_dwordx4 v1, s[4:7], s20 offen offset:1024 sc1 lds
    v_mul_f32 v186, v50, v176
    v_mfma_f32_16x16x32_bf16 v[60:63], v[196:199], v[244:247], v[60:63]
    v_exp_f32 v184, v184
    v_mfma_f32_16x16x32_bf16 v[68:71], v[28:31], a[200:203], v[68:71]
    buffer_load_dwordx4 a[52:55], v1, s[48:51], s39 offen offset:1024 sc1
    v_mul_f32 v187, v51, v176
    v_mfma_f32_16x16x32_bf16 v[68:71], v[32:35], a[216:219], v[68:71]
    v_exp_f32 v185, v185
    v_mfma_f32_16x16x32_bf16 v[68:71], v[36:39], a[232:235], v[68:71]
    v_exp_f32 v186, v186
    v_mfma_f32_16x16x32_bf16 v[68:71], v[220:223], a[248:251], v[68:71]
    buffer_load_dwordx4 v1, s[4:7], s20 offen offset:2048 sc1 lds
    v_mul_f32 v48, v48, v52
    v_mfma_f32_16x16x32_bf16 v[68:71], v[192:195], v[232:235], v[68:71]
    v_exp_f32 v187, v187
    v_mfma_f32_16x16x32_bf16 v[68:71], v[196:199], v[248:251], v[68:71]
    v_mul_f32 v49, v49, v53
    v_mul_f32 v50, v50, v54
    v_mfma_f32_16x16x32_bf16 v[76:79], v[28:31], a[204:207], v[76:79]
    buffer_load_dwordx4 a[56:59], v1, s[48:51], s39 offen offset:2048 sc1
    v_mul_f32 v51, v51, v55
    v_mfma_f32_16x16x32_bf16 v[76:79], v[32:35], a[220:223], v[76:79]
    v_fma_f32 v184, v184, v180, v180
    v_fma_f32 v185, v185, v180, v180
    v_mfma_f32_16x16x32_bf16 v[76:79], v[36:39], a[236:239], v[76:79]
    s_add_u32 s20, s20, 3072
    v_rcp_f32 v184, v184
    v_mfma_f32_16x16x32_bf16 v[76:79], v[220:223], a[252:255], v[76:79]
    v_rcp_f32 v185, v185
    v_mfma_f32_16x16x32_bf16 v[76:79], v[192:195], v[236:239], v[76:79]
    s_waitcnt vmcnt(36)
    v_fma_f32 v186, v186, v180, v180
    v_fma_f32 v187, v187, v180, v180
    v_mfma_f32_16x16x32_bf16 v[76:79], v[196:199], v[252:255], v[76:79]
    s_waitcnt lgkmcnt(4)
    buffer_load_dwordx4 a[60:63], v1, s[48:51], s39 offen offset:3072 sc1
    v_mul_f32 v48, v48, v184
    v_mfma_f32_16x16x32_bf16 v[16:19], a[128:131], v[80:83], 0
    ds_read_b128 a[160:163], v1 offset:38912
    v_mul_f32 v49, v49, v185
    v_mfma_f32_16x16x32_bf16 v[16:19], a[132:135], v[84:87], v[16:19]
    s_add_u32 m0, s18, 3072
    ds_read_b128 a[164:167], v1 offset:48128
    v_cvt_pk_bf16_f32 v202, v48, v49
    v_mfma_f32_16x16x32_bf16 v[16:19], a[136:139], v[88:91], v[16:19]
    v_rcp_f32 v186, v186
    v_mfma_f32_16x16x32_bf16 v[16:19], a[140:143], v[92:95], v[16:19]
    ds_read_b128 a[168:171], v3 offset:8192
    v_mul_f32 v50, v50, v186
    v_mfma_f32_16x16x32_bf16 v[224:227], a[128:131], v[96:99], 0
    v_rcp_f32 v187, v187
    v_mfma_f32_16x16x32_bf16 v[224:227], a[132:135], v[100:103], v[224:227]
    s_add_u32 s38, s38, 4096
    ds_read_b128 a[172:175], v3 offset:17408
    v_mul_f32 v51, v51, v187
    v_mfma_f32_16x16x32_bf16 v[224:227], a[136:139], v[104:107], v[224:227]
    buffer_load_dwordx4 v1, s[4:7], s20 offen offset:0 sc1 lds
    v_cvt_pk_bf16_f32 v203, v50, v51
    v_mfma_f32_16x16x32_bf16 v[224:227], a[140:143], v[108:111], v[224:227]
    s_waitcnt lgkmcnt(4)
    buffer_store_dwordx4 v[200:203], v1, s[48:51], s28 offen sc1
    v_mfma_f32_16x16x32_bf16 v[20:23], a[144:147], v[80:83], 0
    ds_read_b128 a[128:131], v1 offset:39936
    v_mul_f32 v188, v56, v177
    v_mfma_f32_16x16x32_bf16 v[20:23], a[148:151], v[84:87], v[20:23]
    ds_read_b128 a[132:135], v3 offset:0
    v_mul_f32 v189, v57, v177
    v_mfma_f32_16x16x32_bf16 v[20:23], a[152:155], v[88:91], v[20:23]
    buffer_load_dwordx4 a[64:67], v1, s[48:51], s38 offen offset:0 sc1
    v_mul_f32 v190, v58, v177
    v_mfma_f32_16x16x32_bf16 v[20:23], a[156:159], v[92:95], v[20:23]
    buffer_load_dwordx4 v1, s[4:7], s20 offen offset:1024 sc1 lds
    ds_read_b128 a[136:139], v3 offset:9216
    v_mfma_f32_16x16x32_bf16 v[228:231], a[144:147], v[96:99], 0
    v_exp_f32 v188, v188
    v_mfma_f32_16x16x32_bf16 v[228:231], a[148:151], v[100:103], v[228:231]
    ds_read_b128 a[140:143], v3 offset:18432
    v_mul_f32 v191, v59, v177
    v_mfma_f32_16x16x32_bf16 v[228:231], a[152:155], v[104:107], v[228:231]
    v_exp_f32 v189, v189
    v_mfma_f32_16x16x32_bf16 v[228:231], a[156:159], v[108:111], v[228:231]
    s_waitcnt lgkmcnt(4)
    buffer_load_dwordx4 v1, s[4:7], s20 offen offset:2048 sc1 lds
    v_mul_f32 v56, v56, v60
    v_mfma_f32_16x16x32_bf16 v[24:27], a[160:163], v[80:83], 0
    buffer_load_dword v9, v7, s[88:91], s17 offen sc1
    ds_read_b128 a[144:147], v1 offset:40960
    v_mfma_f32_16x16x32_bf16 v[24:27], a[164:167], v[84:87], v[24:27]
    buffer_load_dwordx4 a[68:71], v1, s[48:51], s38 offen offset:1024 sc1
    ds_read_b128 a[148:151], v3 offset:1024
    v_mfma_f32_16x16x32_bf16 v[24:27], a[168:171], v[88:91], v[24:27]
    v_exp_f32 v190, v190
    v_mfma_f32_16x16x32_bf16 v[24:27], a[172:175], v[92:95], v[24:27]
    ds_read_b128 a[152:155], v3 offset:10240
    v_mul_f32 v57, v57, v61
    v_mfma_f32_16x16x32_bf16 v[232:235], a[160:163], v[96:99], 0
    s_add_u32 s20, s20, 3072
    v_exp_f32 v191, v191
    v_mfma_f32_16x16x32_bf16 v[232:235], a[164:167], v[100:103], v[232:235]
    buffer_load_dwordx4 a[72:75], v1, s[48:51], s38 offen offset:2048 sc1
    ds_read_b128 a[156:159], v3 offset:19456
    v_mfma_f32_16x16x32_bf16 v[232:235], a[168:171], v[104:107], v[232:235]
    v_mul_f32 v58, v58, v62
    v_mul_f32 v59, v59, v63
    v_mfma_f32_16x16x32_bf16 v[232:235], a[172:175], v[108:111], v[232:235]
    s_waitcnt lgkmcnt(4)
    v_fma_f32 v188, v188, v181, v181
    v_fma_f32 v189, v189, v181, v181
    v_mfma_f32_16x16x32_bf16 v[28:31], a[128:131], v[80:83], 0
    ds_read_b128 a[160:163], v1 offset:41984
    v_fma_f32 v190, v190, v181, v181
    v_mfma_f32_16x16x32_bf16 v[28:31], a[132:135], v[84:87], v[28:31]
    s_add_u32 m0, s18, 6144
    ds_read_b128 a[164:167], v3 offset:2048
    v_fma_f32 v191, v191, v181, v181
    v_mfma_f32_16x16x32_bf16 v[28:31], a[136:139], v[88:91], v[28:31]
    v_rcp_f32 v188, v188
    v_mfma_f32_16x16x32_bf16 v[28:31], a[140:143], v[92:95], v[28:31]
    buffer_load_dwordx4 a[76:79], v1, s[48:51], s38 offen offset:3072 sc1
    ds_read_b128 a[168:171], v3 offset:11264
    v_mfma_f32_16x16x32_bf16 v[236:239], a[128:131], v[96:99], 0
    v_rcp_f32 v189, v189
    v_mfma_f32_16x16x32_bf16 v[236:239], a[132:135], v[100:103], v[236:239]
    ds_read_b128 a[172:175], v3 offset:20480
    v_mul_f32 v56, v56, v188
    v_mfma_f32_16x16x32_bf16 v[236:239], a[136:139], v[104:107], v[236:239]
    buffer_load_dwordx4 v1, s[4:7], s20 offen offset:0 sc1 lds
    v_mul_f32 v57, v57, v189
    v_mfma_f32_16x16x32_bf16 v[236:239], a[140:143], v[108:111], v[236:239]
    s_waitcnt lgkmcnt(4)
    v_rcp_f32 v190, v190
    v_mfma_f32_16x16x32_bf16 v[32:35], a[144:147], v[80:83], 0
    s_add_u32 s39, s39, 4096
    ds_read_b128 a[128:131], v1 offset:43008
    v_mul_f32 v58, v58, v190
    v_mfma_f32_16x16x32_bf16 v[32:35], a[148:151], v[84:87], v[32:35]
    ds_read_b128 a[132:135], v3 offset:3072
    v_cvt_pk_bf16_f32 v206, v56, v57
    v_mfma_f32_16x16x32_bf16 v[32:35], a[152:155], v[88:91], v[32:35]
    v_rcp_f32 v191, v191
    v_mfma_f32_16x16x32_bf16 v[32:35], a[156:159], v[92:95], v[32:35]
    buffer_load_dwordx4 v1, s[4:7], s20 offen offset:1024 sc1 lds
    ds_read_b128 a[136:139], v3 offset:12288
    v_mfma_f32_16x16x32_bf16 v[240:243], a[144:147], v[96:99], 0
    v_mul_f32 v59, v59, v191
    v_cvt_pk_bf16_f32 v207, v58, v59
    v_mfma_f32_16x16x32_bf16 v[240:243], a[148:151], v[100:103], v[240:243]
    ds_read_b128 a[140:143], v3 offset:21504
    v_mul_f32 v184, v64, v178
    v_mfma_f32_16x16x32_bf16 v[240:243], a[152:155], v[104:107], v[240:243]
    buffer_load_dwordx4 a[80:83], v1, s[48:51], s39 offen offset:0 sc1
    v_mul_f32 v185, v65, v178
    v_mfma_f32_16x16x32_bf16 v[240:243], a[156:159], v[108:111], v[240:243]
    s_waitcnt lgkmcnt(4)
    buffer_store_dwordx4 v[204:207], v1, s[48:51], s29 offen sc1
    v_mfma_f32_16x16x32_bf16 v[36:39], a[160:163], v[80:83], 0
    buffer_load_dwordx4 v1, s[4:7], s20 offen offset:2048 sc1 lds
    ds_read_b128 a[144:147], v1 offset:44032
    v_mfma_f32_16x16x32_bf16 v[36:39], a[164:167], v[84:87], v[36:39]
    ds_read_b128 a[148:151], v3 offset:4096
    v_mul_f32 v186, v66, v178
    v_mfma_f32_16x16x32_bf16 v[36:39], a[168:171], v[88:91], v[36:39]
    v_exp_f32 v184, v184
    v_mfma_f32_16x16x32_bf16 v[36:39], a[172:175], v[92:95], v[36:39]
    buffer_load_dwordx4 a[84:87], v1, s[48:51], s39 offen offset:1024 sc1
    ds_read_b128 a[152:155], v3 offset:13312
    v_mfma_f32_16x16x32_bf16 v[244:247], a[160:163], v[96:99], 0
    v_exp_f32 v185, v185
    v_mfma_f32_16x16x32_bf16 v[244:247], a[164:167], v[100:103], v[244:247]
    s_add_u32 s20, s20, 30720
    ds_read_b128 a[156:159], v3 offset:22528
    v_mul_f32 v187, v67, v178
    v_mfma_f32_16x16x32_bf16 v[244:247], a[168:171], v[104:107], v[244:247]
    v_exp_f32 v186, v186
    v_mfma_f32_16x16x32_bf16 v[244:247], a[172:175], v[108:111], v[244:247]
    s_waitcnt lgkmcnt(4)
    v_exp_f32 v187, v187
    v_mfma_f32_16x16x32_bf16 v[40:43], a[128:131], v[80:83], 0
    ds_read_b128 a[160:163], v1 offset:45056
    v_mul_f32 v64, v64, v68
    v_mfma_f32_16x16x32_bf16 v[40:43], a[132:135], v[84:87], v[40:43]
    buffer_load_dwordx4 a[88:91], v1, s[48:51], s39 offen offset:2048 sc1
    ds_read_b128 a[164:167], v3 offset:5120
    v_mfma_f32_16x16x32_bf16 v[40:43], a[136:139], v[88:91], v[40:43]
    ds_read_b128 a[168:171], v3 offset:14336
    v_mul_f32 v65, v65, v69
    v_mfma_f32_16x16x32_bf16 v[40:43], a[140:143], v[92:95], v[40:43]
    ds_read_b128 a[172:175], v3 offset:23552
    v_mul_f32 v66, v66, v70
    v_mfma_f32_16x16x32_bf16 v[248:251], a[128:131], v[96:99], 0
    v_mul_f32 v67, v67, v71
    v_fma_f32 v184, v184, v182, v182
    v_mfma_f32_16x16x32_bf16 v[248:251], a[132:135], v[100:103], v[248:251]
    v_rcp_f32 v184, v184
    v_mfma_f32_16x16x32_bf16 v[248:251], a[136:139], v[104:107], v[248:251]
    buffer_load_dwordx4 a[92:95], v1, s[48:51], s39 offen offset:3072 sc1
    v_fma_f32 v185, v185, v182, v182
    v_mfma_f32_16x16x32_bf16 v[248:251], a[140:143], v[108:111], v[248:251]
    s_waitcnt lgkmcnt(0)
    v_rcp_f32 v185, v185
    v_mfma_f32_16x16x32_bf16 v[44:47], a[144:147], v[80:83], 0
    s_barrier
    v_mfma_f32_16x16x32_bf16 v[44:47], a[148:151], v[84:87], v[44:47]
    s_add_u32 m0, s18, 36864
    ds_read_b128 a[128:131], v3 offset:24576
    s_waitcnt vmcnt(11)
    v_cmp_gt_u32 vcc, 2, v9
    v_mfma_f32_16x16x32_bf16 v[44:47], a[152:155], v[88:91], v[44:47]
    ds_read_b128 a[132:135], v3 offset:33792
    v_fma_f32 v186, v186, v182, v182
    v_mfma_f32_16x16x32_bf16 v[44:47], a[156:159], v[92:95], v[44:47]
    s_cbranch_vccnz spin12
back12:
    v_rcp_f32 v186, v186
    v_mfma_f32_16x16x32_bf16 v[252:255], a[144:147], v[96:99], 0
    ds_read_b128 a[136:139], v3 offset:43008
    v_fma_f32 v187, v187, v182, v182
    v_mfma_f32_16x16x32_bf16 v[252:255], a[148:151], v[100:103], v[252:255]
    buffer_load_dwordx4 v1, s[4:7], s20 offen offset:0 sc1 lds
    ds_read_b128 a[140:143], v4 offset:3072
    v_mfma_f32_16x16x32_bf16 v[252:255], a[152:155], v[104:107], v[252:255]
    s_add_u32 s38, s38, 12288
    v_rcp_f32 v187, v187
    v_mfma_f32_16x16x32_bf16 v[252:255], a[156:159], v[108:111], v[252:255]
    s_waitcnt lgkmcnt(4)
    v_mul_f32 v64, v64, v184
    v_mul_f32 v65, v65, v185
    v_mfma_f32_16x16x32_bf16 v[144:147], a[160:163], v[80:83], 0
    ds_read_b128 a[144:147], v3 offset:25600
    v_mul_f32 v66, v66, v186
    v_mfma_f32_16x16x32_bf16 v[144:147], a[164:167], v[84:87], v[144:147]
    ds_read_b128 a[148:151], v3 offset:34816
    v_mul_f32 v67, v67, v187
    v_mfma_f32_16x16x32_bf16 v[144:147], a[168:171], v[88:91], v[144:147]
    buffer_load_dwordx4 v1, s[4:7], s20 offen offset:1024 sc1 lds
    v_cvt_pk_bf16_f32 v210, v64, v65
    v_mfma_f32_16x16x32_bf16 v[144:147], a[172:175], v[92:95], v[144:147]
    ds_read_b128 a[152:155], v3 offset:44032
    v_cvt_pk_bf16_f32 v211, v66, v67
    v_mfma_f32_16x16x32_bf16 v[148:151], a[160:163], v[96:99], 0
    buffer_store_dwordx4 v[208:211], v1, s[48:51], s30 offen sc1
    v_mfma_f32_16x16x32_bf16 v[148:151], a[164:167], v[100:103], v[148:151]
    ds_read_b128 a[156:159], v4 offset:4096
    v_mul_f32 v188, v72, v179
    v_mfma_f32_16x16x32_bf16 v[148:151], a[168:171], v[104:107], v[148:151]
    v_exp_f32 v188, v188
    v_mfma_f32_16x16x32_bf16 v[148:151], a[172:175], v[108:111], v[148:151]
    s_waitcnt lgkmcnt(4)
    buffer_load_dwordx4 v1, s[4:7], s20 offen offset:2048 sc1 lds
    v_mul_f32 v189, v73, v179
    v_mfma_f32_16x16x32_bf16 v[16:19], a[128:131], v[112:115], v[16:19]
    buffer_load_dwordx4 a[96:99], v1, s[48:51], s38 offen offset:0 sc1
    ds_read_b128 a[160:163], v3 offset:26624
    v_mfma_f32_16x16x32_bf16 v[16:19], a[132:135], v[116:119], v[16:19]
    ds_read_b128 a[164:167], v3 offset:35840
    v_mul_f32 v190, v74, v179
    v_mfma_f32_16x16x32_bf16 v[16:19], a[136:139], v[120:123], v[16:19]
    v_exp_f32 v189, v189
    v_mfma_f32_16x16x32_bf16 v[16:19], a[140:143], v[124:127], v[16:19]
    ds_read_b128 a[168:171], v3 offset:45056
    v_mul_f32 v191, v75, v179
    v_mfma_f32_16x16x32_bf16 v[224:227], a[128:131], v[128:131], v[224:227]
    s_add_u32 s20, s20, 3072
    v_exp_f32 v190, v190
    v_mfma_f32_16x16x32_bf16 v[224:227], a[132:135], v[132:135], v[224:227]
    ds_read_b128 a[172:175], v4 offset:5120
    v_mul_f32 v72, v72, v76
    v_mfma_f32_16x16x32_bf16 v[224:227], a[136:139], v[136:139], v[224:227]
    v_exp_f32 v191, v191
    v_mfma_f32_16x16x32_bf16 v[224:227], a[140:143], v[140:143], v[224:227]
    s_waitcnt lgkmcnt(4)
    v_mul_f32 v73, v73, v77
    v_mul_f32 v74, v74, v78
    v_mfma_f32_16x16x32_bf16 v[20:23], a[144:147], v[112:115], v[20:23]
    ds_read_b128 a[128:131], v3 offset:27648
    v_mul_f32 v75, v75, v79
    v_mfma_f32_16x16x32_bf16 v[20:23], a[148:151], v[116:119], v[20:23]
    s_add_u32 m0, s18, 39936
    ds_read_b128 a[132:135], v3 offset:36864
    v_fma_f32 v188, v188, v183, v183
    v_mfma_f32_16x16x32_bf16 v[20:23], a[152:155], v[120:123], v[20:23]
    buffer_load_dwordx4 a[100:103], v1, s[48:51], s38 offen offset:1024 sc1
    v_fma_f32 v189, v189, v183, v183
    v_mfma_f32_16x16x32_bf16 v[20:23], a[156:159], v[124:127], v[20:23]
    ds_read_b128 a[136:139], v3 offset:46080
    v_fma_f32 v190, v190, v183, v183
    v_mfma_f32_16x16x32_bf16 v[228:231], a[144:147], v[128:131], v[228:231]
    v_rcp_f32 v188, v188
    v_mfma_f32_16x16x32_bf16 v[228:231], a[148:151], v[132:135], v[228:231]
    ds_read_b128 a[140:143], v4 offset:6144
    v_fma_f32 v191, v191, v183, v183
    v_mfma_f32_16x16x32_bf16 v[228:231], a[152:155], v[136:139], v[228:231]
    buffer_load_dwordx4 v1, s[4:7], s20 offen offset:0 sc1 lds
    v_mul_f32 v72, v72, v188
    v_mfma_f32_16x16x32_bf16 v[228:231], a[156:159], v[140:143], v[228:231]
    s_waitcnt lgkmcnt(4)
    v_rcp_f32 v189, v189
    v_mfma_f32_16x16x32_bf16 v[24:27], a[160:163], v[112:115], v[24:27]
    ds_read_b128 a[144:147], v3 offset:28672
    v_mul_f32 v73, v73, v189
    v_mfma_f32_16x16x32_bf16 v[24:27], a[164:167], v[116:119], v[24:27]
    ds_read_b128 a[148:151], v3 offset:37888
    v_cvt_pk_bf16_f32 v214, v72, v73
    v_mfma_f32_16x16x32_bf16 v[24:27], a[168:171], v[120:123], v[24:27]
    v_rcp_f32 v190, v190
    v_mfma_f32_16x16x32_bf16 v[24:27], a[172:175], v[124:127], v[24:27]
    buffer_load_dwordx4 v1, s[4:7], s20 offen offset:1024 sc1 lds
    ds_read_b128 a[152:155], v3 offset:47104
    v_mfma_f32_16x16x32_bf16 v[232:235], a[160:163], v[128:131], v[232:235]
    v_rcp_f32 v191, v191
    v_mfma_f32_16x16x32_bf16 v[232:235], a[164:167], v[132:135], v[232:235]
    buffer_load_dwordx4 a[104:107], v1, s[48:51], s38 offen offset:2048 sc1
    ds_read_b128 a[156:159], v4 offset:7168
    v_mfma_f32_16x16x32_bf16 v[232:235], a[168:171], v[136:139], v[232:235]
    v_mul_f32 v74, v74, v190
    v_mul_f32 v75, v75, v191
    v_mfma_f32_16x16x32_bf16 v[232:235], a[172:175], v[140:143], v[232:235]
    s_waitcnt lgkmcnt(4)
    buffer_load_dwordx4 v1, s[4:7], s20 offen offset:2048 sc1 lds
    v_cvt_pk_bf16_f32 v215, v74, v75
    v_mfma_f32_16x16x32_bf16 v[28:31], a[128:131], v[112:115], v[28:31]
    ds_read_b128 a[160:163], v3 offset:29696
    v_mfma_f32_16x16x32_bf16 v[28:31], a[132:135], v[116:119], v[28:31]
    ds_read_b128 a[164:167], v3 offset:38912
    v_mfma_f32_16x16x32_bf16 v[28:31], a[136:139], v[120:123], v[28:31]
    buffer_store_dwordx4 v[212:215], v1, s[48:51], s31 offen sc1
    v_mfma_f32_16x16x32_bf16 v[28:31], a[140:143], v[124:127], v[28:31]
    ds_read_b128 a[168:171], v3 offset:48128
    v_mfma_f32_16x16x32_bf16 v[236:239], a[128:131], v[128:131], v[236:239]
    s_add_u32 s20, s20, 3072
    v_mfma_f32_16x16x32_bf16 v[236:239], a[132:135], v[132:135], v[236:239]
    ds_read_b128 a[172:175], v4 offset:8192
    v_mfma_f32_16x16x32_bf16 v[236:239], a[136:139], v[136:139], v[236:239]
    v_mfma_f32_16x16x32_bf16 v[236:239], a[140:143], v[140:143], v[236:239]
    s_waitcnt lgkmcnt(4)
    buffer_load_dwordx4 a[108:111], v1, s[48:51], s38 offen offset:3072 sc1
    v_mfma_f32_16x16x32_bf16 v[32:35], a[144:147], v[112:115], v[32:35]
    ds_read_b128 a[128:131], v3 offset:30720
    v_mfma_f32_16x16x32_bf16 v[32:35], a[148:151], v[116:119], v[32:35]
    s_add_u32 m0, s18, 43008
    ds_read_b128 a[132:135], v3 offset:39936
    v_mfma_f32_16x16x32_bf16 v[32:35], a[152:155], v[120:123], v[32:35]
    v_mfma_f32_16x16x32_bf16 v[32:35], a[156:159], v[124:127], v[32:35]
    ds_read_b128 a[136:139], v4 offset:0
    v_mfma_f32_16x16x32_bf16 v[240:243], a[144:147], v[128:131], v[240:243]
    v_mfma_f32_16x16x32_bf16 v[240:243], a[148:151], v[132:135], v[240:243]
    ds_read_b128 a[140:143], v4 offset:9216
    v_mfma_f32_16x16x32_bf16 v[240:243], a[152:155], v[136:139], v[240:243]
    buffer_load_dwordx4 v1, s[4:7], s20 offen offset:0 sc1 lds
    v_mfma_f32_16x16x32_bf16 v[240:243], a[156:159], v[140:143], v[240:243]
    s_waitcnt lgkmcnt(4)
    v_mfma_f32_16x16x32_bf16 v[36:39], a[160:163], v[112:115], v[36:39]
    ds_read_b128 a[144:147], v3 offset:31744
    v_mfma_f32_16x16x32_bf16 v[36:39], a[164:167], v[116:119], v[36:39]
    ds_read_b128 a[148:151], v3 offset:40960
    v_mfma_f32_16x16x32_bf16 v[36:39], a[168:171], v[120:123], v[36:39]
    s_add_u32 s39, s39, 12288
    v_mfma_f32_16x16x32_bf16 v[36:39], a[172:175], v[124:127], v[36:39]
    buffer_load_dwordx4 v1, s[4:7], s20 offen offset:1024 sc1 lds
    ds_read_b128 a[152:155], v4 offset:1024
    v_mfma_f32_16x16x32_bf16 v[244:247], a[160:163], v[128:131], v[244:247]
    v_mfma_f32_16x16x32_bf16 v[244:247], a[164:167], v[132:135], v[244:247]
    ds_read_b128 a[156:159], v4 offset:10240
    v_mfma_f32_16x16x32_bf16 v[244:247], a[168:171], v[136:139], v[244:247]
    v_mfma_f32_16x16x32_bf16 v[244:247], a[172:175], v[140:143], v[244:247]
    s_waitcnt lgkmcnt(4)
    v_mfma_f32_16x16x32_bf16 v[40:43], a[128:131], v[112:115], v[40:43]
    buffer_load_dwordx4 v1, s[4:7], s20 offen offset:2048 sc1 lds
    ds_read_b128 a[160:163], v3 offset:32768
    v_mfma_f32_16x16x32_bf16 v[40:43], a[132:135], v[116:119], v[40:43]
    ds_read_b128 a[164:167], v3 offset:41984
    v_mfma_f32_16x16x32_bf16 v[40:43], a[136:139], v[120:123], v[40:43]
    ds_read_b128 a[168:171], v4 offset:2048
    v_mfma_f32_16x16x32_bf16 v[40:43], a[140:143], v[124:127], v[40:43]
    ds_read_b128 a[172:175], v4 offset:11264
    v_mfma_f32_16x16x32_bf16 v[248:251], a[128:131], v[128:131], v[248:251]
    buffer_load_dwordx4 a[112:115], v1, s[48:51], s39 offen offset:0 sc1
    v_mfma_f32_16x16x32_bf16 v[248:251], a[132:135], v[132:135], v[248:251]
    s_add_u32 s20, s20, 30720
    v_mfma_f32_16x16x32_bf16 v[248:251], a[136:139], v[136:139], v[248:251]
    v_mfma_f32_16x16x32_bf16 v[248:251], a[140:143], v[140:143], v[248:251]
    s_waitcnt lgkmcnt(0)
    v_mfma_f32_16x16x32_bf16 v[44:47], a[144:147], v[112:115], v[44:47]
    s_barrier
    v_mfma_f32_16x16x32_bf16 v[44:47], a[148:151], v[116:119], v[44:47]
    ds_read_b128 a[128:131], v4 offset:12288
    v_mfma_f32_16x16x32_bf16 v[44:47], a[152:155], v[120:123], v[44:47]
    s_add_u32 m0, s18, 73728
    ds_read_b128 a[132:135], v4 offset:21504
    v_mfma_f32_16x16x32_bf16 v[44:47], a[156:159], v[124:127], v[44:47]
    v_mfma_f32_16x16x32_bf16 v[252:255], a[144:147], v[128:131], v[252:255]
    ds_read_b128 a[136:139], v4 offset:30720
    v_mfma_f32_16x16x32_bf16 v[252:255], a[148:151], v[132:135], v[252:255]
    ds_read_b128 a[140:143], v4 offset:39936
    v_mfma_f32_16x16x32_bf16 v[252:255], a[152:155], v[136:139], v[252:255]
    buffer_load_dwordx4 a[116:119], v1, s[48:51], s39 offen offset:1024 sc1
    v_mfma_f32_16x16x32_bf16 v[252:255], a[156:159], v[140:143], v[252:255]
    s_waitcnt lgkmcnt(4)
    buffer_load_dwordx4 v1, s[4:7], s20 offen offset:0 sc1 lds
    v_mfma_f32_16x16x32_bf16 v[144:147], a[160:163], v[112:115], v[144:147]
    ds_read_b128 a[144:147], v4 offset:13312
    v_mfma_f32_16x16x32_bf16 v[144:147], a[164:167], v[116:119], v[144:147]
    ds_read_b128 a[148:151], v4 offset:22528
    v_mfma_f32_16x16x32_bf16 v[144:147], a[168:171], v[120:123], v[144:147]
    v_mfma_f32_16x16x32_bf16 v[144:147], a[172:175], v[124:127], v[144:147]
    buffer_load_dwordx4 v1, s[4:7], s20 offen offset:1024 sc1 lds
    ds_read_b128 a[152:155], v4 offset:31744
    v_mfma_f32_16x16x32_bf16 v[148:151], a[160:163], v[128:131], v[148:151]
    v_mfma_f32_16x16x32_bf16 v[148:151], a[164:167], v[132:135], v[148:151]
    ds_read_b128 a[156:159], v4 offset:40960
    v_mfma_f32_16x16x32_bf16 v[148:151], a[168:171], v[136:139], v[148:151]
    v_mfma_f32_16x16x32_bf16 v[148:151], a[172:175], v[140:143], v[148:151]
    s_waitcnt lgkmcnt(4)
    v_mfma_f32_16x16x32_bf16 v[16:19], a[128:131], a[0:3], v[16:19]
    buffer_load_dwordx4 v1, s[4:7], s20 offen offset:2048 sc1 lds
    ds_read_b128 a[160:163], v4 offset:14336
    v_mfma_f32_16x16x32_bf16 v[16:19], a[132:135], a[4:7], v[16:19]
    buffer_load_dwordx4 a[120:123], v1, s[48:51], s39 offen offset:2048 sc1
    ds_read_b128 a[164:167], v4 offset:23552
    v_mfma_f32_16x16x32_bf16 v[16:19], a[136:139], a[8:11], v[16:19]
    v_mfma_f32_16x16x32_bf16 v[16:19], a[140:143], a[12:15], v[16:19]
    ds_read_b128 a[168:171], v4 offset:32768
    v_mfma_f32_16x16x32_bf16 v[224:227], a[128:131], a[16:19], v[224:227]
    v_mfma_f32_16x16x32_bf16 v[224:227], a[132:135], a[20:23], v[224:227]
    s_add_u32 s20, s20, 3072
    ds_read_b128 a[172:175], v4 offset:41984
    v_mfma_f32_16x16x32_bf16 v[224:227], a[136:139], a[24:27], v[224:227]
    v_mfma_f32_16x16x32_bf16 v[224:227], a[140:143], a[28:31], v[224:227]
    s_waitcnt lgkmcnt(4)
    v_mfma_f32_16x16x32_bf16 v[20:23], a[144:147], a[0:3], v[20:23]
    ds_read_b128 a[128:131], v4 offset:15360
    v_mfma_f32_16x16x32_bf16 v[20:23], a[148:151], a[4:7], v[20:23]
    ds_read_b128 a[132:135], v4 offset:24576
    v_mfma_f32_16x16x32_bf16 v[20:23], a[152:155], a[8:11], v[20:23]
    s_add_u32 m0, s18, 76800
    v_mfma_f32_16x16x32_bf16 v[20:23], a[156:159], a[12:15], v[20:23]
    buffer_load_dwordx4 a[124:127], v1, s[48:51], s39 offen offset:3072 sc1
    ds_read_b128 a[136:139], v4 offset:33792
    v_mfma_f32_16x16x32_bf16 v[228:231], a[144:147], a[16:19], v[228:231]
    s_waitcnt vmcnt(11)
    v_mfma_f32_16x16x32_bf16 v[228:231], a[148:151], a[20:23], v[228:231]
    ds_read_b128 a[140:143], v4 offset:43008
    v_mfma_f32_16x16x32_bf16 v[228:231], a[152:155], a[24:27], v[228:231]
    v_mov_b32 v8, 3
    v_mfma_f32_16x16x32_bf16 v[228:231], a[156:159], a[28:31], v[228:231]
    s_waitcnt lgkmcnt(4)
    buffer_load_dwordx4 v1, s[4:7], s20 offen offset:0 sc1 lds
    v_mfma_f32_16x16x32_bf16 v[24:27], a[160:163], a[0:3], v[24:27]
    buffer_store_dword v8, v219, s[88:91], s16 offen sc1
    ds_read_b128 a[144:147], v4 offset:16384
    v_mfma_f32_16x16x32_bf16 v[24:27], a[164:167], a[4:7], v[24:27]
    ds_read_b128 a[148:151], v4 offset:25600
    v_mfma_f32_16x16x32_bf16 v[24:27], a[168:171], a[8:11], v[24:27]
    v_mfma_f32_16x16x32_bf16 v[24:27], a[172:175], a[12:15], v[24:27]
    ds_read_b128 a[152:155], v4 offset:34816
    v_mfma_f32_16x16x32_bf16 v[232:235], a[160:163], a[16:19], v[232:235]
    buffer_load_dwordx4 v1, s[4:7], s20 offen offset:1024 sc1 lds
    v_mfma_f32_16x16x32_bf16 v[232:235], a[164:167], a[20:23], v[232:235]
    ds_read_b128 a[156:159], v4 offset:44032
    v_mfma_f32_16x16x32_bf16 v[232:235], a[168:171], a[24:27], v[232:235]
    s_add_u32 s38, s38, 4096
    v_mfma_f32_16x16x32_bf16 v[232:235], a[172:175], a[28:31], v[232:235]
    s_waitcnt lgkmcnt(4)
    v_mfma_f32_16x16x32_bf16 v[28:31], a[128:131], a[0:3], v[28:31]
    buffer_load_dwordx4 v1, s[4:7], s20 offen offset:2048 sc1 lds
    ds_read_b128 a[160:163], v4 offset:17408
    v_mfma_f32_16x16x32_bf16 v[28:31], a[132:135], a[4:7], v[28:31]
    ds_read_b128 a[164:167], v4 offset:26624
    v_mfma_f32_16x16x32_bf16 v[28:31], a[136:139], a[8:11], v[28:31]
    v_mfma_f32_16x16x32_bf16 v[28:31], a[140:143], a[12:15], v[28:31]
    ds_read_b128 a[168:171], v4 offset:35840
    v_mfma_f32_16x16x32_bf16 v[236:239], a[128:131], a[16:19], v[236:239]
    v_mfma_f32_16x16x32_bf16 v[236:239], a[132:135], a[20:23], v[236:239]
    s_add_u32 s20, s20, 3072
    ds_read_b128 a[172:175], v4 offset:45056
    v_mfma_f32_16x16x32_bf16 v[236:239], a[136:139], a[24:27], v[236:239]
    v_mfma_f32_16x16x32_bf16 v[236:239], a[140:143], a[28:31], v[236:239]
    s_waitcnt lgkmcnt(4)
    v_mfma_f32_16x16x32_bf16 v[32:35], a[144:147], a[0:3], v[32:35]
    buffer_load_dwordx4 v[80:83], v1, s[48:51], s38 offen offset:0 sc1
    ds_read_b128 a[128:131], v4 offset:18432
    v_mfma_f32_16x16x32_bf16 v[32:35], a[148:151], a[4:7], v[32:35]
    ds_read_b128 a[132:135], v4 offset:27648
    v_mfma_f32_16x16x32_bf16 v[32:35], a[152:155], a[8:11], v[32:35]
    s_add_u32 m0, s18, 79872
    v_mfma_f32_16x16x32_bf16 v[32:35], a[156:159], a[12:15], v[32:35]
    ds_read_b128 a[136:139], v4 offset:36864
    v_mfma_f32_16x16x32_bf16 v[240:243], a[144:147], a[16:19], v[240:243]
    v_mfma_f32_16x16x32_bf16 v[240:243], a[148:151], a[20:23], v[240:243]
    ds_read_b128 a[140:143], v4 offset:46080
    v_mfma_f32_16x16x32_bf16 v[240:243], a[152:155], a[24:27], v[240:243]
    v_mfma_f32_16x16x32_bf16 v[240:243], a[156:159], a[28:31], v[240:243]
    s_waitcnt lgkmcnt(4)
    buffer_load_dwordx4 v1, s[4:7], s20 offen offset:0 sc1 lds
    v_mfma_f32_16x16x32_bf16 v[36:39], a[160:163], a[0:3], v[36:39]
    ds_read_b128 a[144:147], v4 offset:19456
    v_mfma_f32_16x16x32_bf16 v[36:39], a[164:167], a[4:7], v[36:39]
    ds_read_b128 a[148:151], v4 offset:28672
    v_mfma_f32_16x16x32_bf16 v[36:39], a[168:171], a[8:11], v[36:39]
    buffer_load_dwordx4 v[84:87], v1, s[48:51], s38 offen offset:1024 sc1
    v_mfma_f32_16x16x32_bf16 v[36:39], a[172:175], a[12:15], v[36:39]
    ds_read_b128 a[152:155], v4 offset:37888
    v_mfma_f32_16x16x32_bf16 v[244:247], a[160:163], a[16:19], v[244:247]
    buffer_load_dwordx4 v1, s[4:7], s20 offen offset:1024 sc1 lds
    v_mfma_f32_16x16x32_bf16 v[244:247], a[164:167], a[20:23], v[244:247]
    ds_read_b128 a[156:159], v4 offset:47104
    v_mfma_f32_16x16x32_bf16 v[244:247], a[168:171], a[24:27], v[244:247]
    v_mfma_f32_16x16x32_bf16 v[244:247], a[172:175], a[28:31], v[244:247]
    s_waitcnt lgkmcnt(4)
    v_mfma_f32_16x16x32_bf16 v[40:43], a[128:131], a[0:3], v[40:43]
    ds_read_b128 a[160:163], v4 offset:20480
    v_mfma_f32_16x16x32_bf16 v[40:43], a[132:135], a[4:7], v[40:43]
    buffer_load_dwordx4 v1, s[4:7], s20 offen offset:2048 sc1 lds
    ds_read_b128 a[164:167], v4 offset:29696
    v_mfma_f32_16x16x32_bf16 v[40:43], a[136:139], a[8:11], v[40:43]
    ds_read_b128 a[168:171], v4 offset:38912
    v_mfma_f32_16x16x32_bf16 v[40:43], a[140:143], a[12:15], v[40:43]
    ds_read_b128 a[172:175], v4 offset:48128
    v_mfma_f32_16x16x32_bf16 v[248:251], a[128:131], a[16:19], v[248:251]
    v_mfma_f32_16x16x32_bf16 v[248:251], a[132:135], a[20:23], v[248:251]
    buffer_load_dwordx4 v[88:91], v1, s[48:51], s38 offen offset:2048 sc1
    v_mfma_f32_16x16x32_bf16 v[248:251], a[136:139], a[24:27], v[248:251]
    s_add_u32 s20, s20, 30720
    v_mfma_f32_16x16x32_bf16 v[248:251], a[140:143], a[28:31], v[248:251]
    s_waitcnt lgkmcnt(0)
    v_mfma_f32_16x16x32_bf16 v[44:47], a[144:147], a[0:3], v[44:47]
    s_barrier
    v_mfma_f32_16x16x32_bf16 v[44:47], a[148:151], a[4:7], v[44:47]
    ds_read_b128 a[128:131], v1 offset:0
    v_mfma_f32_16x16x32_bf16 v[44:47], a[152:155], a[8:11], v[44:47]
    ds_read_b128 a[132:135], v1 offset:9216
    v_mfma_f32_16x16x32_bf16 v[44:47], a[156:159], a[12:15], v[44:47]
    s_add_u32 m0, s18, 110592
    v_mfma_f32_16x16x32_bf16 v[252:255], a[144:147], a[16:19], v[252:255]
    ds_read_b128 a[136:139], v1 offset:18432
    v_mfma_f32_16x16x32_bf16 v[252:255], a[148:151], a[20:23], v[252:255]
    ds_read_b128 a[140:143], v1 offset:27648
    v_mfma_f32_16x16x32_bf16 v[252:255], a[152:155], a[24:27], v[252:255]
    v_mfma_f32_16x16x32_bf16 v[252:255], a[156:159], a[28:31], v[252:255]
    s_waitcnt lgkmcnt(4)
    buffer_load_dwordx4 v[92:95], v1, s[48:51], s38 offen offset:3072 sc1
    v_mfma_f32_16x16x32_bf16 v[144:147], a[160:163], a[0:3], v[144:147]
    buffer_load_dwordx4 v1, s[4:7], s20 offen offset:0 sc1 lds
    ds_read_b128 a[144:147], v1 offset:1024
    v_mfma_f32_16x16x32_bf16 v[144:147], a[164:167], a[4:7], v[144:147]
    ds_read_b128 a[148:151], v1 offset:10240
    v_mfma_f32_16x16x32_bf16 v[144:147], a[168:171], a[8:11], v[144:147]
    v_mfma_f32_16x16x32_bf16 v[144:147], a[172:175], a[12:15], v[144:147]
    ds_read_b128 a[152:155], v1 offset:19456
    v_mfma_f32_16x16x32_bf16 v[148:151], a[160:163], a[16:19], v[148:151]
    buffer_load_dwordx4 v1, s[4:7], s20 offen offset:1024 sc1 lds
    v_mfma_f32_16x16x32_bf16 v[148:151], a[164:167], a[20:23], v[148:151]
    ds_read_b128 a[156:159], v1 offset:28672
    v_mfma_f32_16x16x32_bf16 v[148:151], a[168:171], a[24:27], v[148:151]
    v_mfma_f32_16x16x32_bf16 v[148:151], a[172:175], a[28:31], v[148:151]
    s_waitcnt lgkmcnt(4)
    v_mfma_f32_16x16x32_bf16 v[16:19], a[128:131], a[32:35], v[16:19]
    s_lshr_b32 s22, s45, 1
    ds_read_b128 a[160:163], v1 offset:2048
    v_mfma_f32_16x16x32_bf16 v[16:19], a[132:135], a[36:39], v[16:19]
    s_and_b32 s23, s45, 1
    buffer_load_dwordx4 v1, s[4:7], s20 offen offset:2048 sc1 lds
    ds_read_b128 a[164:167], v1 offset:11264
    v_mfma_f32_16x16x32_bf16 v[16:19], a[136:139], a[40:43], v[16:19]
    s_add_u32 s39, s39, 4096
    v_mfma_f32_16x16x32_bf16 v[16:19], a[140:143], a[44:47], v[16:19]
    s_mul_i32 s22, s22, 9216
    ds_read_b128 a[168:171], v1 offset:20480
    v_mfma_f32_16x16x32_bf16 v[224:227], a[128:131], a[48:51], v[224:227]
    s_and_b32 s28, s3, 1
    v_mfma_f32_16x16x32_bf16 v[224:227], a[132:135], a[52:55], v[224:227]
    ds_read_b128 a[172:175], v1 offset:29696
    v_mfma_f32_16x16x32_bf16 v[224:227], a[136:139], a[56:59], v[224:227]
    s_add_u32 s20, s20, 3072
    s_mul_i32 s28, s28, 36864
    v_mfma_f32_16x16x32_bf16 v[224:227], a[140:143], a[60:63], v[224:227]
    s_waitcnt lgkmcnt(4)
    s_add_u32 s22, s22, s28
    v_mfma_f32_16x16x32_bf16 v[20:23], a[144:147], a[32:35], v[20:23]
    ds_read_b128 a[128:131], v1 offset:3072
    v_mfma_f32_16x16x32_bf16 v[20:23], a[148:151], a[36:39], v[20:23]
    s_mul_i32 s28, s44, 147456
    ds_read_b128 a[132:135], v1 offset:12288
    v_mfma_f32_16x16x32_bf16 v[20:23], a[152:155], a[40:43], v[20:23]
    s_add_u32 s28, s28, s64
    buffer_load_dword v9, v7, s[88:91], s17 offen sc1
    v_mfma_f32_16x16x32_bf16 v[20:23], a[156:159], a[44:47], v[20:23]
    s_add_u32 m0, s18, 113664
    ds_read_b128 a[136:139], v1 offset:21504
    v_mfma_f32_16x16x32_bf16 v[228:231], a[144:147], a[48:51], v[228:231]
    s_add_u32 s28, s28, 0x120000
    buffer_load_dwordx4 v[96:99], v1, s[48:51], s39 offen offset:0 sc1
    v_mfma_f32_16x16x32_bf16 v[228:231], a[148:151], a[52:55], v[228:231]
    s_lshl_b32 s30, s23, 9
    ds_read_b128 a[140:143], v1 offset:30720
    v_mfma_f32_16x16x32_bf16 v[228:231], a[152:155], a[56:59], v[228:231]
    v_mfma_f32_16x16x32_bf16 v[228:231], a[156:159], a[60:63], v[228:231]
    s_waitcnt lgkmcnt(4)
    s_add_u32 s30, s30, s22
    v_mfma_f32_16x16x32_bf16 v[24:27], a[160:163], a[32:35], v[24:27]
    s_add_u32 s30, s30, 4096
    buffer_load_dwordx4 v1, s[4:7], s20 offen offset:0 sc1 lds
    ds_read_b128 a[144:147], v1 offset:4096
    v_mfma_f32_16x16x32_bf16 v[24:27], a[164:167], a[36:39], v[24:27]
    ds_read_b128 a[148:151], v1 offset:13312
    v_mfma_f32_16x16x32_bf16 v[24:27], a[168:171], a[40:43], v[24:27]
    s_add_u32 s29, s30, 18432
    v_mfma_f32_16x16x32_bf16 v[24:27], a[172:175], a[44:47], v[24:27]
    ds_read_b128 a[152:155], v1 offset:22528
    v_mfma_f32_16x16x32_bf16 v[232:235], a[160:163], a[48:51], v[232:235]
    s_and_b32 s15, s30, 0xffffe000
    v_mfma_f32_16x16x32_bf16 v[232:235], a[164:167], a[52:55], v[232:235]
    s_add_u32 s30, s30, s15
    buffer_load_dwordx4 v1, s[4:7], s20 offen offset:1024 sc1 lds
    ds_read_b128 a[156:159], v1 offset:31744
    v_mfma_f32_16x16x32_bf16 v[232:235], a[168:171], a[56:59], v[232:235]
    buffer_load_dwordx4 v[100:103], v1, s[48:51], s39 offen offset:1024 sc1
    v_mfma_f32_16x16x32_bf16 v[232:235], a[172:175], a[60:63], v[232:235]
    s_waitcnt lgkmcnt(4)
    s_and_b32 s15, s29, 0xffffe000
    v_mfma_f32_16x16x32_bf16 v[28:31], a[128:131], a[32:35], v[28:31]
    s_add_u32 s29, s29, s15
    ds_read_b128 a[160:163], v1 offset:5120
    v_mfma_f32_16x16x32_bf16 v[28:31], a[132:135], a[36:39], v[28:31]
    buffer_load_dwordx4 v1, s[4:7], s20 offen offset:2048 sc1 lds
    ds_read_b128 a[164:167], v1 offset:14336
    v_mfma_f32_16x16x32_bf16 v[28:31], a[136:139], a[40:43], v[28:31]
    v_mul_u32_u24 v5, 294912, v11
    v_mfma_f32_16x16x32_bf16 v[28:31], a[140:143], a[44:47], v[28:31]
    ds_read_b128 a[168:171], v1 offset:23552
    v_sub_u32 v5, v10, v5
    v_mfma_f32_16x16x32_bf16 v[236:239], a[128:131], a[48:51], v[236:239]
    v_mfma_f32_16x16x32_bf16 v[236:239], a[132:135], a[52:55], v[236:239]
    ds_read_b128 a[172:175], v1 offset:32768
    v_lshl_add_u32 v5, v11, 30, v5
    v_mfma_f32_16x16x32_bf16 v[236:239], a[136:139], a[56:59], v[236:239]
    s_add_u32 s20, s20, 3072
    s_add_u32 s29, s29, s28
    v_mfma_f32_16x16x32_bf16 v[236:239], a[140:143], a[60:63], v[236:239]
    s_waitcnt lgkmcnt(4)
    v_mfma_f32_16x16x32_bf16 v[32:35], a[144:147], a[32:35], v[32:35]
    s_add_u32 s30, s30, s28
    ds_read_b128 a[128:131], v1 offset:6144
    v_mfma_f32_16x16x32_bf16 v[32:35], a[148:151], a[36:39], v[32:35]
    s_mul_i32 s23, s23, 5120
    buffer_load_dwordx4 v[104:107], v1, s[48:51], s39 offen offset:2048 sc1
    ds_read_b128 a[132:135], v1 offset:15360
    v_mfma_f32_16x16x32_bf16 v[32:35], a[152:155], a[40:43], v[32:35]
    v_mfma_f32_16x16x32_bf16 v[32:35], a[156:159], a[44:47], v[32:35]
    s_add_u32 m0, s18, 116736
    s_add_u32 s22, s22, s23
    ds_read_b128 a[136:139], v1 offset:24576
    v_mfma_f32_16x16x32_bf16 v[240:243], a[144:147], a[48:51], v[240:243]
    v_mfma_f32_16x16x32_bf16 v[240:243], a[148:151], a[52:55], v[240:243]
    s_add_u32 s68, s22, 0
    ds_read_b128 a[140:143], v1 offset:33792
    v_mfma_f32_16x16x32_bf16 v[240:243], a[152:155], a[56:59], v[240:243]
    s_and_b32 s15, s68, 0xffffe000
    v_mfma_f32_16x16x32_bf16 v[240:243], a[156:159], a[60:63], v[240:243]
    s_waitcnt lgkmcnt(4)
    v_mfma_f32_16x16x32_bf16 v[36:39], a[160:163], a[32:35], v[36:39]
    s_add_u32 s68, s68, s15
    buffer_load_dwordx4 v1, s[4:7], s20 offen offset:0 sc1 lds
    ds_read_b128 a[144:147], v1 offset:7168
    v_mfma_f32_16x16x32_bf16 v[36:39], a[164:167], a[36:39], v[36:39]
    s_add_u32 s68, s68, s28
    ds_read_b128 a[148:151], v1 offset:16384
    v_mfma_f32_16x16x32_bf16 v[36:39], a[168:171], a[40:43], v[36:39]
    v_mfma_f32_16x16x32_bf16 v[36:39], a[172:175], a[44:47], v[36:39]
    s_add_u32 s69, s22, 18432
    buffer_load_dwordx4 v[108:111], v1, s[48:51], s39 offen offset:3072 sc1
    ds_read_b128 a[152:155], v1 offset:25600
    v_mfma_f32_16x16x32_bf16 v[244:247], a[160:163], a[48:51], v[244:247]
    s_and_b32 s15, s69, 0xffffe000
    v_mfma_f32_16x16x32_bf16 v[244:247], a[164:167], a[52:55], v[244:247]
    buffer_load_dwordx4 v1, s[4:7], s20 offen offset:1024 sc1 lds
    ds_read_b128 a[156:159], v1 offset:34816
    v_mfma_f32_16x16x32_bf16 v[244:247], a[168:171], a[56:59], v[244:247]
    s_add_u32 s69, s69, s15
    v_mfma_f32_16x16x32_bf16 v[244:247], a[172:175], a[60:63], v[244:247]
    s_waitcnt lgkmcnt(4)
    s_add_u32 s69, s69, s28
    v_mfma_f32_16x16x32_bf16 v[40:43], a[128:131], a[32:35], v[40:43]
    ds_read_b128 a[160:163], v1 offset:8192
    v_mfma_f32_16x16x32_bf16 v[40:43], a[132:135], a[36:39], v[40:43]
    s_add_u32 s70, s22, 1024
    ds_read_b128 a[164:167], v1 offset:17408
    v_mfma_f32_16x16x32_bf16 v[40:43], a[136:139], a[40:43], v[40:43]
    s_and_b32 s15, s70, 0xffffe000
    buffer_load_dwordx4 v1, s[4:7], s20 offen offset:2048 sc1 lds
    ds_read_b128 a[168:171], v1 offset:26624
    v_mfma_f32_16x16x32_bf16 v[40:43], a[140:143], a[44:47], v[40:43]
    ds_read_b128 a[172:175], v1 offset:35840
    s_waitcnt vmcnt(10)
    v_cmp_gt_u32 vcc, 3, v9
    v_mfma_f32_16x16x32_bf16 v[248:251], a[128:131], a[48:51], v[248:251]
    s_add_u32 s70, s70, s15
    v_mfma_f32_16x16x32_bf16 v[248:251], a[132:135], a[52:55], v[248:251]
    s_cbranch_vccnz spin13
back13:
    v_mfma_f32_16x16x32_bf16 v[248:251], a[136:139], a[56:59], v[248:251]
    s_add_u32 s70, s70, s28
    v_mfma_f32_16x16x32_bf16 v[248:251], a[140:143], a[60:63], v[248:251]
    s_waitcnt lgkmcnt(0)
    s_add_u32 s20, s20, 30720
    s_add_u32 s71, s22, 19456
    v_mfma_f32_16x16x32_bf16 v[44:47], a[144:147], a[32:35], v[44:47]
    s_barrier
    v_mfma_f32_16x16x32_bf16 v[44:47], a[148:151], a[36:39], v[44:47]
    s_add_u32 s38, s38, 12288
    s_and_b32 s15, s71, 0xffffe000
    ds_read_b128 a[128:131], v1 offset:36864
    v_mfma_f32_16x16x32_bf16 v[44:47], a[152:155], a[40:43], v[44:47]
    s_add_u32 s71, s71, s15
    ds_read_b128 a[132:135], v1 offset:46080
    v_mfma_f32_16x16x32_bf16 v[44:47], a[156:159], a[44:47], v[44:47]
    v_mfma_f32_16x16x32_bf16 v[252:255], a[144:147], a[48:51], v[252:255]
    s_add_u32 m0, s18, 0
    s_add_u32 s71, s71, s28
    ds_read_b128 a[136:139], v3 offset:6144
    v_mfma_f32_16x16x32_bf16 v[252:255], a[148:151], a[52:55], v[252:255]
    s_add_u32 s72, s22, 2048
    ds_read_b128 a[140:143], v3 offset:15360
    v_mfma_f32_16x16x32_bf16 v[252:255], a[152:155], a[56:59], v[252:255]
    v_mfma_f32_16x16x32_bf16 v[252:255], a[156:159], a[60:63], v[252:255]
    s_waitcnt lgkmcnt(4)
    s_and_b32 s15, s72, 0xffffe000
    v_mfma_f32_16x16x32_bf16 v[144:147], a[160:163], a[32:35], v[144:147]
    s_add_u32 s72, s72, s15
    buffer_load_dwordx4 v1, s[4:7], s20 offen offset:0 sc1 lds
    ds_read_b128 a[144:147], v1 offset:37888
    v_mfma_f32_16x16x32_bf16 v[144:147], a[164:167], a[36:39], v[144:147]
    buffer_load_dwordx4 v[112:115], v1, s[48:51], s38 offen offset:0 sc1
    ds_read_b128 a[148:151], v1 offset:47104
    v_mfma_f32_16x16x32_bf16 v[144:147], a[168:171], a[40:43], v[144:147]
    s_add_u32 s72, s72, s28
    v_mfma_f32_16x16x32_bf16 v[144:147], a[172:175], a[44:47], v[144:147]
    s_add_u32 s73, s22, 20480
    ds_read_b128 a[152:155], v3 offset:7168
    v_mfma_f32_16x16x32_bf16 v[148:151], a[160:163], a[48:51], v[148:151]
    v_mfma_f32_16x16x32_bf16 v[148:151], a[164:167], a[52:55], v[148:151]
    s_and_b32 s15, s73, 0xffffe000
    buffer_load_dwordx4 v1, s[4:7], s20 offen offset:1024 sc1 lds
    ds_read_b128 a[156:159], v3 offset:16384
    v_mfma_f32_16x16x32_bf16 v[148:151], a[168:171], a[56:59], v[148:151]
    s_add_u32 s73, s73, s15
    v_mfma_f32_16x16x32_bf16 v[148:151], a[172:175], a[60:63], v[148:151]
    s_waitcnt lgkmcnt(4)
    v_mfma_f32_16x16x32_bf16 v[16:19], a[128:131], a[64:67], v[16:19]
    s_add_u32 s73, s73, s28
    ds_read_b128 a[160:163], v1 offset:38912
    v_mfma_f32_16x16x32_bf16 v[16:19], a[132:135], a[68:71], v[16:19]
    ds_read_b128 a[164:167], v1 offset:48128
    v_mfma_f32_16x16x32_bf16 v[16:19], a[136:139], a[72:75], v[16:19]
    s_add_u32 s74, s22, 3072
    buffer_load_dwordx4 v[116:119], v1, s[48:51], s38 offen offset:1024 sc1
    v_mfma_f32_16x16x32_bf16 v[16:19], a[140:143], a[76:79], v[16:19]
    s_and_b32 s15, s74, 0xffffe000
    buffer_load_dwordx4 v1, s[4:7], s20 offen offset:2048 sc1 lds
    ds_read_b128 a[168:171], v3 offset:8192
    v_mfma_f32_16x16x32_bf16 v[224:227], a[128:131], a[80:83], v[224:227]
    v_mfma_f32_16x16x32_bf16 v[224:227], a[132:135], a[84:87], v[224:227]
    s_add_u32 s74, s74, s15
    ds_read_b128 a[172:175], v3 offset:17408
    v_mfma_f32_16x16x32_bf16 v[224:227], a[136:139], a[88:91], v[224:227]
    s_add_u32 s74, s74, s28
    v_mfma_f32_16x16x32_bf16 v[224:227], a[140:143], a[92:95], v[224:227]
    s_waitcnt lgkmcnt(4)
    s_add_u32 s20, s20, 3072
    v_mfma_f32_16x16x32_bf16 v[20:23], a[144:147], a[64:67], v[20:23]
    s_add_u32 s75, s22, 21504
    ds_read_b128 a[128:131], v1 offset:39936
    v_mfma_f32_16x16x32_bf16 v[20:23], a[148:151], a[68:71], v[20:23]
    s_and_b32 s15, s75, 0xffffe000
    ds_read_b128 a[132:135], v3 offset:0
    v_mfma_f32_16x16x32_bf16 v[20:23], a[152:155], a[72:75], v[20:23]
    v_mfma_f32_16x16x32_bf16 v[20:23], a[156:159], a[76:79], v[20:23]
    s_add_u32 s75, s75, s15
    buffer_load_dwordx4 v[120:123], v1, s[48:51], s38 offen offset:2048 sc1
    ds_read_b128 a[136:139], v3 offset:9216
    v_mfma_f32_16x16x32_bf16 v[228:231], a[144:147], a[80:83], v[228:231]
    s_add_u32 m0, s18, 3072
    s_add_u32 s75, s75, s28
    v_mfma_f32_16x16x32_bf16 v[228:231], a[148:151], a[84:87], v[228:231]
    ds_read_b128 a[140:143], v3 offset:18432
    v_mfma_f32_16x16x32_bf16 v[228:231], a[152:155], a[88:91], v[228:231]
    s_and_b32 s22, s46, 31
    v_mfma_f32_16x16x32_bf16 v[228:231], a[156:159], a[92:95], v[228:231]
    s_waitcnt lgkmcnt(4)
    s_lshl_b32 s22, s22, 4
    v_mfma_f32_16x16x32_bf16 v[24:27], a[160:163], a[64:67], v[24:27]
    ds_read_b128 a[144:147], v1 offset:40960
    v_mfma_f32_16x16x32_bf16 v[24:27], a[164:167], a[68:71], v[24:27]
    s_add_u32 s22, s22, s47
    buffer_load_dwordx4 v1, s[4:7], s20 offen offset:0 sc1 lds
    ds_read_b128 a[148:151], v3 offset:1024
    v_mfma_f32_16x16x32_bf16 v[24:27], a[168:171], a[72:75], v[24:27]
    v_mfma_f32_16x16x32_bf16 v[24:27], a[172:175], a[76:79], v[24:27]
    s_mul_i32 s22, s22, 128
    ds_read_b128 a[152:155], v3 offset:10240
    v_mfma_f32_16x16x32_bf16 v[232:235], a[160:163], a[80:83], v[232:235]
    s_and_b32 s15, s22, 0xffffe000
    buffer_load_dwordx4 v[124:127], v1, s[48:51], s38 offen offset:3072 sc1
    v_mfma_f32_16x16x32_bf16 v[232:235], a[164:167], a[84:87], v[232:235]
    ds_read_b128 a[156:159], v3 offset:19456
    v_mfma_f32_16x16x32_bf16 v[232:235], a[168:171], a[88:91], v[232:235]
    s_add_u32 s22, s22, s15
    buffer_load_dwordx4 v1, s[4:7], s20 offen offset:1024 sc1 lds
    v_mfma_f32_16x16x32_bf16 v[232:235], a[172:175], a[92:95], v[232:235]
    s_waitcnt lgkmcnt(4)
    s_add_u32 s22, s22, 458752
    v_mfma_f32_16x16x32_bf16 v[28:31], a[128:131], a[64:67], v[28:31]
    ds_read_b128 a[160:163], v1 offset:41984
    v_mfma_f32_16x16x32_bf16 v[28:31], a[132:135], a[68:71], v[28:31]
    s_add_u32 s22, s22, s66
    ds_read_b128 a[164:167], v3 offset:2048
    v_mfma_f32_16x16x32_bf16 v[28:31], a[136:139], a[72:75], v[28:31]
    s_lshl_b32 s26, s8, 5
    buffer_load_dwordx4 v1, s[4:7], s20 offen offset:2048 sc1 lds
    v_mfma_f32_16x16x32_bf16 v[28:31], a[140:143], a[76:79], v[28:31]
    ds_read_b128 a[168:171], v3 offset:11264
    v_mfma_f32_16x16x32_bf16 v[236:239], a[128:131], a[80:83], v[236:239]
    s_add_u32 s26, s26, s9
    v_mfma_f32_16x16x32_bf16 v[236:239], a[132:135], a[84:87], v[236:239]
    s_add_u32 s39, s39, 12288
    s_bfe_u32 s25, s26, 0x50002
    ds_read_b128 a[172:175], v3 offset:20480
    v_mfma_f32_16x16x32_bf16 v[236:239], a[136:139], a[88:91], v[236:239]
    v_mfma_f32_16x16x32_bf16 v[236:239], a[140:143], a[92:95], v[236:239]
    s_waitcnt lgkmcnt(4)
    s_add_u32 s20, s20, 3072
    s_mul_i32 s25, s25, 2048
    v_mfma_f32_16x16x32_bf16 v[32:35], a[144:147], a[64:67], v[32:35]
    s_and_b32 s15, s25, 0xffffe000
    ds_read_b128 a[128:131], v1 offset:43008
    v_mfma_f32_16x16x32_bf16 v[32:35], a[148:151], a[68:71], v[32:35]
    ds_read_b128 a[132:135], v3 offset:3072
    v_mfma_f32_16x16x32_bf16 v[32:35], a[152:155], a[72:75], v[32:35]
    s_add_u32 s25, s25, s15
    v_mfma_f32_16x16x32_bf16 v[32:35], a[156:159], a[76:79], v[32:35]
    ds_read_b128 a[136:139], v3 offset:12288
    v_mfma_f32_16x16x32_bf16 v[240:243], a[144:147], a[80:83], v[240:243]
    s_add_u32 m0, s18, 6144
    s_add_u32 s25, s25, 458752
    v_mfma_f32_16x16x32_bf16 v[240:243], a[148:151], a[84:87], v[240:243]
    s_add_u32 s25, s25, s66
    ds_read_b128 a[140:143], v3 offset:21504
    v_mfma_f32_16x16x32_bf16 v[240:243], a[152:155], a[88:91], v[240:243]
    buffer_load_dwordx4 v[128:131], v1, s[48:51], s39 offen offset:0 sc1
    v_mfma_f32_16x16x32_bf16 v[240:243], a[156:159], a[92:95], v[240:243]
    s_waitcnt lgkmcnt(4)
    s_bfe_u32 s77, s26, 0x10001
    v_mfma_f32_16x16x32_bf16 v[36:39], a[160:163], a[64:67], v[36:39]
    s_add_u32 s77, s77, 1
    ds_read_b128 a[144:147], v1 offset:44032
    v_mfma_f32_16x16x32_bf16 v[36:39], a[164:167], a[68:71], v[36:39]
    buffer_load_dwordx4 v1, s[4:7], s20 offen offset:0 sc1 lds
    ds_read_b128 a[148:151], v3 offset:4096
    v_mfma_f32_16x16x32_bf16 v[36:39], a[168:171], a[72:75], v[36:39]
    s_and_b32 s76, s26, 0x79
    v_mfma_f32_16x16x32_bf16 v[36:39], a[172:175], a[76:79], v[36:39]
    s_bfe_u32 s15, s26, 0x10002
    ds_read_b128 a[152:155], v3 offset:13312
    v_mfma_f32_16x16x32_bf16 v[244:247], a[160:163], a[80:83], v[244:247]
    v_mfma_f32_16x16x32_bf16 v[244:247], a[164:167], a[84:87], v[244:247]
    s_lshl_b32 s15, s15, 1
    ds_read_b128 a[156:159], v3 offset:22528
    v_mfma_f32_16x16x32_bf16 v[244:247], a[168:171], a[88:91], v[244:247]
    s_add_u32 s76, s76, s15
    buffer_load_dwordx4 v1, s[4:7], s20 offen offset:1024 sc1 lds
    v_mfma_f32_16x16x32_bf16 v[244:247], a[172:175], a[92:95], v[244:247]
    s_waitcnt lgkmcnt(4)
    buffer_load_dwordx4 v[132:135], v1, s[48:51], s39 offen offset:1024 sc1
    v_mfma_f32_16x16x32_bf16 v[40:43], a[128:131], a[64:67], v[40:43]
    s_and_b32 s15, s26, 2
    ds_read_b128 a[160:163], v1 offset:45056
    v_mfma_f32_16x16x32_bf16 v[40:43], a[132:135], a[68:71], v[40:43]
    s_lshl_b32 s15, s15, 1
    ds_read_b128 a[164:167], v3 offset:5120
    v_mfma_f32_16x16x32_bf16 v[40:43], a[136:139], a[72:75], v[40:43]
    ds_read_b128 a[168:171], v3 offset:14336
    v_mfma_f32_16x16x32_bf16 v[40:43], a[140:143], a[76:79], v[40:43]
    s_add_u32 s76, s76, s15
    buffer_load_dwordx4 v1, s[4:7], s20 offen offset:2048 sc1 lds
    ds_read_b128 a[172:175], v3 offset:23552
    v_mfma_f32_16x16x32_bf16 v[248:251], a[128:131], a[80:83], v[248:251]
    v_mfma_f32_16x16x32_bf16 v[248:251], a[132:135], a[84:87], v[248:251]
    s_mul_i32 s76, s76, 32
    v_mfma_f32_16x16x32_bf16 v[248:251], a[136:139], a[88:91], v[248:251]
    s_add_u32 s76, s76, 622592
    v_mfma_f32_16x16x32_bf16 v[248:251], a[140:143], a[92:95], v[248:251]
    s_waitcnt lgkmcnt(0)
    v_mfma_f32_16x16x32_bf16 v[44:47], a[144:147], a[64:67], v[44:47]
    s_barrier
    v_mfma_f32_16x16x32_bf16 v[44:47], a[148:151], a[68:71], v[44:47]
    s_add_u32 s20, s20, 30720
    buffer_load_dwordx4 v[136:139], v1, s[48:51], s39 offen offset:2048 sc1
    ds_read_b128 a[128:131], v3 offset:24576
    v_mfma_f32_16x16x32_bf16 v[44:47], a[152:155], a[72:75], v[44:47]
    s_add_u32 s76, s76, s66
    s_lshr_b32 s24, s26, 3
    ds_read_b128 a[132:135], v3 offset:33792
    v_mfma_f32_16x16x32_bf16 v[44:47], a[156:159], a[76:79], v[44:47]
    s_and_b32 s15, s24, 15
    v_mfma_f32_16x16x32_bf16 v[252:255], a[144:147], a[80:83], v[252:255]
    s_lshr_b32 s31, s82, s15
    ds_read_b128 a[136:139], v3 offset:43008
    v_mfma_f32_16x16x32_bf16 v[252:255], a[148:151], a[84:87], v[252:255]
    s_add_u32 m0, s18, 36864
    ds_read_b128 a[140:143], v4 offset:3072
    v_mfma_f32_16x16x32_bf16 v[252:255], a[152:155], a[88:91], v[252:255]
    s_and_b32 s31, s31, 1
    v_mfma_f32_16x16x32_bf16 v[252:255], a[156:159], a[92:95], v[252:255]
    s_waitcnt lgkmcnt(4)
    s_lshl_b32 s31, s31, 13
    v_mfma_f32_16x16x32_bf16 v[144:147], a[160:163], a[64:67], v[144:147]
    ds_read_b128 a[144:147], v3 offset:25600
    v_mfma_f32_16x16x32_bf16 v[144:147], a[164:167], a[68:71], v[144:147]
    s_lshl_b32 s15, s15, 21
    buffer_load_dwordx4 v[140:143], v1, s[48:51], s39 offen offset:3072 sc1
    ds_read_b128 a[148:151], v3 offset:34816
    v_mfma_f32_16x16x32_bf16 v[144:147], a[168:171], a[72:75], v[144:147]
    s_add_u32 s31, s31, s15
    buffer_load_dwordx4 v1, s[4:7], s20 offen offset:0 sc1 lds
    v_mfma_f32_16x16x32_bf16 v[144:147], a[172:175], a[76:79], v[144:147]
    ds_read_b128 a[152:155], v3 offset:44032
    v_mfma_f32_16x16x32_bf16 v[148:151], a[160:163], a[80:83], v[148:151]
    s_bfe_u32 s23, s26, 0x20001
    v_mfma_f32_16x16x32_bf16 v[148:151], a[164:167], a[84:87], v[148:151]
    s_mul_i32 s23, s23, 18432
    ds_read_b128 a[156:159], v4 offset:4096
    v_mfma_f32_16x16x32_bf16 v[148:151], a[168:171], a[88:91], v[148:151]
    buffer_load_dwordx4 v1, s[4:7], s20 offen offset:1024 sc1 lds
    v_mfma_f32_16x16x32_bf16 v[148:151], a[172:175], a[92:95], v[148:151]
    s_waitcnt lgkmcnt(4)
    s_and_b32 s24, s26, 1
    v_mfma_f32_16x16x32_bf16 v[16:19], a[128:131], a[96:99], v[16:19]
    ds_read_b128 a[160:163], v3 offset:26624
    v_mfma_f32_16x16x32_bf16 v[16:19], a[132:135], a[100:103], v[16:19]
    s_lshl_b32 s24, s24, 7
    ds_read_b128 a[164:167], v3 offset:35840
    v_mfma_f32_16x16x32_bf16 v[16:19], a[136:139], a[104:107], v[16:19]
    s_add_u32 s23, s23, s24
    v_mfma_f32_16x16x32_bf16 v[16:19], a[140:143], a[108:111], v[16:19]
    s_add_u32 s38, s38, 4096
    buffer_load_dwordx4 v1, s[4:7], s20 offen offset:2048 sc1 lds
    ds_read_b128 a[168:171], v3 offset:45056
    v_mfma_f32_16x16x32_bf16 v[224:227], a[128:131], a[112:115], v[224:227]
    s_mul_i32 s24, s26, 9216
    v_mfma_f32_16x16x32_bf16 v[224:227], a[132:135], a[116:119], v[224:227]
    s_min_u32 s27, s3, 2
    ds_read_b128 a[172:175], v4 offset:5120
    v_mfma_f32_16x16x32_bf16 v[224:227], a[136:139], a[120:123], v[224:227]
    v_mfma_f32_16x16x32_bf16 v[224:227], a[140:143], a[124:127], v[224:227]
    s_waitcnt lgkmcnt(4)
    s_lshl_b32 s27, s27, 3
    v_mfma_f32_16x16x32_bf16 v[20:23], a[144:147], a[96:99], v[20:23]
    s_add_u32 s20, s20, 3072
    ds_read_b128 a[128:131], v3 offset:27648
    v_and_b32 v10, 7, v0
    v_mfma_f32_16x16x32_bf16 v[20:23], a[148:151], a[100:103], v[20:23]
    ds_read_b128 a[132:135], v3 offset:36864
    v_mfma_f32_16x16x32_bf16 v[20:23], a[152:155], a[104:107], v[20:23]
    v_lshrrev_b32 v11, 3, v0
    v_mfma_f32_16x16x32_bf16 v[20:23], a[156:159], a[108:111], v[20:23]
    ds_read_b128 a[136:139], v3 offset:46080
    v_add_u32 v11, s27, v11
    v_mfma_f32_16x16x32_bf16 v[228:231], a[144:147], a[112:115], v[228:231]
    buffer_load_dwordx4 a[0:3], v1, s[48:51], s38 offen offset:0 sc1
    v_mfma_f32_16x16x32_bf16 v[228:231], a[148:151], a[116:119], v[228:231]
    s_add_u32 m0, s18, 39936
    ds_read_b128 a[140:143], v4 offset:6144
    v_mul_u32_u24 v13, 16, v11
    v_mfma_f32_16x16x32_bf16 v[228:231], a[152:155], a[120:123], v[228:231]
    v_mul_u32_u24 v14, 1152, v10
    v_mfma_f32_16x16x32_bf16 v[228:231], a[156:159], a[124:127], v[228:231]
    s_waitcnt lgkmcnt(4)
    v_mfma_f32_16x16x32_bf16 v[24:27], a[160:163], a[96:99], v[24:27]
    ds_read_b128 a[144:147], v3 offset:28672
    v_add_u32 v13, v13, v14
    v_mfma_f32_16x16x32_bf16 v[24:27], a[164:167], a[100:103], v[24:27]
    ds_read_b128 a[148:151], v3 offset:37888
    v_mfma_f32_16x16x32_bf16 v[24:27], a[168:171], a[104:107], v[24:27]
    buffer_load_dwordx4 v1, s[4:7], s20 offen offset:0 sc1 lds
    v_mul_u32_u24 v218, 256, v11
    v_mfma_f32_16x16x32_bf16 v[24:27], a[172:175], a[108:111], v[24:27]
    ds_read_b128 a[152:155], v3 offset:47104
    v_lshl_add_u32 v218, v10, 4, v218
    v_mfma_f32_16x16x32_bf16 v[232:235], a[160:163], a[112:115], v[232:235]
    v_mfma_f32_16x16x32_bf16 v[232:235], a[164:167], a[116:119], v[232:235]
    buffer_load_dwordx4 a[4:7], v1, s[48:51], s38 offen offset:1024 sc1
    ds_read_b128 a[156:159], v4 offset:7168
    v_mfma_f32_16x16x32_bf16 v[232:235], a[168:171], a[120:123], v[232:235]
    v_add_u32 v218, s23, v218
    v_add_u32 v12, 6144, v218
    v_mfma_f32_16x16x32_bf16 v[232:235], a[172:175], a[124:127], v[232:235]
    s_waitcnt lgkmcnt(4)
    buffer_load_dwordx4 v1, s[4:7], s20 offen offset:1024 sc1 lds
    v_mfma_f32_16x16x32_bf16 v[28:31], a[128:131], a[96:99], v[28:31]
    ds_read_b128 a[160:163], v3 offset:29696
    v_add_u32 v15, 12288, v218
    v_mfma_f32_16x16x32_bf16 v[28:31], a[132:135], a[100:103], v[28:31]
    ds_read_b128 a[164:167], v3 offset:38912
    v_and_b32 v14, 0xffffe000, v218
    v_mfma_f32_16x16x32_bf16 v[28:31], a[136:139], a[104:107], v[28:31]
    v_mfma_f32_16x16x32_bf16 v[28:31], a[140:143], a[108:111], v[28:31]
    buffer_load_dwordx4 v1, s[4:7], s20 offen offset:2048 sc1 lds
    ds_read_b128 a[168:171], v3 offset:48128
    v_mfma_f32_16x16x32_bf16 v[236:239], a[128:131], a[112:115], v[236:239]
    v_add_u32 v218, v218, v14
    v_and_b32 v14, 0xffffe000, v12
    v_mfma_f32_16x16x32_bf16 v[236:239], a[132:135], a[116:119], v[236:239]
    ds_read_b128 a[172:175], v4 offset:8192
    v_mfma_f32_16x16x32_bf16 v[236:239], a[136:139], a[120:123], v[236:239]
    buffer_load_dwordx4 a[8:11], v1, s[48:51], s38 offen offset:2048 sc1
    v_add_u32 v12, v12, v14
    v_mfma_f32_16x16x32_bf16 v[236:239], a[140:143], a[124:127], v[236:239]
    s_waitcnt lgkmcnt(4)
    v_and_b32 v14, 0xffffe000, v15
    v_mfma_f32_16x16x32_bf16 v[32:35], a[144:147], a[96:99], v[32:35]
    s_add_u32 s20, s20, 3072
    ds_read_b128 a[128:131], v3 offset:30720
    v_mfma_f32_16x16x32_bf16 v[32:35], a[148:151], a[100:103], v[32:35]
    ds_read_b128 a[132:135], v3 offset:39936
    v_add_u32 v15, v15, v14
    v_mfma_f32_16x16x32_bf16 v[32:35], a[152:155], a[104:107], v[32:35]
    v_mfma_f32_16x16x32_bf16 v[32:35], a[156:159], a[108:111], v[32:35]
    ds_read_b128 a[136:139], v4 offset:0
    v_lshlrev_b32 v217, 5, v10
    v_mfma_f32_16x16x32_bf16 v[240:243], a[144:147], a[112:115], v[240:243]
    v_add_u32 v217, 147456, v217
    v_mfma_f32_16x16x32_bf16 v[240:243], a[148:151], a[116:119], v[240:243]
    s_add_u32 m0, s18, 43008
    ds_read_b128 a[140:143], v4 offset:9216
    v_mfma_f32_16x16x32_bf16 v[240:243], a[152:155], a[120:123], v[240:243]
    v_add_u32 v216, s27, v217
    v_mfma_f32_16x16x32_bf16 v[240:243], a[156:159], a[124:127], v[240:243]
    s_waitcnt lgkmcnt(4)
    buffer_load_dwordx4 a[12:15], v1, s[48:51], s38 offen offset:3072 sc1
    v_and_b32 v14, 15, v0
    v_mfma_f32_16x16x32_bf16 v[36:39], a[160:163], a[96:99], v[36:39]
    ds_read_b128 a[144:147], v3 offset:31744
    v_mfma_f32_16x16x32_bf16 v[36:39], a[164:167], a[100:103], v[36:39]
    ds_read_b128 a[148:151], v3 offset:40960
    v_mul_u32_u24 v14, 128, v14
    v_mfma_f32_16x16x32_bf16 v[36:39], a[168:171], a[104:107], v[36:39]
    s_add_u32 s27, s31, 0x1b0000
    buffer_load_dwordx4 v1, s[4:7], s20 offen offset:0 sc1 lds
    v_mfma_f32_16x16x32_bf16 v[36:39], a[172:175], a[108:111], v[36:39]
    ds_read_b128 a[152:155], v4 offset:1024
    v_mfma_f32_16x16x32_bf16 v[244:247], a[160:163], a[112:115], v[244:247]
    s_mov_b32 s34, 0x3f80
    v_mfma_f32_16x16x32_bf16 v[244:247], a[164:167], a[116:119], v[244:247]
    s_mov_b32 s35, 0x3f800000
    ds_read_b128 a[156:159], v4 offset:10240
    v_mfma_f32_16x16x32_bf16 v[244:247], a[168:171], a[120:123], v[244:247]
    v_mfma_f32_16x16x32_bf16 v[244:247], a[172:175], a[124:127], v[244:247]
    s_waitcnt lgkmcnt(4)
    buffer_load_dwordx4 v1, s[4:7], s20 offen offset:1024 sc1 lds
    v_mfma_f32_16x16x32_bf16 v[40:43], a[128:131], a[96:99], v[40:43]
    s_add_u32 s39, s39, 4096
    buffer_load_dwordx4 v[152:155], v218, s[48:51], s27 offen sc1
    ds_read_b128 a[160:163], v3 offset:32768
    v_mfma_f32_16x16x32_bf16 v[40:43], a[132:135], a[100:103], v[40:43]
    buffer_load_dwordx4 v[156:159], v12, s[48:51], s27 offen sc1
    ds_read_b128 a[164:167], v3 offset:41984
    v_mfma_f32_16x16x32_bf16 v[40:43], a[136:139], a[104:107], v[40:43]
    buffer_load_dwordx4 v[160:163], v15, s[48:51], s27 offen sc1
    ds_read_b128 a[168:171], v4 offset:2048
    v_mfma_f32_16x16x32_bf16 v[40:43], a[140:143], a[108:111], v[40:43]
    ds_read_b128 a[172:175], v4 offset:11264
    v_mfma_f32_16x16x32_bf16 v[248:251], a[128:131], a[112:115], v[248:251]
    buffer_load_dwordx4 v1, s[4:7], s20 offen offset:2048 sc1 lds
    v_mfma_f32_16x16x32_bf16 v[248:251], a[132:135], a[116:119], v[248:251]
    v_mfma_f32_16x16x32_bf16 v[248:251], a[136:139], a[120:123], v[248:251]
    v_mfma_f32_16x16x32_bf16 v[248:251], a[140:143], a[124:127], v[248:251]
    s_waitcnt lgkmcnt(0)
    v_mfma_f32_16x16x32_bf16 v[44:47], a[144:147], a[96:99], v[44:47]
    s_waitcnt vmcnt(33)
    s_barrier
    v_mfma_f32_16x16x32_bf16 v[44:47], a[148:151], a[100:103], v[44:47]
    s_add_u32 s20, s20, 30720
    buffer_load_dwordx4 a[16:19], v1, s[48:51], s39 offen offset:0 sc1
    ds_read_b128 a[128:131], v4 offset:12288
    v_mfma_f32_16x16x32_bf16 v[44:47], a[152:155], a[104:107], v[44:47]
    ds_read_b128 a[132:135], v4 offset:21504
    v_mfma_f32_16x16x32_bf16 v[44:47], a[156:159], a[108:111], v[44:47]
    v_mfma_f32_16x16x32_bf16 v[252:255], a[144:147], a[112:115], v[252:255]
    ds_read_b128 a[136:139], v4 offset:30720
    v_mfma_f32_16x16x32_bf16 v[252:255], a[148:151], a[116:119], v[252:255]
    ds_read_b128 a[140:143], v4 offset:39936
    v_mfma_f32_16x16x32_bf16 v[252:255], a[152:155], a[120:123], v[252:255]
    s_add_u32 s20, s85, s18
    v_mfma_f32_16x16x32_bf16 v[252:255], a[156:159], a[124:127], v[252:255]
    s_waitcnt lgkmcnt(4)
    v_mfma_f32_16x16x32_bf16 v[144:147], a[160:163], a[96:99], v[144:147]
    ds_read_b128 a[144:147], v4 offset:13312
    v_mfma_f32_16x16x32_bf16 v[144:147], a[164:167], a[100:103], v[144:147]
    ds_read_b128 a[148:151], v4 offset:22528
    v_mfma_f32_16x16x32_bf16 v[144:147], a[168:171], a[104:107], v[144:147]
    s_add_u32 m0, s18, 73728
    buffer_load_dwordx4 a[20:23], v1, s[48:51], s39 offen offset:1024 sc1
    v_mfma_f32_16x16x32_bf16 v[144:147], a[172:175], a[108:111], v[144:147]
    ds_read_b128 a[152:155], v4 offset:31744
    v_mfma_f32_16x16x32_bf16 v[148:151], a[160:163], a[112:115], v[148:151]
    v_mfma_f32_16x16x32_bf16 v[148:151], a[164:167], a[116:119], v[148:151]
    ds_read_b128 a[156:159], v4 offset:40960
    v_mfma_f32_16x16x32_bf16 v[148:151], a[168:171], a[120:123], v[148:151]
    v_mfma_f32_16x16x32_bf16 v[148:151], a[172:175], a[124:127], v[148:151]
    s_waitcnt lgkmcnt(4)
    buffer_load_dwordx4 v1, s[4:7], s20 offen offset:0 sc1 lds
    v_mfma_f32_16x16x32_bf16 v[16:19], a[128:131], v[80:83], v[16:19]
    ds_read_b128 a[160:163], v4 offset:14336
    v_mfma_f32_16x16x32_bf16 v[16:19], a[132:135], v[84:87], v[16:19]
    ds_read_b128 a[164:167], v4 offset:23552
    v_mfma_f32_16x16x32_bf16 v[16:19], a[136:139], v[88:91], v[16:19]
    v_mfma_f32_16x16x32_bf16 v[16:19], a[140:143], v[92:95], v[16:19]
    buffer_load_dwordx4 a[24:27], v1, s[48:51], s39 offen offset:2048 sc1
    ds_read_b128 a[168:171], v4 offset:32768
    v_mfma_f32_16x16x32_bf16 v[224:227], a[128:131], v[96:99], v[224:227]
    buffer_load_dwordx4 v1, s[4:7], s20 offen offset:1024 sc1 lds
    v_mfma_f32_16x16x32_bf16 v[224:227], a[132:135], v[100:103], v[224:227]
    ds_read_b128 a[172:175], v4 offset:41984
    v_mfma_f32_16x16x32_bf16 v[224:227], a[136:139], v[104:107], v[224:227]
    v_mfma_f32_16x16x32_bf16 v[224:227], a[140:143], v[108:111], v[224:227]
    s_waitcnt lgkmcnt(4)
    v_mfma_f32_16x16x32_bf16 v[20:23], a[144:147], v[80:83], v[20:23]
    buffer_load_dwordx4 v1, s[4:7], s20 offen offset:2048 sc1 lds
    ds_read_b128 a[128:131], v4 offset:15360
    v_mfma_f32_16x16x32_bf16 v[20:23], a[148:151], v[84:87], v[20:23]
    ds_read_b128 a[132:135], v4 offset:24576
    v_mfma_f32_16x16x32_bf16 v[20:23], a[152:155], v[88:91], v[20:23]
    v_mfma_f32_16x16x32_bf16 v[20:23], a[156:159], v[92:95], v[20:23]
    ds_read_b128 a[136:139], v4 offset:33792
    v_mfma_f32_16x16x32_bf16 v[228:231], a[144:147], v[96:99], v[228:231]
    s_add_u32 s20, s20, 3072
    buffer_load_dwordx4 a[28:31], v1, s[48:51], s39 offen offset:3072 sc1
    v_mfma_f32_16x16x32_bf16 v[228:231], a[148:151], v[100:103], v[228:231]
    ds_read_b128 a[140:143], v4 offset:43008
    v_mfma_f32_16x16x32_bf16 v[228:231], a[152:155], v[104:107], v[228:231]
    v_mfma_f32_16x16x32_bf16 v[228:231], a[156:159], v[108:111], v[228:231]
    s_waitcnt lgkmcnt(4)
    v_mfma_f32_16x16x32_bf16 v[24:27], a[160:163], v[80:83], v[24:27]
    ds_read_b128 a[144:147], v4 offset:16384
    v_mfma_f32_16x16x32_bf16 v[24:27], a[164:167], v[84:87], v[24:27]
    s_add_u32 m0, s18, 76800
    ds_read_b128 a[148:151], v4 offset:25600
    v_mfma_f32_16x16x32_bf16 v[24:27], a[168:171], v[88:91], v[24:27]
    v_mfma_f32_16x16x32_bf16 v[24:27], a[172:175], v[92:95], v[24:27]
    ds_read_b128 a[152:155], v4 offset:34816
    v_mfma_f32_16x16x32_bf16 v[232:235], a[160:163], v[96:99], v[232:235]
    s_waitcnt vmcnt(10)
    v_lshlrev_b32 v48, 16, v152
    v_mfma_f32_16x16x32_bf16 v[232:235], a[164:167], v[100:103], v[232:235]
    buffer_load_dwordx4 v1, s[4:7], s20 offen offset:0 sc1 lds
    ds_read_b128 a[156:159], v4 offset:44032
    v_mfma_f32_16x16x32_bf16 v[232:235], a[168:171], v[104:107], v[232:235]
    v_and_b32 v49, 0xffff0000, v152
    v_mfma_f32_16x16x32_bf16 v[232:235], a[172:175], v[108:111], v[232:235]
    s_waitcnt lgkmcnt(4)
    v_lshlrev_b32 v50, 16, v153
    v_mfma_f32_16x16x32_bf16 v[28:31], a[128:131], v[80:83], v[28:31]
    ds_read_b128 a[160:163], v4 offset:17408
    v_and_b32 v51, 0xffff0000, v153
    v_mfma_f32_16x16x32_bf16 v[28:31], a[132:135], v[84:87], v[28:31]
    ds_read_b128 a[164:167], v4 offset:26624
    v_mfma_f32_16x16x32_bf16 v[28:31], a[136:139], v[88:91], v[28:31]
    buffer_load_dwordx4 v1, s[4:7], s20 offen offset:1024 sc1 lds
    v_lshlrev_b32 v52, 16, v154
    v_mfma_f32_16x16x32_bf16 v[28:31], a[140:143], v[92:95], v[28:31]
    ds_read_b128 a[168:171], v4 offset:35840
    v_and_b32 v53, 0xffff0000, v154
    v_mfma_f32_16x16x32_bf16 v[236:239], a[128:131], v[96:99], v[236:239]
    v_mfma_f32_16x16x32_bf16 v[236:239], a[132:135], v[100:103], v[236:239]
    ds_read_b128 a[172:175], v4 offset:45056
    v_lshlrev_b32 v54, 16, v155
    v_mfma_f32_16x16x32_bf16 v[236:239], a[136:139], v[104:107], v[236:239]
    v_and_b32 v55, 0xffff0000, v155
    v_mfma_f32_16x16x32_bf16 v[236:239], a[140:143], v[108:111], v[236:239]
    s_waitcnt lgkmcnt(4)
    buffer_load_dwordx4 v1, s[4:7], s20 offen offset:2048 sc1 lds
    v_mfma_f32_16x16x32_bf16 v[32:35], a[144:147], v[80:83], v[32:35]
    ds_read_b128 a[128:131], v4 offset:18432
    s_waitcnt vmcnt(12)
    v_lshlrev_b32 v56, 16, v156
    v_mfma_f32_16x16x32_bf16 v[32:35], a[148:151], v[84:87], v[32:35]
    ds_read_b128 a[132:135], v4 offset:27648
    v_and_b32 v57, 0xffff0000, v156
    v_mfma_f32_16x16x32_bf16 v[32:35], a[152:155], v[88:91], v[32:35]
    v_mfma_f32_16x16x32_bf16 v[32:35], a[156:159], v[92:95], v[32:35]
    s_add_u32 s20, s20, 3072
    ds_read_b128 a[136:139], v4 offset:36864
    v_lshlrev_b32 v58, 16, v157
    v_mfma_f32_16x16x32_bf16 v[240:243], a[144:147], v[96:99], v[240:243]
    v_and_b32 v59, 0xffff0000, v157
    v_mfma_f32_16x16x32_bf16 v[240:243], a[148:151], v[100:103], v[240:243]
    ds_read_b128 a[140:143], v4 offset:46080
    v_mfma_f32_16x16x32_bf16 v[240:243], a[152:155], v[104:107], v[240:243]
    v_lshlrev_b32 v60, 16, v158
    v_mfma_f32_16x16x32_bf16 v[240:243], a[156:159], v[108:111], v[240:243]
    s_waitcnt lgkmcnt(4)
    v_and_b32 v61, 0xffff0000, v158
    v_mfma_f32_16x16x32_bf16 v[36:39], a[160:163], v[80:83], v[36:39]
    s_add_u32 m0, s18, 79872
    ds_read_b128 a[144:147], v4 offset:19456
    v_mfma_f32_16x16x32_bf16 v[36:39], a[164:167], v[84:87], v[36:39]
    ds_read_b128 a[148:151], v4 offset:28672
    v_lshlrev_b32 v62, 16, v159
    v_mfma_f32_16x16x32_bf16 v[36:39], a[168:171], v[88:91], v[36:39]
    v_and_b32 v63, 0xffff0000, v159
    v_mfma_f32_16x16x32_bf16 v[36:39], a[172:175], v[92:95], v[36:39]
    ds_read_b128 a[152:155], v4 offset:37888
    v_mfma_f32_16x16x32_bf16 v[244:247], a[160:163], v[96:99], v[244:247]
    buffer_load_dwordx4 v1, s[4:7], s20 offen offset:0 sc1 lds
    s_waitcnt vmcnt(12)
    v_lshlrev_b32 v64, 16, v160
    v_mfma_f32_16x16x32_bf16 v[244:247], a[164:167], v[100:103], v[244:247]
    ds_read_b128 a[156:159], v4 offset:47104
    v_and_b32 v65, 0xffff0000, v160
    v_mfma_f32_16x16x32_bf16 v[244:247], a[168:171], v[104:107], v[244:247]
    v_mfma_f32_16x16x32_bf16 v[244:247], a[172:175], v[108:111], v[244:247]
    s_waitcnt lgkmcnt(4)
    v_lshlrev_b32 v66, 16, v161
    v_mfma_f32_16x16x32_bf16 v[40:43], a[128:131], v[80:83], v[40:43]
    ds_read_b128 a[160:163], v4 offset:20480
    v_and_b32 v67, 0xffff0000, v161
    v_mfma_f32_16x16x32_bf16 v[40:43], a[132:135], v[84:87], v[40:43]
    buffer_load_dwordx4 v1, s[4:7], s20 offen offset:1024 sc1 lds
    ds_read_b128 a[164:167], v4 offset:29696
    v_mfma_f32_16x16x32_bf16 v[40:43], a[136:139], v[88:91], v[40:43]
    ds_read_b128 a[168:171], v4 offset:38912
    v_lshlrev_b32 v68, 16, v162
    v_mfma_f32_16x16x32_bf16 v[40:43], a[140:143], v[92:95], v[40:43]
    ds_read_b128 a[172:175], v4 offset:48128
    v_and_b32 v69, 0xffff0000, v162
    v_mfma_f32_16x16x32_bf16 v[248:251], a[128:131], v[96:99], v[248:251]
    v_mfma_f32_16x16x32_bf16 v[248:251], a[132:135], v[100:103], v[248:251]
    buffer_load_dwordx4 v1, s[4:7], s20 offen offset:2048 sc1 lds
    v_lshlrev_b32 v70, 16, v163
    v_mfma_f32_16x16x32_bf16 v[248:251], a[136:139], v[104:107], v[248:251]
    v_and_b32 v71, 0xffff0000, v163
    v_mfma_f32_16x16x32_bf16 v[248:251], a[140:143], v[108:111], v[248:251]
    s_waitcnt lgkmcnt(0)
    v_mfma_f32_16x16x32_bf16 v[44:47], a[144:147], v[80:83], v[44:47]
    s_waitcnt vmcnt(13)
    s_barrier
    v_mfma_f32_16x16x32_bf16 v[44:47], a[148:151], v[84:87], v[44:47]
    ds_read_b128 a[176:179], v1 offset:0
    v_mfma_f32_16x16x32_bf16 v[44:47], a[152:155], v[88:91], v[44:47]
    s_add_u32 s20, s20, 30720
    ds_read_b128 a[180:183], v1 offset:9216
    v_mfma_f32_16x16x32_bf16 v[44:47], a[156:159], v[92:95], v[44:47]
    ds_read_b128 a[184:187], v1 offset:18432
    v_mfma_f32_16x16x32_bf16 v[252:255], a[144:147], v[96:99], v[252:255]
    ds_read_b128 a[188:191], v1 offset:27648
    v_mfma_f32_16x16x32_bf16 v[252:255], a[148:151], v[100:103], v[252:255]
    ds_read_b128 a[192:195], v1 offset:36864
    v_mfma_f32_16x16x32_bf16 v[252:255], a[152:155], v[104:107], v[252:255]
    ds_read_b128 a[196:199], v1 offset:46080
    v_mfma_f32_16x16x32_bf16 v[252:255], a[156:159], v[108:111], v[252:255]
    ds_read_b128 a[200:203], v3 offset:6144
    v_mfma_f32_16x16x32_bf16 v[144:147], a[160:163], v[80:83], v[144:147]
    ds_read_b128 a[204:207], v3 offset:15360
    v_mfma_f32_16x16x32_bf16 v[144:147], a[164:167], v[84:87], v[144:147]
    ds_read_b128 a[208:211], v1 offset:1024
    v_mfma_f32_16x16x32_bf16 v[144:147], a[168:171], v[88:91], v[144:147]
    ds_read_b128 a[212:215], v1 offset:10240
    v_mfma_f32_16x16x32_bf16 v[144:147], a[172:175], v[92:95], v[144:147]
    ds_read_b128 a[216:219], v1 offset:19456
    v_mfma_f32_16x16x32_bf16 v[148:151], a[160:163], v[96:99], v[148:151]
    ds_read_b128 a[220:223], v1 offset:28672
    v_mfma_f32_16x16x32_bf16 v[148:151], a[164:167], v[100:103], v[148:151]
    ds_read_b128 a[224:227], v1 offset:37888
    v_mfma_f32_16x16x32_bf16 v[148:151], a[168:171], v[104:107], v[148:151]
    s_waitcnt vmcnt(6)
    ds_read_b128 a[228:231], v1 offset:47104
    v_mfma_f32_16x16x32_bf16 v[148:151], a[172:175], v[108:111], v[148:151]
    s_waitcnt lgkmcnt(10)
    ds_read_b128 a[232:235], v3 offset:7168
    v_mfma_f32_16x16x32_bf16 v[16:19], a[176:179], v[112:115], v[16:19]
    ds_read_b128 a[236:239], v3 offset:16384
    v_mfma_f32_16x16x32_bf16 v[16:19], a[180:183], v[116:119], v[16:19]
    ds_read_b128 a[240:243], v1 offset:8192
    v_mfma_f32_16x16x32_bf16 v[16:19], a[184:187], v[120:123], v[16:19]
    ds_read_b128 a[244:247], v1 offset:17408
    v_mfma_f32_16x16x32_bf16 v[16:19], a[188:191], v[124:127], v[16:19]
    s_waitcnt lgkmcnt(10)
    ds_read_b128 a[248:251], v1 offset:26624
    v_mfma_f32_16x16x32_bf16 v[16:19], a[192:195], a[0:3], v[16:19]
    ds_read_b128 a[252:255], v1 offset:35840
    v_mfma_f32_16x16x32_bf16 v[16:19], a[196:199], a[4:7], v[16:19]
    ds_read_b128 a[32:35], v1 offset:45056
    v_mfma_f32_16x16x32_bf16 v[16:19], a[200:203], a[8:11], v[16:19]
    ds_read_b128 a[36:39], v3 offset:5120
    v_mfma_f32_16x16x32_bf16 v[16:19], a[204:207], a[12:15], v[16:19]
    s_waitcnt lgkmcnt(10)
    ds_read_b128 a[40:43], v3 offset:14336
    v_mfma_f32_16x16x32_bf16 v[20:23], a[208:211], v[112:115], v[20:23]
    ds_read_b128 a[44:47], v3 offset:23552
    v_mfma_f32_16x16x32_bf16 v[20:23], a[212:215], v[116:119], v[20:23]
    ds_read_b128 a[48:51], v1 offset:2048
    v_mfma_f32_16x16x32_bf16 v[20:23], a[216:219], v[120:123], v[20:23]
    ds_read_b128 a[52:55], v1 offset:11264
    v_mfma_f32_16x16x32_bf16 v[20:23], a[220:223], v[124:127], v[20:23]
    s_waitcnt lgkmcnt(10)
    ds_read_b128 a[56:59], v1 offset:20480
    v_mfma_f32_16x16x32_bf16 v[20:23], a[224:227], a[0:3], v[20:23]
    ds_read_b128 a[60:63], v1 offset:29696
    v_mfma_f32_16x16x32_bf16 v[20:23], a[228:231], a[4:7], v[20:23]
    ds_read_b128 a[64:67], v1 offset:38912
    v_mfma_f32_16x16x32_bf16 v[20:23], a[232:235], a[8:11], v[20:23]
    ds_read_b128 a[68:71], v1 offset:48128
    v_mfma_f32_16x16x32_bf16 v[20:23], a[236:239], a[12:15], v[20:23]
    s_waitcnt lgkmcnt(10)
    ds_read_b128 a[72:75], v3 offset:8192
    v_mfma_f32_16x16x32_bf16 v[144:147], a[240:243], v[112:115], v[144:147]
    ds_read_b128 a[76:79], v3 offset:17408
    v_mfma_f32_16x16x32_bf16 v[144:147], a[244:247], v[116:119], v[144:147]
    ds_read_b128 a[80:83], v1 offset:3072
    v_mfma_f32_16x16x32_bf16 v[144:147], a[248:251], v[120:123], v[144:147]
    ds_read_b128 a[84:87], v1 offset:12288
    v_mfma_f32_16x16x32_bf16 v[144:147], a[252:255], v[124:127], v[144:147]
    s_waitcnt lgkmcnt(10)
    ds_read_b128 a[88:91], v1 offset:21504
    v_cvt_pk_bf16_f32 v184, v16, v17
    v_mfma_f32_16x16x32_bf16 v[144:147], a[32:35], a[0:3], v[144:147]
    ds_read_b128 a[92:95], v1 offset:30720
    v_cvt_pk_bf16_f32 v185, v18, v19
    v_mfma_f32_16x16x32_bf16 v[144:147], a[36:39], a[4:7], v[144:147]
    ds_read_b128 a[96:99], v1 offset:39936
    v_cvt_pk_bf16_f32 v186, v20, v21
    v_mfma_f32_16x16x32_bf16 v[144:147], a[40:43], a[8:11], v[144:147]
    ds_read_b128 a[100:103], v3 offset:0
    v_cvt_pk_bf16_f32 v187, v22, v23
    v_mfma_f32_16x16x32_bf16 v[144:147], a[44:47], a[12:15], v[144:147]
    s_waitcnt lgkmcnt(10)
    buffer_store_dwordx4 v[184:187], v1, s[48:51], s68 offen sc1
    ds_read_b128 a[104:107], v3 offset:9216
    v_mfma_f32_16x16x32_bf16 v[24:27], a[48:51], v[112:115], v[24:27]
    ds_read_b128 a[108:111], v3 offset:18432
    v_mfma_f32_16x16x32_bf16 v[24:27], a[52:55], v[116:119], v[24:27]
    ds_read_b128 a[112:115], v1 offset:4096
    v_mfma_f32_16x16x32_bf16 v[24:27], a[56:59], v[120:123], v[24:27]
    ds_read_b128 a[116:119], v1 offset:13312
    v_mfma_f32_16x16x32_bf16 v[24:27], a[60:63], v[124:127], v[24:27]
    s_waitcnt lgkmcnt(10)
    ds_read_b128 a[120:123], v1 offset:22528
    v_cvt_pk_bf16_f32 v188, v144, v145
    v_mfma_f32_16x16x32_bf16 v[24:27], a[64:67], a[0:3], v[24:27]
    ds_read_b128 a[124:127], v1 offset:31744
    v_cvt_pk_bf16_f32 v189, v146, v147
    v_mfma_f32_16x16x32_bf16 v[24:27], a[68:71], a[4:7], v[24:27]
    ds_read_b128 a[128:131], v1 offset:40960
    v_cvt_pk_bf16_f32 v190, v144, v145
    v_mfma_f32_16x16x32_bf16 v[24:27], a[72:75], a[8:11], v[24:27]
    ds_read_b128 a[132:135], v3 offset:1024
    v_cvt_pk_bf16_f32 v191, v146, v147
    v_mfma_f32_16x16x32_bf16 v[24:27], a[76:79], a[12:15], v[24:27]
    s_waitcnt lgkmcnt(10)
    ds_read_b128 a[136:139], v3 offset:10240
    v_permlane16_swap_b32 v188, v190
    v_mfma_f32_16x16x32_bf16 v[28:31], a[80:83], v[112:115], v[28:31]
    ds_read_b128 a[140:143], v3 offset:19456
    v_permlane16_swap_b32 v189, v191
    v_mfma_f32_16x16x32_bf16 v[28:31], a[84:87], v[116:119], v[28:31]
    buffer_store_dwordx4 v[188:191], v5, s[48:51], s30 offen sc1
    ds_read_b128 a[144:147], v1 offset:5120
    v_mfma_f32_16x16x32_bf16 v[28:31], a[88:91], v[120:123], v[28:31]
    ds_read_b128 a[148:151], v1 offset:14336
    v_mfma_f32_16x16x32_bf16 v[28:31], a[92:95], v[124:127], v[28:31]
    s_waitcnt lgkmcnt(10)
    ds_read_b128 a[152:155], v1 offset:23552
    v_mfma_f32_16x16x32_bf16 v[28:31], a[96:99], a[0:3], v[28:31]
    ds_read_b128 a[156:159], v1 offset:32768
    v_mfma_f32_16x16x32_bf16 v[28:31], a[100:103], a[4:7], v[28:31]
    ds_read_b128 a[160:163], v1 offset:41984
    v_mfma_f32_16x16x32_bf16 v[28:31], a[104:107], a[8:11], v[28:31]
    ds_read_b128 a[164:167], v3 offset:2048
    v_mfma_f32_16x16x32_bf16 v[28:31], a[108:111], a[12:15], v[28:31]
    s_waitcnt lgkmcnt(10)
    ds_read_b128 a[168:171], v3 offset:11264
    v_mfma_f32_16x16x32_bf16 v[32:35], a[112:115], v[112:115], v[32:35]
    ds_read_b128 a[172:175], v3 offset:20480
    v_mfma_f32_16x16x32_bf16 v[32:35], a[116:119], v[116:119], v[32:35]
    ds_read_b128 a[176:179], v1 offset:6144
    v_mfma_f32_16x16x32_bf16 v[32:35], a[120:123], v[120:123], v[32:35]
    ds_read_b128 a[180:183], v1 offset:15360
    v_mfma_f32_16x16x32_bf16 v[32:35], a[124:127], v[124:127], v[32:35]
    s_waitcnt lgkmcnt(10)
    ds_read_b128 a[184:187], v1 offset:24576
    v_cvt_pk_bf16_f32 v192, v24, v25
    v_mfma_f32_16x16x32_bf16 v[32:35], a[128:131], a[0:3], v[32:35]
    ds_read_b128 a[188:191], v1 offset:33792
    v_cvt_pk_bf16_f32 v193, v26, v27
    v_mfma_f32_16x16x32_bf16 v[32:35], a[132:135], a[4:7], v[32:35]
    ds_read_b128 a[192:195], v1 offset:43008
    v_cvt_pk_bf16_f32 v194, v28, v29
    v_mfma_f32_16x16x32_bf16 v[32:35], a[136:139], a[8:11], v[32:35]
    ds_read_b128 a[196:199], v3 offset:3072
    v_cvt_pk_bf16_f32 v195, v30, v31
    v_mfma_f32_16x16x32_bf16 v[32:35], a[140:143], a[12:15], v[32:35]
    s_waitcnt lgkmcnt(10)
    buffer_store_dwordx4 v[192:195], v1, s[48:51], s70 offen sc1
    ds_read_b128 a[200:203], v3 offset:12288
    v_mfma_f32_16x16x32_bf16 v[36:39], a[144:147], v[112:115], v[36:39]
    ds_read_b128 a[204:207], v3 offset:21504
    v_mfma_f32_16x16x32_bf16 v[36:39], a[148:151], v[116:119], v[36:39]
    ds_read_b128 a[208:211], v1 offset:7168
    v_mfma_f32_16x16x32_bf16 v[36:39], a[152:155], v[120:123], v[36:39]
    ds_read_b128 a[212:215], v1 offset:16384
    v_mfma_f32_16x16x32_bf16 v[36:39], a[156:159], v[124:127], v[36:39]
    s_waitcnt lgkmcnt(10)
    ds_read_b128 a[216:219], v1 offset:25600
    v_mfma_f32_16x16x32_bf16 v[36:39], a[160:163], a[0:3], v[36:39]
    ds_read_b128 a[220:223], v1 offset:34816
    v_mfma_f32_16x16x32_bf16 v[36:39], a[164:167], a[4:7], v[36:39]
    ds_read_b128 a[224:227], v1 offset:44032
    v_mfma_f32_16x16x32_bf16 v[36:39], a[168:171], a[8:11], v[36:39]
    ds_read_b128 a[228:231], v3 offset:4096
    v_mfma_f32_16x16x32_bf16 v[36:39], a[172:175], a[12:15], v[36:39]
    s_waitcnt lgkmcnt(10)
    ds_read_b128 a[232:235], v3 offset:13312
    v_mfma_f32_16x16x32_bf16 v[40:43], a[176:179], v[112:115], v[40:43]
    ds_read_b128 a[236:239], v3 offset:22528
    v_mfma_f32_16x16x32_bf16 v[40:43], a[180:183], v[116:119], v[40:43]
    v_mfma_f32_16x16x32_bf16 v[40:43], a[184:187], v[120:123], v[40:43]
    v_mfma_f32_16x16x32_bf16 v[40:43], a[188:191], v[124:127], v[40:43]
    s_waitcnt lgkmcnt(8)
    v_cvt_pk_bf16_f32 v196, v32, v33
    v_cvt_pk_bf16_f32 v197, v34, v35
    v_mfma_f32_16x16x32_bf16 v[40:43], a[192:195], a[0:3], v[40:43]
    v_cvt_pk_bf16_f32 v198, v36, v37
    v_cvt_pk_bf16_f32 v199, v38, v39
    v_mfma_f32_16x16x32_bf16 v[40:43], a[196:199], a[4:7], v[40:43]
    buffer_store_dwordx4 v[196:199], v1, s[48:51], s72 offen sc1
    v_mfma_f32_16x16x32_bf16 v[40:43], a[200:203], a[8:11], v[40:43]
    v_mfma_f32_16x16x32_bf16 v[40:43], a[204:207], a[12:15], v[40:43]
    s_waitcnt lgkmcnt(4)
    v_mfma_f32_16x16x32_bf16 v[44:47], a[208:211], v[112:115], v[44:47]
    v_mfma_f32_16x16x32_bf16 v[44:47], a[212:215], v[116:119], v[44:47]
    v_mfma_f32_16x16x32_bf16 v[44:47], a[216:219], v[120:123], v[44:47]
    v_mfma_f32_16x16x32_bf16 v[44:47], a[220:223], v[124:127], v[44:47]
    s_waitcnt lgkmcnt(0)
    v_mfma_f32_16x16x32_bf16 v[44:47], a[224:227], a[0:3], v[44:47]
    v_mfma_f32_16x16x32_bf16 v[44:47], a[228:231], a[4:7], v[44:47]
    v_mfma_f32_16x16x32_bf16 v[44:47], a[232:235], a[8:11], v[44:47]
    v_mfma_f32_16x16x32_bf16 v[44:47], a[236:239], a[12:15], v[44:47]
    v_mfma_f32_16x16x32_bf16 v[148:151], a[240:243], v[128:131], v[148:151]
    v_mfma_f32_16x16x32_bf16 v[148:151], a[244:247], v[132:135], v[148:151]
    v_mfma_f32_16x16x32_bf16 v[148:151], a[248:251], v[136:139], v[148:151]
    v_mfma_f32_16x16x32_bf16 v[148:151], a[252:255], v[140:143], v[148:151]
    v_cvt_pk_bf16_f32 v200, v40, v41
    v_cvt_pk_bf16_f32 v201, v42, v43
    v_mfma_f32_16x16x32_bf16 v[148:151], a[32:35], a[16:19], v[148:151]
    s_nop 0
    v_cvt_pk_bf16_f32 v202, v44, v45
    v_cvt_pk_bf16_f32 v203, v46, v47
    v_mfma_f32_16x16x32_bf16 v[148:151], a[36:39], a[20:23], v[148:151]
    buffer_store_dwordx4 v[200:203], v1, s[48:51], s74 offen sc1
    v_mfma_f32_16x16x32_bf16 v[148:151], a[40:43], a[24:27], v[148:151]
    v_mfma_f32_16x16x32_bf16 v[148:151], a[44:47], a[28:31], v[148:151]
    v_mfma_f32_16x16x32_bf16 v[232:235], a[48:51], v[128:131], v[232:235]
    v_mfma_f32_16x16x32_bf16 v[232:235], a[52:55], v[132:135], v[232:235]
    v_mfma_f32_16x16x32_bf16 v[232:235], a[56:59], v[136:139], v[232:235]
    v_mfma_f32_16x16x32_bf16 v[232:235], a[60:63], v[140:143], v[232:235]
    s_nop 3
    v_cvt_pk_bf16_f32 v204, v148, v149
    v_cvt_pk_bf16_f32 v205, v150, v151
    v_mfma_f32_16x16x32_bf16 v[232:235], a[64:67], a[16:19], v[232:235]
    v_cvt_pk_bf16_f32 v206, v148, v149
    v_cvt_pk_bf16_f32 v207, v150, v151
    v_mfma_f32_16x16x32_bf16 v[232:235], a[68:71], a[20:23], v[232:235]
    v_permlane16_swap_b32 v204, v206
    v_permlane16_swap_b32 v205, v207
    v_mfma_f32_16x16x32_bf16 v[232:235], a[72:75], a[24:27], v[232:235]
    buffer_store_dwordx4 v[204:207], v5, s[48:51], s29 offen sc1
    v_mfma_f32_16x16x32_bf16 v[232:235], a[76:79], a[28:31], v[232:235]
    v_mfma_f32_16x16x32_bf16 v[236:239], a[80:83], v[128:131], v[236:239]
    v_mfma_f32_16x16x32_bf16 v[236:239], a[84:87], v[132:135], v[236:239]
    ds_read_b128 a[240:243], v1 offset:0
    v_mfma_f32_16x16x32_bf16 v[236:239], a[88:91], v[136:139], v[236:239]
    v_mfma_f32_16x16x32_bf16 v[236:239], a[92:95], v[140:143], v[236:239]
    ds_read_b128 a[244:247], v1 offset:9216
    v_mfma_f32_16x16x32_bf16 v[236:239], a[96:99], a[16:19], v[236:239]
    v_mfma_f32_16x16x32_bf16 v[236:239], a[100:103], a[20:23], v[236:239]
    ds_read_b128 a[248:251], v1 offset:18432
    v_mfma_f32_16x16x32_bf16 v[236:239], a[104:107], a[24:27], v[236:239]
    v_mfma_f32_16x16x32_bf16 v[236:239], a[108:111], a[28:31], v[236:239]
    ds_read_b128 a[252:255], v1 offset:27648
    v_mfma_f32_16x16x32_bf16 v[240:243], a[112:115], v[128:131], v[240:243]
    v_mfma_f32_16x16x32_bf16 v[240:243], a[116:119], v[132:135], v[240:243]
    ds_read_b128 a[32:35], v1 offset:36864
    v_mfma_f32_16x16x32_bf16 v[240:243], a[120:123], v[136:139], v[240:243]
    v_mfma_f32_16x16x32_bf16 v[240:243], a[124:127], v[140:143], v[240:243]
    ds_read_b128 a[36:39], v1 offset:46080
    v_cvt_pk_bf16_f32 v208, v232, v233
    v_mfma_f32_16x16x32_bf16 v[240:243], a[128:131], a[16:19], v[240:243]
    v_cvt_pk_bf16_f32 v209, v234, v235
    v_cvt_pk_bf16_f32 v210, v236, v237
    v_mfma_f32_16x16x32_bf16 v[240:243], a[132:135], a[20:23], v[240:243]
    ds_read_b128 a[40:43], v3 offset:6144
    v_cvt_pk_bf16_f32 v211, v238, v239
    v_mfma_f32_16x16x32_bf16 v[240:243], a[136:139], a[24:27], v[240:243]
    buffer_store_dwordx4 v[208:211], v1, s[48:51], s71 offen sc1
    v_mfma_f32_16x16x32_bf16 v[240:243], a[140:143], a[28:31], v[240:243]
    ds_read_b128 a[44:47], v3 offset:15360
    v_mfma_f32_16x16x32_bf16 v[244:247], a[144:147], v[128:131], v[244:247]
    v_mfma_f32_16x16x32_bf16 v[244:247], a[148:151], v[132:135], v[244:247]
    ds_read_b128 a[48:51], v1 offset:1024
    v_mfma_f32_16x16x32_bf16 v[244:247], a[152:155], v[136:139], v[244:247]
    v_mfma_f32_16x16x32_bf16 v[244:247], a[156:159], v[140:143], v[244:247]
    ds_read_b128 a[52:55], v1 offset:10240
    v_mfma_f32_16x16x32_bf16 v[244:247], a[160:163], a[16:19], v[244:247]
    v_mfma_f32_16x16x32_bf16 v[244:247], a[164:167], a[20:23], v[244:247]
    ds_read_b128 a[56:59], v1 offset:19456
    v_mfma_f32_16x16x32_bf16 v[244:247], a[168:171], a[24:27], v[244:247]
    v_mfma_f32_16x16x32_bf16 v[244:247], a[172:175], a[28:31], v[244:247]
    ds_read_b128 a[60:63], v1 offset:28672
    v_mfma_f32_16x16x32_bf16 v[248:251], a[176:179], v[128:131], v[248:251]
    s_waitcnt vmcnt(2)
    v_mfma_f32_16x16x32_bf16 v[248:251], a[180:183], v[132:135], v[248:251]
    ds_read_b128 a[64:67], v1 offset:37888
    v_mov_b32 v8, 1
    v_mfma_f32_16x16x32_bf16 v[248:251], a[184:187], v[136:139], v[248:251]
    buffer_store_dword v8, v219, s[88:91], s22 offen sc1
    v_mfma_f32_16x16x32_bf16 v[248:251], a[188:191], v[140:143], v[248:251]
    ds_read_b128 a[68:71], v1 offset:47104
    v_cvt_pk_bf16_f32 v212, v240, v241
    v_mfma_f32_16x16x32_bf16 v[248:251], a[192:195], a[16:19], v[248:251]
    v_cvt_pk_bf16_f32 v213, v242, v243
    v_cvt_pk_bf16_f32 v214, v244, v245
    v_mfma_f32_16x16x32_bf16 v[248:251], a[196:199], a[20:23], v[248:251]
    ds_read_b128 a[72:75], v3 offset:7168
    v_cvt_pk_bf16_f32 v215, v246, v247
    v_mfma_f32_16x16x32_bf16 v[248:251], a[200:203], a[24:27], v[248:251]
    buffer_store_dwordx4 v[212:215], v1, s[48:51], s73 offen sc1
    v_mfma_f32_16x16x32_bf16 v[248:251], a[204:207], a[28:31], v[248:251]
    ds_read_b128 a[76:79], v3 offset:16384
    v_mfma_f32_16x16x32_bf16 v[252:255], a[208:211], v[128:131], v[252:255]
    v_mfma_f32_16x16x32_bf16 v[252:255], a[212:215], v[132:135], v[252:255]
    v_mfma_f32_16x16x32_bf16 v[252:255], a[216:219], v[136:139], v[252:255]
    v_mfma_f32_16x16x32_bf16 v[252:255], a[220:223], v[140:143], v[252:255]
    v_mfma_f32_16x16x32_bf16 v[252:255], a[224:227], a[16:19], v[252:255]
    v_mfma_f32_16x16x32_bf16 v[252:255], a[228:231], a[20:23], v[252:255]
    v_mfma_f32_16x16x32_bf16 v[252:255], a[232:235], a[24:27], v[252:255]
    v_mfma_f32_16x16x32_bf16 v[252:255], a[236:239], a[28:31], v[252:255]
    s_waitcnt lgkmcnt(0)
    v_mfma_f32_16x16x32_bf16 v[224:227], a[240:243], v[128:131], v[224:227]
    v_mfma_f32_16x16x32_bf16 v[224:227], a[244:247], v[132:135], v[224:227]
    v_mfma_f32_16x16x32_bf16 v[224:227], a[248:251], v[136:139], v[224:227]
    v_mfma_f32_16x16x32_bf16 v[224:227], a[252:255], v[140:143], v[224:227]
    v_cvt_pk_bf16_f32 v184, v248, v249
    v_cvt_pk_bf16_f32 v185, v250, v251
    v_mfma_f32_16x16x32_bf16 v[224:227], a[32:35], a[16:19], v[224:227]
    v_cvt_pk_bf16_f32 v186, v252, v253
    v_cvt_pk_bf16_f32 v187, v254, v255
    v_mfma_f32_16x16x32_bf16 v[224:227], a[36:39], a[20:23], v[224:227]
    buffer_store_dwordx4 v[184:187], v1, s[48:51], s75 offen sc1
    v_mfma_f32_16x16x32_bf16 v[224:227], a[40:43], a[24:27], v[224:227]
    v_mfma_f32_16x16x32_bf16 v[224:227], a[44:47], a[28:31], v[224:227]
    v_mfma_f32_16x16x32_bf16 v[228:231], a[48:51], v[128:131], v[228:231]
    v_mfma_f32_16x16x32_bf16 v[228:231], a[52:55], v[132:135], v[228:231]
    v_mfma_f32_16x16x32_bf16 v[228:231], a[56:59], v[136:139], v[228:231]
    v_mfma_f32_16x16x32_bf16 v[228:231], a[60:63], v[140:143], v[228:231]
    v_mfma_f32_16x16x32_bf16 v[228:231], a[64:67], a[16:19], v[228:231]
    v_mfma_f32_16x16x32_bf16 v[228:231], a[68:71], a[20:23], v[228:231]
    v_mfma_f32_16x16x32_bf16 v[228:231], a[72:75], a[24:27], v[228:231]
    v_mfma_f32_16x16x32_bf16 v[228:231], a[76:79], a[28:31], v[228:231]
    s_load_dwordx2 s[52:53], s[0:1], 56
    s_mov_b32 s54, 0x240000
    s_mov_b32 s55, 0x00020000
    s_add_u32 s64, s31, 0x120000
    s_add_u32 s65, s31, 0x144000
    s_add_u32 s66, s31, 0x168000
    s_add_u32 s67, s31, 0x18c000
    v_mov_b32 v8, 2
    v_cvt_pk_bf16_f32 v188, v224, v225
    v_cvt_pk_bf16_f32 v189, v226, v227
    v_cvt_pk_bf16_f32 v190, v228, v229
    v_cvt_pk_bf16_f32 v191, v230, v231
    buffer_store_dwordx4 v[188:191], v1, s[48:51], s69 offen sc1
    s_cmp_eq_u32 s3, 3
    s_cselect_b32 s15, 1073741824, s25
    buffer_load_dword v9, v14, s[88:91], s15 offen sc1
    s_waitcnt vmcnt(1)
    buffer_store_dword v8, v219, s[88:91], s22 offen sc1
    s_cmp_eq_u32 s3, 3
    s_cbranch_scc1 red_idle
    s_waitcnt vmcnt(1)
    v_cmp_gt_u32 vcc, s77, v9
    s_nop 0
    s_cbranch_vccz red_go
spin14:
    buffer_load_dword v9, v14, s[88:91], s25 offen sc1
    s_sub_u32 s14, s14, 1
    s_cbranch_scc1 spin14_out
    s_waitcnt vmcnt(0)
    v_cmp_gt_u32 vcc, s77, v9
    s_nop 0
    s_cbranch_vccnz spin14
back14:
red_go:
    buffer_load_dwordx4 v[80:83], v218, s[48:51], s64 offen sc1
    buffer_load_dwordx4 v[92:95], v218, s[48:51], s65 offen sc1
    buffer_load_dwordx4 v[104:107], v218, s[48:51], s66 offen sc1
    buffer_load_dwordx4 v[116:119], v218, s[48:51], s67 offen sc1
    buffer_load_dwordx4 v[84:87], v12, s[48:51], s64 offen sc1
    buffer_load_dwordx4 v[96:99], v12, s[48:51], s65 offen sc1
    buffer_load_dwordx4 v[108:111], v12, s[48:51], s66 offen sc1
    buffer_load_dwordx4 v[120:123], v12, s[48:51], s67 offen sc1
    buffer_load_dwordx4 v[88:91], v15, s[48:51], s64 offen sc1
    buffer_load_dwordx4 v[100:103], v15, s[48:51], s65 offen sc1
    buffer_load_dwordx4 v[112:115], v15, s[48:51], s66 offen sc1
    buffer_load_dwordx4 v[124:127], v15, s[48:51], s67 offen sc1
    s_barrier
    s_waitcnt vmcnt(11)
    v_dot2_f32_bf16 v48, v80, s34, v48
    v_dot2_f32_bf16 v49, v80, s35, v49
    v_dot2_f32_bf16 v50, v81, s34, v50
    v_dot2_f32_bf16 v51, v81, s35, v51
    v_dot2_f32_bf16 v52, v82, s34, v52
    v_dot2_f32_bf16 v53, v82, s35, v53
    v_dot2_f32_bf16 v54, v83, s34, v54
    v_dot2_f32_bf16 v55, v83, s35, v55
    s_waitcnt vmcnt(10)
    v_dot2_f32_bf16 v48, v92, s34, v48
    v_dot2_f32_bf16 v49, v92, s35, v49
    v_dot2_f32_bf16 v50, v93, s34, v50
    v_dot2_f32_bf16 v51, v93, s35, v51
    v_dot2_f32_bf16 v52, v94, s34, v52
    v_dot2_f32_bf16 v53, v94, s35, v53
    v_dot2_f32_bf16 v54, v95, s34, v54
    v_dot2_f32_bf16 v55, v95, s35, v55
    s_waitcnt vmcnt(9)
    v_dot2_f32_bf16 v48, v104, s34, v48
    v_dot2_f32_bf16 v49, v104, s35, v49
    v_dot2_f32_bf16 v50, v105, s34, v50
    v_dot2_f32_bf16 v51, v105, s35, v51
    v_dot2_f32_bf16 v52, v106, s34, v52
    v_dot2_f32_bf16 v53, v106, s35, v53
    v_dot2_f32_bf16 v54, v107, s34, v54
    v_dot2_f32_bf16 v55, v107, s35, v55
    s_waitcnt vmcnt(8)
    v_dot2_f32_bf16 v48, v116, s34, v48
    v_dot2_f32_bf16 v49, v116, s35, v49
    v_dot2_f32_bf16 v50, v117, s34, v50
    v_dot2_f32_bf16 v51, v117, s35, v51
    v_dot2_f32_bf16 v52, v118, s34, v52
    v_dot2_f32_bf16 v53, v118, s35, v53
    v_dot2_f32_bf16 v54, v119, s34, v54
    v_dot2_f32_bf16 v55, v119, s35, v55
    v_pk_mul_f32 v[10:11], v[48:49], v[48:49]
    v_pk_add_f32 v[8:9], v[48:49], v[50:51]
    v_pk_fma_f32 v[10:11], v[50:51], v[50:51], v[10:11]
    v_pk_add_f32 v[8:9], v[8:9], v[52:53]
    v_pk_fma_f32 v[10:11], v[52:53], v[52:53], v[10:11]
    s_waitcnt vmcnt(7)
    v_dot2_f32_bf16 v56, v84, s34, v56
    v_dot2_f32_bf16 v57, v84, s35, v57
    v_dot2_f32_bf16 v58, v85, s34, v58
    v_dot2_f32_bf16 v59, v85, s35, v59
    v_dot2_f32_bf16 v60, v86, s34, v60
    v_dot2_f32_bf16 v61, v86, s35, v61
    v_dot2_f32_bf16 v62, v87, s34, v62
    v_dot2_f32_bf16 v63, v87, s35, v63
    s_waitcnt vmcnt(6)
    v_dot2_f32_bf16 v56, v96, s34, v56
    v_dot2_f32_bf16 v57, v96, s35, v57
    v_dot2_f32_bf16 v58, v97, s34, v58
    v_dot2_f32_bf16 v59, v97, s35, v59
    v_dot2_f32_bf16 v60, v98, s34, v60
    v_dot2_f32_bf16 v61, v98, s35, v61
    v_dot2_f32_bf16 v62, v99, s34, v62
    v_dot2_f32_bf16 v63, v99, s35, v63
    s_waitcnt vmcnt(5)
    v_dot2_f32_bf16 v56, v108, s34, v56
    v_dot2_f32_bf16 v57, v108, s35, v57
    v_dot2_f32_bf16 v58, v109, s34, v58
    v_dot2_f32_bf16 v59, v109, s35, v59
    v_dot2_f32_bf16 v60, v110, s34, v60
    v_dot2_f32_bf16 v61, v110, s35, v61
    v_dot2_f32_bf16 v62, v111, s34, v62
    v_dot2_f32_bf16 v63, v111, s35, v63
    s_waitcnt vmcnt(4)
    v_dot2_f32_bf16 v56, v120, s34, v56
    v_dot2_f32_bf16 v57, v120, s35, v57
    v_dot2_f32_bf16 v58, v121, s34, v58
    v_dot2_f32_bf16 v59, v121, s35, v59
    v_dot2_f32_bf16 v60, v122, s34, v60
    v_dot2_f32_bf16 v61, v122, s35, v61
    v_dot2_f32_bf16 v62, v123, s34, v62
    v_dot2_f32_bf16 v63, v123, s35, v63
    v_pk_add_f32 v[8:9], v[8:9], v[54:55]
    v_pk_fma_f32 v[10:11], v[54:55], v[54:55], v[10:11]
    v_pk_add_f32 v[8:9], v[8:9], v[56:57]
    v_pk_fma_f32 v[10:11], v[56:57], v[56:57], v[10:11]
    v_pk_add_f32 v[8:9], v[8:9], v[58:59]
    v_pk_fma_f32 v[10:11], v[58:59], v[58:59], v[10:11]
    v_pk_add_f32 v[8:9], v[8:9], v[60:61]
    v_pk_fma_f32 v[10:11], v[60:61], v[60:61], v[10:11]
    s_waitcnt vmcnt(3)
    v_dot2_f32_bf16 v64, v88, s34, v64
    v_dot2_f32_bf16 v65, v88, s35, v65
    v_dot2_f32_bf16 v66, v89, s34, v66
    v_dot2_f32_bf16 v67, v89, s35, v67
    v_dot2_f32_bf16 v68, v90, s34, v68
    v_dot2_f32_bf16 v69, v90, s35, v69
    v_dot2_f32_bf16 v70, v91, s34, v70
    v_dot2_f32_bf16 v71, v91, s35, v71
    s_waitcnt vmcnt(2)
    v_dot2_f32_bf16 v64, v100, s34, v64
    v_dot2_f32_bf16 v65, v100, s35, v65
    v_dot2_f32_bf16 v66, v101, s34, v66
    v_dot2_f32_bf16 v67, v101, s35, v67
    v_dot2_f32_bf16 v68, v102, s34, v68
    v_dot2_f32_bf16 v69, v102, s35, v69
    v_dot2_f32_bf16 v70, v103, s34, v70
    v_dot2_f32_bf16 v71, v103, s35, v71
    s_waitcnt vmcnt(1)
    v_dot2_f32_bf16 v64, v112, s34, v64
    v_dot2_f32_bf16 v65, v112, s35, v65
    v_dot2_f32_bf16 v66, v113, s34, v66
    v_dot2_f32_bf16 v67, v113, s35, v67
    v_dot2_f32_bf16 v68, v114, s34, v68
    v_dot2_f32_bf16 v69, v114, s35, v69
    v_dot2_f32_bf16 v70, v115, s34, v70
    v_dot2_f32_bf16 v71, v115, s35, v71
    s_waitcnt vmcnt(0)
    v_dot2_f32_bf16 v64, v124, s34, v64
    v_dot2_f32_bf16 v65, v124, s35, v65
    v_dot2_f32_bf16 v66, v125, s34, v66
    v_dot2_f32_bf16 v67, v125, s35, v67
    v_dot2_f32_bf16 v68, v126, s34, v68
    v_dot2_f32_bf16 v69, v126, s35, v69
    v_dot2_f32_bf16 v70, v127, s34, v70
    v_dot2_f32_bf16 v71, v127, s35, v71
    v_pk_add_f32 v[8:9], v[8:9], v[62:63]
    v_pk_fma_f32 v[10:11], v[62:63], v[62:63], v[10:11]
    v_pk_add_f32 v[8:9], v[8:9], v[64:65]
    v_pk_fma_f32 v[10:11], v[64:65], v[64:65], v[10:11]
    v_pk_add_f32 v[8:9], v[8:9], v[66:67]
    v_pk_fma_f32 v[10:11], v[66:67], v[66:67], v[10:11]
    v_pk_add_f32 v[8:9], v[8:9], v[68:69]
    v_pk_fma_f32 v[10:11], v[68:69], v[68:69], v[10:11]
    v_pk_add_f32 v[8:9], v[8:9], v[70:71]
    v_pk_fma_f32 v[10:11], v[70:71], v[70:71], v[10:11]
    s_cmp_lg_u32 s13, 0
    s_cbranch_scc1 red_out
    v_add_f32 v8, v8, v9
    v_add_f32 v9, v10, v11
    s_nop 0
    v_add_f32_dpp v8, v8, v8 row_ror:8 row_mask:0xf bank_mask:0xf
    v_add_f32_dpp v9, v9, v9 row_ror:8 row_mask:0xf bank_mask:0xf
    v_mov_b32 v10, v8
    v_mov_b32 v11, v9
    s_nop 0
    v_permlane16_swap_b32 v8, v10
    v_permlane16_swap_b32 v9, v11
    v_add_f32 v8, v8, v10
    v_add_f32 v9, v9, v11
    v_mov_b32 v10, v8
    v_mov_b32 v11, v9
    s_nop 0
    v_permlane32_swap_b32 v8, v10
    v_permlane32_swap_b32 v9, v11
    v_add_f32 v8, v8, v10
    v_add_f32 v9, v9, v11
    ds_write_b64 v216, v[8:9]
    v_cvt_pk_bf16_f32 v80, v48, v49
    v_cvt_pk_bf16_f32 v81, v50, v51
    v_cvt_pk_bf16_f32 v82, v52, v53
    v_cvt_pk_bf16_f32 v83, v54, v55
    v_cvt_pk_bf16_f32 v84, v56, v57
    v_cvt_pk_bf16_f32 v85, v58, v59
    v_cvt_pk_bf16_f32 v86, v60, v61
    v_cvt_pk_bf16_f32 v87, v62, v63
    v_cvt_pk_bf16_f32 v88, v64, v65
    v_cvt_pk_bf16_f32 v89, v66, v67
    v_cvt_pk_bf16_f32 v90, v68, v69
    v_cvt_pk_bf16_f32 v91, v70, v71
    s_add_u32 s27, s31, 0x1d4000
    s_waitcnt lgkmcnt(0)
    s_barrier
    ds_read_b128 v[8:11], v217
    ds_read_b64 v[6:7], v217 offset:16
    buffer_store_dwordx4 v[80:83], v218, s[48:51], s27 offen sc1
    buffer_store_dwordx4 v[84:87], v12, s[48:51], s27 offen sc1
    buffer_store_dwordx4 v[88:91], v15, s[48:51], s27 offen sc1
    s_waitcnt lgkmcnt(1)
    v_add_f32 v8, v8, v10
    v_add_f32 v9, v9, v11
    s_waitcnt lgkmcnt(0)
    v_add_f32 v8, v8, v6
    v_add_f32 v9, v9, v7
    v_mul_f32 v8, 0x3ae38e39, v8
    v_mul_f32 v9, 0x3ae38e39, v9
    v_fma_f32 v9, -v8, v8, v9
    v_max_f32 v9, 0, v9
    v_add_f32 v9, 0x3727c5ac, v9
    v_rsq_f32 v9, v9
    s_add_u32 s27, s31, 0x1b0000
    v_mul_f32 v8, -v8, v9
    v_pk_fma_f32 v[48:49], v[48:49], v[8:9], v[8:9] op_sel:[0,1,0] op_sel_hi:[1,1,0]
    v_pk_fma_f32 v[50:51], v[50:51], v[8:9], v[8:9] op_sel:[0,1,0] op_sel_hi:[1,1,0]
    v_pk_fma_f32 v[52:53], v[52:53], v[8:9], v[8:9] op_sel:[0,1,0] op_sel_hi:[1,1,0]
    v_pk_fma_f32 v[54:55], v[54:55], v[8:9], v[8:9] op_sel:[0,1,0] op_sel_hi:[1,1,0]
    v_cvt_pk_bf16_f32 v152, v48, v49
    v_cvt_pk_bf16_f32 v153, v50, v51
    v_cvt_pk_bf16_f32 v154, v52, v53
    v_cvt_pk_bf16_f32 v155, v54, v55
    buffer_store_dwordx4 v[152:155], v218, s[48:51], s27 offen sc1
    v_pk_fma_f32 v[56:57], v[56:57], v[8:9], v[8:9] op_sel:[0,1,0] op_sel_hi:[1,1,0]
    v_pk_fma_f32 v[58:59], v[58:59], v[8:9], v[8:9] op_sel:[0,1,0] op_sel_hi:[1,1,0]
    v_pk_fma_f32 v[60:61], v[60:61], v[8:9], v[8:9] op_sel:[0,1,0] op_sel_hi:[1,1,0]
    v_pk_fma_f32 v[62:63], v[62:63], v[8:9], v[8:9] op_sel:[0,1,0] op_sel_hi:[1,1,0]
    v_cvt_pk_bf16_f32 v156, v56, v57
    v_cvt_pk_bf16_f32 v157, v58, v59
    v_cvt_pk_bf16_f32 v158, v60, v61
    v_cvt_pk_bf16_f32 v159, v62, v63
    buffer_store_dwordx4 v[156:159], v12, s[48:51], s27 offen sc1
    v_pk_fma_f32 v[64:65], v[64:65], v[8:9], v[8:9] op_sel:[0,1,0] op_sel_hi:[1,1,0]
    v_pk_fma_f32 v[66:67], v[66:67], v[8:9], v[8:9] op_sel:[0,1,0] op_sel_hi:[1,1,0]
    v_pk_fma_f32 v[68:69], v[68:69], v[8:9], v[8:9] op_sel:[0,1,0] op_sel_hi:[1,1,0]
    v_pk_fma_f32 v[70:71], v[70:71], v[8:9], v[8:9] op_sel:[0,1,0] op_sel_hi:[1,1,0]
    v_cvt_pk_bf16_f32 v160, v64, v65
    v_cvt_pk_bf16_f32 v161, v66, v67
    v_cvt_pk_bf16_f32 v162, v68, v69
    v_cvt_pk_bf16_f32 v163, v70, v71
    buffer_store_dwordx4 v[160:163], v15, s[48:51], s27 offen sc1
red_join:
    s_add_u32 s88, s88, 0xb4000
    s_addc_u32 s89, s89, 0
    s_mov_b32 s90, 0xb4000
    s_mov_b32 s13, 1
    s_cmp_lg_u32 s3, 0
    s_cmov_b32 s76, 1073741824
    v_mov_b32 v8, 1
    v_and_b32 v3, 3, v0
    v_mul_u32_u24 v3, 32, v3
    s_and_b32 s16, s10, 15
    s_mul_i32 s16, s16, 256
    s_lshr_b32 s17, s82, 16
    s_and_b32 s17, s17, 1
    s_lshl_b32 s17, s17, 13
    s_add_u32 s16, s16, s17
    s_add_u32 s16, s16, 622592
    s_add_u32 s45, s16, 128
    s_and_b32 s15, s10, 15
    s_lshr_b32 s24, s82, s15
    s_and_b32 s24, s24, 1
    s_lshl_b32 s24, s24, 13
    s_lshl_b32 s15, s15, 21
    s_add_u32 s24, s24, s15
    s_add_u32 s24, s24, 0x1b0000
    s_mov_b32 s84, 0
    s_mov_b32 s12, 1073741824
    s_mov_b32 s92, 1073741824
    s_mov_b32 s58, 0
    s_mov_b32 s44, 1073741824
    s_mov_b32 s47, 1073741824
    s_mov_b32 s86, 99
    s_mov_b32 s46, 99
    s_mov_b32 s98, 99
    s_mov_b32 s99, 99
    s_mov_b32 s100, 99
    s_mov_b32 s101, 99
    buffer_load_dword v4, v3, s[88:91], s16 offen sc1
    s_waitcnt vmcnt(1)
    s_barrier
    buffer_store_dword v8, v219, s[88:91], s76 offen sc1
    s_branch layer
red_out:
    v_cvt_pk_bf16_f32 v152, v48, v49
    v_cvt_pk_bf16_f32 v153, v50, v51
    v_cvt_pk_bf16_f32 v154, v52, v53
    v_cvt_pk_bf16_f32 v155, v54, v55
    s_waitcnt lgkmcnt(0)
    buffer_store_dwordx4 v[152:155], v13, s[52:55], s24 offen offset:0 nt
    v_cvt_pk_bf16_f32 v156, v56, v57
    v_cvt_pk_bf16_f32 v157, v58, v59
    v_cvt_pk_bf16_f32 v158, v60, v61
    v_cvt_pk_bf16_f32 v159, v62, v63
    buffer_store_dwordx4 v[156:159], v13, s[52:55], s24 offen offset:384 nt
    v_cvt_pk_bf16_f32 v160, v64, v65
    v_cvt_pk_bf16_f32 v161, v66, v67
    v_cvt_pk_bf16_f32 v162, v68, v69
    v_cvt_pk_bf16_f32 v163, v70, v71
    buffer_store_dwordx4 v[160:163], v13, s[52:55], s24 offen offset:768 nt
fin:
interleave_layers__mha_block__glu_gated_swiglu__prompt_end:
    s_endpgm
red_idle:
    s_waitcnt lgkmcnt(0)
    s_cmp_lg_u32 s13, 0
    s_cbranch_scc1 fin
    s_add_u32 s20, s11, 36864
    s_barrier
    s_mov_b32 m0, 110592
    s_nop 0
    buffer_load_dwordx4 v1, s[4:7], s20 offen offset:0 sc1 lds
    buffer_load_dwordx4 v1, s[4:7], s20 offen offset:1024 sc1 lds
    buffer_load_dwordx4 v1, s[4:7], s20 offen offset:2048 sc1 lds
    buffer_load_dwordx4 v1, s[4:7], s20 offen offset:3072 sc1 lds
    s_mov_b32 m0, 114688
    s_add_u32 s20, s20, 4096
    buffer_load_dwordx4 v1, s[4:7], s20 offen offset:0 sc1 lds
    buffer_load_dwordx4 v1, s[4:7], s20 offen offset:1024 sc1 lds
    buffer_load_dwordx4 v1, s[4:7], s20 offen offset:2048 sc1 lds
    buffer_load_dwordx4 v1, s[4:7], s20 offen offset:3072 sc1 lds
    s_mov_b32 m0, 118784
    s_add_u32 s20, s20, 4096
    buffer_load_dwordx4 v1, s[4:7], s20 offen offset:0 sc1 lds
    buffer_load_dwordx4 v1, s[4:7], s20 offen offset:1024 sc1 lds
    buffer_load_dwordx4 v1, s[4:7], s20 offen offset:2048 sc1 lds
    buffer_load_dwordx4 v1, s[4:7], s20 offen offset:3072 sc1 lds
    s_mov_b32 m0, 122880
    s_add_u32 s20, s20, 4096
    buffer_load_dwordx4 v1, s[4:7], s20 offen offset:0 sc1 lds
    buffer_load_dwordx4 v1, s[4:7], s20 offen offset:1024 sc1 lds
    buffer_load_dwordx4 v1, s[4:7], s20 offen offset:2048 sc1 lds
    buffer_load_dwordx4 v1, s[4:7], s20 offen offset:3072 sc1 lds
    s_mov_b32 m0, 126976
    s_add_u32 s20, s20, 4096
    buffer_load_dwordx4 v1, s[4:7], s20 offen offset:0 sc1 lds
    buffer_load_dwordx4 v1, s[4:7], s20 offen offset:1024 sc1 lds
    buffer_load_dwordx4 v1, s[4:7], s20 offen offset:2048 sc1 lds
    buffer_load_dwordx4 v1, s[4:7], s20 offen offset:3072 sc1 lds
    s_mov_b32 m0, 131072
    s_add_u32 s20, s20, 4096
    buffer_load_dwordx4 v1, s[4:7], s20 offen offset:0 sc1 lds
    buffer_load_dwordx4 v1, s[4:7], s20 offen offset:1024 sc1 lds
    buffer_load_dwordx4 v1, s[4:7], s20 offen offset:2048 sc1 lds
    buffer_load_dwordx4 v1, s[4:7], s20 offen offset:3072 sc1 lds
    s_mov_b32 m0, 135168
    s_add_u32 s20, s20, 4096
    buffer_load_dwordx4 v1, s[4:7], s20 offen offset:0 sc1 lds
    buffer_load_dwordx4 v1, s[4:7], s20 offen offset:1024 sc1 lds
    buffer_load_dwordx4 v1, s[4:7], s20 offen offset:2048 sc1 lds
    buffer_load_dwordx4 v1, s[4:7], s20 offen offset:3072 sc1 lds
    s_mov_b32 m0, 139264
    s_add_u32 s20, s20, 4096
    buffer_load_dwordx4 v1, s[4:7], s20 offen offset:0 sc1 lds
    buffer_load_dwordx4 v1, s[4:7], s20 offen offset:1024 sc1 lds
    buffer_load_dwordx4 v1, s[4:7], s20 offen offset:2048 sc1 lds
    buffer_load_dwordx4 v1, s[4:7], s20 offen offset:3072 sc1 lds
    s_mov_b32 m0, 143360
    s_add_u32 s20, s20, 4096
    buffer_load_dwordx4 v1, s[4:7], s20 offen offset:0 sc1 lds
    buffer_load_dwordx4 v1, s[4:7], s20 offen offset:1024 sc1 lds
    buffer_load_dwordx4 v1, s[4:7], s20 offen offset:2048 sc1 lds
    buffer_load_dwordx4 v1, s[4:7], s20 offen offset:3072 sc1 lds
    s_barrier
    s_branch red_join
spin0:
    s_sub_u32 s14, s14, 1
    s_cbranch_scc1 spin0_out
    buffer_load_dword v9, v14, s[52:55], 0 offen sc1
    s_waitcnt vmcnt(0)
    v_cmp_gt_u32 vcc, 1, v9
    s_nop 0
    s_cbranch_vccnz spin0
    s_branch back0
spin0_out:
    s_mov_b32 s14, 0
    s_branch back0
spin1:
    s_sub_u32 s14, s14, 1
    s_cbranch_scc1 spin1_out
    buffer_load_dword v246, v245, s[88:91], s45 offen sc1
    s_waitcnt vmcnt(0)
    v_cmp_gt_u32 vcc, 1, v246
    s_nop 0
    s_cbranch_vccnz spin1
    s_branch back1
spin1_out:
    s_mov_b32 s14, 0
    s_branch back1
spin2_out:
    s_mov_b32 s14, 0
    s_waitcnt vmcnt(0)
    s_branch back2
spin3:
    s_sub_u32 s14, s14, 1
    s_cbranch_scc1 spin3_out
    buffer_load_dword v246, v166, s[88:91], s45 offen sc1
    s_waitcnt vmcnt(0)
    v_cmp_gt_u32 vcc, s13, v246
    s_nop 0
    s_cbranch_vccnz spin3
    s_branch back3
spin3_out:
    s_mov_b32 s14, 0
    s_branch back3
spin4:
    s_sub_u32 s14, s14, 1
    s_cbranch_scc1 spin4_out
    buffer_load_dword v246, v247, s[88:91], s44 offen sc1
    s_waitcnt vmcnt(0)
    v_cmp_gt_u32 vcc, s84, v246
    s_nop 0
    s_cbranch_vccnz spin4
    s_branch back4
spin4_out:
    s_mov_b32 s14, 0
    s_branch back4
spin5:
    s_sub_u32 s14, s14, 1
    s_cbranch_scc1 spin5_out
    buffer_load_dword v8, v175, s[88:91], s41 offen sc1
    s_waitcnt vmcnt(0)
    v_cmp_gt_u32 vcc, 1, v8
    s_nop 0
    s_cbranch_vccnz spin5
    s_branch back5
spin5_out:
    s_mov_b32 s14, 0
    s_branch back5
spin6:
    s_sub_u32 s14, s14, 1
    s_cbranch_scc1 spin6_out
    buffer_load_dword v9, v167, s[88:91], s41 offen sc1
    s_waitcnt vmcnt(0)
    v_cmp_gt_u32 vcc, 1, v9
    s_nop 0
    s_cbranch_vccnz spin6
    s_branch back6
spin6_out:
    s_mov_b32 s14, 0
    s_branch back6
spin7:
    s_sub_u32 s14, s14, 1
    s_cbranch_scc1 spin7_out
    buffer_load_dword v246, v245, s[88:91], s47 offen sc1
    s_waitcnt vmcnt(0)
    v_cmp_gt_u32 vcc, s84, v246
    s_nop 0
    s_cbranch_vccnz spin7
    s_branch back7
spin7_out:
    s_mov_b32 s14, 0
    s_branch back7
spin8:
    s_sub_u32 s14, s14, 1
    s_cbranch_scc1 spin8_out
    buffer_load_dword v243, v241, s[88:91], s42 offen sc1
    s_waitcnt vmcnt(0)
    v_cmp_gt_u32 vcc, s83, v243
    s_nop 0
    s_cbranch_vccnz spin8
    s_branch back8
spin8_out:
    s_mov_b32 s14, 0
    s_branch back8
spin9_out:
    s_mov_b32 s14, 0
    s_waitcnt vmcnt(0)
    s_branch back9
spin10_out:
    s_mov_b32 s14, 0
    s_waitcnt vmcnt(0)
    s_branch back10
spin11:
    s_sub_u32 s14, s14, 1
    s_cbranch_scc1 spin11_out
    buffer_load_dword v9, v7, s[88:91], s17 offen sc1
    s_waitcnt vmcnt(0)
    v_cmp_gt_u32 vcc, 1, v9
    s_nop 0
    s_cbranch_vccnz spin11
    s_branch back11
spin11_out:
    s_mov_b32 s14, 0
    s_branch back11
spin12:
    s_sub_u32 s14, s14, 1
    s_cbranch_scc1 spin12_out
    buffer_load_dword v9, v7, s[88:91], s17 offen sc1
    s_waitcnt vmcnt(0)
    v_cmp_gt_u32 vcc, 2, v9
    s_nop 0
    s_cbranch_vccnz spin12
    s_branch back12
spin12_out:
    s_mov_b32 s14, 0
    s_branch back12
spin13:
    s_sub_u32 s14, s14, 1
    s_cbranch_scc1 spin13_out
    buffer_load_dword v9, v7, s[88:91], s17 offen sc1
    s_waitcnt vmcnt(0)
    v_cmp_gt_u32 vcc, 3, v9
    s_nop 0
    s_cbranch_vccnz spin13
    s_branch back13
spin13_out:
    s_mov_b32 s14, 0
    s_branch back13
spin14_out:
    s_mov_b32 s14, 0
    s_waitcnt vmcnt(0)
    s_branch back14
pack_blk:
    v_add_u32 v6, 0x8000, v244
    s_cmp_ge_u32 s2, 144
    s_cbranch_scc1 pack_w2
    v_add_u32 v7, s87, v1
    ds_read_b128 v[8:11], v7
    ds_read_b128 a[0:3], v244 offset:0
    ds_read_b128 a[4:7], v244 offset:512
    ds_read_b128 a[8:11], v244 offset:4096
    ds_read_b128 a[12:15], v244 offset:4608
    ds_read_b128 a[16:19], v244 offset:8192
    ds_read_b128 a[20:23], v244 offset:8704
    s_waitcnt lgkmcnt(5)
    v_mfma_f32_16x16x32_bf16 v[12:15], a[0:3], v[8:11], 0
    ds_read_b128 a[24:27], v244 offset:12288
    s_waitcnt lgkmcnt(5)
    v_mfma_f32_16x16x32_bf16 v[12:15], a[4:7], v[8:11], v[12:15]
    ds_read_b128 a[28:31], v244 offset:12800
    s_waitcnt lgkmcnt(5)
    v_mfma_f32_16x16x32_bf16 v[12:15], a[8:11], v[8:11], v[12:15]
    ds_read_b128 a[32:35], v244 offset:16384
    s_waitcnt lgkmcnt(5)
    v_mfma_f32_16x16x32_bf16 v[12:15], a[12:15], v[8:11], v[12:15]
    ds_read_b128 a[36:39], v244 offset:16896
    s_waitcnt lgkmcnt(5)
    v_mfma_f32_16x16x32_bf16 v[12:15], a[16:19], v[8:11], v[12:15]
    ds_read_b128 a[40:43], v244 offset:20480
    s_waitcnt lgkmcnt(5)
    v_mfma_f32_16x16x32_bf16 v[12:15], a[20:23], v[8:11], v[12:15]
    ds_read_b128 a[44:47], v244 offset:20992
    s_waitcnt lgkmcnt(5)
    v_mfma_f32_16x16x32_bf16 v[12:15], a[24:27], v[8:11], v[12:15]
    ds_read_b128 a[48:51], v244 offset:24576
    s_waitcnt lgkmcnt(5)
    v_mfma_f32_16x16x32_bf16 v[12:15], a[28:31], v[8:11], v[12:15]
    ds_read_b128 a[52:55], v244 offset:25088
    s_waitcnt lgkmcnt(5)
    v_mfma_f32_16x16x32_bf16 v[12:15], a[32:35], v[8:11], v[12:15]
    ds_read_b128 a[56:59], v244 offset:28672
    s_waitcnt lgkmcnt(5)
    v_mfma_f32_16x16x32_bf16 v[12:15], a[36:39], v[8:11], v[12:15]
    ds_read_b128 a[60:63], v244 offset:29184
    s_waitcnt lgkmcnt(5)
    v_mfma_f32_16x16x32_bf16 v[12:15], a[40:43], v[8:11], v[12:15]
    ds_read_b128 a[64:67], v244 offset:32768
    s_waitcnt lgkmcnt(5)
    v_mfma_f32_16x16x32_bf16 v[12:15], a[44:47], v[8:11], v[12:15]
    ds_read_b128 a[68:71], v244 offset:33280
    s_waitcnt lgkmcnt(5)
    v_mfma_f32_16x16x32_bf16 v[12:15], a[48:51], v[8:11], v[12:15]
    ds_read_b128 a[72:75], v244 offset:36864
    s_waitcnt lgkmcnt(5)
    v_mfma_f32_16x16x32_bf16 v[12:15], a[52:55], v[8:11], v[12:15]
    ds_read_b128 a[76:79], v244 offset:37376
    s_waitcnt lgkmcnt(5)
    v_mfma_f32_16x16x32_bf16 v[12:15], a[56:59], v[8:11], v[12:15]
    ds_read_b128 a[80:83], v244 offset:40960
    s_waitcnt lgkmcnt(5)
    v_mfma_f32_16x16x32_bf16 v[12:15], a[60:63], v[8:11], v[12:15]
    ds_read_b128 a[84:87], v244 offset:41472
    s_waitcnt lgkmcnt(5)
    v_mfma_f32_16x16x32_bf16 v[12:15], a[64:67], v[8:11], v[12:15]
    ds_read_b128 a[88:91], v244 offset:45056
    s_waitcnt lgkmcnt(5)
    v_mfma_f32_16x16x32_bf16 v[12:15], a[68:71], v[8:11], v[12:15]
    ds_read_b128 a[92:95], v244 offset:45568
    s_waitcnt lgkmcnt(5)
    v_mfma_f32_16x16x32_bf16 v[12:15], a[72:75], v[8:11], v[12:15]
    ds_read_b128 a[96:99], v6 offset:16384
    s_waitcnt lgkmcnt(5)
    v_mfma_f32_16x16x32_bf16 v[12:15], a[76:79], v[8:11], v[12:15]
    ds_read_b128 a[100:103], v6 offset:16896
    s_waitcnt lgkmcnt(5)
    v_mfma_f32_16x16x32_bf16 v[12:15], a[80:83], v[8:11], v[12:15]
    ds_read_b128 a[104:107], v6 offset:20480
    s_waitcnt lgkmcnt(5)
    v_mfma_f32_16x16x32_bf16 v[12:15], a[84:87], v[8:11], v[12:15]
    ds_read_b128 a[108:111], v6 offset:20992
    s_waitcnt lgkmcnt(5)
    v_mfma_f32_16x16x32_bf16 v[12:15], a[88:91], v[8:11], v[12:15]
    ds_read_b128 a[112:115], v6 offset:24576
    s_waitcnt lgkmcnt(5)
    v_mfma_f32_16x16x32_bf16 v[12:15], a[92:95], v[8:11], v[12:15]
    ds_read_b128 a[116:119], v6 offset:25088
    s_waitcnt lgkmcnt(5)
    v_mfma_f32_16x16x32_bf16 v[12:15], a[96:99], v[8:11], v[12:15]
    ds_read_b128 a[120:123], v6 offset:28672
    s_waitcnt lgkmcnt(5)
    v_mfma_f32_16x16x32_bf16 v[12:15], a[100:103], v[8:11], v[12:15]
    ds_read_b128 a[124:127], v6 offset:29184
    s_waitcnt lgkmcnt(5)
    v_mfma_f32_16x16x32_bf16 v[12:15], a[104:107], v[8:11], v[12:15]
    ds_read_b128 a[128:131], v6 offset:32768
    s_waitcnt lgkmcnt(5)
    v_mfma_f32_16x16x32_bf16 v[12:15], a[108:111], v[8:11], v[12:15]
    ds_read_b128 a[132:135], v6 offset:33280
    s_waitcnt lgkmcnt(5)
    v_mfma_f32_16x16x32_bf16 v[12:15], a[112:115], v[8:11], v[12:15]
    ds_read_b128 a[136:139], v6 offset:36864
    s_waitcnt lgkmcnt(5)
    v_mfma_f32_16x16x32_bf16 v[12:15], a[116:119], v[8:11], v[12:15]
    ds_read_b128 a[140:143], v6 offset:37376
    s_waitcnt lgkmcnt(5)
    v_mfma_f32_16x16x32_bf16 v[12:15], a[120:123], v[8:11], v[12:15]
    s_waitcnt lgkmcnt(4)
    v_mfma_f32_16x16x32_bf16 v[12:15], a[124:127], v[8:11], v[12:15]
    s_waitcnt lgkmcnt(3)
    v_mfma_f32_16x16x32_bf16 v[12:15], a[128:131], v[8:11], v[12:15]
    s_waitcnt lgkmcnt(2)
    v_mfma_f32_16x16x32_bf16 v[12:15], a[132:135], v[8:11], v[12:15]
    s_waitcnt lgkmcnt(1)
    v_mfma_f32_16x16x32_bf16 v[12:15], a[136:139], v[8:11], v[12:15]
    s_waitcnt lgkmcnt(0)
    v_mfma_f32_16x16x32_bf16 v[12:15], a[140:143], v[8:11], v[12:15]
    s_nop 7
    v_add_f32 v12, v12, v13
    v_add_f32 v14, v14, v15
    v_add_f32 v12, v12, v14
    v_mov_b32 v13, v12
    s_nop 1
    v_permlane16_swap_b32 v12, v13
    v_add_f32 v12, v12, v13
    v_mov_b32 v13, v12
    s_nop 1
    v_permlane32_swap_b32 v12, v13
    v_add_f32 v12, v12, v13
    v_mul_f32 v15, 0xbae38e39, v12
    v_mul_f32 v14, 0xbae38e39, v12
    v_mul_f32 v13, 0xbae38e39, v12
    v_mul_f32 v12, 0xbae38e39, v12
    s_nop 1
    v_mfma_f32_16x16x32_bf16 v[176:179], a[0:3], v[8:11], v[12:15]
    v_mfma_f32_16x16x32_bf16 v[180:183], a[4:7], v[8:11], v[12:15]
    v_mfma_f32_16x16x32_bf16 v[184:187], a[8:11], v[8:11], v[12:15]
    v_mfma_f32_16x16x32_bf16 v[188:191], a[12:15], v[8:11], v[12:15]
    v_mfma_f32_16x16x32_bf16 v[192:195], a[16:19], v[8:11], v[12:15]
    s_nop 3
    v_cvt_pk_bf16_f32 v160, v176, v177
    v_mfma_f32_16x16x32_bf16 v[196:199], a[20:23], v[8:11], v[12:15]
    v_cvt_pk_bf16_f32 v161, v178, v179
    v_cvt_pk_bf16_f32 v162, v180, v181
    v_cvt_pk_bf16_f32 v163, v182, v183
    v_mfma_f32_16x16x32_bf16 v[200:203], a[24:27], v[8:11], v[12:15]
    buffer_store_dwordx4 v[160:163], v1, s[4:7], s94 offen sc1
    v_cvt_pk_bf16_f32 v164, v184, v185
    v_mfma_f32_16x16x32_bf16 v[204:207], a[28:31], v[8:11], v[12:15]
    v_cvt_pk_bf16_f32 v165, v186, v187
    v_cvt_pk_bf16_f32 v166, v188, v189
    v_cvt_pk_bf16_f32 v167, v190, v191
    v_mfma_f32_16x16x32_bf16 v[176:179], a[32:35], v[8:11], v[12:15]
    s_add_u32 s94, s94, s95
    buffer_store_dwordx4 v[164:167], v1, s[4:7], s94 offen sc1
    v_cvt_pk_bf16_f32 v168, v192, v193
    v_mfma_f32_16x16x32_bf16 v[180:183], a[36:39], v[8:11], v[12:15]
    v_cvt_pk_bf16_f32 v169, v194, v195
    v_cvt_pk_bf16_f32 v170, v196, v197
    v_cvt_pk_bf16_f32 v171, v198, v199
    v_mfma_f32_16x16x32_bf16 v[184:187], a[40:43], v[8:11], v[12:15]
    s_add_u32 s94, s94, s95
    buffer_store_dwordx4 v[168:171], v1, s[4:7], s94 offen sc1
    v_cvt_pk_bf16_f32 v160, v200, v201
    v_mfma_f32_16x16x32_bf16 v[188:191], a[44:47], v[8:11], v[12:15]
    v_cvt_pk_bf16_f32 v161, v202, v203
    v_cvt_pk_bf16_f32 v162, v204, v205
    v_cvt_pk_bf16_f32 v163, v206, v207
    v_mfma_f32_16x16x32_bf16 v[192:195], a[48:51], v[8:11], v[12:15]
    s_add_u32 s94, s94, s95
    buffer_store_dwordx4 v[160:163], v1, s[4:7], s94 offen sc1
    v_cvt_pk_bf16_f32 v164, v176, v177
    v_mfma_f32_16x16x32_bf16 v[196:199], a[52:55], v[8:11], v[12:15]
    v_cvt_pk_bf16_f32 v165, v178, v179
    v_cvt_pk_bf16_f32 v166, v180, v181
    v_cvt_pk_bf16_f32 v167, v182, v183
    v_mfma_f32_16x16x32_bf16 v[200:203], a[56:59], v[8:11], v[12:15]
    s_add_u32 s94, s94, s95
    buffer_store_dwordx4 v[164:167], v1, s[4:7], s94 offen sc1
    v_cvt_pk_bf16_f32 v168, v184, v185
    v_mfma_f32_16x16x32_bf16 v[204:207], a[60:63], v[8:11], v[12:15]
    v_cvt_pk_bf16_f32 v169, v186, v187
    v_cvt_pk_bf16_f32 v170, v188, v189
    v_cvt_pk_bf16_f32 v171, v190, v191
    v_mfma_f32_16x16x32_bf16 v[176:179], a[64:67], v[8:11], v[12:15]
    s_add_u32 s94, s94, s95
    buffer_store_dwordx4 v[168:171], v1, s[4:7], s94 offen sc1
    v_cvt_pk_bf16_f32 v160, v192, v193
    v_mfma_f32_16x16x32_bf16 v[180:183], a[68:71], v[8:11], v[12:15]
    v_cvt_pk_bf16_f32 v161, v194, v195
    v_cvt_pk_bf16_f32 v162, v196, v197
    v_cvt_pk_bf16_f32 v163, v198, v199
    v_mfma_f32_16x16x32_bf16 v[184:187], a[72:75], v[8:11], v[12:15]
    s_add_u32 s94, s94, s95
    buffer_store_dwordx4 v[160:163], v1, s[4:7], s94 offen sc1
    v_cvt_pk_bf16_f32 v164, v200, v201
    v_mfma_f32_16x16x32_bf16 v[188:191], a[76:79], v[8:11], v[12:15]
    v_cvt_pk_bf16_f32 v165, v202, v203
    v_cvt_pk_bf16_f32 v166, v204, v205
    v_cvt_pk_bf16_f32 v167, v206, v207
    v_mfma_f32_16x16x32_bf16 v[192:195], a[80:83], v[8:11], v[12:15]
    s_add_u32 s94, s94, s95
    buffer_store_dwordx4 v[164:167], v1, s[4:7], s94 offen sc1
    v_cvt_pk_bf16_f32 v168, v176, v177
    v_mfma_f32_16x16x32_bf16 v[196:199], a[84:87], v[8:11], v[12:15]
    v_cvt_pk_bf16_f32 v169, v178, v179
    v_cvt_pk_bf16_f32 v170, v180, v181
    v_cvt_pk_bf16_f32 v171, v182, v183
    v_mfma_f32_16x16x32_bf16 v[200:203], a[88:91], v[8:11], v[12:15]
    s_add_u32 s94, s94, s95
    buffer_store_dwordx4 v[168:171], v1, s[4:7], s94 offen sc1
    v_cvt_pk_bf16_f32 v160, v184, v185
    v_mfma_f32_16x16x32_bf16 v[204:207], a[92:95], v[8:11], v[12:15]
    v_cvt_pk_bf16_f32 v161, v186, v187
    v_cvt_pk_bf16_f32 v162, v188, v189
    v_cvt_pk_bf16_f32 v163, v190, v191
    v_mfma_f32_16x16x32_bf16 v[176:179], a[96:99], v[8:11], v[12:15]
    s_add_u32 s94, s94, s95
    buffer_store_dwordx4 v[160:163], v1, s[4:7], s94 offen sc1
    v_cvt_pk_bf16_f32 v164, v192, v193
    v_mfma_f32_16x16x32_bf16 v[180:183], a[100:103], v[8:11], v[12:15]
    v_cvt_pk_bf16_f32 v165, v194, v195
    v_cvt_pk_bf16_f32 v166, v196, v197
    v_cvt_pk_bf16_f32 v167, v198, v199
    v_mfma_f32_16x16x32_bf16 v[184:187], a[104:107], v[8:11], v[12:15]
    s_add_u32 s94, s94, s95
    buffer_store_dwordx4 v[164:167], v1, s[4:7], s94 offen sc1
    v_cvt_pk_bf16_f32 v168, v200, v201
    v_mfma_f32_16x16x32_bf16 v[188:191], a[108:111], v[8:11], v[12:15]
    v_cvt_pk_bf16_f32 v169, v202, v203
    v_cvt_pk_bf16_f32 v170, v204, v205
    v_cvt_pk_bf16_f32 v171, v206, v207
    v_mfma_f32_16x16x32_bf16 v[192:195], a[112:115], v[8:11], v[12:15]
    s_add_u32 s94, s94, s95
    buffer_store_dwordx4 v[168:171], v1, s[4:7], s94 offen sc1
    v_cvt_pk_bf16_f32 v160, v176, v177
    v_mfma_f32_16x16x32_bf16 v[196:199], a[116:119], v[8:11], v[12:15]
    v_cvt_pk_bf16_f32 v161, v178, v179
    v_cvt_pk_bf16_f32 v162, v180, v181
    v_cvt_pk_bf16_f32 v163, v182, v183
    v_mfma_f32_16x16x32_bf16 v[200:203], a[120:123], v[8:11], v[12:15]
    s_add_u32 s94, s94, s95
    buffer_store_dwordx4 v[160:163], v1, s[4:7], s94 offen sc1
    v_cvt_pk_bf16_f32 v164, v184, v185
    v_mfma_f32_16x16x32_bf16 v[204:207], a[124:127], v[8:11], v[12:15]
    v_cvt_pk_bf16_f32 v165, v186, v187
    v_cvt_pk_bf16_f32 v166, v188, v189
    v_cvt_pk_bf16_f32 v167, v190, v191
    v_mfma_f32_16x16x32_bf16 v[176:179], a[128:131], v[8:11], v[12:15]
    s_add_u32 s94, s94, s95
    buffer_store_dwordx4 v[164:167], v1, s[4:7], s94 offen sc1
    v_cvt_pk_bf16_f32 v168, v192, v193
    v_mfma_f32_16x16x32_bf16 v[180:183], a[132:135], v[8:11], v[12:15]
    v_cvt_pk_bf16_f32 v169, v194, v195
    v_cvt_pk_bf16_f32 v170, v196, v197
    v_cvt_pk_bf16_f32 v171, v198, v199
    v_mfma_f32_16x16x32_bf16 v[184:187], a[136:139], v[8:11], v[12:15]
    s_add_u32 s94, s94, s95
    buffer_store_dwordx4 v[168:171], v1, s[4:7], s94 offen sc1
    v_cvt_pk_bf16_f32 v160, v200, v201
    v_mfma_f32_16x16x32_bf16 v[188:191], a[140:143], v[8:11], v[12:15]
    v_cvt_pk_bf16_f32 v161, v202, v203
    v_cvt_pk_bf16_f32 v162, v204, v205
    v_cvt_pk_bf16_f32 v163, v206, v207
    s_add_u32 s94, s94, s95
    buffer_store_dwordx4 v[160:163], v1, s[4:7], s94 offen sc1
    v_cvt_pk_bf16_f32 v164, v176, v177
    v_cvt_pk_bf16_f32 v165, v178, v179
    v_cvt_pk_bf16_f32 v166, v180, v181
    v_cvt_pk_bf16_f32 v167, v182, v183
    s_add_u32 s94, s94, s95
    buffer_store_dwordx4 v[164:167], v1, s[4:7], s94 offen sc1
    v_cvt_pk_bf16_f32 v168, v184, v185
    v_cvt_pk_bf16_f32 v169, v186, v187
    v_cvt_pk_bf16_f32 v170, v188, v189
    v_cvt_pk_bf16_f32 v171, v190, v191
    s_add_u32 s94, s94, s95
    buffer_store_dwordx4 v[168:171], v1, s[4:7], s94 offen sc1
    s_branch pack_ret
pack_probe:
    s_add_u32 s95, s94, 8192
    s_mov_b32 s87, -1
    s_mov_b32 s15, -1
    s_mov_b32 s20, 2
    v_lshlrev_b32 v8, 11, v0
    s_waitcnt vmcnt(0)
    s_barrier
    s_cmp_lg_u32 s3, 0
    s_cbranch_scc1 probe_end
    s_mov_b64 exec, 1
probe_l:
    s_memtime s[44:45]
    s_waitcnt lgkmcnt(0)
    buffer_load_dword v10, v8, s[48:51], s94 offen sc1
    s_waitcnt vmcnt(0)
    s_memtime s[18:19]
    s_waitcnt lgkmcnt(0)
    buffer_load_dword v10, v8, s[48:51], s95 offen sc1
    s_sub_u32 s44, s18, s44
    s_min_u32 s15, s15, s44
    s_waitcnt vmcnt(0)
    s_memtime s[44:45]
    v_add_u32 v8, 512, v8
    s_waitcnt lgkmcnt(0)
    s_sub_u32 s44, s44, s18
    s_min_u32 s87, s87, s44
    s_sub_u32 s20, s20, 1
    s_cmp_lg_u32 s20, 0
    s_cbranch_scc1 probe_l
    s_mov_b64 exec, -1
    s_cmp_lt_u32 s87, s15
    s_cselect_b32 s95, 1, 0
probe_end:
    s_barrier
    s_branch hook6
pack_w2:
    v_add_u32 v7, 151552, v1
    ds_read_b128 v[8:11], v7 offset:0
    ds_read_b128 v[12:15], v7 offset:1024
    ds_read_b128 v[208:211], v7 offset:2048
    ds_read_b128 v[212:215], v7 offset:3072
    ds_read_b128 a[0:3], v244 offset:0
    ds_read_b128 a[4:7], v244 offset:4608
    ds_read_b128 a[8:11], v244 offset:64
    ds_read_b128 a[12:15], v244 offset:4672
    ds_read_b128 a[16:19], v244 offset:128
    ds_read_b128 a[20:23], v244 offset:4736
    s_waitcnt lgkmcnt(5)
    v_mfma_f32_16x16x32_bf16 v[176:179], a[0:3], v[8:11], 0
    s_waitcnt lgkmcnt(4)
    v_mfma_f32_16x16x32_bf16 v[180:183], a[4:7], v[8:11], 0
    ds_read_b128 a[24:27], v244 offset:192
    v_mfma_f32_16x16x32_bf16 v[184:187], a[0:3], v[12:15], 0
    v_mfma_f32_16x16x32_bf16 v[188:191], a[4:7], v[12:15], 0
    ds_read_b128 a[28:31], v244 offset:4800
    s_waitcnt lgkmcnt(5)
    v_mfma_f32_16x16x32_bf16 v[192:195], a[8:11], v[8:11], 0
    v_cvt_pk_bf16_f32 v160, v176, v177
    s_waitcnt lgkmcnt(4)
    v_mfma_f32_16x16x32_bf16 v[196:199], a[12:15], v[8:11], 0
    ds_read_b128 a[32:35], v244 offset:256
    v_cvt_pk_bf16_f32 v161, v178, v179
    v_cvt_pk_bf16_f32 v162, v180, v181
    v_cvt_pk_bf16_f32 v163, v182, v183
    v_mfma_f32_16x16x32_bf16 v[200:203], a[8:11], v[12:15], 0
    s_add_u32 s15, s94, 0
    buffer_store_dwordx4 v[160:163], v1, s[4:7], s15 offen sc1
    v_cvt_pk_bf16_f32 v164, v184, v185
    v_mfma_f32_16x16x32_bf16 v[204:207], a[12:15], v[12:15], 0
    ds_read_b128 a[36:39], v244 offset:4864
    v_cvt_pk_bf16_f32 v165, v186, v187
    v_cvt_pk_bf16_f32 v166, v188, v189
    v_cvt_pk_bf16_f32 v167, v190, v191
    s_waitcnt lgkmcnt(5)
    v_mfma_f32_16x16x32_bf16 v[176:179], a[16:19], v[8:11], 0
    s_add_u32 s15, s94, 1024
    buffer_store_dwordx4 v[164:167], v1, s[4:7], s15 offen sc1
    v_cvt_pk_bf16_f32 v168, v192, v193
    s_waitcnt lgkmcnt(4)
    v_mfma_f32_16x16x32_bf16 v[180:183], a[20:23], v[8:11], 0
    ds_read_b128 a[40:43], v244 offset:320
    v_cvt_pk_bf16_f32 v169, v194, v195
    v_cvt_pk_bf16_f32 v170, v196, v197
    v_cvt_pk_bf16_f32 v171, v198, v199
    v_mfma_f32_16x16x32_bf16 v[184:187], a[16:19], v[12:15], 0
    s_add_u32 s15, s94, 2048
    buffer_store_dwordx4 v[168:171], v1, s[4:7], s15 offen sc1
    v_cvt_pk_bf16_f32 v160, v200, v201
    v_mfma_f32_16x16x32_bf16 v[188:191], a[20:23], v[12:15], 0
    ds_read_b128 a[44:47], v244 offset:4928
    v_cvt_pk_bf16_f32 v161, v202, v203
    v_cvt_pk_bf16_f32 v162, v204, v205
    v_cvt_pk_bf16_f32 v163, v206, v207
    s_waitcnt lgkmcnt(5)
    v_mfma_f32_16x16x32_bf16 v[192:195], a[24:27], v[8:11], 0
    s_add_u32 s15, s94, 3072
    buffer_store_dwordx4 v[160:163], v1, s[4:7], s15 offen sc1
    v_cvt_pk_bf16_f32 v164, v176, v177
    s_waitcnt lgkmcnt(4)
    v_mfma_f32_16x16x32_bf16 v[196:199], a[28:31], v[8:11], 0
    ds_read_b128 a[48:51], v244 offset:384
    v_cvt_pk_bf16_f32 v165, v178, v179
    v_cvt_pk_bf16_f32 v166, v180, v181
    v_cvt_pk_bf16_f32 v167, v182, v183
    v_mfma_f32_16x16x32_bf16 v[200:203], a[24:27], v[12:15], 0
    s_add_u32 s15, s94, 4096
    buffer_store_dwordx4 v[164:167], v1, s[4:7], s15 offen sc1
    v_cvt_pk_bf16_f32 v168, v184, v185
    v_mfma_f32_16x16x32_bf16 v[204:207], a[28:31], v[12:15], 0
    ds_read_b128 a[52:55], v244 offset:4992
    v_cvt_pk_bf16_f32 v169, v186, v187
    v_cvt_pk_bf16_f32 v170, v188, v189
    v_cvt_pk_bf16_f32 v171, v190, v191
    s_waitcnt lgkmcnt(5)
    v_mfma_f32_16x16x32_bf16 v[176:179], a[32:35], v[208:211], 0
    s_add_u32 s15, s94, 5120
    buffer_store_dwordx4 v[168:171], v1, s[4:7], s15 offen sc1
    v_cvt_pk_bf16_f32 v160, v192, v193
    s_waitcnt lgkmcnt(4)
    v_mfma_f32_16x16x32_bf16 v[180:183], a[36:39], v[208:211], 0
    ds_read_b128 a[56:59], v244 offset:448
    v_cvt_pk_bf16_f32 v161, v194, v195
    v_cvt_pk_bf16_f32 v162, v196, v197
    v_cvt_pk_bf16_f32 v163, v198, v199
    v_mfma_f32_16x16x32_bf16 v[184:187], a[32:35], v[212:215], 0
    s_add_u32 s15, s94, 6144
    buffer_store_dwordx4 v[160:163], v1, s[4:7], s15 offen sc1
    v_cvt_pk_bf16_f32 v164, v200, v201
    v_mfma_f32_16x16x32_bf16 v[188:191], a[36:39], v[212:215], 0
    ds_read_b128 a[60:63], v244 offset:5056
    v_cvt_pk_bf16_f32 v165, v202, v203
    v_cvt_pk_bf16_f32 v166, v204, v205
    v_cvt_pk_bf16_f32 v167, v206, v207
    s_waitcnt lgkmcnt(5)
    v_mfma_f32_16x16x32_bf16 v[192:195], a[40:43], v[8:11], 0
    s_add_u32 s15, s94, 7168
    buffer_store_dwordx4 v[164:167], v1, s[4:7], s15 offen sc1
    v_cvt_pk_bf16_f32 v168, v176, v177
    s_waitcnt lgkmcnt(4)
    v_mfma_f32_16x16x32_bf16 v[196:199], a[44:47], v[8:11], 0
    ds_read_b128 a[64:67], v244 offset:512
    v_cvt_pk_bf16_f32 v169, v178, v179
    v_cvt_pk_bf16_f32 v170, v180, v181
    v_cvt_pk_bf16_f32 v171, v182, v183
    v_mfma_f32_16x16x32_bf16 v[200:203], a[40:43], v[12:15], 0
    s_add_u32 s15, s94, 8192
    buffer_store_dwordx4 v[168:171], v1, s[4:7], s15 offen sc1
    v_cvt_pk_bf16_f32 v160, v184, v185
    v_mfma_f32_16x16x32_bf16 v[204:207], a[44:47], v[12:15], 0
    ds_read_b128 a[68:71], v244 offset:5120
    v_cvt_pk_bf16_f32 v161, v186, v187
    v_cvt_pk_bf16_f32 v162, v188, v189
    v_cvt_pk_bf16_f32 v163, v190, v191
    s_waitcnt lgkmcnt(5)
    v_mfma_f32_16x16x32_bf16 v[176:179], a[48:51], v[8:11], 0
    s_add_u32 s15, s94, 339968
    buffer_store_dwordx4 v[160:163], v1, s[4:7], s15 offen sc1
    v_cvt_pk_bf16_f32 v164, v192, v193
    s_waitcnt lgkmcnt(4)
    v_mfma_f32_16x16x32_bf16 v[180:183], a[52:55], v[8:11], 0
    v_cvt_pk_bf16_f32 v165, v194, v195
    v_cvt_pk_bf16_f32 v166, v196, v197
    v_cvt_pk_bf16_f32 v167, v198, v199
    v_mfma_f32_16x16x32_bf16 v[184:187], a[48:51], v[12:15], 0
    s_add_u32 s15, s94, 331776
    buffer_store_dwordx4 v[164:167], v1, s[4:7], s15 offen sc1
    v_cvt_pk_bf16_f32 v168, v200, v201
    v_mfma_f32_16x16x32_bf16 v[188:191], a[52:55], v[12:15], 0
    v_cvt_pk_bf16_f32 v169, v202, v203
    v_cvt_pk_bf16_f32 v170, v204, v205
    v_cvt_pk_bf16_f32 v171, v206, v207
    s_waitcnt lgkmcnt(3)
    v_mfma_f32_16x16x32_bf16 v[192:195], a[56:59], v[8:11], 0
    s_add_u32 s15, s94, 332800
    buffer_store_dwordx4 v[168:171], v1, s[4:7], s15 offen sc1
    v_cvt_pk_bf16_f32 v160, v176, v177
    s_waitcnt lgkmcnt(2)
    v_mfma_f32_16x16x32_bf16 v[196:199], a[60:63], v[8:11], 0
    v_cvt_pk_bf16_f32 v161, v178, v179
    v_cvt_pk_bf16_f32 v162, v180, v181
    v_cvt_pk_bf16_f32 v163, v182, v183
    v_mfma_f32_16x16x32_bf16 v[200:203], a[56:59], v[12:15], 0
    s_add_u32 s15, s94, 333824
    buffer_store_dwordx4 v[160:163], v1, s[4:7], s15 offen sc1
    v_cvt_pk_bf16_f32 v164, v184, v185
    v_mfma_f32_16x16x32_bf16 v[204:207], a[60:63], v[12:15], 0
    v_cvt_pk_bf16_f32 v165, v186, v187
    v_cvt_pk_bf16_f32 v166, v188, v189
    v_cvt_pk_bf16_f32 v167, v190, v191
    s_waitcnt lgkmcnt(1)
    v_mfma_f32_16x16x32_bf16 v[176:179], a[64:67], v[8:11], 0
    s_add_u32 s15, s94, 334848
    buffer_store_dwordx4 v[164:167], v1, s[4:7], s15 offen sc1
    v_cvt_pk_bf16_f32 v168, v192, v193
    s_waitcnt lgkmcnt(0)
    v_mfma_f32_16x16x32_bf16 v[180:183], a[68:71], v[8:11], 0
    v_cvt_pk_bf16_f32 v169, v194, v195
    v_cvt_pk_bf16_f32 v170, v196, v197
    v_cvt_pk_bf16_f32 v171, v198, v199
    v_mfma_f32_16x16x32_bf16 v[184:187], a[64:67], v[12:15], 0
    s_add_u32 s15, s94, 335872
    buffer_store_dwordx4 v[168:171], v1, s[4:7], s15 offen sc1
    v_cvt_pk_bf16_f32 v160, v200, v201
    v_mfma_f32_16x16x32_bf16 v[188:191], a[68:71], v[12:15], 0
    v_cvt_pk_bf16_f32 v161, v202, v203
    v_cvt_pk_bf16_f32 v162, v204, v205
    v_cvt_pk_bf16_f32 v163, v206, v207
    s_add_u32 s15, s94, 336896
    buffer_store_dwordx4 v[160:163], v1, s[4:7], s15 offen sc1
    v_cvt_pk_bf16_f32 v164, v176, v177
    v_cvt_pk_bf16_f32 v165, v178, v179
    v_cvt_pk_bf16_f32 v166, v180, v181
    v_cvt_pk_bf16_f32 v167, v182, v183
    s_add_u32 s15, s94, 337920
    buffer_store_dwordx4 v[164:167], v1, s[4:7], s15 offen sc1
    v_cvt_pk_bf16_f32 v168, v184, v185
    v_cvt_pk_bf16_f32 v169, v186, v187
    v_cvt_pk_bf16_f32 v170, v188, v189
    v_cvt_pk_bf16_f32 v171, v190, v191
    s_add_u32 s15, s94, 338944
    buffer_store_dwordx4 v[168:171], v1, s[4:7], s15 offen sc1
pack_ret:
    s_cmp_eq_u32 s85, 0
    s_cbranch_scc1 hook0
    s_cmp_eq_u32 s85, 1
    s_cbranch_scc1 hook1
    s_cmp_eq_u32 s85, 2
    s_cbranch_scc1 hook2
    s_branch hook3
pack_bar0:
    s_waitcnt vmcnt(8)
    s_barrier
    s_branch hook5
pack_bar:
    s_waitcnt vmcnt(7)
    s_barrier
    s_lshr_b32 s16, s8, 2
    s_xor_b32 s16, s16, s95
    s_xor_b32 s16, s16, 0
    s_and_b32 s16, s16, 1
    s_add_u32 s16, s16, 1
    v_mov_b32 v10, s16
    buffer_store_dword v10, v219, s[88:91], s81 offen sc1
    s_getpc_b64 s[16:17]
pc_two:
    s_sub_u32 s16, s16, pc_two-att_norm
    s_subb_u32 s17, s17, 0
    s_lshr_b32 s15, s2, 3
    s_lshl_b32 s15, s15, 2
    s_add_u32 s15, s15, s3
    s_mul_i32 s15, s15, 384
    s_min_u32 s15, s15, code_end-att_norm-512
    v_add_u32 v8, s15, v2
    global_load_dwordx2 v[12:13], v8, s[16:17]
    s_branch hook4
att_exact:
    s_waitcnt vmcnt(0)
    s_mul_i32 s16, s9, 262144
    s_add_u32 s16, s16, s25
    s_add_u32 s52, s48, s16
    s_addc_u32 s53, s49, 0
    s_mov_b32 s54, 262144
    v_and_b32 v144, 0xffff, v144
    v_mov_b32 v147, v144
    v_mov_b32 v10, 0xff800000
    v_mov_b32 v16, 0
    v_mov_b32 v17, 0
    v_mov_b32 v18, 0
    v_mov_b32 v19, 0
    v_mov_b32 v20, 0
    v_mov_b32 v21, 0
    v_mov_b32 v22, 0
    v_mov_b32 v23, 0
    v_mov_b32 v24, 0
    v_mov_b32 v25, 0
    v_mov_b32 v26, 0
    v_mov_b32 v27, 0
    v_mov_b32 v28, 0
    v_mov_b32 v29, 0
    v_mov_b32 v30, 0
    v_mov_b32 v31, 0
    v_and_b32 v148, 0xffff, v148
    v_mov_b32 v151, v148
    v_mov_b32 v11, 0xff800000
    v_mov_b32 v32, 0
    v_mov_b32 v33, 0
    v_mov_b32 v34, 0
    v_mov_b32 v35, 0
    v_mov_b32 v36, 0
    v_mov_b32 v37, 0
    v_mov_b32 v38, 0
    v_mov_b32 v39, 0
    v_mov_b32 v40, 0
    v_mov_b32 v41, 0
    v_mov_b32 v42, 0
    v_mov_b32 v43, 0
    v_mov_b32 v44, 0
    v_mov_b32 v45, 0
    v_mov_b32 v46, 0
    v_mov_b32 v47, 0
    s_mov_b32 s16, 0
exact0:
    s_lshr_b32 s28, s16, 1
    s_mul_i32 s28, s28, 6400
    s_mul_i32 s17, s16, 4992
    s_add_u32 s28, s28, s17
    buffer_load_dwordx2 a[160:161], v2, s[52:55], s28 offen
    buffer_load_dwordx4 a[152:155], v1, s[52:55], s28 offen offset:512
    buffer_load_dwordx4 a[156:159], v1, s[52:55], s28 offen offset:1536
    s_waitcnt vmcnt(1)
    v_mfma_f32_32x32x16_bf16 v[80:95], a[152:155], v[128:131], 0
    v_mfma_f32_32x32x8_bf16 v[80:95], a[160:161], v[144:145], v[80:95]
    s_nop 11
    v_max3_f32 v10, v10, v80, v81
    v_max3_f32 v10, v10, v82, v83
    v_max3_f32 v10, v10, v84, v85
    v_max3_f32 v10, v10, v86, v87
    v_max3_f32 v10, v10, v88, v89
    v_max3_f32 v10, v10, v90, v91
    v_max3_f32 v10, v10, v92, v93
    v_max3_f32 v10, v10, v94, v95
    v_mfma_f32_32x32x16_bf16 v[96:111], a[152:155], v[132:135], 0
    v_mfma_f32_32x32x8_bf16 v[96:111], a[160:161], v[148:149], v[96:111]
    s_nop 11
    v_max3_f32 v11, v11, v96, v97
    v_max3_f32 v11, v11, v98, v99
    v_max3_f32 v11, v11, v100, v101
    v_max3_f32 v11, v11, v102, v103
    v_max3_f32 v11, v11, v104, v105
    v_max3_f32 v11, v11, v106, v107
    v_max3_f32 v11, v11, v108, v109
    v_max3_f32 v11, v11, v110, v111
    s_waitcnt vmcnt(0)
    v_mfma_f32_32x32x16_bf16 v[80:95], a[156:159], v[128:131], 0
    v_mfma_f32_32x32x8_bf16 v[80:95], a[160:161], v[146:147], v[80:95]
    s_nop 11
    v_max3_f32 v10, v10, v80, v81
    v_max3_f32 v10, v10, v82, v83
    v_max3_f32 v10, v10, v84, v85
    v_max3_f32 v10, v10, v86, v87
    v_max3_f32 v10, v10, v88, v89
    v_max3_f32 v10, v10, v90, v91
    v_max3_f32 v10, v10, v92, v93
    v_max3_f32 v10, v10, v94, v95
    v_mfma_f32_32x32x16_bf16 v[96:111], a[156:159], v[132:135], 0
    v_mfma_f32_32x32x8_bf16 v[96:111], a[160:161], v[150:151], v[96:111]
    s_nop 11
    v_max3_f32 v11, v11, v96, v97
    v_max3_f32 v11, v11, v98, v99
    v_max3_f32 v11, v11, v100, v101
    v_max3_f32 v11, v11, v102, v103
    v_max3_f32 v11, v11, v104, v105
    v_max3_f32 v11, v11, v106, v107
    v_max3_f32 v11, v11, v108, v109
    v_max3_f32 v11, v11, v110, v111
    s_add_u32 s16, s16, 1
    s_cmp_lt_u32 s16, 32
    s_cbranch_scc1 exact0
    v_mov_b32 v12, v10
    v_mov_b32 v13, v11
    s_nop 0
    v_permlane32_swap_b32 v10, v12
    v_permlane32_swap_b32 v11, v13
    v_max_f32 v10, v10, v12
    v_max_f32 v11, v11, v13
    s_mov_b32 s16, 0
exact1:
    s_lshr_b32 s28, s16, 1
    s_mul_i32 s28, s28, 6400
    s_mul_i32 s17, s16, 4992
    s_add_u32 s28, s28, s17
    buffer_load_dwordx2 a[160:161], v2, s[52:55], s28 offen
    buffer_load_dwordx4 a[152:155], v1, s[52:55], s28 offen offset:512
    buffer_load_dwordx4 a[156:159], v1, s[52:55], s28 offen offset:1536
    buffer_load_dwordx4 a[192:195], v3, s[52:55], s28 offen offset:0
    buffer_load_dwordx4 a[196:199], v3, s[52:55], s28 offen offset:592
    buffer_load_dwordx4 a[200:203], v3, s[52:55], s28 offen offset:1184
    buffer_load_dwordx4 a[204:207], v3, s[52:55], s28 offen offset:1776
    s_waitcnt vmcnt(5)
    v_mfma_f32_32x32x16_bf16 v[80:95], a[152:155], v[128:131], 0
    v_mfma_f32_32x32x8_bf16 v[80:95], a[160:161], v[144:145], v[80:95]
    s_nop 11
    v_sub_f32 v80, v80, v10
    v_sub_f32 v81, v81, v10
    v_sub_f32 v82, v82, v10
    v_sub_f32 v83, v83, v10
    v_sub_f32 v84, v84, v10
    v_sub_f32 v85, v85, v10
    v_sub_f32 v86, v86, v10
    v_sub_f32 v87, v87, v10
    v_sub_f32 v88, v88, v10
    v_sub_f32 v89, v89, v10
    v_sub_f32 v90, v90, v10
    v_sub_f32 v91, v91, v10
    v_sub_f32 v92, v92, v10
    v_sub_f32 v93, v93, v10
    v_sub_f32 v94, v94, v10
    v_sub_f32 v95, v95, v10
    v_exp_f32 v80, v80
    v_exp_f32 v81, v81
    v_exp_f32 v82, v82
    v_exp_f32 v83, v83
    v_exp_f32 v84, v84
    v_exp_f32 v85, v85
    v_exp_f32 v86, v86
    v_exp_f32 v87, v87
    v_exp_f32 v88, v88
    v_exp_f32 v89, v89
    v_exp_f32 v90, v90
    v_exp_f32 v91, v91
    v_exp_f32 v92, v92
    v_exp_f32 v93, v93
    v_exp_f32 v94, v94
    v_exp_f32 v95, v95
    v_cvt_pk_bf16_f32 v112, v80, v81
    v_cvt_pk_bf16_f32 v113, v82, v83
    v_cvt_pk_bf16_f32 v114, v84, v85
    v_cvt_pk_bf16_f32 v115, v86, v87
    v_cvt_pk_bf16_f32 v116, v88, v89
    v_cvt_pk_bf16_f32 v117, v90, v91
    v_cvt_pk_bf16_f32 v118, v92, v93
    v_cvt_pk_bf16_f32 v119, v94, v95
    s_waitcnt vmcnt(3)
    v_mfma_f32_32x32x16_bf16 v[16:31], a[192:195], v[112:115], v[16:31]
    s_waitcnt vmcnt(2)
    v_mfma_f32_32x32x16_bf16 v[16:31], a[196:199], v[116:119], v[16:31]
    v_mfma_f32_32x32x16_bf16 v[96:111], a[152:155], v[132:135], 0
    v_mfma_f32_32x32x8_bf16 v[96:111], a[160:161], v[148:149], v[96:111]
    s_nop 11
    v_sub_f32 v96, v96, v11
    v_sub_f32 v97, v97, v11
    v_sub_f32 v98, v98, v11
    v_sub_f32 v99, v99, v11
    v_sub_f32 v100, v100, v11
    v_sub_f32 v101, v101, v11
    v_sub_f32 v102, v102, v11
    v_sub_f32 v103, v103, v11
    v_sub_f32 v104, v104, v11
    v_sub_f32 v105, v105, v11
    v_sub_f32 v106, v106, v11
    v_sub_f32 v107, v107, v11
    v_sub_f32 v108, v108, v11
    v_sub_f32 v109, v109, v11
    v_sub_f32 v110, v110, v11
    v_sub_f32 v111, v111, v11
    v_exp_f32 v96, v96
    v_exp_f32 v97, v97
    v_exp_f32 v98, v98
    v_exp_f32 v99, v99
    v_exp_f32 v100, v100
    v_exp_f32 v101, v101
    v_exp_f32 v102, v102
    v_exp_f32 v103, v103
    v_exp_f32 v104, v104
    v_exp_f32 v105, v105
    v_exp_f32 v106, v106
    v_exp_f32 v107, v107
    v_exp_f32 v108, v108
    v_exp_f32 v109, v109
    v_exp_f32 v110, v110
    v_exp_f32 v111, v111
    v_cvt_pk_bf16_f32 v120, v96, v97
    v_cvt_pk_bf16_f32 v121, v98, v99
    v_cvt_pk_bf16_f32 v122, v100, v101
    v_cvt_pk_bf16_f32 v123, v102, v103
    v_cvt_pk_bf16_f32 v124, v104, v105
    v_cvt_pk_bf16_f32 v125, v106, v107
    v_cvt_pk_bf16_f32 v126, v108, v109
    v_cvt_pk_bf16_f32 v127, v110, v111
    v_mfma_f32_32x32x16_bf16 v[32:47], a[192:195], v[120:123], v[32:47]
    s_nop 0
    v_mfma_f32_32x32x16_bf16 v[32:47], a[196:199], v[124:127], v[32:47]
    v_mfma_f32_32x32x16_bf16 v[80:95], a[156:159], v[128:131], 0
    v_mfma_f32_32x32x8_bf16 v[80:95], a[160:161], v[146:147], v[80:95]
    s_nop 11
    v_sub_f32 v80, v80, v10
    v_sub_f32 v81, v81, v10
    v_sub_f32 v82, v82, v10
    v_sub_f32 v83, v83, v10
    v_sub_f32 v84, v84, v10
    v_sub_f32 v85, v85, v10
    v_sub_f32 v86, v86, v10
    v_sub_f32 v87, v87, v10
    v_sub_f32 v88, v88, v10
    v_sub_f32 v89, v89, v10
    v_sub_f32 v90, v90, v10
    v_sub_f32 v91, v91, v10
    v_sub_f32 v92, v92, v10
    v_sub_f32 v93, v93, v10
    v_sub_f32 v94, v94, v10
    v_sub_f32 v95, v95, v10
    v_exp_f32 v80, v80
    v_exp_f32 v81, v81
    v_exp_f32 v82, v82
    v_exp_f32 v83, v83
    v_exp_f32 v84, v84
    v_exp_f32 v85, v85
    v_exp_f32 v86, v86
    v_exp_f32 v87, v87
    v_exp_f32 v88, v88
    v_exp_f32 v89, v89
    v_exp_f32 v90, v90
    v_exp_f32 v91, v91
    v_exp_f32 v92, v92
    v_exp_f32 v93, v93
    v_exp_f32 v94, v94
    v_exp_f32 v95, v95
    v_cvt_pk_bf16_f32 v112, v80, v81
    v_cvt_pk_bf16_f32 v113, v82, v83
    v_cvt_pk_bf16_f32 v114, v84, v85
    v_cvt_pk_bf16_f32 v115, v86, v87
    v_cvt_pk_bf16_f32 v116, v88, v89
    v_cvt_pk_bf16_f32 v117, v90, v91
    v_cvt_pk_bf16_f32 v118, v92, v93
    v_cvt_pk_bf16_f32 v119, v94, v95
    s_waitcnt vmcnt(1)
    v_mfma_f32_32x32x16_bf16 v[16:31], a[200:203], v[112:115], v[16:31]
    s_waitcnt vmcnt(0)
    v_mfma_f32_32x32x16_bf16 v[16:31], a[204:207], v[116:119], v[16:31]
    v_mfma_f32_32x32x16_bf16 v[96:111], a[156:159], v[132:135], 0
    v_mfma_f32_32x32x8_bf16 v[96:111], a[160:161], v[150:151], v[96:111]
    s_nop 11
    v_sub_f32 v96, v96, v11
    v_sub_f32 v97, v97, v11
    v_sub_f32 v98, v98, v11
    v_sub_f32 v99, v99, v11
    v_sub_f32 v100, v100, v11
    v_sub_f32 v101, v101, v11
    v_sub_f32 v102, v102, v11
    v_sub_f32 v103, v103, v11
    v_sub_f32 v104, v104, v11
    v_sub_f32 v105, v105, v11
    v_sub_f32 v106, v106, v11
    v_sub_f32 v107, v107, v11
    v_sub_f32 v108, v108, v11
    v_sub_f32 v109, v109, v11
    v_sub_f32 v110, v110, v11
    v_sub_f32 v111, v111, v11
    v_exp_f32 v96, v96
    v_exp_f32 v97, v97
    v_exp_f32 v98, v98
    v_exp_f32 v99, v99
    v_exp_f32 v100, v100
    v_exp_f32 v101, v101
    v_exp_f32 v102, v102
    v_exp_f32 v103, v103
    v_exp_f32 v104, v104
    v_exp_f32 v105, v105
    v_exp_f32 v106, v106
    v_exp_f32 v107, v107
    v_exp_f32 v108, v108
    v_exp_f32 v109, v109
    v_exp_f32 v110, v110
    v_exp_f32 v111, v111
    v_cvt_pk_bf16_f32 v120, v96, v97
    v_cvt_pk_bf16_f32 v121, v98, v99
    v_cvt_pk_bf16_f32 v122, v100, v101
    v_cvt_pk_bf16_f32 v123, v102, v103
    v_cvt_pk_bf16_f32 v124, v104, v105
    v_cvt_pk_bf16_f32 v125, v106, v107
    v_cvt_pk_bf16_f32 v126, v108, v109
    v_cvt_pk_bf16_f32 v127, v110, v111
    v_mfma_f32_32x32x16_bf16 v[32:47], a[200:203], v[120:123], v[32:47]
    s_nop 0
    v_mfma_f32_32x32x16_bf16 v[32:47], a[204:207], v[124:127], v[32:47]
    s_add_u32 s16, s16, 1
    s_cmp_lt_u32 s16, 32
    s_cbranch_scc1 exact1
    s_nop 15
    s_branch att_norm
code_end:
    s_endpgm
.section .rodata,"a"
.p2align 6
.amdhsa_kernel interleave_layers__mha_block__glu_gated_swiglu__prompt_kernel
  .amdhsa_next_free_vgpr 512
  .amdhsa_next_free_sgpr 102
  .amdhsa_accum_offset 256
  .amdhsa_group_segment_fixed_size 0
  .amdhsa_kernarg_size 80
  .amdhsa_user_sgpr_count 2
  .amdhsa_user_sgpr_kernarg_segment_ptr 1
  .amdhsa_system_sgpr_workgroup_id_x 1
.end_amdhsa_kernel
```
